```python
import torch

def _softmax(x, axis=-1):
    return torch.softmax(x, dim=axis)
def _gelu(x):
    return torch.nn.functional.gelu(x, approximate="tanh")
def _silu(x):
    return torch.nn.functional.silu(x)
def _sigmoid(x):
    return torch.sigmoid(x)
def _layernorm(x, axis=-1, eps=1e-5):
    m = x.mean(dim=axis, keepdim=True)
    v = x.var(dim=axis, keepdim=True, unbiased=False)
    return (x - m) / torch.sqrt(v + eps)
def _scatter_add(tgt, idx, src, axis=0):
    return tgt.clone().index_add_(axis, idx, src)
def _segment_sum(src, seg, n):
    out = torch.zeros((n,) + src.shape[1:], dtype=src.dtype)
    return out.index_add_(0, seg, src)
def _pad(x, pw):
    flat = tuple(v for pair in reversed(pw) for v in pair)
    return torch.nn.functional.pad(x, flat)

kernel_name = 'parallel_sum__compressed_kv_cla__dense_activation_silu__prompt'

def setup_inputs():

    _w = (lambda a: (lambda t: t.to(torch.bfloat16) if t.is_floating_point() else t)(torch.as_tensor(a)))
    def _A_setup():
        B, H, Sq, Sk, D, M = 1, 16, 2048, 2048, 256, 448
        Dc = 4 * D
        return {
            "x": _w((lambda *s: torch.randn(*s, dtype=torch.bfloat16) * 0.05)(B, Sq, M)),
            "c_kv": _w((lambda *s: torch.randn(*s, dtype=torch.bfloat16) * 0.4)(B, Sk, Dc)),
            "w_q": _w((lambda *s: torch.randn(*s, dtype=torch.bfloat16) * 3.2)(M, H, D) * (M ** -0.5)),
            "w_uk": _w((lambda *s: torch.randn(*s, dtype=torch.bfloat16) * 3.2)(Dc, H, D) * (Dc ** -0.5)),
            "w_uv": _w((lambda *s: torch.randn(*s, dtype=torch.bfloat16) * 0.4)(Dc, H, D) * (Dc ** -0.5)),
            "w_o": _w((lambda *s: torch.randn(*s, dtype=torch.bfloat16) * 0.4)(H, D, M) * ((H * D) ** -0.5)),
        }
    _A_in = _A_setup()

    def _B_setup():
        B, S, D, F = 1, 2048, 448, 1792
        return {
            "x": _w((lambda *s: torch.randn(*s, dtype=torch.bfloat16) * 0.05)(B, S, D)),
            "w1": _w((lambda *s: torch.randn(*s, dtype=torch.bfloat16) * 0.8)(D, F) * (D ** -0.5)),
            "w2": _w((lambda *s: torch.randn(*s, dtype=torch.bfloat16) * 0.1)(F, D) * (F ** -0.5)),
        }
    _B_in = _B_setup()

    return {
        "A_x": _A_in["x"],
        "A_c_kv": _A_in["c_kv"],
        "A_w_q": _A_in["w_q"],
        "A_w_uk": _A_in["w_uk"],
        "A_w_uv": _A_in["w_uv"],
        "A_w_o": _A_in["w_o"],
        "B_x": _B_in["x"],
        "B_w1": _B_in["w1"],
        "B_w2": _B_in["w2"],
    }

def reference(A_x, A_c_kv, A_w_q, A_w_uk, A_w_uv, A_w_o, B_x, B_w1, B_w2):
    def _A_ref(x, c_kv, w_q, w_uk, w_uv, w_o):
        B, Sq, M = x.shape[0], x.shape[1], x.shape[2]
        Sk = c_kv.shape[1]
        H, D = w_q.shape[1], w_q.shape[2]
        q = torch.einsum("bqm,mhd->bhqd", x, w_q)
        k = torch.einsum("bkc,chd->bhkd", c_kv, w_uk)
        v = torch.einsum("bkc,chd->bhkd", c_kv, w_uv)
        scores = torch.einsum("bhqd,bhkd->bhqk", q, k) * (D ** -0.5)
        off = Sk - Sq
        qi = torch.arange(Sq)[:, None]
        kj = torch.arange(Sk)[None, :]
        cmask = kj <= (qi + off)
        scores = torch.where(cmask[None, None], scores, -1e9)
        p = _softmax(scores, axis=-1)
        ctx = torch.einsum("bhqk,bhkd->bhqd", p, v)
        return torch.einsum("bhqd,hdm->bqm", ctx, w_o)

    def _B_ref(x, w1, w2):
        h = torch.einsum("bsd,df->bsf", x, w1)
        h = _silu(h)
        out = torch.einsum("bsf,fd->bsd", h, w2)
        return out

    x = A_x
    xn = _layernorm(x, axis=-1)
    return x + _A_ref(xn, A_c_kv, A_w_q, A_w_uk, A_w_uv, A_w_o) + _B_ref(xn, B_w1, B_w2)
```

```asm
; @launch grid=(256,1,1) block=(256,1,1) lds=163840
.amdgcn_target "amdgcn-amd-amdhsa--gfx950"
.text
.globl parallel_sum__compressed_kv_cla__dense_activation_silu__prompt_kernel
.type parallel_sum__compressed_kv_cla__dense_activation_silu__prompt_kernel,@function
.p2align 8
parallel_sum__compressed_kv_cla__dense_activation_silu__prompt_kernel:
  s_cmp_ge_u32 s2, 256
  s_cbranch_scc1 M_END
  s_load_dwordx16 s[64:79], s[0:1], 0
  s_load_dwordx8 s[80:87], s[0:1], 64
  s_getpc_b64 s[50:51]
M_PC0:
  s_lshr_b32 s5, s2, 3
  s_lshl_b32 s5, s5, 11
  v_lshrrev_b32 v1, 4, v0
  v_lshl_add_u32 v1, v1, 7, s5
  v_min_u32 v1, M_B-M_PC0, v1
  global_load_dword v2, v1, s[50:51]
  v_lshrrev_b32 v1, 6, v0
  v_and_b32 v0, 63, v0
  v_readfirstlane_b32 s3, v1
  s_and_b32 s4, s2, 7
  s_lshl_b32 s4, s4, 1
  s_lshr_b32 s5, s2, 3
  s_and_b32 s34, s5, 7
  s_lshr_b32 s35, s5, 3
  s_and_b32 s42, s35, 1
  s_add_u32 s42, s42, s4
  s_lshr_b32 s58, s35, 1
  s_lshr_b32 s33, s5, 1
  s_and_b32 s32, s5, 1
  s_add_u32 s32, s32, s4
  s_and_b32 s36, s3, 1
  s_lshr_b32 s37, s3, 1
  v_and_b32 v224, 31, v0
  v_lshrrev_b32 v225, 5, v0
  v_lshrrev_b32 v226, 4, v0
  v_bfe_u32 v227, v0, 2, 2
  v_and_b32 v228, 3, v0
  s_and_b32 s7, s35, 1
  s_lshl_b32 s7, s7, 1
  s_add_u32 s7, s7, s37
  s_sub_u32 s39, 3, s7
  s_add_u32 s7, s7, 4
  s_cmp_ge_u32 s35, 2
  s_cselect_b32 s7, s7, s39
  s_lshl_b32 s7, s7, 3
  s_add_u32 s7, s7, s34
  s_lshl_b32 s7, s7, 1
  s_add_u32 s7, s7, s36
  s_lshl_b32 s7, s7, 4
  v_lshrrev_b32 v6, 2, v0
  v_add_u32 v6, s7, v6
  v_lshlrev_b32 v3, 11, v6
  v_bfe_u32 v7, v0, 1, 1
  v_lshl_add_u32 v7, v7, 7, v3
  s_lshl_b32 s7, s34, 3
  s_lshl_b32 s39, s3, 1
  s_add_u32 s7, s7, s39
  v_add_u32 v6, s7, v225
  v_lshlrev_b32 v6, 13, v6
  v_bfe_u32 v5, v0, 3, 2
  v_lshl_add_u32 v6, v5, 7, v6
  s_lshl_b32 s7, s42, 9
  v_add_u32 v4, s7, v6
  v_bfe_u32 v6, v0, 2, 1
  v_lshl_add_u32 v5, v6, 19, v4
  v_lshrrev_b32 v1, 3, v0
  s_waitcnt lgkmcnt(0)
  s_mov_b32 s76, s42
  s_lshl_b32 s77, s58, 3
  s_add_u32 s77, s77, s34
  s_lshl_b32 s77, s77, 3
  s_mov_b32 s8, s66
  s_mov_b32 s9, s67
  s_mov_b32 s10, 0x400000
  s_mov_b32 s11, 0x20000
  s_cmp_eq_u32 s58, 0
  s_cselect_b32 s12, s70, s72
  s_cselect_b32 s13, s71, s73
  s_mov_b32 s14, 0x800000
  s_mov_b32 s15, 0x20000
  buffer_load_dword v2, v7, s[8:11], 0 offen
  buffer_load_dword v2, v5, s[12:15], 0 offen
  v_add_u32 v144, 256, v7
  v_add_u32 v145, 0x100000, v5
  v_add_u32 v3, 256, v3
  v_add_u32 v4, 1048576, v4
  s_lshl_b32 s7, s36, 1
  s_sub_u32 s39, 3, s7
  s_add_u32 s7, s7, 4
  s_cmp_eq_u32 s37, 1
  s_cselect_b32 s7, s7, s39
  s_mov_b32 s39, 0xfff80000
  s_cselect_b32 s39, 0x80000, s39
  s_lshl_b32 s7, s7, 3
  s_add_u32 s7, s7, s34
  s_lshl_b32 s7, s7, 5
  v_add_u32 v6, s7, v1
  v_lshlrev_b32 v6, 11, v6
  v_and_b32 v7, 7, v0
  v_xor_b32 v7, v7, v226
  v_lshlrev_b32 v7, 4, v7
  v_xor_b32 v16, 0, v7
  v_add_u32 v16, v16, v6
  v_xor_b32 v17, 64, v7
  v_add_u32 v17, v17, v6
  v_add_u32 v17, 15360, v17
  v_xor_b32 v18, 64, v7
  v_add_u32 v18, v18, v6
  v_add_u32 v18, 30720, v18
  v_xor_b32 v19, 0, v7
  v_add_u32 v19, v19, v6
  v_add_u32 v19, 46080, v19
  v_add_u32 v6, s39, v6
  v_xor_b32 v20, 0, v7
  v_add_u32 v20, v20, v6
  v_xor_b32 v21, 64, v7
  v_add_u32 v21, v21, v6
  v_add_u32 v21, 15360, v21
  v_xor_b32 v22, 64, v7
  v_add_u32 v22, v22, v6
  v_add_u32 v22, 30720, v22
  v_xor_b32 v23, 0, v7
  v_add_u32 v23, v23, v6
  v_add_u32 v23, 46080, v23
  s_lshl_b32 s7, s3, 4
  v_add_u32 v6, s7, v225
  v_lshlrev_b32 v6, 13, v6
  s_lshl_b32 s7, s76, 9
  v_add_u32 v6, s7, v6
  v_lshrrev_b32 v7, 2, v224
  v_xor_b32 v7, v7, v225
  v_lshlrev_b32 v7, 6, v7
  v_lshl_add_u32 v7, v228, 4, v7
  v_xor_b32 v24, 0, v7
  v_add_u32 v24, v24, v6
  v_xor_b32 v25, 128, v7
  v_add_u32 v25, v25, v6
  v_add_u32 v25, 15360, v25
  v_xor_b32 v26, 0, v7
  v_add_u32 v26, v26, v6
  v_add_u32 v26, 30720, v26
  v_xor_b32 v27, 128, v7
  v_add_u32 v27, v27, v6
  v_add_u32 v27, 46080, v27
  v_xor_b32 v28, 48, v7
  v_add_u32 v28, v28, v6
  v_add_u32 v28, 65536, v28
  v_xor_b32 v29, 176, v7
  v_add_u32 v29, v29, v6
  v_add_u32 v29, 80896, v29
  v_xor_b32 v30, 48, v7
  v_add_u32 v30, v30, v6
  v_add_u32 v30, 96256, v30
  v_xor_b32 v31, 176, v7
  v_add_u32 v31, v31, v6
  v_add_u32 v31, 111616, v31
  s_lshl_b32 s56, s3, 13
  s_mov_b32 s53, 0
  s_mov_b32 s54, 0
  s_mov_b32 s16, s86
  s_mov_b32 s17, s87
  s_mov_b32 s18, 0x10000000
  s_mov_b32 s19, 0x20000
  s_mov_b32 s20, s64
  s_mov_b32 s21, s65
  s_mov_b32 s22, 0x1c0000
  s_mov_b32 s23, 0x20000
  s_mov_b32 s24, s68
  s_mov_b32 s25, s69
  s_mov_b32 s26, 0x380000
  s_mov_b32 s27, 0x20000
  s_mov_b32 s28, s78
  s_mov_b32 s29, s79
  s_mov_b32 s30, 0x188000
  s_mov_b32 s31, 0x20000
  v_and_b32 v6, 15, v0
  s_lshl_b32 s7, s36, 7
  v_add_u32 v6, s7, v6
  v_lshlrev_b32 v6, 7, v6
  v_bfe_u32 v7, v0, 1, 3
  v_xor_b32 v7, v7, v226
  v_lshl_add_u32 v212, v7, 4, v6
  v_xor_b32 v213, 64, v212
  v_lshl_add_u32 v6, v226, 3, v227
  v_lshlrev_b32 v6, 9, v6
  s_lshl_b32 s7, s37, 8
  s_add_u32 s7, s7, 0x10000
  v_add_u32 v6, s7, v6
  v_and_b32 v7, 1, v228
  v_lshl_add_u32 v6, v7, 3, v6
  v_and_b32 v7, 1, v226
  v_mul_u32_u24 v7, 3, v7
  v_lshl_add_u32 v7, v227, 2, v7
  v_lshrrev_b32 v231, 1, v228
  v_xor_b32 v7, v7, v231
  v_lshl_add_u32 v6, v7, 4, v6
  v_xor_b32 v8, 0, v6
  v_xor_b32 v9, 32, v6
  v_xor_b32 v10, 64, v6
  v_xor_b32 v11, 96, v6
  v_xor_b32 v12, 128, v6
  v_xor_b32 v13, 160, v6
  v_xor_b32 v14, 192, v6
  v_xor_b32 v15, 224, v6
  s_lshl_b32 s7, s3, 4
  v_add_u32 v6, s7, v226
  v_xor_b32 v7, v227, v226
  v_lshlrev_b32 v7, 6, v7
  v_lshl_add_u32 v7, v228, 4, v7
  s_lshl_b32 s38, s32, 9
  v_xor_b32 v231, 32, v7
  v_lshlrev_b32 v232, 13, v6
  v_add3_u32 v208, v232, v7, s38
  v_add3_u32 v210, v232, v231, s38
  v_add_u32 v209, 31744, v208
  v_add_u32 v211, 95232, v210
  v_add_u32 v210, 63488, v210
  s_mul_i32 s39, s32, 224
  v_mul_u32_u24 v232, 3584, v6
  v_add3_u32 v214, v232, v7, s39
  v_add3_u32 v215, v232, v231, s39
  v_lshl_add_u32 v6, v226, 3, v227
  v_lshlrev_b32 v6, 8, v6
  v_and_b32 v7, 1, v226
  v_lshl_add_u32 v7, v227, 1, v7
  v_lshl_add_u32 v6, v7, 5, v6
  v_lshl_add_u32 v6, v228, 3, v6
  v_add_u32 v6, 98304, v6
  v_xor_b32 v216, 0, v6
  v_xor_b32 v217, 32, v6
  v_xor_b32 v218, 64, v6
  v_xor_b32 v219, 96, v6
  v_xor_b32 v220, 128, v6
  v_xor_b32 v221, 160, v6
  v_xor_b32 v222, 192, v6
  v_xor_b32 v223, 224, v6
  s_mul_i32 s7, s33, 28
  s_mul_i32 s6, s3, 7
  s_add_u32 s7, s7, s6
  v_lshrrev_b32 v6, 2, v0
  v_add_u32 v6, s7, v6
  v_lshlrev_b32 v7, 13, v6
  v_lshl_add_u32 v7, v228, 7, v7
  v_add_u32 v7, s38, v7
  v_subrev_u32 v6, 7, v6
  v_mul_u32_u24 v6, 3584, v6
  v_min_u32 v231, 2, v228
  v_lshl_add_u32 v6, v231, 7, v6
  v_add_u32 v6, s39, v6
  v_min_u32 v6, 1605628, v6
  v_cmp_gt_u32 vcc, 28, v0
  s_lshr_b32 s7, s2, 3
  s_lshl_b32 s7, s7, 2
  v_cndmask_b32 v6, v6, v7, vcc
  v_mov_b32 v142, s78
  v_mov_b32 v143, s79
  v_mov_b32 v7, s68
  v_mov_b32 v231, s69
  v_cndmask_b32 v142, v142, v7, vcc
  v_cndmask_b32 v143, v143, v231, vcc
  s_add_u32 s7, s7, s3
  s_mul_i32 s7, s7, 640
  s_add_u32 s7, s7, M_B-M_PC0
  v_and_b32 v7, 7, v0
  v_min_u32 v7, 4, v7
  v_lshl_add_u32 v7, v7, 7, s7
  v_min_u32 v7, M_CODE_END-M_PC0-8, v7
  v_cmp_gt_u32 vcc, 56, v0
  v_mov_b32 v231, s50
  v_mov_b32 v232, s51
  v_cndmask_b32 v6, v7, v6, vcc
  v_cndmask_b32 v142, v231, v142, vcc
  v_cndmask_b32 v143, v232, v143, vcc
  v_add_co_u32 v142, vcc, v142, v6
  s_nop 1
  v_addc_co_u32 v143, vcc, 0, v143, vcc
  s_mul_i32 s7, s33, 14336
  s_mul_i32 s6, s3, 3584
  s_add_u32 s7, s7, s6
  s_mul_i32 s6, s32, 229376
  s_add_u32 s7, s7, s6
  v_min_u32 v6, 27, v224
  v_lshl_add_u32 v6, v6, 7, s7
  s_mul_i32 s7, s33, 6272
  s_mul_i32 s6, s3, 1664
  s_add_u32 s7, s7, s6
  s_mul_i32 s6, s32, 100352
  s_add_u32 s7, s7, s6
  v_lshrrev_b32 v7, 1, v224
  v_lshl_add_u32 v7, v7, 7, s7
  v_min_u32 v7, 1605628, v7
  v_cmp_gt_u32 vcc, 32, v0
  v_mov_b32 v176, s80
  v_mov_b32 v177, s81
  v_mov_b32 v231, s74
  v_mov_b32 v232, s75
  v_cndmask_b32 v6, v7, v6, vcc
  v_cndmask_b32 v176, v176, v231, vcc
  v_cndmask_b32 v177, v177, v232, vcc
  v_add_co_u32 v176, vcc, v176, v6
  s_nop 1
  v_addc_co_u32 v177, vcc, 0, v177, vcc
  s_add_u32 s7, s36, 3
  s_lshl_b32 s7, s7, 3
  s_add_u32 s7, s7, s34
  s_lshl_b32 s60, s76, 6
  s_add_u32 s60, s60, s7
  s_lshl_b32 s60, s60, 15
  s_lshl_b32 s7, s58, 14
  s_add_u32 s60, s60, s7
  s_lshl_b32 s7, s37, 13
  s_add_u32 s60, s60, s7
  s_lshl_b32 s7, s36, 19
  s_sub_u32 s57, s7, 0x40000
  s_lshl_b32 s7, s33, 2
  v_and_b32 v5, 15, v0
  v_lshlrev_b32 v5, 3, v5
  s_add_u32 s66, s7, s3
  s_mul_i32 s66, s66, 28672
  s_add_u32 s66, s66, 117440512
  v_lshlrev_b32 v1, 4, v0
  s_lshl_b32 s7, s33, 4
  s_add_u32 s7, s7, s32
  s_mul_i32 s7, s7, 7168
  s_mul_i32 s6, s3, 1792
  s_add_u32 s7, s7, s6
  v_lshrrev_b32 v6, 2, v0
  v_min_u32 v6, 14, v6
  v_lshl_add_u32 v146, v6, 7, s7
  s_lshl_b32 s4, s33, 2
  s_sub_u32 s34, 30, s4
  s_sub_u32 s6, 15, s33
  s_cmp_ge_u32 s33, 8
  s_cselect_b32 s34, 0, s34
  s_cselect_b32 s48, s6, s33
  s_lshl_b32 s5, s32, 3
  s_add_u32 s48, s48, s5
  s_lshl_b32 s43, s3, 12
  s_lshl_b32 s42, s32, 21
  s_sub_u32 s5, 29, s34
  s_lshl_b32 s5, s5, 15
  s_add_u32 s40, s5, s42
  s_lshl_b32 s5, s4, 15
  s_add_u32 s41, s5, s42
  s_sub_u32 s5, s34, 6
  s_lshr_b32 s5, s5, 2
  s_cmp_ge_u32 s34, 6
  s_cselect_b32 s39, s5, 99
  s_lshr_b32 s5, s34, 2
  s_cmp_ge_u32 s33, 8
  s_cselect_b32 s49, 99, s5
  s_mov_b32 s50, s49
  s_cmp_eq_u32 s3, 0
  s_cselect_b32 s50, s50, 99
  s_mov_b32 s52, 0xffff8000
  s_mov_b32 s51, 0
  s_mov_b32 s35, 0
  s_mov_b32 s36, 0x41800000
  s_mov_b32 s68, s86
  s_mov_b32 s69, s87
  s_cmp_ge_u32 s33, 8
  s_cselect_b32 s70, 0x10000000, 0
  s_mov_b32 s71, 0x20000
  s_lshl_b32 s62, s48, 2
  s_add_u32 s62, s62, s3
  s_lshl_b32 s62, s62, 14
  s_add_u32 s62, s62, 33554432
  s_waitcnt vmcnt(0)
  s_add_u32 m0, s56, 0
  s_nop 0
  buffer_load_dwordx4 v16, s[8:11], s53 offen offset:0 sc1 lds
  buffer_load_dwordx4 v17, s[8:11], s53 offen offset:1024 sc1 lds
  buffer_load_dwordx4 v18, s[8:11], s53 offen offset:2048 sc1 lds
  buffer_load_dwordx4 v19, s[8:11], s53 offen offset:3072 sc1 lds
  s_add_u32 m0, s56, 4096
  s_nop 0
  buffer_load_dwordx4 v20, s[8:11], s53 offen offset:0 sc1 lds
  buffer_load_dwordx4 v21, s[8:11], s53 offen offset:1024 sc1 lds
  buffer_load_dwordx4 v22, s[8:11], s53 offen offset:2048 sc1 lds
  buffer_load_dwordx4 v23, s[8:11], s53 offen offset:3072 sc1 lds
  s_add_u32 s53, s53, 128
  s_add_u32 m0, s56, 65536
  s_nop 0
  buffer_load_dwordx4 v24, s[12:15], s54 offen offset:0 sc1 lds
  buffer_load_dwordx4 v25, s[12:15], s54 offen offset:1024 sc1 lds
  buffer_load_dwordx4 v26, s[12:15], s54 offen offset:2048 sc1 lds
  buffer_load_dwordx4 v27, s[12:15], s54 offen offset:3072 sc1 lds
  s_add_u32 m0, s56, 69632
  s_nop 0
  buffer_load_dwordx4 v28, s[12:15], s54 offen offset:0 sc1 lds
  buffer_load_dwordx4 v29, s[12:15], s54 offen offset:1024 sc1 lds
  buffer_load_dwordx4 v30, s[12:15], s54 offen offset:2048 sc1 lds
  buffer_load_dwordx4 v31, s[12:15], s54 offen offset:3072 sc1 lds
  s_add_u32 s54, s54, 0x80000
  s_add_u32 m0, s56, 32768
  s_nop 0
  buffer_load_dwordx4 v16, s[8:11], s53 offen offset:0 sc1 lds
  buffer_load_dwordx4 v17, s[8:11], s53 offen offset:1024 sc1 lds
  buffer_load_dwordx4 v18, s[8:11], s53 offen offset:2048 sc1 lds
  buffer_load_dwordx4 v19, s[8:11], s53 offen offset:3072 sc1 lds
  s_add_u32 m0, s56, 36864
  s_nop 0
  buffer_load_dwordx4 v20, s[8:11], s53 offen offset:0 sc1 lds
  buffer_load_dwordx4 v21, s[8:11], s53 offen offset:1024 sc1 lds
  buffer_load_dwordx4 v22, s[8:11], s53 offen offset:2048 sc1 lds
  buffer_load_dwordx4 v23, s[8:11], s53 offen offset:3072 sc1 lds
  s_add_u32 s53, s53, 128
  s_add_u32 m0, s56, 98304
  s_nop 0
  buffer_load_dwordx4 v24, s[12:15], s54 offen offset:0 sc1 lds
  buffer_load_dwordx4 v25, s[12:15], s54 offen offset:1024 sc1 lds
  buffer_load_dwordx4 v26, s[12:15], s54 offen offset:2048 sc1 lds
  buffer_load_dwordx4 v27, s[12:15], s54 offen offset:3072 sc1 lds
  buffer_load_dword v2, v144, s[8:11], 0 offen
  buffer_load_dword v2, v145, s[12:15], 0 offen
  buffer_load_dword v2, v146, s[20:23], 0 offen
  s_or_b32 s7, s2, s3
  s_cbranch_scc1 M_NOPUB
  s_memrealtime s[4:5]
  v_mov_b32 v6, 0
  s_waitcnt lgkmcnt(0)
  s_or_b32 s4, s4, 1
  v_mov_b32 v7, s4
  s_mov_b64 exec, 1
  global_store_dword v6, v7, s[84:85] sc1
  s_mov_b64 exec, -1
M_NOPUB:
  s_waitcnt vmcnt(15)
  s_barrier
  s_mov_b32 s55, 2
  s_cmp_eq_u32 s58, 0
  s_cbranch_scc0 M_PRE_V
M_PRE_K:
  ds_read_b64_tr_b16 v[224:225], v8 offset:0
  ds_read_b64_tr_b16 v[226:227], v8 offset:2048
  ds_read_b128 v[32:35], v212 offset:0
  ds_read_b64_tr_b16 v[228:229], v9 offset:0
  ds_read_b64_tr_b16 v[230:231], v9 offset:2048
  ds_read_b128 v[36:39], v213 offset:2048
  ds_read_b128 v[40:43], v212 offset:4096
  ds_read_b64_tr_b16 v[232:233], v10 offset:0
  ds_read_b64_tr_b16 v[234:235], v10 offset:2048
  ds_read_b128 v[44:47], v213 offset:6144
  ds_read_b64_tr_b16 v[236:237], v11 offset:0
  ds_read_b64_tr_b16 v[238:239], v11 offset:2048
  ds_read_b128 v[48:51], v212 offset:8192
  ds_read_b64_tr_b16 v[240:241], v12 offset:0
  ds_read_b64_tr_b16 v[242:243], v12 offset:2048
  ds_read_b128 v[52:55], v213 offset:10240
  ds_read_b128 v[56:59], v212 offset:12288
  ds_read_b64_tr_b16 v[244:245], v13 offset:0
  ds_read_b64_tr_b16 v[246:247], v13 offset:2048
  ds_read_b128 v[60:63], v213 offset:14336
  ds_read_b64_tr_b16 v[248:249], v14 offset:0
  ds_read_b64_tr_b16 v[250:251], v14 offset:2048
  ds_read_b64_tr_b16 v[252:253], v15 offset:0
  ds_read_b64_tr_b16 v[254:255], v15 offset:2048
  s_waitcnt lgkmcnt(15)
  s_waitcnt lgkmcnt(4)
  v_mfma_f32_16x16x32_bf16 a[0:3], v[224:227], v[32:35], 0
  s_add_u32 m0, s56, 102400
  v_mfma_f32_16x16x32_bf16 a[8:11], v[224:227], v[36:39], 0
  buffer_load_dwordx4 v28, s[12:15], s54 offen offset:0 sc1 lds
  v_mfma_f32_16x16x32_bf16 a[64:67], v[224:227], v[40:43], 0
  v_mfma_f32_16x16x32_bf16 a[72:75], v[224:227], v[44:47], 0
  v_mfma_f32_16x16x32_bf16 a[128:131], v[224:227], v[48:51], 0
  buffer_load_dwordx4 v29, s[12:15], s54 offen offset:1024 sc1 lds
  v_mfma_f32_16x16x32_bf16 a[136:139], v[224:227], v[52:55], 0
  v_mfma_f32_16x16x32_bf16 a[192:195], v[224:227], v[56:59], 0
  v_mfma_f32_16x16x32_bf16 a[200:203], v[224:227], v[60:63], 0
  ds_read_b64_tr_b16 v[224:225], v8 offset:16384
  v_mfma_f32_16x16x32_bf16 a[4:7], v[228:231], v[32:35], 0
  ds_read_b64_tr_b16 v[226:227], v8 offset:18432
  v_mfma_f32_16x16x32_bf16 a[12:15], v[228:231], v[36:39], 0
  buffer_load_dwordx4 v30, s[12:15], s54 offen offset:2048 sc1 lds
  v_mfma_f32_16x16x32_bf16 a[68:71], v[228:231], v[40:43], 0
  ds_read_b128 v[64:67], v213 offset:0
  v_mfma_f32_16x16x32_bf16 a[76:79], v[228:231], v[44:47], 0
  v_mfma_f32_16x16x32_bf16 a[132:135], v[228:231], v[48:51], 0
  buffer_load_dwordx4 v31, s[12:15], s54 offen offset:3072 sc1 lds
  s_add_u32 s54, s54, 0x80000
  v_mfma_f32_16x16x32_bf16 a[140:143], v[228:231], v[52:55], 0
  v_mfma_f32_16x16x32_bf16 a[196:199], v[228:231], v[56:59], 0
  v_mfma_f32_16x16x32_bf16 a[204:207], v[228:231], v[60:63], 0
  ds_read_b64_tr_b16 v[228:229], v9 offset:16384
  v_mfma_f32_16x16x32_bf16 a[16:19], v[232:235], v[32:35], 0
  ds_read_b64_tr_b16 v[230:231], v9 offset:18432
  v_mfma_f32_16x16x32_bf16 a[24:27], v[232:235], v[36:39], 0
  ds_read_b128 v[68:71], v212 offset:2048
  v_mfma_f32_16x16x32_bf16 a[80:83], v[232:235], v[40:43], 0
  v_mfma_f32_16x16x32_bf16 a[88:91], v[232:235], v[44:47], 0
  v_mfma_f32_16x16x32_bf16 a[144:147], v[232:235], v[48:51], 0
  v_mfma_f32_16x16x32_bf16 a[152:155], v[232:235], v[52:55], 0
  v_mfma_f32_16x16x32_bf16 a[208:211], v[232:235], v[56:59], 0
  ds_read_b128 v[72:75], v213 offset:4096
  v_mfma_f32_16x16x32_bf16 a[216:219], v[232:235], v[60:63], 0
  ds_read_b64_tr_b16 v[232:233], v10 offset:16384
  v_mfma_f32_16x16x32_bf16 a[20:23], v[236:239], v[32:35], 0
  ds_read_b64_tr_b16 v[234:235], v10 offset:18432
  v_mfma_f32_16x16x32_bf16 a[28:31], v[236:239], v[36:39], 0
  v_mfma_f32_16x16x32_bf16 a[84:87], v[236:239], v[40:43], 0
  v_mfma_f32_16x16x32_bf16 a[92:95], v[236:239], v[44:47], 0
  v_mfma_f32_16x16x32_bf16 a[148:151], v[236:239], v[48:51], 0
  ds_read_b128 v[76:79], v212 offset:6144
  v_mfma_f32_16x16x32_bf16 a[156:159], v[236:239], v[52:55], 0
  v_mfma_f32_16x16x32_bf16 a[212:215], v[236:239], v[56:59], 0
  v_mfma_f32_16x16x32_bf16 a[220:223], v[236:239], v[60:63], 0
  ds_read_b64_tr_b16 v[236:237], v11 offset:16384
  v_mfma_f32_16x16x32_bf16 a[32:35], v[240:243], v[32:35], 0
  ds_read_b64_tr_b16 v[238:239], v11 offset:18432
  v_mfma_f32_16x16x32_bf16 a[40:43], v[240:243], v[36:39], 0
  v_mfma_f32_16x16x32_bf16 a[96:99], v[240:243], v[40:43], 0
  ds_read_b128 v[80:83], v213 offset:8192
  v_mfma_f32_16x16x32_bf16 a[104:107], v[240:243], v[44:47], 0
  v_mfma_f32_16x16x32_bf16 a[160:163], v[240:243], v[48:51], 0
  buffer_load_dword v2, v3, s[8:11], s53 offen
  v_mfma_f32_16x16x32_bf16 a[168:171], v[240:243], v[52:55], 0
  v_mfma_f32_16x16x32_bf16 a[224:227], v[240:243], v[56:59], 0
  v_mfma_f32_16x16x32_bf16 a[232:235], v[240:243], v[60:63], 0
  ds_read_b64_tr_b16 v[240:241], v12 offset:16384
  v_mfma_f32_16x16x32_bf16 a[36:39], v[244:247], v[32:35], 0
  ds_read_b64_tr_b16 v[242:243], v12 offset:18432
  v_mfma_f32_16x16x32_bf16 a[44:47], v[244:247], v[36:39], 0
  ds_read_b128 v[84:87], v212 offset:10240
  v_mfma_f32_16x16x32_bf16 a[100:103], v[244:247], v[40:43], 0
  v_mfma_f32_16x16x32_bf16 a[108:111], v[244:247], v[44:47], 0
  v_mfma_f32_16x16x32_bf16 a[164:167], v[244:247], v[48:51], 0
  buffer_load_dword v2, v4, s[12:15], s54 offen
  v_mfma_f32_16x16x32_bf16 a[172:175], v[244:247], v[52:55], 0
  v_mfma_f32_16x16x32_bf16 a[228:231], v[244:247], v[56:59], 0
  ds_read_b128 v[88:91], v213 offset:12288
  v_mfma_f32_16x16x32_bf16 a[236:239], v[244:247], v[60:63], 0
  s_waitcnt lgkmcnt(15)
  ds_read_b64_tr_b16 v[244:245], v13 offset:16384
  v_mfma_f32_16x16x32_bf16 a[48:51], v[248:251], v[32:35], 0
  ds_read_b64_tr_b16 v[246:247], v13 offset:18432
  v_mfma_f32_16x16x32_bf16 a[56:59], v[248:251], v[36:39], 0
  v_mfma_f32_16x16x32_bf16 a[112:115], v[248:251], v[40:43], 0
  v_mfma_f32_16x16x32_bf16 a[120:123], v[248:251], v[44:47], 0
  v_mfma_f32_16x16x32_bf16 a[176:179], v[248:251], v[48:51], 0
  ds_read_b128 v[92:95], v212 offset:14336
  v_mfma_f32_16x16x32_bf16 a[184:187], v[248:251], v[52:55], 0
  v_mfma_f32_16x16x32_bf16 a[240:243], v[248:251], v[56:59], 0
  v_mfma_f32_16x16x32_bf16 a[248:251], v[248:251], v[60:63], 0
  ds_read_b64_tr_b16 v[248:249], v14 offset:16384
  v_mfma_f32_16x16x32_bf16 a[52:55], v[252:255], v[32:35], 0
  ds_read_b64_tr_b16 v[250:251], v14 offset:18432
  v_mfma_f32_16x16x32_bf16 a[60:63], v[252:255], v[36:39], 0
  v_mfma_f32_16x16x32_bf16 a[116:119], v[252:255], v[40:43], 0
  v_mfma_f32_16x16x32_bf16 a[124:127], v[252:255], v[44:47], 0
  v_mfma_f32_16x16x32_bf16 a[180:183], v[252:255], v[48:51], 0
  v_mfma_f32_16x16x32_bf16 a[188:191], v[252:255], v[52:55], 0
  v_mfma_f32_16x16x32_bf16 a[244:247], v[252:255], v[56:59], 0
  v_mfma_f32_16x16x32_bf16 a[252:255], v[252:255], v[60:63], 0
  ds_read_b64_tr_b16 v[252:253], v15 offset:16384
  ds_read_b64_tr_b16 v[254:255], v15 offset:18432
  s_waitcnt lgkmcnt(4)
  v_mfma_f32_16x16x32_bf16 a[0:3], v[224:227], v[64:67], a[0:3]
  v_mfma_f32_16x16x32_bf16 a[8:11], v[224:227], v[68:71], a[8:11]
  v_mfma_f32_16x16x32_bf16 a[64:67], v[224:227], v[72:75], a[64:67]
  v_mfma_f32_16x16x32_bf16 a[72:75], v[224:227], v[76:79], a[72:75]
  v_mfma_f32_16x16x32_bf16 a[128:131], v[224:227], v[80:83], a[128:131]
  v_mfma_f32_16x16x32_bf16 a[136:139], v[224:227], v[84:87], a[136:139]
  v_mfma_f32_16x16x32_bf16 a[192:195], v[224:227], v[88:91], a[192:195]
  v_mfma_f32_16x16x32_bf16 a[200:203], v[224:227], v[92:95], a[200:203]
  s_waitcnt vmcnt(2)
  s_waitcnt lgkmcnt(0)
  s_barrier
  ds_read_b64_tr_b16 v[224:225], v8 offset:32768
  v_mfma_f32_16x16x32_bf16 a[4:7], v[228:231], v[64:67], a[4:7]
  ds_read_b64_tr_b16 v[226:227], v8 offset:34816
  v_mfma_f32_16x16x32_bf16 a[12:15], v[228:231], v[68:71], a[12:15]
  v_mfma_f32_16x16x32_bf16 a[68:71], v[228:231], v[72:75], a[68:71]
  ds_read_b128 v[32:35], v212 offset:32768
  s_add_u32 m0, s56, 0
  v_mfma_f32_16x16x32_bf16 a[76:79], v[228:231], v[76:79], a[76:79]
  buffer_load_dwordx4 v16, s[8:11], s53 offen offset:0 sc1 lds
  v_mfma_f32_16x16x32_bf16 a[132:135], v[228:231], v[80:83], a[132:135]
  v_mfma_f32_16x16x32_bf16 a[140:143], v[228:231], v[84:87], a[140:143]
  v_mfma_f32_16x16x32_bf16 a[196:199], v[228:231], v[88:91], a[196:199]
  v_mfma_f32_16x16x32_bf16 a[204:207], v[228:231], v[92:95], a[204:207]
  ds_read_b64_tr_b16 v[228:229], v9 offset:32768
  v_mfma_f32_16x16x32_bf16 a[16:19], v[232:235], v[64:67], a[16:19]
  buffer_load_dwordx4 v17, s[8:11], s53 offen offset:1024 sc1 lds
  v_mfma_f32_16x16x32_bf16 a[24:27], v[232:235], v[68:71], a[24:27]
  ds_read_b64_tr_b16 v[230:231], v9 offset:34816
  v_mfma_f32_16x16x32_bf16 a[80:83], v[232:235], v[72:75], a[80:83]
  ds_read_b128 v[36:39], v213 offset:34816
  v_mfma_f32_16x16x32_bf16 a[88:91], v[232:235], v[76:79], a[88:91]
  buffer_load_dwordx4 v18, s[8:11], s53 offen offset:2048 sc1 lds
  v_mfma_f32_16x16x32_bf16 a[144:147], v[232:235], v[80:83], a[144:147]
  v_mfma_f32_16x16x32_bf16 a[152:155], v[232:235], v[84:87], a[152:155]
  v_mfma_f32_16x16x32_bf16 a[208:211], v[232:235], v[88:91], a[208:211]
  ds_read_b128 v[40:43], v212 offset:36864
  v_mfma_f32_16x16x32_bf16 a[216:219], v[232:235], v[92:95], a[216:219]
  ds_read_b64_tr_b16 v[232:233], v10 offset:32768
  v_mfma_f32_16x16x32_bf16 a[20:23], v[236:239], v[64:67], a[20:23]
  buffer_load_dwordx4 v19, s[8:11], s53 offen offset:3072 sc1 lds
  v_mfma_f32_16x16x32_bf16 a[28:31], v[236:239], v[68:71], a[28:31]
  ds_read_b64_tr_b16 v[234:235], v10 offset:34816
  v_mfma_f32_16x16x32_bf16 a[84:87], v[236:239], v[72:75], a[84:87]
  v_mfma_f32_16x16x32_bf16 a[92:95], v[236:239], v[76:79], a[92:95]
  s_add_u32 m0, s56, 4096
  v_mfma_f32_16x16x32_bf16 a[148:151], v[236:239], v[80:83], a[148:151]
  ds_read_b128 v[44:47], v213 offset:38912
  v_mfma_f32_16x16x32_bf16 a[156:159], v[236:239], v[84:87], a[156:159]
  buffer_load_dwordx4 v20, s[8:11], s53 offen offset:0 sc1 lds
  v_mfma_f32_16x16x32_bf16 a[212:215], v[236:239], v[88:91], a[212:215]
  v_mfma_f32_16x16x32_bf16 a[220:223], v[236:239], v[92:95], a[220:223]
  ds_read_b64_tr_b16 v[236:237], v11 offset:32768
  v_mfma_f32_16x16x32_bf16 a[32:35], v[240:243], v[64:67], a[32:35]
  ds_read_b64_tr_b16 v[238:239], v11 offset:34816
  v_mfma_f32_16x16x32_bf16 a[40:43], v[240:243], v[68:71], a[40:43]
  buffer_load_dwordx4 v21, s[8:11], s53 offen offset:1024 sc1 lds
  v_mfma_f32_16x16x32_bf16 a[96:99], v[240:243], v[72:75], a[96:99]
  ds_read_b128 v[48:51], v212 offset:40960
  v_mfma_f32_16x16x32_bf16 a[104:107], v[240:243], v[76:79], a[104:107]
  v_mfma_f32_16x16x32_bf16 a[160:163], v[240:243], v[80:83], a[160:163]
  buffer_load_dwordx4 v22, s[8:11], s53 offen offset:2048 sc1 lds
  v_mfma_f32_16x16x32_bf16 a[168:171], v[240:243], v[84:87], a[168:171]
  v_mfma_f32_16x16x32_bf16 a[224:227], v[240:243], v[88:91], a[224:227]
  v_mfma_f32_16x16x32_bf16 a[232:235], v[240:243], v[92:95], a[232:235]
  ds_read_b64_tr_b16 v[240:241], v12 offset:32768
  v_mfma_f32_16x16x32_bf16 a[36:39], v[244:247], v[64:67], a[36:39]
  ds_read_b64_tr_b16 v[242:243], v12 offset:34816
  v_mfma_f32_16x16x32_bf16 a[44:47], v[244:247], v[68:71], a[44:47]
  ds_read_b128 v[52:55], v213 offset:43008
  v_mfma_f32_16x16x32_bf16 a[100:103], v[244:247], v[72:75], a[100:103]
  buffer_load_dwordx4 v23, s[8:11], s53 offen offset:3072 sc1 lds
  s_add_u32 s53, s53, 128
  v_mfma_f32_16x16x32_bf16 a[108:111], v[244:247], v[76:79], a[108:111]
  v_mfma_f32_16x16x32_bf16 a[164:167], v[244:247], v[80:83], a[164:167]
  s_add_u32 m0, s56, 65536
  v_mfma_f32_16x16x32_bf16 a[172:175], v[244:247], v[84:87], a[172:175]
  buffer_load_dwordx4 v24, s[12:15], s54 offen offset:0 sc1 lds
  v_mfma_f32_16x16x32_bf16 a[228:231], v[244:247], v[88:91], a[228:231]
  ds_read_b128 v[56:59], v212 offset:45056
  v_mfma_f32_16x16x32_bf16 a[236:239], v[244:247], v[92:95], a[236:239]
  ds_read_b64_tr_b16 v[244:245], v13 offset:32768
  v_mfma_f32_16x16x32_bf16 a[48:51], v[248:251], v[64:67], a[48:51]
  ds_read_b64_tr_b16 v[246:247], v13 offset:34816
  v_mfma_f32_16x16x32_bf16 a[56:59], v[248:251], v[68:71], a[56:59]
  buffer_load_dwordx4 v25, s[12:15], s54 offen offset:1024 sc1 lds
  v_mfma_f32_16x16x32_bf16 a[112:115], v[248:251], v[72:75], a[112:115]
  v_mfma_f32_16x16x32_bf16 a[120:123], v[248:251], v[76:79], a[120:123]
  v_mfma_f32_16x16x32_bf16 a[176:179], v[248:251], v[80:83], a[176:179]
  ds_read_b128 v[60:63], v213 offset:47104
  v_mfma_f32_16x16x32_bf16 a[184:187], v[248:251], v[84:87], a[184:187]
  buffer_load_dwordx4 v26, s[12:15], s54 offen offset:2048 sc1 lds
  v_mfma_f32_16x16x32_bf16 a[240:243], v[248:251], v[88:91], a[240:243]
  v_mfma_f32_16x16x32_bf16 a[248:251], v[248:251], v[92:95], a[248:251]
  ds_read_b64_tr_b16 v[248:249], v14 offset:32768
  v_mfma_f32_16x16x32_bf16 a[52:55], v[252:255], v[64:67], a[52:55]
  ds_read_b64_tr_b16 v[250:251], v14 offset:34816
  v_mfma_f32_16x16x32_bf16 a[60:63], v[252:255], v[68:71], a[60:63]
  buffer_load_dwordx4 v27, s[12:15], s54 offen offset:3072 sc1 lds
  v_mfma_f32_16x16x32_bf16 a[116:119], v[252:255], v[72:75], a[116:119]
  v_mfma_f32_16x16x32_bf16 a[124:127], v[252:255], v[76:79], a[124:127]
  v_mfma_f32_16x16x32_bf16 a[180:183], v[252:255], v[80:83], a[180:183]
  v_mfma_f32_16x16x32_bf16 a[188:191], v[252:255], v[84:87], a[188:191]
  v_mfma_f32_16x16x32_bf16 a[244:247], v[252:255], v[88:91], a[244:247]
  v_mfma_f32_16x16x32_bf16 a[252:255], v[252:255], v[92:95], a[252:255]
  ds_read_b64_tr_b16 v[252:253], v15 offset:32768
  ds_read_b64_tr_b16 v[254:255], v15 offset:34816
  s_waitcnt lgkmcnt(15)
  s_waitcnt lgkmcnt(4)
  v_mfma_f32_16x16x32_bf16 a[0:3], v[224:227], v[32:35], a[0:3]
  v_mfma_f32_16x16x32_bf16 a[8:11], v[224:227], v[36:39], a[8:11]
  s_add_u32 m0, s56, 69632
  v_mfma_f32_16x16x32_bf16 a[64:67], v[224:227], v[40:43], a[64:67]
  buffer_load_dwordx4 v28, s[12:15], s54 offen offset:0 sc1 lds
  v_mfma_f32_16x16x32_bf16 a[72:75], v[224:227], v[44:47], a[72:75]
  v_mfma_f32_16x16x32_bf16 a[128:131], v[224:227], v[48:51], a[128:131]
  v_mfma_f32_16x16x32_bf16 a[136:139], v[224:227], v[52:55], a[136:139]
  buffer_load_dwordx4 v29, s[12:15], s54 offen offset:1024 sc1 lds
  v_mfma_f32_16x16x32_bf16 a[192:195], v[224:227], v[56:59], a[192:195]
  v_mfma_f32_16x16x32_bf16 a[200:203], v[224:227], v[60:63], a[200:203]
  ds_read_b64_tr_b16 v[224:225], v8 offset:49152
  v_mfma_f32_16x16x32_bf16 a[4:7], v[228:231], v[32:35], a[4:7]
  ds_read_b64_tr_b16 v[226:227], v8 offset:51200
  v_mfma_f32_16x16x32_bf16 a[12:15], v[228:231], v[36:39], a[12:15]
  buffer_load_dwordx4 v30, s[12:15], s54 offen offset:2048 sc1 lds
  v_mfma_f32_16x16x32_bf16 a[68:71], v[228:231], v[40:43], a[68:71]
  ds_read_b128 v[64:67], v213 offset:32768
  v_mfma_f32_16x16x32_bf16 a[76:79], v[228:231], v[44:47], a[76:79]
  v_mfma_f32_16x16x32_bf16 a[132:135], v[228:231], v[48:51], a[132:135]
  buffer_load_dwordx4 v31, s[12:15], s54 offen offset:3072 sc1 lds
  s_add_u32 s54, s54, 0x80000
  v_mfma_f32_16x16x32_bf16 a[140:143], v[228:231], v[52:55], a[140:143]
  v_mfma_f32_16x16x32_bf16 a[196:199], v[228:231], v[56:59], a[196:199]
  v_mfma_f32_16x16x32_bf16 a[204:207], v[228:231], v[60:63], a[204:207]
  ds_read_b64_tr_b16 v[228:229], v9 offset:49152
  v_mfma_f32_16x16x32_bf16 a[16:19], v[232:235], v[32:35], a[16:19]
  ds_read_b64_tr_b16 v[230:231], v9 offset:51200
  v_mfma_f32_16x16x32_bf16 a[24:27], v[232:235], v[36:39], a[24:27]
  ds_read_b128 v[68:71], v212 offset:34816
  v_mfma_f32_16x16x32_bf16 a[80:83], v[232:235], v[40:43], a[80:83]
  s_lshl_b32 s63, s3, 8
  v_mfma_f32_16x16x32_bf16 a[88:91], v[232:235], v[44:47], a[88:91]
  s_add_u32 s61, s63, 128
  v_mfma_f32_16x16x32_bf16 a[144:147], v[232:235], v[48:51], a[144:147]
  v_mfma_f32_16x16x32_bf16 a[152:155], v[232:235], v[52:55], a[152:155]
  s_cmp_eq_u32 s3, 3
  s_cselect_b32 s61, 0, s61
  v_mfma_f32_16x16x32_bf16 a[208:211], v[232:235], v[56:59], a[208:211]
  ds_read_b128 v[72:75], v213 offset:36864
  v_mfma_f32_16x16x32_bf16 a[216:219], v[232:235], v[60:63], a[216:219]
  ds_read_b64_tr_b16 v[232:233], v10 offset:49152
  v_mfma_f32_16x16x32_bf16 a[20:23], v[236:239], v[32:35], a[20:23]
  ds_read_b64_tr_b16 v[234:235], v10 offset:51200
  v_mfma_f32_16x16x32_bf16 a[28:31], v[236:239], v[36:39], a[28:31]
  v_mfma_f32_16x16x32_bf16 a[84:87], v[236:239], v[40:43], a[84:87]
  s_lshl_b32 s7, s33, 7
  v_mfma_f32_16x16x32_bf16 a[92:95], v[236:239], v[44:47], a[92:95]
  s_lshl_b32 s6, s32, 3
  v_mfma_f32_16x16x32_bf16 a[148:151], v[236:239], v[48:51], a[148:151]
  ds_read_b128 v[76:79], v212 offset:38912
  v_mfma_f32_16x16x32_bf16 a[156:159], v[236:239], v[52:55], a[156:159]
  s_add_u32 s7, s7, s6
  v_mfma_f32_16x16x32_bf16 a[212:215], v[236:239], v[56:59], a[212:215]
  v_lshrrev_b32 v6, 3, v0
  v_mfma_f32_16x16x32_bf16 a[220:223], v[236:239], v[60:63], a[220:223]
  ds_read_b64_tr_b16 v[236:237], v11 offset:49152
  v_mfma_f32_16x16x32_bf16 a[32:35], v[240:243], v[32:35], a[32:35]
  ds_read_b64_tr_b16 v[238:239], v11 offset:51200
  v_mfma_f32_16x16x32_bf16 a[40:43], v[240:243], v[36:39], a[40:43]
  v_add_u32 v6, s7, v6
  v_mfma_f32_16x16x32_bf16 a[96:99], v[240:243], v[40:43], a[96:99]
  ds_read_b128 v[80:83], v213 offset:40960
  v_mfma_f32_16x16x32_bf16 a[104:107], v[240:243], v[44:47], a[104:107]
  v_mfma_f32_16x16x32_bf16 a[160:163], v[240:243], v[48:51], a[160:163]
  buffer_load_dword v2, v3, s[8:11], s53 offen
  v_mfma_f32_16x16x32_bf16 a[168:171], v[240:243], v[52:55], a[168:171]
  v_mul_u32_u24 v6, 896, v6
  v_mfma_f32_16x16x32_bf16 a[224:227], v[240:243], v[56:59], a[224:227]
  v_and_b32 v7, 7, v0
  v_mfma_f32_16x16x32_bf16 a[232:235], v[240:243], v[60:63], a[232:235]
  ds_read_b64_tr_b16 v[240:241], v12 offset:49152
  v_mfma_f32_16x16x32_bf16 a[36:39], v[244:247], v[32:35], a[36:39]
  ds_read_b64_tr_b16 v[242:243], v12 offset:51200
  v_mfma_f32_16x16x32_bf16 a[44:47], v[244:247], v[36:39], a[44:47]
  ds_read_b128 v[84:87], v212 offset:43008
  v_mfma_f32_16x16x32_bf16 a[100:103], v[244:247], v[40:43], a[100:103]
  v_lshl_add_u32 v132, v7, 4, v6
  v_mfma_f32_16x16x32_bf16 a[108:111], v[244:247], v[44:47], a[108:111]
  v_mov_b32 v137, 0
  v_mfma_f32_16x16x32_bf16 a[164:167], v[244:247], v[48:51], a[164:167]
  buffer_load_dword v2, v4, s[12:15], s54 offen
  v_mfma_f32_16x16x32_bf16 a[172:175], v[244:247], v[52:55], a[172:175]
  buffer_load_dwordx4 v[96:99], v132, s[20:23], 0 offen offset:0
  v_mfma_f32_16x16x32_bf16 a[228:231], v[244:247], v[56:59], a[228:231]
  ds_read_b128 v[88:91], v213 offset:45056
  v_mfma_f32_16x16x32_bf16 a[236:239], v[244:247], v[60:63], a[236:239]
  s_waitcnt lgkmcnt(15)
  ds_read_b64_tr_b16 v[244:245], v13 offset:49152
  v_mfma_f32_16x16x32_bf16 a[48:51], v[248:251], v[32:35], a[48:51]
  ds_read_b64_tr_b16 v[246:247], v13 offset:51200
  v_mfma_f32_16x16x32_bf16 a[56:59], v[248:251], v[36:39], a[56:59]
  v_mfma_f32_16x16x32_bf16 a[112:115], v[248:251], v[40:43], a[112:115]
  buffer_load_dwordx4 v[100:103], v132, s[20:23], 0 offen offset:128
  v_mfma_f32_16x16x32_bf16 a[120:123], v[248:251], v[44:47], a[120:123]
  buffer_load_dwordx4 v[104:107], v132, s[20:23], 0 offen offset:256
  v_mfma_f32_16x16x32_bf16 a[176:179], v[248:251], v[48:51], a[176:179]
  ds_read_b128 v[92:95], v212 offset:47104
  v_mfma_f32_16x16x32_bf16 a[184:187], v[248:251], v[52:55], a[184:187]
  buffer_load_dwordx4 v[108:111], v132, s[20:23], 0 offen offset:384
  v_mfma_f32_16x16x32_bf16 a[240:243], v[248:251], v[56:59], a[240:243]
  buffer_load_dwordx4 v[112:115], v132, s[20:23], 0 offen offset:512
  v_mfma_f32_16x16x32_bf16 a[248:251], v[248:251], v[60:63], a[248:251]
  ds_read_b64_tr_b16 v[248:249], v14 offset:49152
  v_mfma_f32_16x16x32_bf16 a[52:55], v[252:255], v[32:35], a[52:55]
  ds_read_b64_tr_b16 v[250:251], v14 offset:51200
  v_mfma_f32_16x16x32_bf16 a[60:63], v[252:255], v[36:39], a[60:63]
  buffer_load_dwordx4 v[116:119], v132, s[20:23], 0 offen offset:640
  v_mfma_f32_16x16x32_bf16 a[116:119], v[252:255], v[40:43], a[116:119]
  buffer_load_dwordx4 v[120:123], v132, s[20:23], 0 offen offset:768
  v_mfma_f32_16x16x32_bf16 a[124:127], v[252:255], v[44:47], a[124:127]
  v_mfma_f32_16x16x32_bf16 a[180:183], v[252:255], v[48:51], a[180:183]
  buffer_load_dwordx4 v[124:127], v132, s[20:23], s63 offen
  v_mfma_f32_16x16x32_bf16 a[188:191], v[252:255], v[52:55], a[188:191]
  buffer_load_dwordx4 v[128:131], v132, s[20:23], s61 offen
  v_mfma_f32_16x16x32_bf16 a[244:247], v[252:255], v[56:59], a[244:247]
  global_load_dword v139, v137, s[84:85]
  v_mfma_f32_16x16x32_bf16 a[252:255], v[252:255], v[60:63], a[252:255]
  ds_read_b64_tr_b16 v[252:253], v15 offset:49152
  ds_read_b64_tr_b16 v[254:255], v15 offset:51200
  s_waitcnt lgkmcnt(4)
  v_mfma_f32_16x16x32_bf16 a[0:3], v[224:227], v[64:67], a[0:3]
  v_mfma_f32_16x16x32_bf16 a[8:11], v[224:227], v[68:71], a[8:11]
  v_mfma_f32_16x16x32_bf16 a[64:67], v[224:227], v[72:75], a[64:67]
  v_mfma_f32_16x16x32_bf16 a[72:75], v[224:227], v[76:79], a[72:75]
  v_mfma_f32_16x16x32_bf16 a[128:131], v[224:227], v[80:83], a[128:131]
  v_mfma_f32_16x16x32_bf16 a[136:139], v[224:227], v[84:87], a[136:139]
  v_mfma_f32_16x16x32_bf16 a[192:195], v[224:227], v[88:91], a[192:195]
  v_mfma_f32_16x16x32_bf16 a[200:203], v[224:227], v[92:95], a[200:203]
  s_waitcnt vmcnt(12)
  s_waitcnt lgkmcnt(0)
  s_barrier
  ds_read_b64_tr_b16 v[224:225], v8 offset:0
  v_mfma_f32_16x16x32_bf16 a[4:7], v[228:231], v[64:67], a[4:7]
  ds_read_b64_tr_b16 v[226:227], v8 offset:2048
  v_mfma_f32_16x16x32_bf16 a[12:15], v[228:231], v[68:71], a[12:15]
  v_mfma_f32_16x16x32_bf16 a[68:71], v[228:231], v[72:75], a[68:71]
  ds_read_b128 v[32:35], v212 offset:0
  s_add_u32 m0, s56, 32768
  v_mfma_f32_16x16x32_bf16 a[76:79], v[228:231], v[76:79], a[76:79]
  buffer_load_dwordx4 v16, s[8:11], s53 offen offset:0 sc1 lds
  v_mfma_f32_16x16x32_bf16 a[132:135], v[228:231], v[80:83], a[132:135]
  v_mfma_f32_16x16x32_bf16 a[140:143], v[228:231], v[84:87], a[140:143]
  v_mfma_f32_16x16x32_bf16 a[196:199], v[228:231], v[88:91], a[196:199]
  v_mfma_f32_16x16x32_bf16 a[204:207], v[228:231], v[92:95], a[204:207]
  ds_read_b64_tr_b16 v[228:229], v9 offset:0
  v_mfma_f32_16x16x32_bf16 a[16:19], v[232:235], v[64:67], a[16:19]
  buffer_load_dwordx4 v17, s[8:11], s53 offen offset:1024 sc1 lds
  v_mfma_f32_16x16x32_bf16 a[24:27], v[232:235], v[68:71], a[24:27]
  ds_read_b64_tr_b16 v[230:231], v9 offset:2048
  v_mfma_f32_16x16x32_bf16 a[80:83], v[232:235], v[72:75], a[80:83]
  ds_read_b128 v[36:39], v213 offset:2048
  v_mfma_f32_16x16x32_bf16 a[88:91], v[232:235], v[76:79], a[88:91]
  buffer_load_dwordx4 v18, s[8:11], s53 offen offset:2048 sc1 lds
  v_mfma_f32_16x16x32_bf16 a[144:147], v[232:235], v[80:83], a[144:147]
  v_mfma_f32_16x16x32_bf16 a[152:155], v[232:235], v[84:87], a[152:155]
  v_mfma_f32_16x16x32_bf16 a[208:211], v[232:235], v[88:91], a[208:211]
  ds_read_b128 v[40:43], v212 offset:4096
  v_mfma_f32_16x16x32_bf16 a[216:219], v[232:235], v[92:95], a[216:219]
  ds_read_b64_tr_b16 v[232:233], v10 offset:0
  v_mfma_f32_16x16x32_bf16 a[20:23], v[236:239], v[64:67], a[20:23]
  buffer_load_dwordx4 v19, s[8:11], s53 offen offset:3072 sc1 lds
  v_mfma_f32_16x16x32_bf16 a[28:31], v[236:239], v[68:71], a[28:31]
  ds_read_b64_tr_b16 v[234:235], v10 offset:2048
  v_mfma_f32_16x16x32_bf16 a[84:87], v[236:239], v[72:75], a[84:87]
  v_mfma_f32_16x16x32_bf16 a[92:95], v[236:239], v[76:79], a[92:95]
  s_add_u32 m0, s56, 36864
  v_mfma_f32_16x16x32_bf16 a[148:151], v[236:239], v[80:83], a[148:151]
  ds_read_b128 v[44:47], v213 offset:6144
  v_mfma_f32_16x16x32_bf16 a[156:159], v[236:239], v[84:87], a[156:159]
  buffer_load_dwordx4 v20, s[8:11], s53 offen offset:0 sc1 lds
  v_mfma_f32_16x16x32_bf16 a[212:215], v[236:239], v[88:91], a[212:215]
  v_mfma_f32_16x16x32_bf16 a[220:223], v[236:239], v[92:95], a[220:223]
  ds_read_b64_tr_b16 v[236:237], v11 offset:0
  v_mfma_f32_16x16x32_bf16 a[32:35], v[240:243], v[64:67], a[32:35]
  ds_read_b64_tr_b16 v[238:239], v11 offset:2048
  v_mfma_f32_16x16x32_bf16 a[40:43], v[240:243], v[68:71], a[40:43]
  buffer_load_dwordx4 v21, s[8:11], s53 offen offset:1024 sc1 lds
  v_mfma_f32_16x16x32_bf16 a[96:99], v[240:243], v[72:75], a[96:99]
  ds_read_b128 v[48:51], v212 offset:8192
  v_mfma_f32_16x16x32_bf16 a[104:107], v[240:243], v[76:79], a[104:107]
  v_mfma_f32_16x16x32_bf16 a[160:163], v[240:243], v[80:83], a[160:163]
  buffer_load_dwordx4 v22, s[8:11], s53 offen offset:2048 sc1 lds
  v_mfma_f32_16x16x32_bf16 a[168:171], v[240:243], v[84:87], a[168:171]
  v_mfma_f32_16x16x32_bf16 a[224:227], v[240:243], v[88:91], a[224:227]
  v_mfma_f32_16x16x32_bf16 a[232:235], v[240:243], v[92:95], a[232:235]
  ds_read_b64_tr_b16 v[240:241], v12 offset:0
  v_mfma_f32_16x16x32_bf16 a[36:39], v[244:247], v[64:67], a[36:39]
  ds_read_b64_tr_b16 v[242:243], v12 offset:2048
  v_mfma_f32_16x16x32_bf16 a[44:47], v[244:247], v[68:71], a[44:47]
  ds_read_b128 v[52:55], v213 offset:10240
  v_mfma_f32_16x16x32_bf16 a[100:103], v[244:247], v[72:75], a[100:103]
  buffer_load_dwordx4 v23, s[8:11], s53 offen offset:3072 sc1 lds
  s_add_u32 s53, s53, 128
  v_mfma_f32_16x16x32_bf16 a[108:111], v[244:247], v[76:79], a[108:111]
  v_mfma_f32_16x16x32_bf16 a[164:167], v[244:247], v[80:83], a[164:167]
  s_add_u32 m0, s56, 98304
  v_mfma_f32_16x16x32_bf16 a[172:175], v[244:247], v[84:87], a[172:175]
  buffer_load_dwordx4 v24, s[12:15], s54 offen offset:0 sc1 lds
  v_mfma_f32_16x16x32_bf16 a[228:231], v[244:247], v[88:91], a[228:231]
  ds_read_b128 v[56:59], v212 offset:12288
  v_mfma_f32_16x16x32_bf16 a[236:239], v[244:247], v[92:95], a[236:239]
  ds_read_b64_tr_b16 v[244:245], v13 offset:0
  v_mfma_f32_16x16x32_bf16 a[48:51], v[248:251], v[64:67], a[48:51]
  ds_read_b64_tr_b16 v[246:247], v13 offset:2048
  v_mfma_f32_16x16x32_bf16 a[56:59], v[248:251], v[68:71], a[56:59]
  buffer_load_dwordx4 v25, s[12:15], s54 offen offset:1024 sc1 lds
  v_mfma_f32_16x16x32_bf16 a[112:115], v[248:251], v[72:75], a[112:115]
  v_mfma_f32_16x16x32_bf16 a[120:123], v[248:251], v[76:79], a[120:123]
  v_mfma_f32_16x16x32_bf16 a[176:179], v[248:251], v[80:83], a[176:179]
  ds_read_b128 v[60:63], v213 offset:14336
  v_mfma_f32_16x16x32_bf16 a[184:187], v[248:251], v[84:87], a[184:187]
  buffer_load_dwordx4 v26, s[12:15], s54 offen offset:2048 sc1 lds
  v_mfma_f32_16x16x32_bf16 a[240:243], v[248:251], v[88:91], a[240:243]
  v_mfma_f32_16x16x32_bf16 a[248:251], v[248:251], v[92:95], a[248:251]
  ds_read_b64_tr_b16 v[248:249], v14 offset:0
  v_mfma_f32_16x16x32_bf16 a[52:55], v[252:255], v[64:67], a[52:55]
  ds_read_b64_tr_b16 v[250:251], v14 offset:2048
  v_mfma_f32_16x16x32_bf16 a[60:63], v[252:255], v[68:71], a[60:63]
  buffer_load_dwordx4 v27, s[12:15], s54 offen offset:3072 sc1 lds
  v_mfma_f32_16x16x32_bf16 a[116:119], v[252:255], v[72:75], a[116:119]
  v_mfma_f32_16x16x32_bf16 a[124:127], v[252:255], v[76:79], a[124:127]
  v_mfma_f32_16x16x32_bf16 a[180:183], v[252:255], v[80:83], a[180:183]
  v_mfma_f32_16x16x32_bf16 a[188:191], v[252:255], v[84:87], a[188:191]
  v_mfma_f32_16x16x32_bf16 a[244:247], v[252:255], v[88:91], a[244:247]
  v_mfma_f32_16x16x32_bf16 a[252:255], v[252:255], v[92:95], a[252:255]
  ds_read_b64_tr_b16 v[252:253], v15 offset:0
  ds_read_b64_tr_b16 v[254:255], v15 offset:2048
  s_waitcnt lgkmcnt(15)
  s_waitcnt lgkmcnt(4)
  v_mfma_f32_16x16x32_bf16 a[0:3], v[224:227], v[32:35], a[0:3]
  v_mfma_f32_16x16x32_bf16 a[8:11], v[224:227], v[36:39], a[8:11]
  s_add_u32 m0, s56, 102400
  v_mfma_f32_16x16x32_bf16 a[64:67], v[224:227], v[40:43], a[64:67]
  buffer_load_dwordx4 v28, s[12:15], s54 offen offset:0 sc1 lds
  v_mfma_f32_16x16x32_bf16 a[72:75], v[224:227], v[44:47], a[72:75]
  v_mfma_f32_16x16x32_bf16 a[128:131], v[224:227], v[48:51], a[128:131]
  v_mfma_f32_16x16x32_bf16 a[136:139], v[224:227], v[52:55], a[136:139]
  buffer_load_dwordx4 v29, s[12:15], s54 offen offset:1024 sc1 lds
  v_mfma_f32_16x16x32_bf16 a[192:195], v[224:227], v[56:59], a[192:195]
  v_mfma_f32_16x16x32_bf16 a[200:203], v[224:227], v[60:63], a[200:203]
  ds_read_b64_tr_b16 v[224:225], v8 offset:16384
  v_mfma_f32_16x16x32_bf16 a[4:7], v[228:231], v[32:35], a[4:7]
  ds_read_b64_tr_b16 v[226:227], v8 offset:18432
  v_mfma_f32_16x16x32_bf16 a[12:15], v[228:231], v[36:39], a[12:15]
  buffer_load_dwordx4 v30, s[12:15], s54 offen offset:2048 sc1 lds
  v_mfma_f32_16x16x32_bf16 a[68:71], v[228:231], v[40:43], a[68:71]
  ds_read_b128 v[64:67], v213 offset:0
  v_mfma_f32_16x16x32_bf16 a[76:79], v[228:231], v[44:47], a[76:79]
  v_mfma_f32_16x16x32_bf16 a[132:135], v[228:231], v[48:51], a[132:135]
  buffer_load_dwordx4 v31, s[12:15], s54 offen offset:3072 sc1 lds
  s_add_u32 s54, s54, 0x80000
  v_mfma_f32_16x16x32_bf16 a[140:143], v[228:231], v[52:55], a[140:143]
  v_mfma_f32_16x16x32_bf16 a[196:199], v[228:231], v[56:59], a[196:199]
  v_mfma_f32_16x16x32_bf16 a[204:207], v[228:231], v[60:63], a[204:207]
  ds_read_b64_tr_b16 v[228:229], v9 offset:16384
  v_mfma_f32_16x16x32_bf16 a[16:19], v[232:235], v[32:35], a[16:19]
  ds_read_b64_tr_b16 v[230:231], v9 offset:18432
  v_mfma_f32_16x16x32_bf16 a[24:27], v[232:235], v[36:39], a[24:27]
  ds_read_b128 v[68:71], v212 offset:2048
  v_mfma_f32_16x16x32_bf16 a[80:83], v[232:235], v[40:43], a[80:83]
  v_mfma_f32_16x16x32_bf16 a[88:91], v[232:235], v[44:47], a[88:91]
  v_mfma_f32_16x16x32_bf16 a[144:147], v[232:235], v[48:51], a[144:147]
  s_lshr_b32 s5, s32, 2
  s_lshl_b32 s6, s33, 2
  v_mfma_f32_16x16x32_bf16 a[152:155], v[232:235], v[52:55], a[152:155]
  s_add_u32 s5, s5, s6
  v_mfma_f32_16x16x32_bf16 a[208:211], v[232:235], v[56:59], a[208:211]
  ds_read_b128 v[72:75], v213 offset:4096
  s_mul_i32 s5, s5, 28672
  v_mfma_f32_16x16x32_bf16 a[216:219], v[232:235], v[60:63], a[216:219]
  ds_read_b64_tr_b16 v[232:233], v10 offset:16384
  v_mfma_f32_16x16x32_bf16 a[20:23], v[236:239], v[32:35], a[20:23]
  ds_read_b64_tr_b16 v[234:235], v10 offset:18432
  v_mfma_f32_16x16x32_bf16 a[28:31], v[236:239], v[36:39], a[28:31]
  s_add_u32 s5, s5, 117440512
  s_lshl_b32 s63, s63, 5
  v_mfma_f32_16x16x32_bf16 a[84:87], v[236:239], v[40:43], a[84:87]
  s_lshl_b32 s61, s61, 5
  s_add_u32 s63, s63, s5
  v_mfma_f32_16x16x32_bf16 a[92:95], v[236:239], v[44:47], a[92:95]
  s_add_u32 s61, s61, s5
  v_mfma_f32_16x16x32_bf16 a[148:151], v[236:239], v[48:51], a[148:151]
  ds_read_b128 v[76:79], v212 offset:6144
  s_bfe_u32 s6, s32, 0x10001
  v_mfma_f32_16x16x32_bf16 a[156:159], v[236:239], v[52:55], a[156:159]
  s_lshl_b32 s6, s6, 10
  v_mfma_f32_16x16x32_bf16 a[212:215], v[236:239], v[56:59], a[212:215]
  s_and_b32 s5, s32, 1
  s_lshl_b32 s5, s5, 7
  v_mfma_f32_16x16x32_bf16 a[220:223], v[236:239], v[60:63], a[220:223]
  ds_read_b64_tr_b16 v[236:237], v11 offset:16384
  v_mfma_f32_16x16x32_bf16 a[32:35], v[240:243], v[32:35], a[32:35]
  ds_read_b64_tr_b16 v[238:239], v11 offset:18432
  s_add_u32 s6, s6, s5
  v_mfma_f32_16x16x32_bf16 a[40:43], v[240:243], v[36:39], a[40:43]
  v_lshrrev_b32 v6, 3, v0
  v_mfma_f32_16x16x32_bf16 a[96:99], v[240:243], v[40:43], a[96:99]
  ds_read_b128 v[80:83], v213 offset:8192
  v_lshlrev_b32 v6, 4, v6
  v_mfma_f32_16x16x32_bf16 a[104:107], v[240:243], v[44:47], a[104:107]
  v_and_b32 v7, 3, v0
  v_mfma_f32_16x16x32_bf16 a[160:163], v[240:243], v[48:51], a[160:163]
  buffer_load_dword v2, v3, s[8:11], s53 offen
  v_lshl_add_u32 v6, v7, 8, v6
  v_mfma_f32_16x16x32_bf16 a[168:171], v[240:243], v[52:55], a[168:171]
  v_bfe_u32 v7, v0, 2, 1
  v_lshl_add_u32 v6, v7, 11, v6
  v_mfma_f32_16x16x32_bf16 a[224:227], v[240:243], v[56:59], a[224:227]
  v_add_u32 v133, s6, v6
  v_mfma_f32_16x16x32_bf16 a[232:235], v[240:243], v[60:63], a[232:235]
  ds_read_b64_tr_b16 v[240:241], v12 offset:16384
  v_mfma_f32_16x16x32_bf16 a[36:39], v[244:247], v[32:35], a[36:39]
  ds_read_b64_tr_b16 v[242:243], v12 offset:18432
  s_mov_b32 s7, 0x3f803f80
  v_mfma_f32_16x16x32_bf16 a[44:47], v[244:247], v[36:39], a[44:47]
  ds_read_b128 v[84:87], v212 offset:10240
  v_mov_b32 v148, 0
  v_mfma_f32_16x16x32_bf16 a[100:103], v[244:247], v[40:43], a[100:103]
  v_mov_b32 v149, 0
  v_mfma_f32_16x16x32_bf16 a[108:111], v[244:247], v[44:47], a[108:111]
  v_mov_b32 v150, 0
  v_mov_b32 v151, 0
  v_mfma_f32_16x16x32_bf16 a[164:167], v[244:247], v[48:51], a[164:167]
  buffer_load_dword v2, v4, s[12:15], s54 offen
  v_mfma_f32_16x16x32_bf16 a[172:175], v[244:247], v[52:55], a[172:175]
  v_mov_b32 v152, 0
  v_mov_b32 v153, 0
  v_mfma_f32_16x16x32_bf16 a[228:231], v[244:247], v[56:59], a[228:231]
  ds_read_b128 v[88:91], v213 offset:12288
  v_mov_b32 v154, 0
  v_mfma_f32_16x16x32_bf16 a[236:239], v[244:247], v[60:63], a[236:239]
  s_waitcnt lgkmcnt(15)
  ds_read_b64_tr_b16 v[244:245], v13 offset:16384
  v_mfma_f32_16x16x32_bf16 a[48:51], v[248:251], v[32:35], a[48:51]
  ds_read_b64_tr_b16 v[246:247], v13 offset:18432
  v_mfma_f32_16x16x32_bf16 a[56:59], v[248:251], v[36:39], a[56:59]
  v_mov_b32 v155, 0
  s_waitcnt vmcnt(27)
  v_lshlrev_b32 v156, 16, v96
  v_mfma_f32_16x16x32_bf16 a[112:115], v[248:251], v[40:43], a[112:115]
  v_and_b32 v157, 0xffff0000, v96
  v_mfma_f32_16x16x32_bf16 a[120:123], v[248:251], v[44:47], a[120:123]
  v_add_f32 v148, v148, v156
  v_add_f32 v149, v149, v157
  v_mfma_f32_16x16x32_bf16 a[176:179], v[248:251], v[48:51], a[176:179]
  ds_read_b128 v[92:95], v212 offset:14336
  v_fmac_f32 v152, v156, v156
  v_mfma_f32_16x16x32_bf16 a[184:187], v[248:251], v[52:55], a[184:187]
  v_fmac_f32 v153, v157, v157
  v_mfma_f32_16x16x32_bf16 a[240:243], v[248:251], v[56:59], a[240:243]
  v_lshlrev_b32 v158, 16, v97
  v_and_b32 v159, 0xffff0000, v97
  v_mfma_f32_16x16x32_bf16 a[248:251], v[248:251], v[60:63], a[248:251]
  ds_read_b64_tr_b16 v[248:249], v14 offset:16384
  v_mfma_f32_16x16x32_bf16 a[52:55], v[252:255], v[32:35], a[52:55]
  ds_read_b64_tr_b16 v[250:251], v14 offset:18432
  v_mfma_f32_16x16x32_bf16 a[60:63], v[252:255], v[36:39], a[60:63]
  v_add_f32 v150, v150, v158
  v_add_f32 v151, v151, v159
  v_mfma_f32_16x16x32_bf16 a[116:119], v[252:255], v[40:43], a[116:119]
  v_fmac_f32 v154, v158, v158
  v_fmac_f32 v155, v159, v159
  v_mfma_f32_16x16x32_bf16 a[124:127], v[252:255], v[44:47], a[124:127]
  v_lshlrev_b32 v160, 16, v98
  v_mfma_f32_16x16x32_bf16 a[180:183], v[252:255], v[48:51], a[180:183]
  v_and_b32 v161, 0xffff0000, v98
  v_add_f32 v148, v148, v160
  v_mfma_f32_16x16x32_bf16 a[188:191], v[252:255], v[52:55], a[188:191]
  v_add_f32 v149, v149, v161
  v_mfma_f32_16x16x32_bf16 a[244:247], v[252:255], v[56:59], a[244:247]
  v_fmac_f32 v152, v160, v160
  v_fmac_f32 v153, v161, v161
  v_mfma_f32_16x16x32_bf16 a[252:255], v[252:255], v[60:63], a[252:255]
  ds_read_b64_tr_b16 v[252:253], v15 offset:16384
  ds_read_b64_tr_b16 v[254:255], v15 offset:18432
  s_waitcnt lgkmcnt(4)
  v_mfma_f32_16x16x32_bf16 a[0:3], v[224:227], v[64:67], a[0:3]
  v_lshlrev_b32 v162, 16, v99
  v_and_b32 v163, 0xffff0000, v99
  v_mfma_f32_16x16x32_bf16 a[8:11], v[224:227], v[68:71], a[8:11]
  v_add_f32 v150, v150, v162
  v_add_f32 v151, v151, v163
  v_mfma_f32_16x16x32_bf16 a[64:67], v[224:227], v[72:75], a[64:67]
  v_fmac_f32 v154, v162, v162
  v_fmac_f32 v155, v163, v163
  v_mfma_f32_16x16x32_bf16 a[72:75], v[224:227], v[76:79], a[72:75]
  s_waitcnt vmcnt(26)
  v_lshlrev_b32 v156, 16, v100
  v_mfma_f32_16x16x32_bf16 a[128:131], v[224:227], v[80:83], a[128:131]
  v_and_b32 v157, 0xffff0000, v100
  v_add_f32 v148, v148, v156
  v_mfma_f32_16x16x32_bf16 a[136:139], v[224:227], v[84:87], a[136:139]
  v_add_f32 v149, v149, v157
  v_fmac_f32 v152, v156, v156
  v_mfma_f32_16x16x32_bf16 a[192:195], v[224:227], v[88:91], a[192:195]
  v_fmac_f32 v153, v157, v157
  v_lshlrev_b32 v158, 16, v101
  v_mfma_f32_16x16x32_bf16 a[200:203], v[224:227], v[92:95], a[200:203]
  s_waitcnt vmcnt(2)
  s_waitcnt lgkmcnt(0)
  s_barrier
  ds_read_b64_tr_b16 v[224:225], v8 offset:32768
  v_mfma_f32_16x16x32_bf16 a[4:7], v[228:231], v[64:67], a[4:7]
  ds_read_b64_tr_b16 v[226:227], v8 offset:34816
  v_and_b32 v159, 0xffff0000, v101
  v_mfma_f32_16x16x32_bf16 a[12:15], v[228:231], v[68:71], a[12:15]
  v_add_f32 v150, v150, v158
  v_add_f32 v151, v151, v159
  v_mfma_f32_16x16x32_bf16 a[68:71], v[228:231], v[72:75], a[68:71]
  ds_read_b128 v[32:35], v212 offset:32768
  s_add_u32 m0, s56, 0
  v_mfma_f32_16x16x32_bf16 a[76:79], v[228:231], v[76:79], a[76:79]
  buffer_load_dwordx4 v16, s[8:11], s53 offen offset:0 sc1 lds
  v_fmac_f32 v154, v158, v158
  v_mfma_f32_16x16x32_bf16 a[132:135], v[228:231], v[80:83], a[132:135]
  v_fmac_f32 v155, v159, v159
  v_lshlrev_b32 v160, 16, v102
  v_mfma_f32_16x16x32_bf16 a[140:143], v[228:231], v[84:87], a[140:143]
  v_and_b32 v161, 0xffff0000, v102
  v_mfma_f32_16x16x32_bf16 a[196:199], v[228:231], v[88:91], a[196:199]
  v_add_f32 v148, v148, v160
  v_add_f32 v149, v149, v161
  v_mfma_f32_16x16x32_bf16 a[204:207], v[228:231], v[92:95], a[204:207]
  ds_read_b64_tr_b16 v[228:229], v9 offset:32768
  v_mfma_f32_16x16x32_bf16 a[16:19], v[232:235], v[64:67], a[16:19]
  buffer_load_dwordx4 v17, s[8:11], s53 offen offset:1024 sc1 lds
  v_fmac_f32 v152, v160, v160
  v_mfma_f32_16x16x32_bf16 a[24:27], v[232:235], v[68:71], a[24:27]
  ds_read_b64_tr_b16 v[230:231], v9 offset:34816
  v_fmac_f32 v153, v161, v161
  v_mfma_f32_16x16x32_bf16 a[80:83], v[232:235], v[72:75], a[80:83]
  ds_read_b128 v[36:39], v213 offset:34816
  v_lshlrev_b32 v162, 16, v103
  v_mfma_f32_16x16x32_bf16 a[88:91], v[232:235], v[76:79], a[88:91]
  buffer_load_dwordx4 v18, s[8:11], s53 offen offset:2048 sc1 lds
  v_and_b32 v163, 0xffff0000, v103
  v_mfma_f32_16x16x32_bf16 a[144:147], v[232:235], v[80:83], a[144:147]
  v_add_f32 v150, v150, v162
  v_add_f32 v151, v151, v163
  v_mfma_f32_16x16x32_bf16 a[152:155], v[232:235], v[84:87], a[152:155]
  v_fmac_f32 v154, v162, v162
  v_fmac_f32 v155, v163, v163
  v_mfma_f32_16x16x32_bf16 a[208:211], v[232:235], v[88:91], a[208:211]
  ds_read_b128 v[40:43], v212 offset:36864
  v_mfma_f32_16x16x32_bf16 a[216:219], v[232:235], v[92:95], a[216:219]
  ds_read_b64_tr_b16 v[232:233], v10 offset:32768
  v_mfma_f32_16x16x32_bf16 a[20:23], v[236:239], v[64:67], a[20:23]
  buffer_load_dwordx4 v19, s[8:11], s53 offen offset:3072 sc1 lds
  v_lshlrev_b32 v156, 16, v104
  v_mfma_f32_16x16x32_bf16 a[28:31], v[236:239], v[68:71], a[28:31]
  ds_read_b64_tr_b16 v[234:235], v10 offset:34816
  v_and_b32 v157, 0xffff0000, v104
  v_mfma_f32_16x16x32_bf16 a[84:87], v[236:239], v[72:75], a[84:87]
  v_add_f32 v148, v148, v156
  v_add_f32 v149, v149, v157
  v_mfma_f32_16x16x32_bf16 a[92:95], v[236:239], v[76:79], a[92:95]
  s_add_u32 m0, s56, 4096
  v_fmac_f32 v152, v156, v156
  v_mfma_f32_16x16x32_bf16 a[148:151], v[236:239], v[80:83], a[148:151]
  ds_read_b128 v[44:47], v213 offset:38912
  v_fmac_f32 v153, v157, v157
  v_mfma_f32_16x16x32_bf16 a[156:159], v[236:239], v[84:87], a[156:159]
  buffer_load_dwordx4 v20, s[8:11], s53 offen offset:0 sc1 lds
  v_lshlrev_b32 v158, 16, v105
  v_mfma_f32_16x16x32_bf16 a[212:215], v[236:239], v[88:91], a[212:215]
  v_and_b32 v159, 0xffff0000, v105
  v_add_f32 v150, v150, v158
  v_mfma_f32_16x16x32_bf16 a[220:223], v[236:239], v[92:95], a[220:223]
  ds_read_b64_tr_b16 v[236:237], v11 offset:32768
  v_mfma_f32_16x16x32_bf16 a[32:35], v[240:243], v[64:67], a[32:35]
  ds_read_b64_tr_b16 v[238:239], v11 offset:34816
  v_mfma_f32_16x16x32_bf16 a[40:43], v[240:243], v[68:71], a[40:43]
  buffer_load_dwordx4 v21, s[8:11], s53 offen offset:1024 sc1 lds
  v_add_f32 v151, v151, v159
  v_mfma_f32_16x16x32_bf16 a[96:99], v[240:243], v[72:75], a[96:99]
  ds_read_b128 v[48:51], v212 offset:40960
  v_fmac_f32 v154, v158, v158
  v_mfma_f32_16x16x32_bf16 a[104:107], v[240:243], v[76:79], a[104:107]
  v_fmac_f32 v155, v159, v159
  v_lshlrev_b32 v160, 16, v106
  v_mfma_f32_16x16x32_bf16 a[160:163], v[240:243], v[80:83], a[160:163]
  buffer_load_dwordx4 v22, s[8:11], s53 offen offset:2048 sc1 lds
  v_and_b32 v161, 0xffff0000, v106
  v_mfma_f32_16x16x32_bf16 a[168:171], v[240:243], v[84:87], a[168:171]
  v_add_f32 v148, v148, v160
  v_add_f32 v149, v149, v161
  v_mfma_f32_16x16x32_bf16 a[224:227], v[240:243], v[88:91], a[224:227]
  v_fmac_f32 v152, v160, v160
  v_fmac_f32 v153, v161, v161
  v_mfma_f32_16x16x32_bf16 a[232:235], v[240:243], v[92:95], a[232:235]
  ds_read_b64_tr_b16 v[240:241], v12 offset:32768
  v_mfma_f32_16x16x32_bf16 a[36:39], v[244:247], v[64:67], a[36:39]
  ds_read_b64_tr_b16 v[242:243], v12 offset:34816
  v_mfma_f32_16x16x32_bf16 a[44:47], v[244:247], v[68:71], a[44:47]
  ds_read_b128 v[52:55], v213 offset:43008
  v_lshlrev_b32 v162, 16, v107
  v_mfma_f32_16x16x32_bf16 a[100:103], v[244:247], v[72:75], a[100:103]
  buffer_load_dwordx4 v23, s[8:11], s53 offen offset:3072 sc1 lds
  s_add_u32 s53, s53, 128
  v_mfma_f32_16x16x32_bf16 a[108:111], v[244:247], v[76:79], a[108:111]
  v_and_b32 v163, 0xffff0000, v107
  v_add_f32 v150, v150, v162
  v_mfma_f32_16x16x32_bf16 a[164:167], v[244:247], v[80:83], a[164:167]
  s_add_u32 m0, s56, 65536
  v_add_f32 v151, v151, v163
  v_mfma_f32_16x16x32_bf16 a[172:175], v[244:247], v[84:87], a[172:175]
  buffer_load_dwordx4 v24, s[12:15], s54 offen offset:0 sc1 lds
  v_fmac_f32 v154, v162, v162
  v_mfma_f32_16x16x32_bf16 a[228:231], v[244:247], v[88:91], a[228:231]
  ds_read_b128 v[56:59], v212 offset:45056
  v_fmac_f32 v155, v163, v163
  v_mfma_f32_16x16x32_bf16 a[236:239], v[244:247], v[92:95], a[236:239]
  ds_read_b64_tr_b16 v[244:245], v13 offset:32768
  v_mfma_f32_16x16x32_bf16 a[48:51], v[248:251], v[64:67], a[48:51]
  ds_read_b64_tr_b16 v[246:247], v13 offset:34816
  v_lshlrev_b32 v156, 16, v108
  v_mfma_f32_16x16x32_bf16 a[56:59], v[248:251], v[68:71], a[56:59]
  buffer_load_dwordx4 v25, s[12:15], s54 offen offset:1024 sc1 lds
  v_and_b32 v157, 0xffff0000, v108
  v_mfma_f32_16x16x32_bf16 a[112:115], v[248:251], v[72:75], a[112:115]
  v_add_f32 v148, v148, v156
  v_mfma_f32_16x16x32_bf16 a[120:123], v[248:251], v[76:79], a[120:123]
  v_add_f32 v149, v149, v157
  v_fmac_f32 v152, v156, v156
  v_mfma_f32_16x16x32_bf16 a[176:179], v[248:251], v[80:83], a[176:179]
  ds_read_b128 v[60:63], v213 offset:47104
  v_fmac_f32 v153, v157, v157
  v_mfma_f32_16x16x32_bf16 a[184:187], v[248:251], v[84:87], a[184:187]
  buffer_load_dwordx4 v26, s[12:15], s54 offen offset:2048 sc1 lds
  v_lshlrev_b32 v158, 16, v109
  v_mfma_f32_16x16x32_bf16 a[240:243], v[248:251], v[88:91], a[240:243]
  v_and_b32 v159, 0xffff0000, v109
  v_add_f32 v150, v150, v158
  v_mfma_f32_16x16x32_bf16 a[248:251], v[248:251], v[92:95], a[248:251]
  ds_read_b64_tr_b16 v[248:249], v14 offset:32768
  v_mfma_f32_16x16x32_bf16 a[52:55], v[252:255], v[64:67], a[52:55]
  ds_read_b64_tr_b16 v[250:251], v14 offset:34816
  v_add_f32 v151, v151, v159
  v_mfma_f32_16x16x32_bf16 a[60:63], v[252:255], v[68:71], a[60:63]
  buffer_load_dwordx4 v27, s[12:15], s54 offen offset:3072 sc1 lds
  v_fmac_f32 v154, v158, v158
  v_mfma_f32_16x16x32_bf16 a[116:119], v[252:255], v[72:75], a[116:119]
  v_fmac_f32 v155, v159, v159
  v_lshlrev_b32 v160, 16, v110
  v_mfma_f32_16x16x32_bf16 a[124:127], v[252:255], v[76:79], a[124:127]
  v_and_b32 v161, 0xffff0000, v110
  v_mfma_f32_16x16x32_bf16 a[180:183], v[252:255], v[80:83], a[180:183]
  v_add_f32 v148, v148, v160
  v_add_f32 v149, v149, v161
  v_mfma_f32_16x16x32_bf16 a[188:191], v[252:255], v[84:87], a[188:191]
  v_fmac_f32 v152, v160, v160
  v_fmac_f32 v153, v161, v161
  v_mfma_f32_16x16x32_bf16 a[244:247], v[252:255], v[88:91], a[244:247]
  v_lshlrev_b32 v162, 16, v111
  v_and_b32 v163, 0xffff0000, v111
  v_mfma_f32_16x16x32_bf16 a[252:255], v[252:255], v[92:95], a[252:255]
  ds_read_b64_tr_b16 v[252:253], v15 offset:32768
  ds_read_b64_tr_b16 v[254:255], v15 offset:34816
  s_waitcnt lgkmcnt(15)
  s_waitcnt lgkmcnt(4)
  v_mfma_f32_16x16x32_bf16 a[0:3], v[224:227], v[32:35], a[0:3]
  v_add_f32 v150, v150, v162
  v_add_f32 v151, v151, v163
  v_mfma_f32_16x16x32_bf16 a[8:11], v[224:227], v[36:39], a[8:11]
  s_add_u32 m0, s56, 69632
  v_mfma_f32_16x16x32_bf16 a[64:67], v[224:227], v[40:43], a[64:67]
  buffer_load_dwordx4 v28, s[12:15], s54 offen offset:0 sc1 lds
  v_fmac_f32 v154, v162, v162
  v_mfma_f32_16x16x32_bf16 a[72:75], v[224:227], v[44:47], a[72:75]
  v_fmac_f32 v155, v163, v163
  v_lshlrev_b32 v156, 16, v112
  v_mfma_f32_16x16x32_bf16 a[128:131], v[224:227], v[48:51], a[128:131]
  v_and_b32 v157, 0xffff0000, v112
  v_add_f32 v148, v148, v156
  v_mfma_f32_16x16x32_bf16 a[136:139], v[224:227], v[52:55], a[136:139]
  buffer_load_dwordx4 v29, s[12:15], s54 offen offset:1024 sc1 lds
  v_mfma_f32_16x16x32_bf16 a[192:195], v[224:227], v[56:59], a[192:195]
  v_add_f32 v149, v149, v157
  v_fmac_f32 v152, v156, v156
  v_mfma_f32_16x16x32_bf16 a[200:203], v[224:227], v[60:63], a[200:203]
  ds_read_b64_tr_b16 v[224:225], v8 offset:49152
  v_mfma_f32_16x16x32_bf16 a[4:7], v[228:231], v[32:35], a[4:7]
  ds_read_b64_tr_b16 v[226:227], v8 offset:51200
  v_fmac_f32 v153, v157, v157
  v_mfma_f32_16x16x32_bf16 a[12:15], v[228:231], v[36:39], a[12:15]
  buffer_load_dwordx4 v30, s[12:15], s54 offen offset:2048 sc1 lds
  v_lshlrev_b32 v158, 16, v113
  v_mfma_f32_16x16x32_bf16 a[68:71], v[228:231], v[40:43], a[68:71]
  ds_read_b128 v[64:67], v213 offset:32768
  v_mfma_f32_16x16x32_bf16 a[76:79], v[228:231], v[44:47], a[76:79]
  v_and_b32 v159, 0xffff0000, v113
  v_add_f32 v150, v150, v158
  v_mfma_f32_16x16x32_bf16 a[132:135], v[228:231], v[48:51], a[132:135]
  buffer_load_dwordx4 v31, s[12:15], s54 offen offset:3072 sc1 lds
  s_add_u32 s54, s54, 0x80000
  v_mfma_f32_16x16x32_bf16 a[140:143], v[228:231], v[52:55], a[140:143]
  v_add_f32 v151, v151, v159
  v_fmac_f32 v154, v158, v158
  v_mfma_f32_16x16x32_bf16 a[196:199], v[228:231], v[56:59], a[196:199]
  v_fmac_f32 v155, v159, v159
  v_lshlrev_b32 v160, 16, v114
  v_mfma_f32_16x16x32_bf16 a[204:207], v[228:231], v[60:63], a[204:207]
  ds_read_b64_tr_b16 v[228:229], v9 offset:49152
  v_mfma_f32_16x16x32_bf16 a[16:19], v[232:235], v[32:35], a[16:19]
  ds_read_b64_tr_b16 v[230:231], v9 offset:51200
  v_mfma_f32_16x16x32_bf16 a[24:27], v[232:235], v[36:39], a[24:27]
  ds_read_b128 v[68:71], v212 offset:34816
  v_and_b32 v161, 0xffff0000, v114
  v_mfma_f32_16x16x32_bf16 a[80:83], v[232:235], v[40:43], a[80:83]
  v_add_f32 v148, v148, v160
  v_add_f32 v149, v149, v161
  v_mfma_f32_16x16x32_bf16 a[88:91], v[232:235], v[44:47], a[88:91]
  v_fmac_f32 v152, v160, v160
  v_fmac_f32 v153, v161, v161
  v_mfma_f32_16x16x32_bf16 a[144:147], v[232:235], v[48:51], a[144:147]
  v_lshlrev_b32 v162, 16, v115
  v_mfma_f32_16x16x32_bf16 a[152:155], v[232:235], v[52:55], a[152:155]
  v_and_b32 v163, 0xffff0000, v115
  v_add_f32 v150, v150, v162
  v_mfma_f32_16x16x32_bf16 a[208:211], v[232:235], v[56:59], a[208:211]
  ds_read_b128 v[72:75], v213 offset:36864
  v_add_f32 v151, v151, v163
  v_mfma_f32_16x16x32_bf16 a[216:219], v[232:235], v[60:63], a[216:219]
  ds_read_b64_tr_b16 v[232:233], v10 offset:49152
  v_mfma_f32_16x16x32_bf16 a[20:23], v[236:239], v[32:35], a[20:23]
  ds_read_b64_tr_b16 v[234:235], v10 offset:51200
  v_fmac_f32 v154, v162, v162
  v_mfma_f32_16x16x32_bf16 a[28:31], v[236:239], v[36:39], a[28:31]
  v_fmac_f32 v155, v163, v163
  v_mfma_f32_16x16x32_bf16 a[84:87], v[236:239], v[40:43], a[84:87]
  v_lshlrev_b32 v156, 16, v116
  v_and_b32 v157, 0xffff0000, v116
  v_mfma_f32_16x16x32_bf16 a[92:95], v[236:239], v[44:47], a[92:95]
  v_add_f32 v148, v148, v156
  v_add_f32 v149, v149, v157
  v_mfma_f32_16x16x32_bf16 a[148:151], v[236:239], v[48:51], a[148:151]
  ds_read_b128 v[76:79], v212 offset:38912
  v_fmac_f32 v152, v156, v156
  v_mfma_f32_16x16x32_bf16 a[156:159], v[236:239], v[52:55], a[156:159]
  v_fmac_f32 v153, v157, v157
  v_mfma_f32_16x16x32_bf16 a[212:215], v[236:239], v[56:59], a[212:215]
  v_lshlrev_b32 v158, 16, v117
  v_and_b32 v159, 0xffff0000, v117
  v_mfma_f32_16x16x32_bf16 a[220:223], v[236:239], v[60:63], a[220:223]
  ds_read_b64_tr_b16 v[236:237], v11 offset:49152
  v_mfma_f32_16x16x32_bf16 a[32:35], v[240:243], v[32:35], a[32:35]
  ds_read_b64_tr_b16 v[238:239], v11 offset:51200
  v_add_f32 v150, v150, v158
  v_mfma_f32_16x16x32_bf16 a[40:43], v[240:243], v[36:39], a[40:43]
  v_add_f32 v151, v151, v159
  v_fmac_f32 v154, v158, v158
  v_mfma_f32_16x16x32_bf16 a[96:99], v[240:243], v[40:43], a[96:99]
  ds_read_b128 v[80:83], v213 offset:40960
  v_mfma_f32_16x16x32_bf16 a[104:107], v[240:243], v[44:47], a[104:107]
  v_fmac_f32 v155, v159, v159
  v_lshlrev_b32 v160, 16, v118
  v_mfma_f32_16x16x32_bf16 a[160:163], v[240:243], v[48:51], a[160:163]
  buffer_load_dword v2, v3, s[8:11], s53 offen
  v_and_b32 v161, 0xffff0000, v118
  v_mfma_f32_16x16x32_bf16 a[168:171], v[240:243], v[52:55], a[168:171]
  v_add_f32 v148, v148, v160
  v_add_f32 v149, v149, v161
  v_mfma_f32_16x16x32_bf16 a[224:227], v[240:243], v[56:59], a[224:227]
  v_fmac_f32 v152, v160, v160
  v_mfma_f32_16x16x32_bf16 a[232:235], v[240:243], v[60:63], a[232:235]
  ds_read_b64_tr_b16 v[240:241], v12 offset:49152
  v_mfma_f32_16x16x32_bf16 a[36:39], v[244:247], v[32:35], a[36:39]
  ds_read_b64_tr_b16 v[242:243], v12 offset:51200
  v_fmac_f32 v153, v161, v161
  v_mfma_f32_16x16x32_bf16 a[44:47], v[244:247], v[36:39], a[44:47]
  ds_read_b128 v[84:87], v212 offset:43008
  v_lshlrev_b32 v162, 16, v119
  v_mfma_f32_16x16x32_bf16 a[100:103], v[244:247], v[40:43], a[100:103]
  v_and_b32 v163, 0xffff0000, v119
  v_add_f32 v150, v150, v162
  v_mfma_f32_16x16x32_bf16 a[108:111], v[244:247], v[44:47], a[108:111]
  v_add_f32 v151, v151, v163
  v_mfma_f32_16x16x32_bf16 a[164:167], v[244:247], v[48:51], a[164:167]
  buffer_load_dword v2, v4, s[12:15], s54 offen
  v_fmac_f32 v154, v162, v162
  v_mfma_f32_16x16x32_bf16 a[172:175], v[244:247], v[52:55], a[172:175]
  v_fmac_f32 v155, v163, v163
  v_lshlrev_b32 v156, 16, v120
  v_mfma_f32_16x16x32_bf16 a[228:231], v[244:247], v[56:59], a[228:231]
  ds_read_b128 v[88:91], v213 offset:45056
  v_and_b32 v157, 0xffff0000, v120
  v_mfma_f32_16x16x32_bf16 a[236:239], v[244:247], v[60:63], a[236:239]
  s_waitcnt lgkmcnt(15)
  ds_read_b64_tr_b16 v[244:245], v13 offset:49152
  v_mfma_f32_16x16x32_bf16 a[48:51], v[248:251], v[32:35], a[48:51]
  ds_read_b64_tr_b16 v[246:247], v13 offset:51200
  v_mfma_f32_16x16x32_bf16 a[56:59], v[248:251], v[36:39], a[56:59]
  v_add_f32 v148, v148, v156
  v_add_f32 v149, v149, v157
  v_mfma_f32_16x16x32_bf16 a[112:115], v[248:251], v[40:43], a[112:115]
  v_fmac_f32 v152, v156, v156
  v_fmac_f32 v153, v157, v157
  v_mfma_f32_16x16x32_bf16 a[120:123], v[248:251], v[44:47], a[120:123]
  v_lshlrev_b32 v158, 16, v121
  v_and_b32 v159, 0xffff0000, v121
  v_mfma_f32_16x16x32_bf16 a[176:179], v[248:251], v[48:51], a[176:179]
  ds_read_b128 v[92:95], v212 offset:47104
  v_mfma_f32_16x16x32_bf16 a[184:187], v[248:251], v[52:55], a[184:187]
  v_add_f32 v150, v150, v158
  v_add_f32 v151, v151, v159
  v_mfma_f32_16x16x32_bf16 a[240:243], v[248:251], v[56:59], a[240:243]
  v_fmac_f32 v154, v158, v158
  v_fmac_f32 v155, v159, v159
  v_mfma_f32_16x16x32_bf16 a[248:251], v[248:251], v[60:63], a[248:251]
  ds_read_b64_tr_b16 v[248:249], v14 offset:49152
  v_mfma_f32_16x16x32_bf16 a[52:55], v[252:255], v[32:35], a[52:55]
  ds_read_b64_tr_b16 v[250:251], v14 offset:51200
  v_lshlrev_b32 v160, 16, v122
  v_mfma_f32_16x16x32_bf16 a[60:63], v[252:255], v[36:39], a[60:63]
  v_and_b32 v161, 0xffff0000, v122
  v_mfma_f32_16x16x32_bf16 a[116:119], v[252:255], v[40:43], a[116:119]
  v_add_f32 v148, v148, v160
  v_add_f32 v149, v149, v161
  v_mfma_f32_16x16x32_bf16 a[124:127], v[252:255], v[44:47], a[124:127]
  v_fmac_f32 v152, v160, v160
  v_fmac_f32 v153, v161, v161
  v_mfma_f32_16x16x32_bf16 a[180:183], v[252:255], v[48:51], a[180:183]
  v_lshlrev_b32 v162, 16, v123
  v_and_b32 v163, 0xffff0000, v123
  v_mfma_f32_16x16x32_bf16 a[188:191], v[252:255], v[52:55], a[188:191]
  v_add_f32 v150, v150, v162
  v_mfma_f32_16x16x32_bf16 a[244:247], v[252:255], v[56:59], a[244:247]
  v_add_f32 v151, v151, v163
  v_fmac_f32 v154, v162, v162
  v_mfma_f32_16x16x32_bf16 a[252:255], v[252:255], v[60:63], a[252:255]
  ds_read_b64_tr_b16 v[252:253], v15 offset:49152
  ds_read_b64_tr_b16 v[254:255], v15 offset:51200
  s_waitcnt lgkmcnt(4)
  v_mfma_f32_16x16x32_bf16 a[0:3], v[224:227], v[64:67], a[0:3]
  v_fmac_f32 v155, v163, v163
  s_nop 3
  v_mfma_f32_16x16x32_bf16 a[8:11], v[224:227], v[68:71], a[8:11]
  v_add_f32 v148, v148, v149
  v_add_f32 v150, v150, v151
  v_mfma_f32_16x16x32_bf16 a[64:67], v[224:227], v[72:75], a[64:67]
  v_add_f32 v152, v152, v153
  v_add_f32 v154, v154, v155
  v_mfma_f32_16x16x32_bf16 a[72:75], v[224:227], v[76:79], a[72:75]
  v_add_f32 v148, v148, v150
  v_add_f32 v152, v152, v154
  v_mfma_f32_16x16x32_bf16 a[128:131], v[224:227], v[80:83], a[128:131]
  s_nop 1
  v_add_f32_dpp v148, v148, v148 quad_perm:[1,0,3,2] row_mask:0xf bank_mask:0xf
  v_mfma_f32_16x16x32_bf16 a[136:139], v[224:227], v[84:87], a[136:139]
  v_add_f32_dpp v152, v152, v152 quad_perm:[1,0,3,2] row_mask:0xf bank_mask:0xf
  s_nop 1
  v_mfma_f32_16x16x32_bf16 a[192:195], v[224:227], v[88:91], a[192:195]
  v_add_f32_dpp v148, v148, v148 quad_perm:[2,3,0,1] row_mask:0xf bank_mask:0xf
  v_mfma_f32_16x16x32_bf16 a[200:203], v[224:227], v[92:95], a[200:203]
  s_waitcnt vmcnt(2)
  s_waitcnt lgkmcnt(0)
  s_barrier
  ds_read_b64_tr_b16 v[224:225], v8 offset:0
  v_mfma_f32_16x16x32_bf16 a[4:7], v[228:231], v[64:67], a[4:7]
  ds_read_b64_tr_b16 v[226:227], v8 offset:2048
  v_add_f32_dpp v152, v152, v152 quad_perm:[2,3,0,1] row_mask:0xf bank_mask:0xf
  v_mfma_f32_16x16x32_bf16 a[12:15], v[228:231], v[68:71], a[12:15]
  s_nop 1
  v_add_f32_dpp v148, v148, v148 row_half_mirror row_mask:0xf bank_mask:0xf
  v_mfma_f32_16x16x32_bf16 a[68:71], v[228:231], v[72:75], a[68:71]
  ds_read_b128 v[32:35], v212 offset:0
  s_add_u32 m0, s56, 32768
  v_mfma_f32_16x16x32_bf16 a[76:79], v[228:231], v[76:79], a[76:79]
  buffer_load_dwordx4 v16, s[8:11], s53 offen offset:0 sc1 lds
  v_add_f32_dpp v152, v152, v152 row_half_mirror row_mask:0xf bank_mask:0xf
  v_mfma_f32_16x16x32_bf16 a[132:135], v[228:231], v[80:83], a[132:135]
  v_mul_f32 v148, 0x3b124925, v148
  v_mul_f32 v152, 0x3b124925, v152
  v_mfma_f32_16x16x32_bf16 a[140:143], v[228:231], v[84:87], a[140:143]
  v_fma_f32 v152, -v148, v148, v152
  v_max_f32 v152, 0, v152
  v_mfma_f32_16x16x32_bf16 a[196:199], v[228:231], v[88:91], a[196:199]
  v_add_f32 v152, 0x3727c5ac, v152
  v_mfma_f32_16x16x32_bf16 a[204:207], v[228:231], v[92:95], a[204:207]
  ds_read_b64_tr_b16 v[228:229], v9 offset:0
  v_mfma_f32_16x16x32_bf16 a[16:19], v[232:235], v[64:67], a[16:19]
  buffer_load_dwordx4 v17, s[8:11], s53 offen offset:1024 sc1 lds
  v_rsq_f32 v152, v152
  v_mfma_f32_16x16x32_bf16 a[24:27], v[232:235], v[68:71], a[24:27]
  ds_read_b64_tr_b16 v[230:231], v9 offset:2048
  v_mul_f32 v152, 0x3db8aa3b, v152
  v_mfma_f32_16x16x32_bf16 a[80:83], v[232:235], v[72:75], a[80:83]
  ds_read_b128 v[36:39], v213 offset:2048
  v_mul_f32 v148, v148, v152
  v_mfma_f32_16x16x32_bf16 a[88:91], v[232:235], v[76:79], a[88:91]
  buffer_load_dwordx4 v18, s[8:11], s53 offen offset:2048 sc1 lds
  v_mov_b32 v153, v152
  v_mfma_f32_16x16x32_bf16 a[144:147], v[232:235], v[80:83], a[144:147]
  v_sub_f32 v148, 0, v148
  v_mov_b32 v149, v148
  v_mfma_f32_16x16x32_bf16 a[152:155], v[232:235], v[84:87], a[152:155]
  v_lshlrev_b32 v164, 16, v124
  v_and_b32 v165, 0xffff0000, v124
  v_mfma_f32_16x16x32_bf16 a[208:211], v[232:235], v[88:91], a[208:211]
  ds_read_b128 v[40:43], v212 offset:4096
  v_mfma_f32_16x16x32_bf16 a[216:219], v[232:235], v[92:95], a[216:219]
  ds_read_b64_tr_b16 v[232:233], v10 offset:0
  v_mfma_f32_16x16x32_bf16 a[20:23], v[236:239], v[64:67], a[20:23]
  buffer_load_dwordx4 v19, s[8:11], s53 offen offset:3072 sc1 lds
  v_fma_f32 v164, v164, v152, v148
  v_mfma_f32_16x16x32_bf16 a[28:31], v[236:239], v[68:71], a[28:31]
  ds_read_b64_tr_b16 v[234:235], v10 offset:2048
  v_fma_f32 v165, v165, v152, v148
  v_mfma_f32_16x16x32_bf16 a[84:87], v[236:239], v[72:75], a[84:87]
  v_cvt_pk_bf16_f32 v124, v164, v165
  v_lshlrev_b32 v166, 16, v125
  v_mfma_f32_16x16x32_bf16 a[92:95], v[236:239], v[76:79], a[92:95]
  s_add_u32 m0, s56, 36864
  v_and_b32 v167, 0xffff0000, v125
  v_mfma_f32_16x16x32_bf16 a[148:151], v[236:239], v[80:83], a[148:151]
  ds_read_b128 v[44:47], v213 offset:6144
  v_fma_f32 v166, v166, v152, v148
  v_mfma_f32_16x16x32_bf16 a[156:159], v[236:239], v[84:87], a[156:159]
  buffer_load_dwordx4 v20, s[8:11], s53 offen offset:0 sc1 lds
  v_fma_f32 v167, v167, v152, v148
  v_mfma_f32_16x16x32_bf16 a[212:215], v[236:239], v[88:91], a[212:215]
  v_cvt_pk_bf16_f32 v125, v166, v167
  v_lshlrev_b32 v168, 16, v126
  v_mfma_f32_16x16x32_bf16 a[220:223], v[236:239], v[92:95], a[220:223]
  ds_read_b64_tr_b16 v[236:237], v11 offset:0
  v_mfma_f32_16x16x32_bf16 a[32:35], v[240:243], v[64:67], a[32:35]
  ds_read_b64_tr_b16 v[238:239], v11 offset:2048
  v_and_b32 v169, 0xffff0000, v126
  v_mfma_f32_16x16x32_bf16 a[40:43], v[240:243], v[68:71], a[40:43]
  buffer_load_dwordx4 v21, s[8:11], s53 offen offset:1024 sc1 lds
  v_fma_f32 v168, v168, v152, v148
  v_mfma_f32_16x16x32_bf16 a[96:99], v[240:243], v[72:75], a[96:99]
  ds_read_b128 v[48:51], v212 offset:8192
  v_fma_f32 v169, v169, v152, v148
  v_mfma_f32_16x16x32_bf16 a[104:107], v[240:243], v[76:79], a[104:107]
  v_cvt_pk_bf16_f32 v126, v168, v169
  v_lshlrev_b32 v170, 16, v127
  v_mfma_f32_16x16x32_bf16 a[160:163], v[240:243], v[80:83], a[160:163]
  buffer_load_dwordx4 v22, s[8:11], s53 offen offset:2048 sc1 lds
  v_mfma_f32_16x16x32_bf16 a[168:171], v[240:243], v[84:87], a[168:171]
  v_and_b32 v171, 0xffff0000, v127
  v_fma_f32 v170, v170, v152, v148
  v_mfma_f32_16x16x32_bf16 a[224:227], v[240:243], v[88:91], a[224:227]
  v_fma_f32 v171, v171, v152, v148
  v_cvt_pk_bf16_f32 v127, v170, v171
  v_mfma_f32_16x16x32_bf16 a[232:235], v[240:243], v[92:95], a[232:235]
  ds_read_b64_tr_b16 v[240:241], v12 offset:0
  v_mfma_f32_16x16x32_bf16 a[36:39], v[244:247], v[64:67], a[36:39]
  ds_read_b64_tr_b16 v[242:243], v12 offset:2048
  v_lshlrev_b32 v156, 16, v128
  v_mfma_f32_16x16x32_bf16 a[44:47], v[244:247], v[68:71], a[44:47]
  ds_read_b128 v[52:55], v213 offset:10240
  v_and_b32 v157, 0xffff0000, v128
  v_mfma_f32_16x16x32_bf16 a[100:103], v[244:247], v[72:75], a[100:103]
  buffer_load_dwordx4 v23, s[8:11], s53 offen offset:3072 sc1 lds
  s_add_u32 s53, s53, 128
  v_mfma_f32_16x16x32_bf16 a[108:111], v[244:247], v[76:79], a[108:111]
  v_fma_f32 v156, v156, v152, v148
  v_fma_f32 v157, v157, v152, v148
  v_mfma_f32_16x16x32_bf16 a[164:167], v[244:247], v[80:83], a[164:167]
  s_add_u32 m0, s56, 98304
  v_cvt_pk_bf16_f32 v128, v156, v157
  v_mfma_f32_16x16x32_bf16 a[172:175], v[244:247], v[84:87], a[172:175]
  buffer_load_dwordx4 v24, s[12:15], s54 offen offset:0 sc1 lds
  v_lshlrev_b32 v158, 16, v129
  v_mfma_f32_16x16x32_bf16 a[228:231], v[244:247], v[88:91], a[228:231]
  ds_read_b128 v[56:59], v212 offset:12288
  v_and_b32 v159, 0xffff0000, v129
  v_mfma_f32_16x16x32_bf16 a[236:239], v[244:247], v[92:95], a[236:239]
  ds_read_b64_tr_b16 v[244:245], v13 offset:0
  v_mfma_f32_16x16x32_bf16 a[48:51], v[248:251], v[64:67], a[48:51]
  ds_read_b64_tr_b16 v[246:247], v13 offset:2048
  v_fma_f32 v158, v158, v152, v148
  v_mfma_f32_16x16x32_bf16 a[56:59], v[248:251], v[68:71], a[56:59]
  buffer_load_dwordx4 v25, s[12:15], s54 offen offset:1024 sc1 lds
  v_fma_f32 v159, v159, v152, v148
  v_mfma_f32_16x16x32_bf16 a[112:115], v[248:251], v[72:75], a[112:115]
  v_cvt_pk_bf16_f32 v129, v158, v159
  v_lshlrev_b32 v160, 16, v130
  v_mfma_f32_16x16x32_bf16 a[120:123], v[248:251], v[76:79], a[120:123]
  v_and_b32 v161, 0xffff0000, v130
  v_fma_f32 v160, v160, v152, v148
  v_mfma_f32_16x16x32_bf16 a[176:179], v[248:251], v[80:83], a[176:179]
  ds_read_b128 v[60:63], v213 offset:14336
  v_mfma_f32_16x16x32_bf16 a[184:187], v[248:251], v[84:87], a[184:187]
  buffer_load_dwordx4 v26, s[12:15], s54 offen offset:2048 sc1 lds
  v_fma_f32 v161, v161, v152, v148
  v_mfma_f32_16x16x32_bf16 a[240:243], v[248:251], v[88:91], a[240:243]
  v_cvt_pk_bf16_f32 v130, v160, v161
  v_lshlrev_b32 v162, 16, v131
  v_mfma_f32_16x16x32_bf16 a[248:251], v[248:251], v[92:95], a[248:251]
  ds_read_b64_tr_b16 v[248:249], v14 offset:0
  v_mfma_f32_16x16x32_bf16 a[52:55], v[252:255], v[64:67], a[52:55]
  ds_read_b64_tr_b16 v[250:251], v14 offset:2048
  v_and_b32 v163, 0xffff0000, v131
  v_mfma_f32_16x16x32_bf16 a[60:63], v[252:255], v[68:71], a[60:63]
  buffer_load_dwordx4 v27, s[12:15], s54 offen offset:3072 sc1 lds
  v_fma_f32 v162, v162, v152, v148
  v_mfma_f32_16x16x32_bf16 a[116:119], v[252:255], v[72:75], a[116:119]
  v_fma_f32 v163, v163, v152, v148
  v_cvt_pk_bf16_f32 v131, v162, v163
  v_mfma_f32_16x16x32_bf16 a[124:127], v[252:255], v[76:79], a[124:127]
  buffer_store_dwordx4 v[124:127], v133, s[16:19], s63 offen sc1
  buffer_store_dwordx4 v[128:131], v133, s[16:19], s61 offen sc1
  v_mfma_f32_16x16x32_bf16 a[180:183], v[252:255], v[80:83], a[180:183]
  v_mfma_f32_16x16x32_bf16 a[188:191], v[252:255], v[84:87], a[188:191]
  v_mfma_f32_16x16x32_bf16 a[244:247], v[252:255], v[88:91], a[244:247]
  v_mfma_f32_16x16x32_bf16 a[252:255], v[252:255], v[92:95], a[252:255]
  ds_read_b64_tr_b16 v[252:253], v15 offset:0
  ds_read_b64_tr_b16 v[254:255], v15 offset:2048
  s_branch M_HOOK
M_LOOP_K:
  s_waitcnt lgkmcnt(15)
  s_waitcnt lgkmcnt(4)
  v_mfma_f32_16x16x32_bf16 a[0:3], v[224:227], v[32:35], a[0:3]
  v_mfma_f32_16x16x32_bf16 a[8:11], v[224:227], v[36:39], a[8:11]
  s_add_u32 m0, s56, 102400
  v_mfma_f32_16x16x32_bf16 a[64:67], v[224:227], v[40:43], a[64:67]
  buffer_load_dwordx4 v28, s[12:15], s54 offen offset:0 sc1 lds
  v_mfma_f32_16x16x32_bf16 a[72:75], v[224:227], v[44:47], a[72:75]
  v_mfma_f32_16x16x32_bf16 a[128:131], v[224:227], v[48:51], a[128:131]
  v_mfma_f32_16x16x32_bf16 a[136:139], v[224:227], v[52:55], a[136:139]
  buffer_load_dwordx4 v29, s[12:15], s54 offen offset:1024 sc1 lds
  v_mfma_f32_16x16x32_bf16 a[192:195], v[224:227], v[56:59], a[192:195]
  v_mfma_f32_16x16x32_bf16 a[200:203], v[224:227], v[60:63], a[200:203]
  ds_read_b64_tr_b16 v[224:225], v8 offset:16384
  v_mfma_f32_16x16x32_bf16 a[4:7], v[228:231], v[32:35], a[4:7]
  ds_read_b64_tr_b16 v[226:227], v8 offset:18432
  v_mfma_f32_16x16x32_bf16 a[12:15], v[228:231], v[36:39], a[12:15]
  buffer_load_dwordx4 v30, s[12:15], s54 offen offset:2048 sc1 lds
  v_mfma_f32_16x16x32_bf16 a[68:71], v[228:231], v[40:43], a[68:71]
  ds_read_b128 v[64:67], v213 offset:0
  v_mfma_f32_16x16x32_bf16 a[76:79], v[228:231], v[44:47], a[76:79]
  v_mfma_f32_16x16x32_bf16 a[132:135], v[228:231], v[48:51], a[132:135]
  buffer_load_dwordx4 v31, s[12:15], s54 offen offset:3072 sc1 lds
  s_add_u32 s54, s54, 0x80000
  v_mfma_f32_16x16x32_bf16 a[140:143], v[228:231], v[52:55], a[140:143]
  v_mfma_f32_16x16x32_bf16 a[196:199], v[228:231], v[56:59], a[196:199]
  v_mfma_f32_16x16x32_bf16 a[204:207], v[228:231], v[60:63], a[204:207]
  ds_read_b64_tr_b16 v[228:229], v9 offset:16384
  v_mfma_f32_16x16x32_bf16 a[16:19], v[232:235], v[32:35], a[16:19]
  ds_read_b64_tr_b16 v[230:231], v9 offset:18432
  v_mfma_f32_16x16x32_bf16 a[24:27], v[232:235], v[36:39], a[24:27]
  ds_read_b128 v[68:71], v212 offset:2048
  v_mfma_f32_16x16x32_bf16 a[80:83], v[232:235], v[40:43], a[80:83]
  v_mfma_f32_16x16x32_bf16 a[88:91], v[232:235], v[44:47], a[88:91]
  v_mfma_f32_16x16x32_bf16 a[144:147], v[232:235], v[48:51], a[144:147]
  v_mfma_f32_16x16x32_bf16 a[152:155], v[232:235], v[52:55], a[152:155]
  v_mfma_f32_16x16x32_bf16 a[208:211], v[232:235], v[56:59], a[208:211]
  ds_read_b128 v[72:75], v213 offset:4096
  v_mfma_f32_16x16x32_bf16 a[216:219], v[232:235], v[60:63], a[216:219]
  ds_read_b64_tr_b16 v[232:233], v10 offset:16384
  v_mfma_f32_16x16x32_bf16 a[20:23], v[236:239], v[32:35], a[20:23]
  ds_read_b64_tr_b16 v[234:235], v10 offset:18432
  v_mfma_f32_16x16x32_bf16 a[28:31], v[236:239], v[36:39], a[28:31]
  v_mfma_f32_16x16x32_bf16 a[84:87], v[236:239], v[40:43], a[84:87]
  v_mfma_f32_16x16x32_bf16 a[92:95], v[236:239], v[44:47], a[92:95]
  v_mfma_f32_16x16x32_bf16 a[148:151], v[236:239], v[48:51], a[148:151]
  ds_read_b128 v[76:79], v212 offset:6144
  v_mfma_f32_16x16x32_bf16 a[156:159], v[236:239], v[52:55], a[156:159]
  v_mfma_f32_16x16x32_bf16 a[212:215], v[236:239], v[56:59], a[212:215]
  v_mfma_f32_16x16x32_bf16 a[220:223], v[236:239], v[60:63], a[220:223]
  ds_read_b64_tr_b16 v[236:237], v11 offset:16384
  v_mfma_f32_16x16x32_bf16 a[32:35], v[240:243], v[32:35], a[32:35]
  ds_read_b64_tr_b16 v[238:239], v11 offset:18432
  v_mfma_f32_16x16x32_bf16 a[40:43], v[240:243], v[36:39], a[40:43]
  v_mfma_f32_16x16x32_bf16 a[96:99], v[240:243], v[40:43], a[96:99]
  ds_read_b128 v[80:83], v213 offset:8192
  v_mfma_f32_16x16x32_bf16 a[104:107], v[240:243], v[44:47], a[104:107]
  v_mfma_f32_16x16x32_bf16 a[160:163], v[240:243], v[48:51], a[160:163]
  buffer_load_dword v2, v3, s[8:11], s53 offen
  v_mfma_f32_16x16x32_bf16 a[168:171], v[240:243], v[52:55], a[168:171]
  v_mfma_f32_16x16x32_bf16 a[224:227], v[240:243], v[56:59], a[224:227]
  v_mfma_f32_16x16x32_bf16 a[232:235], v[240:243], v[60:63], a[232:235]
  ds_read_b64_tr_b16 v[240:241], v12 offset:16384
  v_mfma_f32_16x16x32_bf16 a[36:39], v[244:247], v[32:35], a[36:39]
  ds_read_b64_tr_b16 v[242:243], v12 offset:18432
  v_mfma_f32_16x16x32_bf16 a[44:47], v[244:247], v[36:39], a[44:47]
  ds_read_b128 v[84:87], v212 offset:10240
  v_mfma_f32_16x16x32_bf16 a[100:103], v[244:247], v[40:43], a[100:103]
  v_mfma_f32_16x16x32_bf16 a[108:111], v[244:247], v[44:47], a[108:111]
  v_mfma_f32_16x16x32_bf16 a[164:167], v[244:247], v[48:51], a[164:167]
  buffer_load_dword v2, v4, s[12:15], s54 offen
  v_mfma_f32_16x16x32_bf16 a[172:175], v[244:247], v[52:55], a[172:175]
  v_mfma_f32_16x16x32_bf16 a[228:231], v[244:247], v[56:59], a[228:231]
  ds_read_b128 v[88:91], v213 offset:12288
  v_mfma_f32_16x16x32_bf16 a[236:239], v[244:247], v[60:63], a[236:239]
  s_waitcnt lgkmcnt(15)
  ds_read_b64_tr_b16 v[244:245], v13 offset:16384
  v_mfma_f32_16x16x32_bf16 a[48:51], v[248:251], v[32:35], a[48:51]
  ds_read_b64_tr_b16 v[246:247], v13 offset:18432
  v_mfma_f32_16x16x32_bf16 a[56:59], v[248:251], v[36:39], a[56:59]
  v_mfma_f32_16x16x32_bf16 a[112:115], v[248:251], v[40:43], a[112:115]
  v_mfma_f32_16x16x32_bf16 a[120:123], v[248:251], v[44:47], a[120:123]
  s_mov_b64 exec, s[72:73]
  global_load_dword v2, v[142:143], off
  global_load_dword v2, v[176:177], off
  s_mov_b64 exec, -1
  v_mfma_f32_16x16x32_bf16 a[176:179], v[248:251], v[48:51], a[176:179]
  ds_read_b128 v[92:95], v212 offset:14336
  v_mfma_f32_16x16x32_bf16 a[184:187], v[248:251], v[52:55], a[184:187]
  v_mfma_f32_16x16x32_bf16 a[240:243], v[248:251], v[56:59], a[240:243]
  s_lshl_b64 s[72:73], s[72:73], 8
  s_or_b32 s72, s72, 1
  v_mfma_f32_16x16x32_bf16 a[248:251], v[248:251], v[60:63], a[248:251]
  ds_read_b64_tr_b16 v[248:249], v14 offset:16384
  v_mfma_f32_16x16x32_bf16 a[52:55], v[252:255], v[32:35], a[52:55]
  ds_read_b64_tr_b16 v[250:251], v14 offset:18432
  v_mfma_f32_16x16x32_bf16 a[60:63], v[252:255], v[36:39], a[60:63]
  v_mfma_f32_16x16x32_bf16 a[116:119], v[252:255], v[40:43], a[116:119]
  v_mfma_f32_16x16x32_bf16 a[124:127], v[252:255], v[44:47], a[124:127]
  v_mfma_f32_16x16x32_bf16 a[180:183], v[252:255], v[48:51], a[180:183]
  v_mfma_f32_16x16x32_bf16 a[188:191], v[252:255], v[52:55], a[188:191]
  v_mfma_f32_16x16x32_bf16 a[244:247], v[252:255], v[56:59], a[244:247]
  v_mfma_f32_16x16x32_bf16 a[252:255], v[252:255], v[60:63], a[252:255]
  ds_read_b64_tr_b16 v[252:253], v15 offset:16384
  ds_read_b64_tr_b16 v[254:255], v15 offset:18432
  s_waitcnt lgkmcnt(4)
  v_mfma_f32_16x16x32_bf16 a[0:3], v[224:227], v[64:67], a[0:3]
  v_mfma_f32_16x16x32_bf16 a[8:11], v[224:227], v[68:71], a[8:11]
  v_mfma_f32_16x16x32_bf16 a[64:67], v[224:227], v[72:75], a[64:67]
  v_mfma_f32_16x16x32_bf16 a[72:75], v[224:227], v[76:79], a[72:75]
  v_mfma_f32_16x16x32_bf16 a[128:131], v[224:227], v[80:83], a[128:131]
  v_mfma_f32_16x16x32_bf16 a[136:139], v[224:227], v[84:87], a[136:139]
  v_mfma_f32_16x16x32_bf16 a[192:195], v[224:227], v[88:91], a[192:195]
  v_mfma_f32_16x16x32_bf16 a[200:203], v[224:227], v[92:95], a[200:203]
  s_waitcnt vmcnt(4) lgkmcnt(0)
  s_barrier
  ds_read_b64_tr_b16 v[224:225], v8 offset:32768
  v_mfma_f32_16x16x32_bf16 a[4:7], v[228:231], v[64:67], a[4:7]
  ds_read_b64_tr_b16 v[226:227], v8 offset:34816
  v_mfma_f32_16x16x32_bf16 a[12:15], v[228:231], v[68:71], a[12:15]
  v_mfma_f32_16x16x32_bf16 a[68:71], v[228:231], v[72:75], a[68:71]
  ds_read_b128 v[32:35], v212 offset:32768
  s_add_u32 m0, s56, 0
  v_mfma_f32_16x16x32_bf16 a[76:79], v[228:231], v[76:79], a[76:79]
  buffer_load_dwordx4 v16, s[8:11], s53 offen offset:0 sc1 lds
  v_mfma_f32_16x16x32_bf16 a[132:135], v[228:231], v[80:83], a[132:135]
  v_mfma_f32_16x16x32_bf16 a[140:143], v[228:231], v[84:87], a[140:143]
  v_mfma_f32_16x16x32_bf16 a[196:199], v[228:231], v[88:91], a[196:199]
  v_mfma_f32_16x16x32_bf16 a[204:207], v[228:231], v[92:95], a[204:207]
  ds_read_b64_tr_b16 v[228:229], v9 offset:32768
  v_mfma_f32_16x16x32_bf16 a[16:19], v[232:235], v[64:67], a[16:19]
  buffer_load_dwordx4 v17, s[8:11], s53 offen offset:1024 sc1 lds
  v_mfma_f32_16x16x32_bf16 a[24:27], v[232:235], v[68:71], a[24:27]
  ds_read_b64_tr_b16 v[230:231], v9 offset:34816
  v_mfma_f32_16x16x32_bf16 a[80:83], v[232:235], v[72:75], a[80:83]
  ds_read_b128 v[36:39], v213 offset:34816
  v_mfma_f32_16x16x32_bf16 a[88:91], v[232:235], v[76:79], a[88:91]
  buffer_load_dwordx4 v18, s[8:11], s53 offen offset:2048 sc1 lds
  v_mfma_f32_16x16x32_bf16 a[144:147], v[232:235], v[80:83], a[144:147]
  v_mfma_f32_16x16x32_bf16 a[152:155], v[232:235], v[84:87], a[152:155]
  v_mfma_f32_16x16x32_bf16 a[208:211], v[232:235], v[88:91], a[208:211]
  ds_read_b128 v[40:43], v212 offset:36864
  v_mfma_f32_16x16x32_bf16 a[216:219], v[232:235], v[92:95], a[216:219]
  ds_read_b64_tr_b16 v[232:233], v10 offset:32768
  v_mfma_f32_16x16x32_bf16 a[20:23], v[236:239], v[64:67], a[20:23]
  buffer_load_dwordx4 v19, s[8:11], s53 offen offset:3072 sc1 lds
  v_mfma_f32_16x16x32_bf16 a[28:31], v[236:239], v[68:71], a[28:31]
  ds_read_b64_tr_b16 v[234:235], v10 offset:34816
  v_mfma_f32_16x16x32_bf16 a[84:87], v[236:239], v[72:75], a[84:87]
  v_mfma_f32_16x16x32_bf16 a[92:95], v[236:239], v[76:79], a[92:95]
  s_add_u32 m0, s56, 4096
  v_mfma_f32_16x16x32_bf16 a[148:151], v[236:239], v[80:83], a[148:151]
  ds_read_b128 v[44:47], v213 offset:38912
  v_mfma_f32_16x16x32_bf16 a[156:159], v[236:239], v[84:87], a[156:159]
  buffer_load_dwordx4 v20, s[8:11], s53 offen offset:0 sc1 lds
  v_mfma_f32_16x16x32_bf16 a[212:215], v[236:239], v[88:91], a[212:215]
  v_mfma_f32_16x16x32_bf16 a[220:223], v[236:239], v[92:95], a[220:223]
  ds_read_b64_tr_b16 v[236:237], v11 offset:32768
  v_mfma_f32_16x16x32_bf16 a[32:35], v[240:243], v[64:67], a[32:35]
  ds_read_b64_tr_b16 v[238:239], v11 offset:34816
  v_mfma_f32_16x16x32_bf16 a[40:43], v[240:243], v[68:71], a[40:43]
  buffer_load_dwordx4 v21, s[8:11], s53 offen offset:1024 sc1 lds
  v_mfma_f32_16x16x32_bf16 a[96:99], v[240:243], v[72:75], a[96:99]
  ds_read_b128 v[48:51], v212 offset:40960
  v_mfma_f32_16x16x32_bf16 a[104:107], v[240:243], v[76:79], a[104:107]
  v_mfma_f32_16x16x32_bf16 a[160:163], v[240:243], v[80:83], a[160:163]
  buffer_load_dwordx4 v22, s[8:11], s53 offen offset:2048 sc1 lds
  v_mfma_f32_16x16x32_bf16 a[168:171], v[240:243], v[84:87], a[168:171]
  v_mfma_f32_16x16x32_bf16 a[224:227], v[240:243], v[88:91], a[224:227]
  v_mfma_f32_16x16x32_bf16 a[232:235], v[240:243], v[92:95], a[232:235]
  ds_read_b64_tr_b16 v[240:241], v12 offset:32768
  v_mfma_f32_16x16x32_bf16 a[36:39], v[244:247], v[64:67], a[36:39]
  ds_read_b64_tr_b16 v[242:243], v12 offset:34816
  v_mfma_f32_16x16x32_bf16 a[44:47], v[244:247], v[68:71], a[44:47]
  ds_read_b128 v[52:55], v213 offset:43008
  v_mfma_f32_16x16x32_bf16 a[100:103], v[244:247], v[72:75], a[100:103]
  buffer_load_dwordx4 v23, s[8:11], s53 offen offset:3072 sc1 lds
  s_add_u32 s53, s53, 128
  v_mfma_f32_16x16x32_bf16 a[108:111], v[244:247], v[76:79], a[108:111]
  v_mfma_f32_16x16x32_bf16 a[164:167], v[244:247], v[80:83], a[164:167]
  s_add_u32 m0, s56, 65536
  v_mfma_f32_16x16x32_bf16 a[172:175], v[244:247], v[84:87], a[172:175]
  buffer_load_dwordx4 v24, s[12:15], s54 offen offset:0 sc1 lds
  v_mfma_f32_16x16x32_bf16 a[228:231], v[244:247], v[88:91], a[228:231]
  ds_read_b128 v[56:59], v212 offset:45056
  v_mfma_f32_16x16x32_bf16 a[236:239], v[244:247], v[92:95], a[236:239]
  ds_read_b64_tr_b16 v[244:245], v13 offset:32768
  v_mfma_f32_16x16x32_bf16 a[48:51], v[248:251], v[64:67], a[48:51]
  ds_read_b64_tr_b16 v[246:247], v13 offset:34816
  v_mfma_f32_16x16x32_bf16 a[56:59], v[248:251], v[68:71], a[56:59]
  buffer_load_dwordx4 v25, s[12:15], s54 offen offset:1024 sc1 lds
  v_mfma_f32_16x16x32_bf16 a[112:115], v[248:251], v[72:75], a[112:115]
  v_mfma_f32_16x16x32_bf16 a[120:123], v[248:251], v[76:79], a[120:123]
  v_mfma_f32_16x16x32_bf16 a[176:179], v[248:251], v[80:83], a[176:179]
  ds_read_b128 v[60:63], v213 offset:47104
  v_mfma_f32_16x16x32_bf16 a[184:187], v[248:251], v[84:87], a[184:187]
  buffer_load_dwordx4 v26, s[12:15], s54 offen offset:2048 sc1 lds
  v_mfma_f32_16x16x32_bf16 a[240:243], v[248:251], v[88:91], a[240:243]
  v_mfma_f32_16x16x32_bf16 a[248:251], v[248:251], v[92:95], a[248:251]
  ds_read_b64_tr_b16 v[248:249], v14 offset:32768
  v_mfma_f32_16x16x32_bf16 a[52:55], v[252:255], v[64:67], a[52:55]
  ds_read_b64_tr_b16 v[250:251], v14 offset:34816
  v_mfma_f32_16x16x32_bf16 a[60:63], v[252:255], v[68:71], a[60:63]
  buffer_load_dwordx4 v27, s[12:15], s54 offen offset:3072 sc1 lds
  v_mfma_f32_16x16x32_bf16 a[116:119], v[252:255], v[72:75], a[116:119]
  v_mfma_f32_16x16x32_bf16 a[124:127], v[252:255], v[76:79], a[124:127]
  v_mfma_f32_16x16x32_bf16 a[180:183], v[252:255], v[80:83], a[180:183]
  v_mfma_f32_16x16x32_bf16 a[188:191], v[252:255], v[84:87], a[188:191]
  v_mfma_f32_16x16x32_bf16 a[244:247], v[252:255], v[88:91], a[244:247]
  v_mfma_f32_16x16x32_bf16 a[252:255], v[252:255], v[92:95], a[252:255]
  ds_read_b64_tr_b16 v[252:253], v15 offset:32768
  ds_read_b64_tr_b16 v[254:255], v15 offset:34816
  s_waitcnt lgkmcnt(15)
  s_waitcnt lgkmcnt(4)
  v_mfma_f32_16x16x32_bf16 a[0:3], v[224:227], v[32:35], a[0:3]
  v_mfma_f32_16x16x32_bf16 a[8:11], v[224:227], v[36:39], a[8:11]
  s_add_u32 m0, s56, 69632
  v_mfma_f32_16x16x32_bf16 a[64:67], v[224:227], v[40:43], a[64:67]
  buffer_load_dwordx4 v28, s[12:15], s54 offen offset:0 sc1 lds
  v_mfma_f32_16x16x32_bf16 a[72:75], v[224:227], v[44:47], a[72:75]
  v_mfma_f32_16x16x32_bf16 a[128:131], v[224:227], v[48:51], a[128:131]
  v_mfma_f32_16x16x32_bf16 a[136:139], v[224:227], v[52:55], a[136:139]
  buffer_load_dwordx4 v29, s[12:15], s54 offen offset:1024 sc1 lds
  v_mfma_f32_16x16x32_bf16 a[192:195], v[224:227], v[56:59], a[192:195]
  v_mfma_f32_16x16x32_bf16 a[200:203], v[224:227], v[60:63], a[200:203]
  ds_read_b64_tr_b16 v[224:225], v8 offset:49152
  v_mfma_f32_16x16x32_bf16 a[4:7], v[228:231], v[32:35], a[4:7]
  ds_read_b64_tr_b16 v[226:227], v8 offset:51200
  v_mfma_f32_16x16x32_bf16 a[12:15], v[228:231], v[36:39], a[12:15]
  buffer_load_dwordx4 v30, s[12:15], s54 offen offset:2048 sc1 lds
  v_mfma_f32_16x16x32_bf16 a[68:71], v[228:231], v[40:43], a[68:71]
  ds_read_b128 v[64:67], v213 offset:32768
  v_mfma_f32_16x16x32_bf16 a[76:79], v[228:231], v[44:47], a[76:79]
  v_mfma_f32_16x16x32_bf16 a[132:135], v[228:231], v[48:51], a[132:135]
  buffer_load_dwordx4 v31, s[12:15], s54 offen offset:3072 sc1 lds
  s_add_u32 s54, s54, 0x80000
  v_mfma_f32_16x16x32_bf16 a[140:143], v[228:231], v[52:55], a[140:143]
  v_mfma_f32_16x16x32_bf16 a[196:199], v[228:231], v[56:59], a[196:199]
  v_mfma_f32_16x16x32_bf16 a[204:207], v[228:231], v[60:63], a[204:207]
  ds_read_b64_tr_b16 v[228:229], v9 offset:49152
  v_mfma_f32_16x16x32_bf16 a[16:19], v[232:235], v[32:35], a[16:19]
  ds_read_b64_tr_b16 v[230:231], v9 offset:51200
  v_mfma_f32_16x16x32_bf16 a[24:27], v[232:235], v[36:39], a[24:27]
  ds_read_b128 v[68:71], v212 offset:34816
  v_mfma_f32_16x16x32_bf16 a[80:83], v[232:235], v[40:43], a[80:83]
  v_mfma_f32_16x16x32_bf16 a[88:91], v[232:235], v[44:47], a[88:91]
  v_mfma_f32_16x16x32_bf16 a[144:147], v[232:235], v[48:51], a[144:147]
  v_mfma_f32_16x16x32_bf16 a[152:155], v[232:235], v[52:55], a[152:155]
  v_mfma_f32_16x16x32_bf16 a[208:211], v[232:235], v[56:59], a[208:211]
  ds_read_b128 v[72:75], v213 offset:36864
  v_mfma_f32_16x16x32_bf16 a[216:219], v[232:235], v[60:63], a[216:219]
  ds_read_b64_tr_b16 v[232:233], v10 offset:49152
  v_mfma_f32_16x16x32_bf16 a[20:23], v[236:239], v[32:35], a[20:23]
  ds_read_b64_tr_b16 v[234:235], v10 offset:51200
  v_mfma_f32_16x16x32_bf16 a[28:31], v[236:239], v[36:39], a[28:31]
  v_mfma_f32_16x16x32_bf16 a[84:87], v[236:239], v[40:43], a[84:87]
  v_mfma_f32_16x16x32_bf16 a[92:95], v[236:239], v[44:47], a[92:95]
  v_mfma_f32_16x16x32_bf16 a[148:151], v[236:239], v[48:51], a[148:151]
  ds_read_b128 v[76:79], v212 offset:38912
  v_mfma_f32_16x16x32_bf16 a[156:159], v[236:239], v[52:55], a[156:159]
  v_mfma_f32_16x16x32_bf16 a[212:215], v[236:239], v[56:59], a[212:215]
  v_mfma_f32_16x16x32_bf16 a[220:223], v[236:239], v[60:63], a[220:223]
  ds_read_b64_tr_b16 v[236:237], v11 offset:49152
  v_mfma_f32_16x16x32_bf16 a[32:35], v[240:243], v[32:35], a[32:35]
  ds_read_b64_tr_b16 v[238:239], v11 offset:51200
  v_mfma_f32_16x16x32_bf16 a[40:43], v[240:243], v[36:39], a[40:43]
  v_mfma_f32_16x16x32_bf16 a[96:99], v[240:243], v[40:43], a[96:99]
  ds_read_b128 v[80:83], v213 offset:40960
  v_mfma_f32_16x16x32_bf16 a[104:107], v[240:243], v[44:47], a[104:107]
  v_mfma_f32_16x16x32_bf16 a[160:163], v[240:243], v[48:51], a[160:163]
  buffer_load_dword v2, v3, s[8:11], s53 offen
  v_mfma_f32_16x16x32_bf16 a[168:171], v[240:243], v[52:55], a[168:171]
  v_mfma_f32_16x16x32_bf16 a[224:227], v[240:243], v[56:59], a[224:227]
  v_mfma_f32_16x16x32_bf16 a[232:235], v[240:243], v[60:63], a[232:235]
  ds_read_b64_tr_b16 v[240:241], v12 offset:49152
  v_mfma_f32_16x16x32_bf16 a[36:39], v[244:247], v[32:35], a[36:39]
  ds_read_b64_tr_b16 v[242:243], v12 offset:51200
  v_mfma_f32_16x16x32_bf16 a[44:47], v[244:247], v[36:39], a[44:47]
  ds_read_b128 v[84:87], v212 offset:43008
  v_mfma_f32_16x16x32_bf16 a[100:103], v[244:247], v[40:43], a[100:103]
  v_mfma_f32_16x16x32_bf16 a[108:111], v[244:247], v[44:47], a[108:111]
  v_mfma_f32_16x16x32_bf16 a[164:167], v[244:247], v[48:51], a[164:167]
  buffer_load_dword v2, v4, s[12:15], s54 offen
  v_mfma_f32_16x16x32_bf16 a[172:175], v[244:247], v[52:55], a[172:175]
  v_mfma_f32_16x16x32_bf16 a[228:231], v[244:247], v[56:59], a[228:231]
  ds_read_b128 v[88:91], v213 offset:45056
  v_mfma_f32_16x16x32_bf16 a[236:239], v[244:247], v[60:63], a[236:239]
  s_waitcnt lgkmcnt(15)
  ds_read_b64_tr_b16 v[244:245], v13 offset:49152
  v_mfma_f32_16x16x32_bf16 a[48:51], v[248:251], v[32:35], a[48:51]
  ds_read_b64_tr_b16 v[246:247], v13 offset:51200
  v_mfma_f32_16x16x32_bf16 a[56:59], v[248:251], v[36:39], a[56:59]
  v_mfma_f32_16x16x32_bf16 a[112:115], v[248:251], v[40:43], a[112:115]
  v_mfma_f32_16x16x32_bf16 a[120:123], v[248:251], v[44:47], a[120:123]
  s_mov_b64 exec, s[72:73]
  global_load_dword v2, v[142:143], off
  global_load_dword v2, v[176:177], off
  s_mov_b64 exec, -1
  v_mfma_f32_16x16x32_bf16 a[176:179], v[248:251], v[48:51], a[176:179]
  ds_read_b128 v[92:95], v212 offset:47104
  v_mfma_f32_16x16x32_bf16 a[184:187], v[248:251], v[52:55], a[184:187]
  v_mfma_f32_16x16x32_bf16 a[240:243], v[248:251], v[56:59], a[240:243]
  s_lshl_b64 s[72:73], s[72:73], 8
  s_or_b32 s72, s72, 1
  v_mfma_f32_16x16x32_bf16 a[248:251], v[248:251], v[60:63], a[248:251]
  ds_read_b64_tr_b16 v[248:249], v14 offset:49152
  v_mfma_f32_16x16x32_bf16 a[52:55], v[252:255], v[32:35], a[52:55]
  ds_read_b64_tr_b16 v[250:251], v14 offset:51200
  v_mfma_f32_16x16x32_bf16 a[60:63], v[252:255], v[36:39], a[60:63]
  v_mfma_f32_16x16x32_bf16 a[116:119], v[252:255], v[40:43], a[116:119]
  v_mfma_f32_16x16x32_bf16 a[124:127], v[252:255], v[44:47], a[124:127]
  v_mfma_f32_16x16x32_bf16 a[180:183], v[252:255], v[48:51], a[180:183]
  v_mfma_f32_16x16x32_bf16 a[188:191], v[252:255], v[52:55], a[188:191]
  v_mfma_f32_16x16x32_bf16 a[244:247], v[252:255], v[56:59], a[244:247]
  v_mfma_f32_16x16x32_bf16 a[252:255], v[252:255], v[60:63], a[252:255]
  ds_read_b64_tr_b16 v[252:253], v15 offset:49152
  ds_read_b64_tr_b16 v[254:255], v15 offset:51200
  s_waitcnt lgkmcnt(4)
  v_mfma_f32_16x16x32_bf16 a[0:3], v[224:227], v[64:67], a[0:3]
  v_mfma_f32_16x16x32_bf16 a[8:11], v[224:227], v[68:71], a[8:11]
  v_mfma_f32_16x16x32_bf16 a[64:67], v[224:227], v[72:75], a[64:67]
  v_mfma_f32_16x16x32_bf16 a[72:75], v[224:227], v[76:79], a[72:75]
  v_mfma_f32_16x16x32_bf16 a[128:131], v[224:227], v[80:83], a[128:131]
  v_mfma_f32_16x16x32_bf16 a[136:139], v[224:227], v[84:87], a[136:139]
  v_mfma_f32_16x16x32_bf16 a[192:195], v[224:227], v[88:91], a[192:195]
  v_mfma_f32_16x16x32_bf16 a[200:203], v[224:227], v[92:95], a[200:203]
  s_waitcnt vmcnt(4) lgkmcnt(0)
  s_barrier
  ds_read_b64_tr_b16 v[224:225], v8 offset:0
  v_mfma_f32_16x16x32_bf16 a[4:7], v[228:231], v[64:67], a[4:7]
  ds_read_b64_tr_b16 v[226:227], v8 offset:2048
  v_mfma_f32_16x16x32_bf16 a[12:15], v[228:231], v[68:71], a[12:15]
  v_mfma_f32_16x16x32_bf16 a[68:71], v[228:231], v[72:75], a[68:71]
  ds_read_b128 v[32:35], v212 offset:0
  s_add_u32 m0, s56, 32768
  v_mfma_f32_16x16x32_bf16 a[76:79], v[228:231], v[76:79], a[76:79]
  buffer_load_dwordx4 v16, s[8:11], s53 offen offset:0 sc1 lds
  v_mfma_f32_16x16x32_bf16 a[132:135], v[228:231], v[80:83], a[132:135]
  v_mfma_f32_16x16x32_bf16 a[140:143], v[228:231], v[84:87], a[140:143]
  v_mfma_f32_16x16x32_bf16 a[196:199], v[228:231], v[88:91], a[196:199]
  v_mfma_f32_16x16x32_bf16 a[204:207], v[228:231], v[92:95], a[204:207]
  ds_read_b64_tr_b16 v[228:229], v9 offset:0
  v_mfma_f32_16x16x32_bf16 a[16:19], v[232:235], v[64:67], a[16:19]
  buffer_load_dwordx4 v17, s[8:11], s53 offen offset:1024 sc1 lds
  v_mfma_f32_16x16x32_bf16 a[24:27], v[232:235], v[68:71], a[24:27]
  ds_read_b64_tr_b16 v[230:231], v9 offset:2048
  v_mfma_f32_16x16x32_bf16 a[80:83], v[232:235], v[72:75], a[80:83]
  ds_read_b128 v[36:39], v213 offset:2048
  v_mfma_f32_16x16x32_bf16 a[88:91], v[232:235], v[76:79], a[88:91]
  buffer_load_dwordx4 v18, s[8:11], s53 offen offset:2048 sc1 lds
  v_mfma_f32_16x16x32_bf16 a[144:147], v[232:235], v[80:83], a[144:147]
  v_mfma_f32_16x16x32_bf16 a[152:155], v[232:235], v[84:87], a[152:155]
  v_mfma_f32_16x16x32_bf16 a[208:211], v[232:235], v[88:91], a[208:211]
  ds_read_b128 v[40:43], v212 offset:4096
  v_mfma_f32_16x16x32_bf16 a[216:219], v[232:235], v[92:95], a[216:219]
  ds_read_b64_tr_b16 v[232:233], v10 offset:0
  v_mfma_f32_16x16x32_bf16 a[20:23], v[236:239], v[64:67], a[20:23]
  buffer_load_dwordx4 v19, s[8:11], s53 offen offset:3072 sc1 lds
  v_mfma_f32_16x16x32_bf16 a[28:31], v[236:239], v[68:71], a[28:31]
  ds_read_b64_tr_b16 v[234:235], v10 offset:2048
  v_mfma_f32_16x16x32_bf16 a[84:87], v[236:239], v[72:75], a[84:87]
  v_mfma_f32_16x16x32_bf16 a[92:95], v[236:239], v[76:79], a[92:95]
  s_add_u32 m0, s56, 36864
  v_mfma_f32_16x16x32_bf16 a[148:151], v[236:239], v[80:83], a[148:151]
  ds_read_b128 v[44:47], v213 offset:6144
  v_mfma_f32_16x16x32_bf16 a[156:159], v[236:239], v[84:87], a[156:159]
  buffer_load_dwordx4 v20, s[8:11], s53 offen offset:0 sc1 lds
  v_mfma_f32_16x16x32_bf16 a[212:215], v[236:239], v[88:91], a[212:215]
  v_mfma_f32_16x16x32_bf16 a[220:223], v[236:239], v[92:95], a[220:223]
  ds_read_b64_tr_b16 v[236:237], v11 offset:0
  v_mfma_f32_16x16x32_bf16 a[32:35], v[240:243], v[64:67], a[32:35]
  ds_read_b64_tr_b16 v[238:239], v11 offset:2048
  v_mfma_f32_16x16x32_bf16 a[40:43], v[240:243], v[68:71], a[40:43]
  buffer_load_dwordx4 v21, s[8:11], s53 offen offset:1024 sc1 lds
  v_mfma_f32_16x16x32_bf16 a[96:99], v[240:243], v[72:75], a[96:99]
  ds_read_b128 v[48:51], v212 offset:8192
  v_mfma_f32_16x16x32_bf16 a[104:107], v[240:243], v[76:79], a[104:107]
  v_mfma_f32_16x16x32_bf16 a[160:163], v[240:243], v[80:83], a[160:163]
  buffer_load_dwordx4 v22, s[8:11], s53 offen offset:2048 sc1 lds
  v_mfma_f32_16x16x32_bf16 a[168:171], v[240:243], v[84:87], a[168:171]
  v_mfma_f32_16x16x32_bf16 a[224:227], v[240:243], v[88:91], a[224:227]
  v_mfma_f32_16x16x32_bf16 a[232:235], v[240:243], v[92:95], a[232:235]
  ds_read_b64_tr_b16 v[240:241], v12 offset:0
  v_mfma_f32_16x16x32_bf16 a[36:39], v[244:247], v[64:67], a[36:39]
  ds_read_b64_tr_b16 v[242:243], v12 offset:2048
  v_mfma_f32_16x16x32_bf16 a[44:47], v[244:247], v[68:71], a[44:47]
  ds_read_b128 v[52:55], v213 offset:10240
  v_mfma_f32_16x16x32_bf16 a[100:103], v[244:247], v[72:75], a[100:103]
  buffer_load_dwordx4 v23, s[8:11], s53 offen offset:3072 sc1 lds
  s_add_u32 s53, s53, 128
  v_mfma_f32_16x16x32_bf16 a[108:111], v[244:247], v[76:79], a[108:111]
  v_mfma_f32_16x16x32_bf16 a[164:167], v[244:247], v[80:83], a[164:167]
  s_add_u32 m0, s56, 98304
  v_mfma_f32_16x16x32_bf16 a[172:175], v[244:247], v[84:87], a[172:175]
  buffer_load_dwordx4 v24, s[12:15], s54 offen offset:0 sc1 lds
  v_mfma_f32_16x16x32_bf16 a[228:231], v[244:247], v[88:91], a[228:231]
  ds_read_b128 v[56:59], v212 offset:12288
  v_mfma_f32_16x16x32_bf16 a[236:239], v[244:247], v[92:95], a[236:239]
  ds_read_b64_tr_b16 v[244:245], v13 offset:0
  v_mfma_f32_16x16x32_bf16 a[48:51], v[248:251], v[64:67], a[48:51]
  ds_read_b64_tr_b16 v[246:247], v13 offset:2048
  v_mfma_f32_16x16x32_bf16 a[56:59], v[248:251], v[68:71], a[56:59]
  buffer_load_dwordx4 v25, s[12:15], s54 offen offset:1024 sc1 lds
  v_mfma_f32_16x16x32_bf16 a[112:115], v[248:251], v[72:75], a[112:115]
  v_mfma_f32_16x16x32_bf16 a[120:123], v[248:251], v[76:79], a[120:123]
  v_mfma_f32_16x16x32_bf16 a[176:179], v[248:251], v[80:83], a[176:179]
  ds_read_b128 v[60:63], v213 offset:14336
  v_mfma_f32_16x16x32_bf16 a[184:187], v[248:251], v[84:87], a[184:187]
  buffer_load_dwordx4 v26, s[12:15], s54 offen offset:2048 sc1 lds
  v_mfma_f32_16x16x32_bf16 a[240:243], v[248:251], v[88:91], a[240:243]
  v_mfma_f32_16x16x32_bf16 a[248:251], v[248:251], v[92:95], a[248:251]
  ds_read_b64_tr_b16 v[248:249], v14 offset:0
  v_mfma_f32_16x16x32_bf16 a[52:55], v[252:255], v[64:67], a[52:55]
  ds_read_b64_tr_b16 v[250:251], v14 offset:2048
  v_mfma_f32_16x16x32_bf16 a[60:63], v[252:255], v[68:71], a[60:63]
  buffer_load_dwordx4 v27, s[12:15], s54 offen offset:3072 sc1 lds
  v_mfma_f32_16x16x32_bf16 a[116:119], v[252:255], v[72:75], a[116:119]
  v_mfma_f32_16x16x32_bf16 a[124:127], v[252:255], v[76:79], a[124:127]
  v_mfma_f32_16x16x32_bf16 a[180:183], v[252:255], v[80:83], a[180:183]
  v_mfma_f32_16x16x32_bf16 a[188:191], v[252:255], v[84:87], a[188:191]
  v_mfma_f32_16x16x32_bf16 a[244:247], v[252:255], v[88:91], a[244:247]
  v_mfma_f32_16x16x32_bf16 a[252:255], v[252:255], v[92:95], a[252:255]
  ds_read_b64_tr_b16 v[252:253], v15 offset:0
  ds_read_b64_tr_b16 v[254:255], v15 offset:2048
  s_add_u32 s55, s55, 1
  s_cmp_eq_u32 s55, s59
  s_cbranch_scc1 M_SIGX
  s_cmp_lg_u32 s55, 5
  s_cbranch_scc1 M_NOPOLL_K
  s_lshl_b32 s7, s33, 9
  s_add_u32 s7, s7, 121634816
  buffer_load_dwordx2 v[6:7], v5, s[16:19], s7 offen sc1
M_NOPOLL_K:
  s_cmp_lt_u32 s55, 6
  s_cbranch_scc1 M_LOOP_K
M_TAIL0:
  v_cmp_eq_u32 vcc, s86, v6
  v_cmp_eq_u32 s[4:5], s87, v7
  s_nop 0
  s_and_b64 vcc, vcc, s[4:5]
  s_cmp_eq_u64 vcc, exec
  s_cselect_b32 s67, 1, 0
  s_waitcnt lgkmcnt(15)
  s_waitcnt lgkmcnt(4)
  v_mfma_f32_16x16x32_bf16 a[0:3], v[224:227], v[32:35], a[0:3]
  v_mfma_f32_16x16x32_bf16 a[8:11], v[224:227], v[36:39], a[8:11]
  s_add_u32 m0, s56, 102400
  v_mfma_f32_16x16x32_bf16 a[64:67], v[224:227], v[40:43], a[64:67]
  buffer_load_dwordx4 v28, s[12:15], s54 offen offset:0 sc1 lds
  v_mfma_f32_16x16x32_bf16 a[72:75], v[224:227], v[44:47], a[72:75]
  v_mfma_f32_16x16x32_bf16 a[128:131], v[224:227], v[48:51], a[128:131]
  v_mfma_f32_16x16x32_bf16 a[136:139], v[224:227], v[52:55], a[136:139]
  buffer_load_dwordx4 v29, s[12:15], s54 offen offset:1024 sc1 lds
  v_mfma_f32_16x16x32_bf16 a[192:195], v[224:227], v[56:59], a[192:195]
  v_mfma_f32_16x16x32_bf16 a[200:203], v[224:227], v[60:63], a[200:203]
  ds_read_b64_tr_b16 v[224:225], v8 offset:16384
  v_mfma_f32_16x16x32_bf16 a[4:7], v[228:231], v[32:35], a[4:7]
  ds_read_b64_tr_b16 v[226:227], v8 offset:18432
  v_mfma_f32_16x16x32_bf16 a[12:15], v[228:231], v[36:39], a[12:15]
  buffer_load_dwordx4 v30, s[12:15], s54 offen offset:2048 sc1 lds
  v_mfma_f32_16x16x32_bf16 a[68:71], v[228:231], v[40:43], a[68:71]
  ds_read_b128 v[64:67], v213 offset:0
  v_mfma_f32_16x16x32_bf16 a[76:79], v[228:231], v[44:47], a[76:79]
  v_mfma_f32_16x16x32_bf16 a[132:135], v[228:231], v[48:51], a[132:135]
  buffer_load_dwordx4 v31, s[12:15], s54 offen offset:3072 sc1 lds
  s_add_u32 s54, s54, 0x80000
  v_mfma_f32_16x16x32_bf16 a[140:143], v[228:231], v[52:55], a[140:143]
  v_mfma_f32_16x16x32_bf16 a[196:199], v[228:231], v[56:59], a[196:199]
  v_mfma_f32_16x16x32_bf16 a[204:207], v[228:231], v[60:63], a[204:207]
  ds_read_b64_tr_b16 v[228:229], v9 offset:16384
  v_mfma_f32_16x16x32_bf16 a[16:19], v[232:235], v[32:35], a[16:19]
  ds_read_b64_tr_b16 v[230:231], v9 offset:18432
  v_mfma_f32_16x16x32_bf16 a[24:27], v[232:235], v[36:39], a[24:27]
  ds_read_b128 v[68:71], v212 offset:2048
  v_mfma_f32_16x16x32_bf16 a[80:83], v[232:235], v[40:43], a[80:83]
  buffer_load_dwordx4 v[96:99], v1, s[16:19], s66 offen offset:0 sc1
  v_mfma_f32_16x16x32_bf16 a[88:91], v[232:235], v[44:47], a[88:91]
  v_mfma_f32_16x16x32_bf16 a[144:147], v[232:235], v[48:51], a[144:147]
  v_mfma_f32_16x16x32_bf16 a[152:155], v[232:235], v[52:55], a[152:155]
  v_mfma_f32_16x16x32_bf16 a[208:211], v[232:235], v[56:59], a[208:211]
  ds_read_b128 v[72:75], v213 offset:4096
  v_mfma_f32_16x16x32_bf16 a[216:219], v[232:235], v[60:63], a[216:219]
  buffer_load_dwordx4 v[100:103], v1, s[16:19], s66 offen offset:1024 sc1
  v_mfma_f32_16x16x32_bf16 a[20:23], v[236:239], v[32:35], a[20:23]
  ds_read_b64_tr_b16 v[232:233], v10 offset:16384
  v_mfma_f32_16x16x32_bf16 a[28:31], v[236:239], v[36:39], a[28:31]
  ds_read_b64_tr_b16 v[234:235], v10 offset:18432
  v_mfma_f32_16x16x32_bf16 a[84:87], v[236:239], v[40:43], a[84:87]
  v_mfma_f32_16x16x32_bf16 a[92:95], v[236:239], v[44:47], a[92:95]
  buffer_load_dwordx4 v[104:107], v1, s[16:19], s66 offen offset:2048 sc1
  v_mfma_f32_16x16x32_bf16 a[148:151], v[236:239], v[48:51], a[148:151]
  ds_read_b128 v[76:79], v212 offset:6144
  v_mfma_f32_16x16x32_bf16 a[156:159], v[236:239], v[52:55], a[156:159]
  v_mfma_f32_16x16x32_bf16 a[212:215], v[236:239], v[56:59], a[212:215]
  v_mfma_f32_16x16x32_bf16 a[220:223], v[236:239], v[60:63], a[220:223]
  ds_read_b64_tr_b16 v[236:237], v11 offset:16384
  v_mfma_f32_16x16x32_bf16 a[32:35], v[240:243], v[32:35], a[32:35]
  buffer_load_dwordx4 v[108:111], v1, s[16:19], s66 offen offset:3072 sc1
  v_mfma_f32_16x16x32_bf16 a[40:43], v[240:243], v[36:39], a[40:43]
  ds_read_b64_tr_b16 v[238:239], v11 offset:18432
  v_mfma_f32_16x16x32_bf16 a[96:99], v[240:243], v[40:43], a[96:99]
  ds_read_b128 v[80:83], v213 offset:8192
  v_mfma_f32_16x16x32_bf16 a[104:107], v[240:243], v[44:47], a[104:107]
  s_add_u32 s66, s66, 4096
  v_mfma_f32_16x16x32_bf16 a[160:163], v[240:243], v[48:51], a[160:163]
  buffer_load_dwordx4 v[112:115], v1, s[16:19], s66 offen offset:0 sc1
  v_mfma_f32_16x16x32_bf16 a[168:171], v[240:243], v[52:55], a[168:171]
  v_mfma_f32_16x16x32_bf16 a[224:227], v[240:243], v[56:59], a[224:227]
  v_mfma_f32_16x16x32_bf16 a[232:235], v[240:243], v[60:63], a[232:235]
  ds_read_b64_tr_b16 v[240:241], v12 offset:16384
  v_mfma_f32_16x16x32_bf16 a[36:39], v[244:247], v[32:35], a[36:39]
  ds_read_b64_tr_b16 v[242:243], v12 offset:18432
  v_mfma_f32_16x16x32_bf16 a[44:47], v[244:247], v[36:39], a[44:47]
  ds_read_b128 v[84:87], v212 offset:10240
  v_mfma_f32_16x16x32_bf16 a[100:103], v[244:247], v[40:43], a[100:103]
  buffer_load_dwordx4 v[116:119], v1, s[16:19], s66 offen offset:1024 sc1
  v_mfma_f32_16x16x32_bf16 a[108:111], v[244:247], v[44:47], a[108:111]
  v_mfma_f32_16x16x32_bf16 a[164:167], v[244:247], v[48:51], a[164:167]
  v_mfma_f32_16x16x32_bf16 a[172:175], v[244:247], v[52:55], a[172:175]
  buffer_load_dwordx4 v[120:123], v1, s[16:19], s66 offen offset:2048 sc1
  v_mfma_f32_16x16x32_bf16 a[228:231], v[244:247], v[56:59], a[228:231]
  ds_read_b128 v[88:91], v213 offset:12288
  v_mfma_f32_16x16x32_bf16 a[236:239], v[244:247], v[60:63], a[236:239]
  s_waitcnt lgkmcnt(15)
  ds_read_b64_tr_b16 v[244:245], v13 offset:16384
  v_mfma_f32_16x16x32_bf16 a[48:51], v[248:251], v[32:35], a[48:51]
  ds_read_b64_tr_b16 v[246:247], v13 offset:18432
  v_mfma_f32_16x16x32_bf16 a[56:59], v[248:251], v[36:39], a[56:59]
  buffer_load_dwordx4 v[124:127], v1, s[16:19], s66 offen offset:3072 sc1
  v_mfma_f32_16x16x32_bf16 a[112:115], v[248:251], v[40:43], a[112:115]
  v_mfma_f32_16x16x32_bf16 a[120:123], v[248:251], v[44:47], a[120:123]
  v_mfma_f32_16x16x32_bf16 a[176:179], v[248:251], v[48:51], a[176:179]
  ds_read_b128 v[92:95], v212 offset:14336
  v_mfma_f32_16x16x32_bf16 a[184:187], v[248:251], v[52:55], a[184:187]
  s_add_u32 s66, s66, 4096
  v_mfma_f32_16x16x32_bf16 a[240:243], v[248:251], v[56:59], a[240:243]
  buffer_load_dwordx4 v[128:131], v1, s[16:19], s66 offen offset:0 sc1
  v_mfma_f32_16x16x32_bf16 a[248:251], v[248:251], v[60:63], a[248:251]
  ds_read_b64_tr_b16 v[248:249], v14 offset:16384
  v_mfma_f32_16x16x32_bf16 a[52:55], v[252:255], v[32:35], a[52:55]
  ds_read_b64_tr_b16 v[250:251], v14 offset:18432
  v_mfma_f32_16x16x32_bf16 a[60:63], v[252:255], v[36:39], a[60:63]
  v_mfma_f32_16x16x32_bf16 a[116:119], v[252:255], v[40:43], a[116:119]
  buffer_load_dwordx4 v[132:135], v1, s[16:19], s66 offen offset:1024 sc1
  v_mfma_f32_16x16x32_bf16 a[124:127], v[252:255], v[44:47], a[124:127]
  v_mfma_f32_16x16x32_bf16 a[180:183], v[252:255], v[48:51], a[180:183]
  v_mfma_f32_16x16x32_bf16 a[188:191], v[252:255], v[52:55], a[188:191]
  v_mfma_f32_16x16x32_bf16 a[244:247], v[252:255], v[56:59], a[244:247]
  v_mfma_f32_16x16x32_bf16 a[252:255], v[252:255], v[60:63], a[252:255]
  ds_read_b64_tr_b16 v[252:253], v15 offset:16384
  ds_read_b64_tr_b16 v[254:255], v15 offset:18432
  s_waitcnt lgkmcnt(4)
  v_mfma_f32_16x16x32_bf16 a[0:3], v[224:227], v[64:67], a[0:3]
  v_mfma_f32_16x16x32_bf16 a[8:11], v[224:227], v[68:71], a[8:11]
  v_mfma_f32_16x16x32_bf16 a[64:67], v[224:227], v[72:75], a[64:67]
  v_mfma_f32_16x16x32_bf16 a[72:75], v[224:227], v[76:79], a[72:75]
  v_mfma_f32_16x16x32_bf16 a[128:131], v[224:227], v[80:83], a[128:131]
  v_mfma_f32_16x16x32_bf16 a[136:139], v[224:227], v[84:87], a[136:139]
  v_mfma_f32_16x16x32_bf16 a[192:195], v[224:227], v[88:91], a[192:195]
  v_mfma_f32_16x16x32_bf16 a[200:203], v[224:227], v[92:95], a[200:203]
  s_waitcnt vmcnt(10)
  s_waitcnt lgkmcnt(0)
  s_barrier
  ds_read_b64_tr_b16 v[224:225], v8 offset:32768
  v_mfma_f32_16x16x32_bf16 a[4:7], v[228:231], v[64:67], a[4:7]
  ds_read_b64_tr_b16 v[226:227], v8 offset:34816
  v_mfma_f32_16x16x32_bf16 a[12:15], v[228:231], v[68:71], a[12:15]
  v_mfma_f32_16x16x32_bf16 a[68:71], v[228:231], v[72:75], a[68:71]
  ds_read_b128 v[32:35], v212 offset:32768
  s_add_u32 m0, s56, 0
  v_mfma_f32_16x16x32_bf16 a[76:79], v[228:231], v[76:79], a[76:79]
  buffer_load_dwordx4 v16, s[8:11], s53 offen offset:0 sc1 lds
  v_mfma_f32_16x16x32_bf16 a[132:135], v[228:231], v[80:83], a[132:135]
  v_mfma_f32_16x16x32_bf16 a[140:143], v[228:231], v[84:87], a[140:143]
  buffer_load_dwordx4 v[136:139], v1, s[16:19], s66 offen offset:2048 sc1
  v_mfma_f32_16x16x32_bf16 a[196:199], v[228:231], v[88:91], a[196:199]
  v_mfma_f32_16x16x32_bf16 a[204:207], v[228:231], v[92:95], a[204:207]
  ds_read_b64_tr_b16 v[228:229], v9 offset:32768
  v_mfma_f32_16x16x32_bf16 a[16:19], v[232:235], v[64:67], a[16:19]
  buffer_load_dwordx4 v17, s[8:11], s53 offen offset:1024 sc1 lds
  v_mfma_f32_16x16x32_bf16 a[24:27], v[232:235], v[68:71], a[24:27]
  ds_read_b64_tr_b16 v[230:231], v9 offset:34816
  v_mfma_f32_16x16x32_bf16 a[80:83], v[232:235], v[72:75], a[80:83]
  ds_read_b128 v[36:39], v213 offset:34816
  v_mfma_f32_16x16x32_bf16 a[88:91], v[232:235], v[76:79], a[88:91]
  buffer_load_dwordx4 v18, s[8:11], s53 offen offset:2048 sc1 lds
  v_mfma_f32_16x16x32_bf16 a[144:147], v[232:235], v[80:83], a[144:147]
  v_mfma_f32_16x16x32_bf16 a[152:155], v[232:235], v[84:87], a[152:155]
  v_mfma_f32_16x16x32_bf16 a[208:211], v[232:235], v[88:91], a[208:211]
  ds_read_b128 v[40:43], v212 offset:36864
  v_mfma_f32_16x16x32_bf16 a[216:219], v[232:235], v[92:95], a[216:219]
  ds_read_b64_tr_b16 v[232:233], v10 offset:32768
  v_mfma_f32_16x16x32_bf16 a[20:23], v[236:239], v[64:67], a[20:23]
  buffer_load_dwordx4 v19, s[8:11], s53 offen offset:3072 sc1 lds
  v_mfma_f32_16x16x32_bf16 a[28:31], v[236:239], v[68:71], a[28:31]
  ds_read_b64_tr_b16 v[234:235], v10 offset:34816
  v_mfma_f32_16x16x32_bf16 a[84:87], v[236:239], v[72:75], a[84:87]
  buffer_load_dwordx4 v[140:143], v1, s[16:19], s66 offen offset:3072 sc1
  v_mfma_f32_16x16x32_bf16 a[92:95], v[236:239], v[76:79], a[92:95]
  s_add_u32 m0, s56, 4096
  v_mfma_f32_16x16x32_bf16 a[148:151], v[236:239], v[80:83], a[148:151]
  ds_read_b128 v[44:47], v213 offset:38912
  v_mfma_f32_16x16x32_bf16 a[156:159], v[236:239], v[84:87], a[156:159]
  buffer_load_dwordx4 v20, s[8:11], s53 offen offset:0 sc1 lds
  v_mfma_f32_16x16x32_bf16 a[212:215], v[236:239], v[88:91], a[212:215]
  v_mfma_f32_16x16x32_bf16 a[220:223], v[236:239], v[92:95], a[220:223]
  ds_read_b64_tr_b16 v[236:237], v11 offset:32768
  v_mfma_f32_16x16x32_bf16 a[32:35], v[240:243], v[64:67], a[32:35]
  ds_read_b64_tr_b16 v[238:239], v11 offset:34816
  v_mfma_f32_16x16x32_bf16 a[40:43], v[240:243], v[68:71], a[40:43]
  buffer_load_dwordx4 v21, s[8:11], s53 offen offset:1024 sc1 lds
  v_mfma_f32_16x16x32_bf16 a[96:99], v[240:243], v[72:75], a[96:99]
  ds_read_b128 v[48:51], v212 offset:40960
  v_mfma_f32_16x16x32_bf16 a[104:107], v[240:243], v[76:79], a[104:107]
  v_mfma_f32_16x16x32_bf16 a[160:163], v[240:243], v[80:83], a[160:163]
  buffer_load_dwordx4 v22, s[8:11], s53 offen offset:2048 sc1 lds
  v_mfma_f32_16x16x32_bf16 a[168:171], v[240:243], v[84:87], a[168:171]
  v_mfma_f32_16x16x32_bf16 a[224:227], v[240:243], v[88:91], a[224:227]
  s_add_u32 s66, s66, 4096
  v_mfma_f32_16x16x32_bf16 a[232:235], v[240:243], v[92:95], a[232:235]
  ds_read_b64_tr_b16 v[240:241], v12 offset:32768
  v_mfma_f32_16x16x32_bf16 a[36:39], v[244:247], v[64:67], a[36:39]
  buffer_load_dwordx4 v[144:147], v1, s[16:19], s66 offen offset:0 sc1
  v_mfma_f32_16x16x32_bf16 a[44:47], v[244:247], v[68:71], a[44:47]
  ds_read_b64_tr_b16 v[242:243], v12 offset:34816
  v_mfma_f32_16x16x32_bf16 a[100:103], v[244:247], v[72:75], a[100:103]
  ds_read_b128 v[52:55], v213 offset:43008
  v_mfma_f32_16x16x32_bf16 a[108:111], v[244:247], v[76:79], a[108:111]
  buffer_load_dwordx4 v23, s[8:11], s53 offen offset:3072 sc1 lds
  s_add_u32 s53, s53, 128
  v_mfma_f32_16x16x32_bf16 a[164:167], v[244:247], v[80:83], a[164:167]
  s_add_u32 m0, s56, 65536
  v_mfma_f32_16x16x32_bf16 a[172:175], v[244:247], v[84:87], a[172:175]
  buffer_load_dwordx4 v24, s[12:15], s54 offen offset:0 sc1 lds
  v_mfma_f32_16x16x32_bf16 a[228:231], v[244:247], v[88:91], a[228:231]
  ds_read_b128 v[56:59], v212 offset:45056
  v_mfma_f32_16x16x32_bf16 a[236:239], v[244:247], v[92:95], a[236:239]
  ds_read_b64_tr_b16 v[244:245], v13 offset:32768
  v_mfma_f32_16x16x32_bf16 a[48:51], v[248:251], v[64:67], a[48:51]
  ds_read_b64_tr_b16 v[246:247], v13 offset:34816
  v_mfma_f32_16x16x32_bf16 a[56:59], v[248:251], v[68:71], a[56:59]
  buffer_load_dwordx4 v25, s[12:15], s54 offen offset:1024 sc1 lds
  v_mfma_f32_16x16x32_bf16 a[112:115], v[248:251], v[72:75], a[112:115]
  v_mfma_f32_16x16x32_bf16 a[120:123], v[248:251], v[76:79], a[120:123]
  v_mfma_f32_16x16x32_bf16 a[176:179], v[248:251], v[80:83], a[176:179]
  ds_read_b128 v[60:63], v213 offset:47104
  v_mfma_f32_16x16x32_bf16 a[184:187], v[248:251], v[84:87], a[184:187]
  buffer_load_dwordx4 v[148:151], v1, s[16:19], s66 offen offset:1024 sc1
  v_mfma_f32_16x16x32_bf16 a[240:243], v[248:251], v[88:91], a[240:243]
  buffer_load_dwordx4 v26, s[12:15], s54 offen offset:2048 sc1 lds
  v_mfma_f32_16x16x32_bf16 a[248:251], v[248:251], v[92:95], a[248:251]
  ds_read_b64_tr_b16 v[248:249], v14 offset:32768
  v_mfma_f32_16x16x32_bf16 a[52:55], v[252:255], v[64:67], a[52:55]
  ds_read_b64_tr_b16 v[250:251], v14 offset:34816
  v_mfma_f32_16x16x32_bf16 a[60:63], v[252:255], v[68:71], a[60:63]
  buffer_load_dwordx4 v27, s[12:15], s54 offen offset:3072 sc1 lds
  v_mfma_f32_16x16x32_bf16 a[116:119], v[252:255], v[72:75], a[116:119]
  v_mfma_f32_16x16x32_bf16 a[124:127], v[252:255], v[76:79], a[124:127]
  v_mfma_f32_16x16x32_bf16 a[180:183], v[252:255], v[80:83], a[180:183]
  v_mfma_f32_16x16x32_bf16 a[188:191], v[252:255], v[84:87], a[188:191]
  v_mfma_f32_16x16x32_bf16 a[244:247], v[252:255], v[88:91], a[244:247]
  v_mfma_f32_16x16x32_bf16 a[252:255], v[252:255], v[92:95], a[252:255]
  ds_read_b64_tr_b16 v[252:253], v15 offset:32768
  ds_read_b64_tr_b16 v[254:255], v15 offset:34816
  s_waitcnt lgkmcnt(15)
  s_waitcnt lgkmcnt(4)
  v_mfma_f32_16x16x32_bf16 a[0:3], v[224:227], v[32:35], a[0:3]
  v_mfma_f32_16x16x32_bf16 a[8:11], v[224:227], v[36:39], a[8:11]
  s_add_u32 m0, s56, 69632
  v_mfma_f32_16x16x32_bf16 a[64:67], v[224:227], v[40:43], a[64:67]
  buffer_load_dwordx4 v28, s[12:15], s54 offen offset:0 sc1 lds
  v_mfma_f32_16x16x32_bf16 a[72:75], v[224:227], v[44:47], a[72:75]
  v_mfma_f32_16x16x32_bf16 a[128:131], v[224:227], v[48:51], a[128:131]
  v_mfma_f32_16x16x32_bf16 a[136:139], v[224:227], v[52:55], a[136:139]
  buffer_load_dwordx4 v29, s[12:15], s54 offen offset:1024 sc1 lds
  v_mfma_f32_16x16x32_bf16 a[192:195], v[224:227], v[56:59], a[192:195]
  v_mfma_f32_16x16x32_bf16 a[200:203], v[224:227], v[60:63], a[200:203]
  ds_read_b64_tr_b16 v[224:225], v8 offset:49152
  v_mfma_f32_16x16x32_bf16 a[4:7], v[228:231], v[32:35], a[4:7]
  ds_read_b64_tr_b16 v[226:227], v8 offset:51200
  v_mfma_f32_16x16x32_bf16 a[12:15], v[228:231], v[36:39], a[12:15]
  buffer_load_dwordx4 v30, s[12:15], s54 offen offset:2048 sc1 lds
  v_mfma_f32_16x16x32_bf16 a[68:71], v[228:231], v[40:43], a[68:71]
  ds_read_b128 v[64:67], v213 offset:32768
  v_mfma_f32_16x16x32_bf16 a[76:79], v[228:231], v[44:47], a[76:79]
  v_mfma_f32_16x16x32_bf16 a[132:135], v[228:231], v[48:51], a[132:135]
  buffer_load_dwordx4 v31, s[12:15], s54 offen offset:3072 sc1 lds
  s_add_u32 s54, s54, 0x80000
  v_mfma_f32_16x16x32_bf16 a[140:143], v[228:231], v[52:55], a[140:143]
  v_mfma_f32_16x16x32_bf16 a[196:199], v[228:231], v[56:59], a[196:199]
  v_mfma_f32_16x16x32_bf16 a[204:207], v[228:231], v[60:63], a[204:207]
  ds_read_b64_tr_b16 v[228:229], v9 offset:49152
  v_mfma_f32_16x16x32_bf16 a[16:19], v[232:235], v[32:35], a[16:19]
  ds_read_b64_tr_b16 v[230:231], v9 offset:51200
  v_mfma_f32_16x16x32_bf16 a[24:27], v[232:235], v[36:39], a[24:27]
  ds_read_b128 v[68:71], v212 offset:34816
  v_mfma_f32_16x16x32_bf16 a[80:83], v[232:235], v[40:43], a[80:83]
  buffer_load_dwordx4 v[152:155], v1, s[16:19], s66 offen offset:2048 sc1
  v_mfma_f32_16x16x32_bf16 a[88:91], v[232:235], v[44:47], a[88:91]
  v_mfma_f32_16x16x32_bf16 a[144:147], v[232:235], v[48:51], a[144:147]
  v_mfma_f32_16x16x32_bf16 a[152:155], v[232:235], v[52:55], a[152:155]
  v_mfma_f32_16x16x32_bf16 a[208:211], v[232:235], v[56:59], a[208:211]
  ds_read_b128 v[72:75], v213 offset:36864
  v_mfma_f32_16x16x32_bf16 a[216:219], v[232:235], v[60:63], a[216:219]
  buffer_load_dwordx4 v[156:159], v1, s[16:19], s66 offen offset:3072 sc1
  v_mfma_f32_16x16x32_bf16 a[20:23], v[236:239], v[32:35], a[20:23]
  ds_read_b64_tr_b16 v[232:233], v10 offset:49152
  v_mfma_f32_16x16x32_bf16 a[28:31], v[236:239], v[36:39], a[28:31]
  ds_read_b64_tr_b16 v[234:235], v10 offset:51200
  v_mfma_f32_16x16x32_bf16 a[84:87], v[236:239], v[40:43], a[84:87]
  s_add_u32 s66, s66, 4096
  v_mfma_f32_16x16x32_bf16 a[92:95], v[236:239], v[44:47], a[92:95]
  buffer_load_dwordx4 v[160:163], v1, s[16:19], s66 offen offset:0 sc1
  v_mfma_f32_16x16x32_bf16 a[148:151], v[236:239], v[48:51], a[148:151]
  ds_read_b128 v[76:79], v212 offset:38912
  v_mfma_f32_16x16x32_bf16 a[156:159], v[236:239], v[52:55], a[156:159]
  v_mfma_f32_16x16x32_bf16 a[212:215], v[236:239], v[56:59], a[212:215]
  v_mfma_f32_16x16x32_bf16 a[220:223], v[236:239], v[60:63], a[220:223]
  ds_read_b64_tr_b16 v[236:237], v11 offset:49152
  v_mfma_f32_16x16x32_bf16 a[32:35], v[240:243], v[32:35], a[32:35]
  buffer_load_dwordx4 v[164:167], v1, s[16:19], s66 offen offset:1024 sc1
  v_mfma_f32_16x16x32_bf16 a[40:43], v[240:243], v[36:39], a[40:43]
  ds_read_b64_tr_b16 v[238:239], v11 offset:51200
  v_mfma_f32_16x16x32_bf16 a[96:99], v[240:243], v[40:43], a[96:99]
  ds_read_b128 v[80:83], v213 offset:40960
  v_mfma_f32_16x16x32_bf16 a[104:107], v[240:243], v[44:47], a[104:107]
  v_mfma_f32_16x16x32_bf16 a[160:163], v[240:243], v[48:51], a[160:163]
  buffer_load_dwordx4 v[168:171], v1, s[16:19], s66 offen offset:2048 sc1
  v_mfma_f32_16x16x32_bf16 a[168:171], v[240:243], v[52:55], a[168:171]
  v_mfma_f32_16x16x32_bf16 a[224:227], v[240:243], v[56:59], a[224:227]
  v_mfma_f32_16x16x32_bf16 a[232:235], v[240:243], v[60:63], a[232:235]
  ds_read_b64_tr_b16 v[240:241], v12 offset:49152
  v_mfma_f32_16x16x32_bf16 a[36:39], v[244:247], v[32:35], a[36:39]
  ds_read_b64_tr_b16 v[242:243], v12 offset:51200
  v_mfma_f32_16x16x32_bf16 a[44:47], v[244:247], v[36:39], a[44:47]
  ds_read_b128 v[84:87], v212 offset:43008
  v_mfma_f32_16x16x32_bf16 a[100:103], v[244:247], v[40:43], a[100:103]
  buffer_load_dwordx4 v[172:175], v1, s[16:19], s66 offen offset:3072 sc1
  v_mfma_f32_16x16x32_bf16 a[108:111], v[244:247], v[44:47], a[108:111]
  v_mfma_f32_16x16x32_bf16 a[164:167], v[244:247], v[48:51], a[164:167]
  s_add_u32 s66, s66, 4096
  v_mfma_f32_16x16x32_bf16 a[172:175], v[244:247], v[52:55], a[172:175]
  buffer_load_dwordx4 v[176:179], v1, s[16:19], s66 offen offset:0 sc1
  v_mfma_f32_16x16x32_bf16 a[228:231], v[244:247], v[56:59], a[228:231]
  ds_read_b128 v[88:91], v213 offset:45056
  v_mfma_f32_16x16x32_bf16 a[236:239], v[244:247], v[60:63], a[236:239]
  s_waitcnt lgkmcnt(15)
  ds_read_b64_tr_b16 v[244:245], v13 offset:49152
  v_mfma_f32_16x16x32_bf16 a[48:51], v[248:251], v[32:35], a[48:51]
  ds_read_b64_tr_b16 v[246:247], v13 offset:51200
  v_mfma_f32_16x16x32_bf16 a[56:59], v[248:251], v[36:39], a[56:59]
  buffer_load_dwordx4 v[180:183], v1, s[16:19], s66 offen offset:1024 sc1
  v_mfma_f32_16x16x32_bf16 a[112:115], v[248:251], v[40:43], a[112:115]
  v_mfma_f32_16x16x32_bf16 a[120:123], v[248:251], v[44:47], a[120:123]
  v_mfma_f32_16x16x32_bf16 a[176:179], v[248:251], v[48:51], a[176:179]
  ds_read_b128 v[92:95], v212 offset:47104
  v_mfma_f32_16x16x32_bf16 a[184:187], v[248:251], v[52:55], a[184:187]
  v_mfma_f32_16x16x32_bf16 a[240:243], v[248:251], v[56:59], a[240:243]
  buffer_load_dwordx4 v[184:187], v1, s[16:19], s66 offen offset:2048 sc1
  v_mfma_f32_16x16x32_bf16 a[248:251], v[248:251], v[60:63], a[248:251]
  ds_read_b64_tr_b16 v[248:249], v14 offset:49152
  v_mfma_f32_16x16x32_bf16 a[52:55], v[252:255], v[32:35], a[52:55]
  ds_read_b64_tr_b16 v[250:251], v14 offset:51200
  v_mfma_f32_16x16x32_bf16 a[60:63], v[252:255], v[36:39], a[60:63]
  v_mfma_f32_16x16x32_bf16 a[116:119], v[252:255], v[40:43], a[116:119]
  buffer_load_dwordx4 v[188:191], v1, s[16:19], s66 offen offset:3072 sc1
  v_mfma_f32_16x16x32_bf16 a[124:127], v[252:255], v[44:47], a[124:127]
  v_mfma_f32_16x16x32_bf16 a[180:183], v[252:255], v[48:51], a[180:183]
  v_mfma_f32_16x16x32_bf16 a[188:191], v[252:255], v[52:55], a[188:191]
  v_mfma_f32_16x16x32_bf16 a[244:247], v[252:255], v[56:59], a[244:247]
  v_mfma_f32_16x16x32_bf16 a[252:255], v[252:255], v[60:63], a[252:255]
  ds_read_b64_tr_b16 v[252:253], v15 offset:49152
  ds_read_b64_tr_b16 v[254:255], v15 offset:51200
  s_waitcnt lgkmcnt(4)
  v_mfma_f32_16x16x32_bf16 a[0:3], v[224:227], v[64:67], a[0:3]
  v_mfma_f32_16x16x32_bf16 a[8:11], v[224:227], v[68:71], a[8:11]
  v_mfma_f32_16x16x32_bf16 a[64:67], v[224:227], v[72:75], a[64:67]
  v_mfma_f32_16x16x32_bf16 a[72:75], v[224:227], v[76:79], a[72:75]
  v_mfma_f32_16x16x32_bf16 a[128:131], v[224:227], v[80:83], a[128:131]
  v_mfma_f32_16x16x32_bf16 a[136:139], v[224:227], v[84:87], a[136:139]
  v_mfma_f32_16x16x32_bf16 a[192:195], v[224:227], v[88:91], a[192:195]
  v_mfma_f32_16x16x32_bf16 a[200:203], v[224:227], v[92:95], a[200:203]
  s_waitcnt vmcnt(10)
  s_waitcnt lgkmcnt(0)
  s_barrier
  ds_read_b64_tr_b16 v[224:225], v8 offset:0
  v_mfma_f32_16x16x32_bf16 a[4:7], v[228:231], v[64:67], a[4:7]
  ds_read_b64_tr_b16 v[226:227], v8 offset:2048
  v_mfma_f32_16x16x32_bf16 a[12:15], v[228:231], v[68:71], a[12:15]
  v_mfma_f32_16x16x32_bf16 a[68:71], v[228:231], v[72:75], a[68:71]
  ds_read_b128 v[32:35], v212 offset:0
  s_add_u32 m0, s56, 32768
  v_mfma_f32_16x16x32_bf16 a[76:79], v[228:231], v[76:79], a[76:79]
  buffer_load_dwordx4 v16, s[8:11], s53 offen offset:0 sc1 lds
  v_mfma_f32_16x16x32_bf16 a[132:135], v[228:231], v[80:83], a[132:135]
  s_add_u32 s66, s66, 4096
  v_mfma_f32_16x16x32_bf16 a[140:143], v[228:231], v[84:87], a[140:143]
  buffer_load_dwordx4 v[192:195], v1, s[16:19], s66 offen offset:0 sc1
  v_mfma_f32_16x16x32_bf16 a[196:199], v[228:231], v[88:91], a[196:199]
  v_mfma_f32_16x16x32_bf16 a[204:207], v[228:231], v[92:95], a[204:207]
  ds_read_b64_tr_b16 v[228:229], v9 offset:0
  v_mfma_f32_16x16x32_bf16 a[16:19], v[232:235], v[64:67], a[16:19]
  buffer_load_dwordx4 v17, s[8:11], s53 offen offset:1024 sc1 lds
  v_mfma_f32_16x16x32_bf16 a[24:27], v[232:235], v[68:71], a[24:27]
  ds_read_b64_tr_b16 v[230:231], v9 offset:2048
  v_mfma_f32_16x16x32_bf16 a[80:83], v[232:235], v[72:75], a[80:83]
  ds_read_b128 v[36:39], v213 offset:2048
  v_mfma_f32_16x16x32_bf16 a[88:91], v[232:235], v[76:79], a[88:91]
  buffer_load_dwordx4 v18, s[8:11], s53 offen offset:2048 sc1 lds
  v_mfma_f32_16x16x32_bf16 a[144:147], v[232:235], v[80:83], a[144:147]
  v_mfma_f32_16x16x32_bf16 a[152:155], v[232:235], v[84:87], a[152:155]
  v_mfma_f32_16x16x32_bf16 a[208:211], v[232:235], v[88:91], a[208:211]
  ds_read_b128 v[40:43], v212 offset:4096
  v_mfma_f32_16x16x32_bf16 a[216:219], v[232:235], v[92:95], a[216:219]
  ds_read_b64_tr_b16 v[232:233], v10 offset:0
  v_mfma_f32_16x16x32_bf16 a[20:23], v[236:239], v[64:67], a[20:23]
  buffer_load_dwordx4 v19, s[8:11], s53 offen offset:3072 sc1 lds
  v_mfma_f32_16x16x32_bf16 a[28:31], v[236:239], v[68:71], a[28:31]
  ds_read_b64_tr_b16 v[234:235], v10 offset:2048
  v_mfma_f32_16x16x32_bf16 a[84:87], v[236:239], v[72:75], a[84:87]
  buffer_load_dwordx4 v[196:199], v1, s[16:19], s66 offen offset:1024 sc1
  v_mfma_f32_16x16x32_bf16 a[92:95], v[236:239], v[76:79], a[92:95]
  s_add_u32 m0, s56, 36864
  v_mfma_f32_16x16x32_bf16 a[148:151], v[236:239], v[80:83], a[148:151]
  ds_read_b128 v[44:47], v213 offset:6144
  v_mfma_f32_16x16x32_bf16 a[156:159], v[236:239], v[84:87], a[156:159]
  buffer_load_dwordx4 v20, s[8:11], s53 offen offset:0 sc1 lds
  v_mfma_f32_16x16x32_bf16 a[212:215], v[236:239], v[88:91], a[212:215]
  v_mfma_f32_16x16x32_bf16 a[220:223], v[236:239], v[92:95], a[220:223]
  ds_read_b64_tr_b16 v[236:237], v11 offset:0
  v_mfma_f32_16x16x32_bf16 a[32:35], v[240:243], v[64:67], a[32:35]
  ds_read_b64_tr_b16 v[238:239], v11 offset:2048
  v_mfma_f32_16x16x32_bf16 a[40:43], v[240:243], v[68:71], a[40:43]
  buffer_load_dwordx4 v21, s[8:11], s53 offen offset:1024 sc1 lds
  v_mfma_f32_16x16x32_bf16 a[96:99], v[240:243], v[72:75], a[96:99]
  ds_read_b128 v[48:51], v212 offset:8192
  v_mfma_f32_16x16x32_bf16 a[104:107], v[240:243], v[76:79], a[104:107]
  v_mfma_f32_16x16x32_bf16 a[160:163], v[240:243], v[80:83], a[160:163]
  buffer_load_dwordx4 v22, s[8:11], s53 offen offset:2048 sc1 lds
  v_mfma_f32_16x16x32_bf16 a[168:171], v[240:243], v[84:87], a[168:171]
  v_mfma_f32_16x16x32_bf16 a[224:227], v[240:243], v[88:91], a[224:227]
  v_mfma_f32_16x16x32_bf16 a[232:235], v[240:243], v[92:95], a[232:235]
  ds_read_b64_tr_b16 v[240:241], v12 offset:0
  v_mfma_f32_16x16x32_bf16 a[36:39], v[244:247], v[64:67], a[36:39]
  buffer_load_dwordx4 v[200:203], v1, s[16:19], s66 offen offset:2048 sc1
  v_mfma_f32_16x16x32_bf16 a[44:47], v[244:247], v[68:71], a[44:47]
  ds_read_b64_tr_b16 v[242:243], v12 offset:2048
  v_mfma_f32_16x16x32_bf16 a[100:103], v[244:247], v[72:75], a[100:103]
  ds_read_b128 v[52:55], v213 offset:10240
  v_mfma_f32_16x16x32_bf16 a[108:111], v[244:247], v[76:79], a[108:111]
  buffer_load_dwordx4 v23, s[8:11], s53 offen offset:3072 sc1 lds
  s_add_u32 s53, s53, 128
  v_mfma_f32_16x16x32_bf16 a[164:167], v[244:247], v[80:83], a[164:167]
  s_add_u32 m0, s56, 98304
  v_mfma_f32_16x16x32_bf16 a[172:175], v[244:247], v[84:87], a[172:175]
  buffer_load_dwordx4 v24, s[12:15], s54 offen offset:0 sc1 lds
  v_mfma_f32_16x16x32_bf16 a[228:231], v[244:247], v[88:91], a[228:231]
  ds_read_b128 v[56:59], v212 offset:12288
  v_mfma_f32_16x16x32_bf16 a[236:239], v[244:247], v[92:95], a[236:239]
  ds_read_b64_tr_b16 v[244:245], v13 offset:0
  v_mfma_f32_16x16x32_bf16 a[48:51], v[248:251], v[64:67], a[48:51]
  ds_read_b64_tr_b16 v[246:247], v13 offset:2048
  v_mfma_f32_16x16x32_bf16 a[56:59], v[248:251], v[68:71], a[56:59]
  buffer_load_dwordx4 v25, s[12:15], s54 offen offset:1024 sc1 lds
  v_mfma_f32_16x16x32_bf16 a[112:115], v[248:251], v[72:75], a[112:115]
  v_mfma_f32_16x16x32_bf16 a[120:123], v[248:251], v[76:79], a[120:123]
  v_mfma_f32_16x16x32_bf16 a[176:179], v[248:251], v[80:83], a[176:179]
  ds_read_b128 v[60:63], v213 offset:14336
  v_mfma_f32_16x16x32_bf16 a[184:187], v[248:251], v[84:87], a[184:187]
  buffer_load_dwordx4 v[204:207], v1, s[16:19], s66 offen offset:3072 sc1
  v_mfma_f32_16x16x32_bf16 a[240:243], v[248:251], v[88:91], a[240:243]
  buffer_load_dwordx4 v26, s[12:15], s54 offen offset:2048 sc1 lds
  v_mfma_f32_16x16x32_bf16 a[248:251], v[248:251], v[92:95], a[248:251]
  ds_read_b64_tr_b16 v[248:249], v14 offset:0
  v_mfma_f32_16x16x32_bf16 a[52:55], v[252:255], v[64:67], a[52:55]
  ds_read_b64_tr_b16 v[250:251], v14 offset:2048
  v_mfma_f32_16x16x32_bf16 a[60:63], v[252:255], v[68:71], a[60:63]
  buffer_load_dwordx4 v27, s[12:15], s54 offen offset:3072 sc1 lds
  v_mfma_f32_16x16x32_bf16 a[116:119], v[252:255], v[72:75], a[116:119]
  v_mfma_f32_16x16x32_bf16 a[124:127], v[252:255], v[76:79], a[124:127]
  v_mfma_f32_16x16x32_bf16 a[180:183], v[252:255], v[80:83], a[180:183]
  v_mfma_f32_16x16x32_bf16 a[188:191], v[252:255], v[84:87], a[188:191]
  v_mfma_f32_16x16x32_bf16 a[244:247], v[252:255], v[88:91], a[244:247]
  v_mfma_f32_16x16x32_bf16 a[252:255], v[252:255], v[92:95], a[252:255]
  ds_read_b64_tr_b16 v[252:253], v15 offset:0
  ds_read_b64_tr_b16 v[254:255], v15 offset:2048
  s_waitcnt lgkmcnt(15)
  s_waitcnt lgkmcnt(4)
  v_mfma_f32_16x16x32_bf16 a[0:3], v[224:227], v[32:35], a[0:3]
  v_mfma_f32_16x16x32_bf16 a[8:11], v[224:227], v[36:39], a[8:11]
  s_add_u32 m0, s56, 102400
  v_mfma_f32_16x16x32_bf16 a[64:67], v[224:227], v[40:43], a[64:67]
  buffer_load_dwordx4 v28, s[12:15], s54 offen offset:0 sc1 lds
  v_mfma_f32_16x16x32_bf16 a[72:75], v[224:227], v[44:47], a[72:75]
  v_mfma_f32_16x16x32_bf16 a[128:131], v[224:227], v[48:51], a[128:131]
  v_mfma_f32_16x16x32_bf16 a[136:139], v[224:227], v[52:55], a[136:139]
  v_mfma_f32_16x16x32_bf16 a[192:195], v[224:227], v[56:59], a[192:195]
  buffer_load_dwordx4 v29, s[12:15], s54 offen offset:1024 sc1 lds
  v_mfma_f32_16x16x32_bf16 a[200:203], v[224:227], v[60:63], a[200:203]
  ds_read_b64_tr_b16 v[224:225], v8 offset:16384
  v_mfma_f32_16x16x32_bf16 a[4:7], v[228:231], v[32:35], a[4:7]
  ds_read_b64_tr_b16 v[226:227], v8 offset:18432
  v_mfma_f32_16x16x32_bf16 a[12:15], v[228:231], v[36:39], a[12:15]
  v_mfma_f32_16x16x32_bf16 a[68:71], v[228:231], v[40:43], a[68:71]
  ds_read_b128 v[64:67], v213 offset:0
  v_mfma_f32_16x16x32_bf16 a[76:79], v[228:231], v[44:47], a[76:79]
  buffer_load_dwordx4 v30, s[12:15], s54 offen offset:2048 sc1 lds
  v_mfma_f32_16x16x32_bf16 a[132:135], v[228:231], v[48:51], a[132:135]
  v_mfma_f32_16x16x32_bf16 a[140:143], v[228:231], v[52:55], a[140:143]
  v_mfma_f32_16x16x32_bf16 a[196:199], v[228:231], v[56:59], a[196:199]
  v_mfma_f32_16x16x32_bf16 a[204:207], v[228:231], v[60:63], a[204:207]
  ds_read_b64_tr_b16 v[228:229], v9 offset:16384
  v_mfma_f32_16x16x32_bf16 a[16:19], v[232:235], v[32:35], a[16:19]
  buffer_load_dwordx4 v31, s[12:15], s54 offen offset:3072 sc1 lds
  s_add_u32 s54, s54, 0x80000
  v_mfma_f32_16x16x32_bf16 a[24:27], v[232:235], v[36:39], a[24:27]
  ds_read_b64_tr_b16 v[230:231], v9 offset:18432
  v_mfma_f32_16x16x32_bf16 a[80:83], v[232:235], v[40:43], a[80:83]
  ds_read_b128 v[68:71], v212 offset:2048
  v_mfma_f32_16x16x32_bf16 a[88:91], v[232:235], v[44:47], a[88:91]
  s_add_u32 m0, s43, 131072
  s_mov_b32 s59, 0
  v_mfma_f32_16x16x32_bf16 a[144:147], v[232:235], v[48:51], a[144:147]
  buffer_load_dwordx4 v208, s[24:27], s59 offen offset:0 sc1 lds
  v_mfma_f32_16x16x32_bf16 a[152:155], v[232:235], v[52:55], a[152:155]
  v_mfma_f32_16x16x32_bf16 a[208:211], v[232:235], v[56:59], a[208:211]
  ds_read_b128 v[72:75], v213 offset:4096
  v_mfma_f32_16x16x32_bf16 a[216:219], v[232:235], v[60:63], a[216:219]
  ds_read_b64_tr_b16 v[232:233], v10 offset:16384
  v_mfma_f32_16x16x32_bf16 a[20:23], v[236:239], v[32:35], a[20:23]
  ds_read_b64_tr_b16 v[234:235], v10 offset:18432
  v_mfma_f32_16x16x32_bf16 a[28:31], v[236:239], v[36:39], a[28:31]
  buffer_load_dwordx4 v209, s[24:27], s59 offen offset:1024 sc1 lds
  v_mfma_f32_16x16x32_bf16 a[84:87], v[236:239], v[40:43], a[84:87]
  v_mfma_f32_16x16x32_bf16 a[92:95], v[236:239], v[44:47], a[92:95]
  v_mfma_f32_16x16x32_bf16 a[148:151], v[236:239], v[48:51], a[148:151]
  ds_read_b128 v[76:79], v212 offset:6144
  v_mfma_f32_16x16x32_bf16 a[156:159], v[236:239], v[52:55], a[156:159]
  buffer_load_dwordx4 v210, s[24:27], s59 offen offset:2048 sc1 lds
  v_mfma_f32_16x16x32_bf16 a[212:215], v[236:239], v[56:59], a[212:215]
  v_mfma_f32_16x16x32_bf16 a[220:223], v[236:239], v[60:63], a[220:223]
  ds_read_b64_tr_b16 v[236:237], v11 offset:16384
  v_mfma_f32_16x16x32_bf16 a[32:35], v[240:243], v[32:35], a[32:35]
  ds_read_b64_tr_b16 v[238:239], v11 offset:18432
  v_mfma_f32_16x16x32_bf16 a[40:43], v[240:243], v[36:39], a[40:43]
  buffer_load_dwordx4 v211, s[24:27], s59 offen offset:3072 sc1 lds
  v_mfma_f32_16x16x32_bf16 a[96:99], v[240:243], v[40:43], a[96:99]
  ds_read_b128 v[80:83], v213 offset:8192
  v_mfma_f32_16x16x32_bf16 a[104:107], v[240:243], v[44:47], a[104:107]
  v_mfma_f32_16x16x32_bf16 a[160:163], v[240:243], v[48:51], a[160:163]
  v_mfma_f32_16x16x32_bf16 a[168:171], v[240:243], v[52:55], a[168:171]
  s_add_u32 m0, s43, 147456
  s_mov_b32 s59, 524288
  v_mfma_f32_16x16x32_bf16 a[224:227], v[240:243], v[56:59], a[224:227]
  buffer_load_dwordx4 v208, s[24:27], s59 offen offset:0 sc1 lds
  v_mfma_f32_16x16x32_bf16 a[232:235], v[240:243], v[60:63], a[232:235]
  ds_read_b64_tr_b16 v[240:241], v12 offset:16384
  v_mfma_f32_16x16x32_bf16 a[36:39], v[244:247], v[32:35], a[36:39]
  ds_read_b64_tr_b16 v[242:243], v12 offset:18432
  v_mfma_f32_16x16x32_bf16 a[44:47], v[244:247], v[36:39], a[44:47]
  ds_read_b128 v[84:87], v212 offset:10240
  v_mfma_f32_16x16x32_bf16 a[100:103], v[244:247], v[40:43], a[100:103]
  buffer_load_dwordx4 v209, s[24:27], s59 offen offset:1024 sc1 lds
  v_mfma_f32_16x16x32_bf16 a[108:111], v[244:247], v[44:47], a[108:111]
  v_mfma_f32_16x16x32_bf16 a[164:167], v[244:247], v[48:51], a[164:167]
  v_mfma_f32_16x16x32_bf16 a[172:175], v[244:247], v[52:55], a[172:175]
  v_mfma_f32_16x16x32_bf16 a[228:231], v[244:247], v[56:59], a[228:231]
  ds_read_b128 v[88:91], v213 offset:12288
  v_mfma_f32_16x16x32_bf16 a[236:239], v[244:247], v[60:63], a[236:239]
  s_waitcnt lgkmcnt(15)
  ds_read_b64_tr_b16 v[244:245], v13 offset:16384
  v_mfma_f32_16x16x32_bf16 a[48:51], v[248:251], v[32:35], a[48:51]
  buffer_load_dwordx4 v210, s[24:27], s59 offen offset:2048 sc1 lds
  v_mfma_f32_16x16x32_bf16 a[56:59], v[248:251], v[36:39], a[56:59]
  ds_read_b64_tr_b16 v[246:247], v13 offset:18432
  v_mfma_f32_16x16x32_bf16 a[112:115], v[248:251], v[40:43], a[112:115]
  v_mfma_f32_16x16x32_bf16 a[120:123], v[248:251], v[44:47], a[120:123]
  buffer_load_dwordx4 v211, s[24:27], s59 offen offset:3072 sc1 lds
  v_mfma_f32_16x16x32_bf16 a[176:179], v[248:251], v[48:51], a[176:179]
  ds_read_b128 v[92:95], v212 offset:14336
  v_mfma_f32_16x16x32_bf16 a[184:187], v[248:251], v[52:55], a[184:187]
  v_mfma_f32_16x16x32_bf16 a[240:243], v[248:251], v[56:59], a[240:243]
  v_mfma_f32_16x16x32_bf16 a[248:251], v[248:251], v[60:63], a[248:251]
  ds_read_b64_tr_b16 v[248:249], v14 offset:16384
  v_mfma_f32_16x16x32_bf16 a[52:55], v[252:255], v[32:35], a[52:55]
  ds_read_b64_tr_b16 v[250:251], v14 offset:18432
  v_mfma_f32_16x16x32_bf16 a[60:63], v[252:255], v[36:39], a[60:63]
  v_mfma_f32_16x16x32_bf16 a[116:119], v[252:255], v[40:43], a[116:119]
  v_mfma_f32_16x16x32_bf16 a[124:127], v[252:255], v[44:47], a[124:127]
  v_mfma_f32_16x16x32_bf16 a[180:183], v[252:255], v[48:51], a[180:183]
  v_mfma_f32_16x16x32_bf16 a[188:191], v[252:255], v[52:55], a[188:191]
  v_mfma_f32_16x16x32_bf16 a[244:247], v[252:255], v[56:59], a[244:247]
  v_mfma_f32_16x16x32_bf16 a[252:255], v[252:255], v[60:63], a[252:255]
  ds_read_b64_tr_b16 v[252:253], v15 offset:16384
  ds_read_b64_tr_b16 v[254:255], v15 offset:18432
  s_waitcnt lgkmcnt(4)
  v_mfma_f32_16x16x32_bf16 a[0:3], v[224:227], v[64:67], a[0:3]
  v_mfma_f32_16x16x32_bf16 a[8:11], v[224:227], v[68:71], a[8:11]
  v_mfma_f32_16x16x32_bf16 a[64:67], v[224:227], v[72:75], a[64:67]
  v_mfma_f32_16x16x32_bf16 a[72:75], v[224:227], v[76:79], a[72:75]
  v_mfma_f32_16x16x32_bf16 a[128:131], v[224:227], v[80:83], a[128:131]
  v_mfma_f32_16x16x32_bf16 a[136:139], v[224:227], v[84:87], a[136:139]
  v_mfma_f32_16x16x32_bf16 a[192:195], v[224:227], v[88:91], a[192:195]
  v_mfma_f32_16x16x32_bf16 a[200:203], v[224:227], v[92:95], a[200:203]
  s_waitcnt vmcnt(8)
  s_waitcnt lgkmcnt(0)
  s_barrier
  ds_read_b64_tr_b16 v[224:225], v8 offset:32768
  v_mfma_f32_16x16x32_bf16 a[4:7], v[228:231], v[64:67], a[4:7]
  ds_read_b64_tr_b16 v[226:227], v8 offset:34816
  v_mfma_f32_16x16x32_bf16 a[12:15], v[228:231], v[68:71], a[12:15]
  v_mfma_f32_16x16x32_bf16 a[68:71], v[228:231], v[72:75], a[68:71]
  ds_read_b128 v[32:35], v212 offset:32768
  s_add_u32 m0, s43, 0
  s_mov_b32 s59, 1048576
  v_mfma_f32_16x16x32_bf16 a[76:79], v[228:231], v[76:79], a[76:79]
  buffer_load_dwordx4 v208, s[24:27], s59 offen offset:0 sc1 lds
  v_mfma_f32_16x16x32_bf16 a[132:135], v[228:231], v[80:83], a[132:135]
  v_mfma_f32_16x16x32_bf16 a[140:143], v[228:231], v[84:87], a[140:143]
  v_mfma_f32_16x16x32_bf16 a[196:199], v[228:231], v[88:91], a[196:199]
  v_mfma_f32_16x16x32_bf16 a[204:207], v[228:231], v[92:95], a[204:207]
  ds_read_b64_tr_b16 v[228:229], v9 offset:32768
  v_mfma_f32_16x16x32_bf16 a[16:19], v[232:235], v[64:67], a[16:19]
  buffer_load_dwordx4 v209, s[24:27], s59 offen offset:1024 sc1 lds
  v_mfma_f32_16x16x32_bf16 a[24:27], v[232:235], v[68:71], a[24:27]
  ds_read_b64_tr_b16 v[230:231], v9 offset:34816
  v_mfma_f32_16x16x32_bf16 a[80:83], v[232:235], v[72:75], a[80:83]
  ds_read_b128 v[36:39], v213 offset:34816
  v_mfma_f32_16x16x32_bf16 a[88:91], v[232:235], v[76:79], a[88:91]
  buffer_load_dwordx4 v210, s[24:27], s59 offen offset:2048 sc1 lds
  v_mfma_f32_16x16x32_bf16 a[144:147], v[232:235], v[80:83], a[144:147]
  v_mfma_f32_16x16x32_bf16 a[152:155], v[232:235], v[84:87], a[152:155]
  v_mfma_f32_16x16x32_bf16 a[208:211], v[232:235], v[88:91], a[208:211]
  ds_read_b128 v[40:43], v212 offset:36864
  v_mfma_f32_16x16x32_bf16 a[216:219], v[232:235], v[92:95], a[216:219]
  ds_read_b64_tr_b16 v[232:233], v10 offset:32768
  v_mfma_f32_16x16x32_bf16 a[20:23], v[236:239], v[64:67], a[20:23]
  buffer_load_dwordx4 v211, s[24:27], s59 offen offset:3072 sc1 lds
  v_mfma_f32_16x16x32_bf16 a[28:31], v[236:239], v[68:71], a[28:31]
  ds_read_b64_tr_b16 v[234:235], v10 offset:34816
  v_mfma_f32_16x16x32_bf16 a[84:87], v[236:239], v[72:75], a[84:87]
  v_mfma_f32_16x16x32_bf16 a[92:95], v[236:239], v[76:79], a[92:95]
  s_add_u32 m0, s43, 16384
  s_mov_b32 s59, 1572864
  v_mfma_f32_16x16x32_bf16 a[148:151], v[236:239], v[80:83], a[148:151]
  ds_read_b128 v[44:47], v213 offset:38912
  v_mfma_f32_16x16x32_bf16 a[156:159], v[236:239], v[84:87], a[156:159]
  buffer_load_dwordx4 v208, s[24:27], s59 offen offset:0 sc1 lds
  v_mfma_f32_16x16x32_bf16 a[212:215], v[236:239], v[88:91], a[212:215]
  v_mfma_f32_16x16x32_bf16 a[220:223], v[236:239], v[92:95], a[220:223]
  ds_read_b64_tr_b16 v[236:237], v11 offset:32768
  v_mfma_f32_16x16x32_bf16 a[32:35], v[240:243], v[64:67], a[32:35]
  ds_read_b64_tr_b16 v[238:239], v11 offset:34816
  v_mfma_f32_16x16x32_bf16 a[40:43], v[240:243], v[68:71], a[40:43]
  buffer_load_dwordx4 v209, s[24:27], s59 offen offset:1024 sc1 lds
  v_mfma_f32_16x16x32_bf16 a[96:99], v[240:243], v[72:75], a[96:99]
  ds_read_b128 v[48:51], v212 offset:40960
  v_mfma_f32_16x16x32_bf16 a[104:107], v[240:243], v[76:79], a[104:107]
  v_mfma_f32_16x16x32_bf16 a[160:163], v[240:243], v[80:83], a[160:163]
  buffer_load_dwordx4 v210, s[24:27], s59 offen offset:2048 sc1 lds
  v_mfma_f32_16x16x32_bf16 a[168:171], v[240:243], v[84:87], a[168:171]
  v_mfma_f32_16x16x32_bf16 a[224:227], v[240:243], v[88:91], a[224:227]
  v_mfma_f32_16x16x32_bf16 a[232:235], v[240:243], v[92:95], a[232:235]
  ds_read_b64_tr_b16 v[240:241], v12 offset:32768
  v_mfma_f32_16x16x32_bf16 a[36:39], v[244:247], v[64:67], a[36:39]
  ds_read_b64_tr_b16 v[242:243], v12 offset:34816
  v_mfma_f32_16x16x32_bf16 a[44:47], v[244:247], v[68:71], a[44:47]
  ds_read_b128 v[52:55], v213 offset:43008
  v_mfma_f32_16x16x32_bf16 a[100:103], v[244:247], v[72:75], a[100:103]
  buffer_load_dwordx4 v211, s[24:27], s59 offen offset:3072 sc1 lds
  v_mfma_f32_16x16x32_bf16 a[108:111], v[244:247], v[76:79], a[108:111]
  v_mfma_f32_16x16x32_bf16 a[164:167], v[244:247], v[80:83], a[164:167]
  s_add_u32 m0, s43, 65536
  s_mov_b32 s59, 2097152
  v_mfma_f32_16x16x32_bf16 a[172:175], v[244:247], v[84:87], a[172:175]
  buffer_load_dwordx4 v208, s[24:27], s59 offen offset:0 sc1 lds
  v_mfma_f32_16x16x32_bf16 a[228:231], v[244:247], v[88:91], a[228:231]
  ds_read_b128 v[56:59], v212 offset:45056
  v_mfma_f32_16x16x32_bf16 a[236:239], v[244:247], v[92:95], a[236:239]
  ds_read_b64_tr_b16 v[244:245], v13 offset:32768
  v_mfma_f32_16x16x32_bf16 a[48:51], v[248:251], v[64:67], a[48:51]
  ds_read_b64_tr_b16 v[246:247], v13 offset:34816
  v_mfma_f32_16x16x32_bf16 a[56:59], v[248:251], v[68:71], a[56:59]
  buffer_load_dwordx4 v209, s[24:27], s59 offen offset:1024 sc1 lds
  v_mfma_f32_16x16x32_bf16 a[112:115], v[248:251], v[72:75], a[112:115]
  v_mfma_f32_16x16x32_bf16 a[120:123], v[248:251], v[76:79], a[120:123]
  v_mfma_f32_16x16x32_bf16 a[176:179], v[248:251], v[80:83], a[176:179]
  ds_read_b128 v[60:63], v213 offset:47104
  v_mfma_f32_16x16x32_bf16 a[184:187], v[248:251], v[84:87], a[184:187]
  buffer_load_dwordx4 v210, s[24:27], s59 offen offset:2048 sc1 lds
  v_mfma_f32_16x16x32_bf16 a[240:243], v[248:251], v[88:91], a[240:243]
  v_mfma_f32_16x16x32_bf16 a[248:251], v[248:251], v[92:95], a[248:251]
  ds_read_b64_tr_b16 v[248:249], v14 offset:32768
  v_mfma_f32_16x16x32_bf16 a[52:55], v[252:255], v[64:67], a[52:55]
  ds_read_b64_tr_b16 v[250:251], v14 offset:34816
  v_mfma_f32_16x16x32_bf16 a[60:63], v[252:255], v[68:71], a[60:63]
  buffer_load_dwordx4 v211, s[24:27], s59 offen offset:3072 sc1 lds
  v_mfma_f32_16x16x32_bf16 a[116:119], v[252:255], v[72:75], a[116:119]
  v_mfma_f32_16x16x32_bf16 a[124:127], v[252:255], v[76:79], a[124:127]
  v_mfma_f32_16x16x32_bf16 a[180:183], v[252:255], v[80:83], a[180:183]
  v_mfma_f32_16x16x32_bf16 a[188:191], v[252:255], v[84:87], a[188:191]
  v_mfma_f32_16x16x32_bf16 a[244:247], v[252:255], v[88:91], a[244:247]
  v_mfma_f32_16x16x32_bf16 a[252:255], v[252:255], v[92:95], a[252:255]
  ds_read_b64_tr_b16 v[252:253], v15 offset:32768
  ds_read_b64_tr_b16 v[254:255], v15 offset:34816
  s_waitcnt lgkmcnt(15)
  s_waitcnt lgkmcnt(4)
  v_mfma_f32_16x16x32_bf16 a[0:3], v[224:227], v[32:35], a[0:3]
  v_mfma_f32_16x16x32_bf16 a[8:11], v[224:227], v[36:39], a[8:11]
  s_add_u32 m0, s43, 81920
  s_mov_b32 s59, 2621440
  v_mfma_f32_16x16x32_bf16 a[64:67], v[224:227], v[40:43], a[64:67]
  buffer_load_dwordx4 v208, s[24:27], s59 offen offset:0 sc1 lds
  v_mfma_f32_16x16x32_bf16 a[72:75], v[224:227], v[44:47], a[72:75]
  v_mfma_f32_16x16x32_bf16 a[128:131], v[224:227], v[48:51], a[128:131]
  v_mfma_f32_16x16x32_bf16 a[136:139], v[224:227], v[52:55], a[136:139]
  buffer_load_dwordx4 v209, s[24:27], s59 offen offset:1024 sc1 lds
  v_mfma_f32_16x16x32_bf16 a[192:195], v[224:227], v[56:59], a[192:195]
  v_mfma_f32_16x16x32_bf16 a[200:203], v[224:227], v[60:63], a[200:203]
  ds_read_b64_tr_b16 v[224:225], v8 offset:49152
  v_mfma_f32_16x16x32_bf16 a[4:7], v[228:231], v[32:35], a[4:7]
  ds_read_b64_tr_b16 v[226:227], v8 offset:51200
  v_mfma_f32_16x16x32_bf16 a[12:15], v[228:231], v[36:39], a[12:15]
  buffer_load_dwordx4 v210, s[24:27], s59 offen offset:2048 sc1 lds
  v_mfma_f32_16x16x32_bf16 a[68:71], v[228:231], v[40:43], a[68:71]
  ds_read_b128 v[64:67], v213 offset:32768
  v_mfma_f32_16x16x32_bf16 a[76:79], v[228:231], v[44:47], a[76:79]
  v_mfma_f32_16x16x32_bf16 a[132:135], v[228:231], v[48:51], a[132:135]
  buffer_load_dwordx4 v211, s[24:27], s59 offen offset:3072 sc1 lds
  v_mfma_f32_16x16x32_bf16 a[140:143], v[228:231], v[52:55], a[140:143]
  v_mfma_f32_16x16x32_bf16 a[196:199], v[228:231], v[56:59], a[196:199]
  v_mfma_f32_16x16x32_bf16 a[204:207], v[228:231], v[60:63], a[204:207]
  ds_read_b64_tr_b16 v[228:229], v9 offset:49152
  v_mfma_f32_16x16x32_bf16 a[16:19], v[232:235], v[32:35], a[16:19]
  ds_read_b64_tr_b16 v[230:231], v9 offset:51200
  v_mfma_f32_16x16x32_bf16 a[24:27], v[232:235], v[36:39], a[24:27]
  ds_read_b128 v[68:71], v212 offset:34816
  v_mfma_f32_16x16x32_bf16 a[80:83], v[232:235], v[40:43], a[80:83]
  v_mfma_f32_16x16x32_bf16 a[88:91], v[232:235], v[44:47], a[88:91]
  v_mfma_f32_16x16x32_bf16 a[144:147], v[232:235], v[48:51], a[144:147]
  v_mfma_f32_16x16x32_bf16 a[152:155], v[232:235], v[52:55], a[152:155]
  v_mfma_f32_16x16x32_bf16 a[208:211], v[232:235], v[56:59], a[208:211]
  ds_read_b128 v[72:75], v213 offset:36864
  v_mfma_f32_16x16x32_bf16 a[216:219], v[232:235], v[60:63], a[216:219]
  ds_read_b64_tr_b16 v[232:233], v10 offset:49152
  v_mfma_f32_16x16x32_bf16 a[20:23], v[236:239], v[32:35], a[20:23]
  ds_read_b64_tr_b16 v[234:235], v10 offset:51200
  v_mfma_f32_16x16x32_bf16 a[28:31], v[236:239], v[36:39], a[28:31]
  v_mfma_f32_16x16x32_bf16 a[84:87], v[236:239], v[40:43], a[84:87]
  v_mfma_f32_16x16x32_bf16 a[92:95], v[236:239], v[44:47], a[92:95]
  v_mfma_f32_16x16x32_bf16 a[148:151], v[236:239], v[48:51], a[148:151]
  ds_read_b128 v[76:79], v212 offset:38912
  v_mfma_f32_16x16x32_bf16 a[156:159], v[236:239], v[52:55], a[156:159]
  v_mfma_f32_16x16x32_bf16 a[212:215], v[236:239], v[56:59], a[212:215]
  v_mfma_f32_16x16x32_bf16 a[220:223], v[236:239], v[60:63], a[220:223]
  ds_read_b64_tr_b16 v[236:237], v11 offset:49152
  v_mfma_f32_16x16x32_bf16 a[32:35], v[240:243], v[32:35], a[32:35]
  ds_read_b64_tr_b16 v[238:239], v11 offset:51200
  v_mfma_f32_16x16x32_bf16 a[40:43], v[240:243], v[36:39], a[40:43]
  v_mfma_f32_16x16x32_bf16 a[96:99], v[240:243], v[40:43], a[96:99]
  ds_read_b128 v[80:83], v213 offset:40960
  v_mfma_f32_16x16x32_bf16 a[104:107], v[240:243], v[44:47], a[104:107]
  v_mfma_f32_16x16x32_bf16 a[160:163], v[240:243], v[48:51], a[160:163]
  v_mfma_f32_16x16x32_bf16 a[168:171], v[240:243], v[52:55], a[168:171]
  v_mfma_f32_16x16x32_bf16 a[224:227], v[240:243], v[56:59], a[224:227]
  v_mfma_f32_16x16x32_bf16 a[232:235], v[240:243], v[60:63], a[232:235]
  ds_read_b64_tr_b16 v[240:241], v12 offset:49152
  v_mfma_f32_16x16x32_bf16 a[36:39], v[244:247], v[32:35], a[36:39]
  ds_read_b64_tr_b16 v[242:243], v12 offset:51200
  v_mfma_f32_16x16x32_bf16 a[44:47], v[244:247], v[36:39], a[44:47]
  ds_read_b128 v[84:87], v212 offset:43008
  v_mfma_f32_16x16x32_bf16 a[100:103], v[244:247], v[40:43], a[100:103]
  v_mfma_f32_16x16x32_bf16 a[108:111], v[244:247], v[44:47], a[108:111]
  v_mfma_f32_16x16x32_bf16 a[164:167], v[244:247], v[48:51], a[164:167]
  v_mfma_f32_16x16x32_bf16 a[172:175], v[244:247], v[52:55], a[172:175]
  v_mfma_f32_16x16x32_bf16 a[228:231], v[244:247], v[56:59], a[228:231]
  ds_read_b128 v[88:91], v213 offset:45056
  v_mfma_f32_16x16x32_bf16 a[236:239], v[244:247], v[60:63], a[236:239]
  s_waitcnt lgkmcnt(15)
  ds_read_b64_tr_b16 v[244:245], v13 offset:49152
  v_mfma_f32_16x16x32_bf16 a[48:51], v[248:251], v[32:35], a[48:51]
  ds_read_b64_tr_b16 v[246:247], v13 offset:51200
  v_mfma_f32_16x16x32_bf16 a[56:59], v[248:251], v[36:39], a[56:59]
  v_mfma_f32_16x16x32_bf16 a[112:115], v[248:251], v[40:43], a[112:115]
  v_mfma_f32_16x16x32_bf16 a[120:123], v[248:251], v[44:47], a[120:123]
  v_mfma_f32_16x16x32_bf16 a[176:179], v[248:251], v[48:51], a[176:179]
  ds_read_b128 v[92:95], v212 offset:47104
  v_mfma_f32_16x16x32_bf16 a[184:187], v[248:251], v[52:55], a[184:187]
  v_mfma_f32_16x16x32_bf16 a[240:243], v[248:251], v[56:59], a[240:243]
  v_mfma_f32_16x16x32_bf16 a[248:251], v[248:251], v[60:63], a[248:251]
  ds_read_b64_tr_b16 v[248:249], v14 offset:49152
  v_mfma_f32_16x16x32_bf16 a[52:55], v[252:255], v[32:35], a[52:55]
  ds_read_b64_tr_b16 v[250:251], v14 offset:51200
  v_mfma_f32_16x16x32_bf16 a[60:63], v[252:255], v[36:39], a[60:63]
  v_mfma_f32_16x16x32_bf16 a[116:119], v[252:255], v[40:43], a[116:119]
  v_mfma_f32_16x16x32_bf16 a[124:127], v[252:255], v[44:47], a[124:127]
  v_mfma_f32_16x16x32_bf16 a[180:183], v[252:255], v[48:51], a[180:183]
  v_mfma_f32_16x16x32_bf16 a[188:191], v[252:255], v[52:55], a[188:191]
  v_mfma_f32_16x16x32_bf16 a[244:247], v[252:255], v[56:59], a[244:247]
  v_mfma_f32_16x16x32_bf16 a[252:255], v[252:255], v[60:63], a[252:255]
  ds_read_b64_tr_b16 v[252:253], v15 offset:49152
  ds_read_b64_tr_b16 v[254:255], v15 offset:51200
  s_waitcnt lgkmcnt(4)
  v_mfma_f32_16x16x32_bf16 a[0:3], v[224:227], v[64:67], a[0:3]
  v_mfma_f32_16x16x32_bf16 a[8:11], v[224:227], v[68:71], a[8:11]
  v_mfma_f32_16x16x32_bf16 a[64:67], v[224:227], v[72:75], a[64:67]
  v_mfma_f32_16x16x32_bf16 a[72:75], v[224:227], v[76:79], a[72:75]
  v_mfma_f32_16x16x32_bf16 a[128:131], v[224:227], v[80:83], a[128:131]
  v_mfma_f32_16x16x32_bf16 a[136:139], v[224:227], v[84:87], a[136:139]
  v_mfma_f32_16x16x32_bf16 a[192:195], v[224:227], v[88:91], a[192:195]
  v_mfma_f32_16x16x32_bf16 a[200:203], v[224:227], v[92:95], a[200:203]
  s_waitcnt lgkmcnt(0)
  s_barrier
  v_mfma_f32_16x16x32_bf16 a[4:7], v[228:231], v[64:67], a[4:7]
  v_mfma_f32_16x16x32_bf16 a[12:15], v[228:231], v[68:71], a[12:15]
  v_mfma_f32_16x16x32_bf16 a[68:71], v[228:231], v[72:75], a[68:71]
  s_add_u32 m0, s43, 32768
  s_mov_b32 s59, 3145728
  v_mfma_f32_16x16x32_bf16 a[76:79], v[228:231], v[76:79], a[76:79]
  buffer_load_dwordx4 v208, s[24:27], s59 offen offset:0 sc1 lds
  v_mfma_f32_16x16x32_bf16 a[132:135], v[228:231], v[80:83], a[132:135]
  v_mfma_f32_16x16x32_bf16 a[140:143], v[228:231], v[84:87], a[140:143]
  v_mfma_f32_16x16x32_bf16 a[196:199], v[228:231], v[88:91], a[196:199]
  v_mfma_f32_16x16x32_bf16 a[204:207], v[228:231], v[92:95], a[204:207]
  buffer_load_dwordx4 v209, s[24:27], s59 offen offset:1024 sc1 lds
  v_mfma_f32_16x16x32_bf16 a[16:19], v[232:235], v[64:67], a[16:19]
  v_mfma_f32_16x16x32_bf16 a[24:27], v[232:235], v[68:71], a[24:27]
  v_mfma_f32_16x16x32_bf16 a[80:83], v[232:235], v[72:75], a[80:83]
  v_mfma_f32_16x16x32_bf16 a[88:91], v[232:235], v[76:79], a[88:91]
  buffer_load_dwordx4 v210, s[24:27], s59 offen offset:2048 sc1 lds
  v_mfma_f32_16x16x32_bf16 a[144:147], v[232:235], v[80:83], a[144:147]
  v_mfma_f32_16x16x32_bf16 a[152:155], v[232:235], v[84:87], a[152:155]
  v_mfma_f32_16x16x32_bf16 a[208:211], v[232:235], v[88:91], a[208:211]
  v_mfma_f32_16x16x32_bf16 a[216:219], v[232:235], v[92:95], a[216:219]
  buffer_load_dwordx4 v211, s[24:27], s59 offen offset:3072 sc1 lds
  v_mfma_f32_16x16x32_bf16 a[20:23], v[236:239], v[64:67], a[20:23]
  v_mfma_f32_16x16x32_bf16 a[28:31], v[236:239], v[68:71], a[28:31]
  v_mfma_f32_16x16x32_bf16 a[84:87], v[236:239], v[72:75], a[84:87]
  v_mfma_f32_16x16x32_bf16 a[92:95], v[236:239], v[76:79], a[92:95]
  s_add_u32 m0, s43, 49152
  s_mov_b32 s59, 256
  v_mfma_f32_16x16x32_bf16 a[148:151], v[236:239], v[80:83], a[148:151]
  buffer_load_dwordx4 v208, s[24:27], s59 offen offset:0 sc1 lds
  v_mfma_f32_16x16x32_bf16 a[156:159], v[236:239], v[84:87], a[156:159]
  v_mfma_f32_16x16x32_bf16 a[212:215], v[236:239], v[88:91], a[212:215]
  v_mfma_f32_16x16x32_bf16 a[220:223], v[236:239], v[92:95], a[220:223]
  v_mfma_f32_16x16x32_bf16 a[32:35], v[240:243], v[64:67], a[32:35]
  buffer_load_dwordx4 v209, s[24:27], s59 offen offset:1024 sc1 lds
  v_mfma_f32_16x16x32_bf16 a[40:43], v[240:243], v[68:71], a[40:43]
  v_mfma_f32_16x16x32_bf16 a[96:99], v[240:243], v[72:75], a[96:99]
  v_mfma_f32_16x16x32_bf16 a[104:107], v[240:243], v[76:79], a[104:107]
  v_mfma_f32_16x16x32_bf16 a[160:163], v[240:243], v[80:83], a[160:163]
  buffer_load_dwordx4 v210, s[24:27], s59 offen offset:2048 sc1 lds
  v_mfma_f32_16x16x32_bf16 a[168:171], v[240:243], v[84:87], a[168:171]
  v_mfma_f32_16x16x32_bf16 a[224:227], v[240:243], v[88:91], a[224:227]
  v_mfma_f32_16x16x32_bf16 a[232:235], v[240:243], v[92:95], a[232:235]
  v_mfma_f32_16x16x32_bf16 a[36:39], v[244:247], v[64:67], a[36:39]
  buffer_load_dwordx4 v211, s[24:27], s59 offen offset:3072 sc1 lds
  v_mfma_f32_16x16x32_bf16 a[44:47], v[244:247], v[68:71], a[44:47]
  v_mfma_f32_16x16x32_bf16 a[100:103], v[244:247], v[72:75], a[100:103]
  v_mfma_f32_16x16x32_bf16 a[108:111], v[244:247], v[76:79], a[108:111]
  v_mfma_f32_16x16x32_bf16 a[164:167], v[244:247], v[80:83], a[164:167]
  s_add_u32 m0, s43, 98304
  s_mov_b32 s59, 524544
  v_mfma_f32_16x16x32_bf16 a[172:175], v[244:247], v[84:87], a[172:175]
  buffer_load_dwordx4 v208, s[24:27], s59 offen offset:0 sc1 lds
  v_mfma_f32_16x16x32_bf16 a[228:231], v[244:247], v[88:91], a[228:231]
  v_mfma_f32_16x16x32_bf16 a[236:239], v[244:247], v[92:95], a[236:239]
  v_mfma_f32_16x16x32_bf16 a[48:51], v[248:251], v[64:67], a[48:51]
  v_mfma_f32_16x16x32_bf16 a[56:59], v[248:251], v[68:71], a[56:59]
  buffer_load_dwordx4 v209, s[24:27], s59 offen offset:1024 sc1 lds
  v_mfma_f32_16x16x32_bf16 a[112:115], v[248:251], v[72:75], a[112:115]
  v_mfma_f32_16x16x32_bf16 a[120:123], v[248:251], v[76:79], a[120:123]
  v_mfma_f32_16x16x32_bf16 a[176:179], v[248:251], v[80:83], a[176:179]
  v_mfma_f32_16x16x32_bf16 a[184:187], v[248:251], v[84:87], a[184:187]
  buffer_load_dwordx4 v210, s[24:27], s59 offen offset:2048 sc1 lds
  v_mfma_f32_16x16x32_bf16 a[240:243], v[248:251], v[88:91], a[240:243]
  v_mfma_f32_16x16x32_bf16 a[248:251], v[248:251], v[92:95], a[248:251]
  v_mfma_f32_16x16x32_bf16 a[52:55], v[252:255], v[64:67], a[52:55]
  v_mfma_f32_16x16x32_bf16 a[60:63], v[252:255], v[68:71], a[60:63]
  buffer_load_dwordx4 v211, s[24:27], s59 offen offset:3072 sc1 lds
  v_mfma_f32_16x16x32_bf16 a[116:119], v[252:255], v[72:75], a[116:119]
  v_mfma_f32_16x16x32_bf16 a[124:127], v[252:255], v[76:79], a[124:127]
  v_mfma_f32_16x16x32_bf16 a[180:183], v[252:255], v[80:83], a[180:183]
  v_mfma_f32_16x16x32_bf16 a[188:191], v[252:255], v[84:87], a[188:191]
  v_mfma_f32_16x16x32_bf16 a[244:247], v[252:255], v[88:91], a[244:247]
  v_mfma_f32_16x16x32_bf16 a[252:255], v[252:255], v[92:95], a[252:255]
  s_branch M_B
M_HOOK:
  s_mov_b32 s6, 0
M_NSPIN:
  v_readfirstlane_b32 s86, v139
  s_cmp_lg_u32 s86, 0
  s_cbranch_scc1 M_NOK
  s_sleep 8
  global_load_dword v139, v137, s[84:85] sc1
  s_waitcnt vmcnt(0)
  s_add_u32 s6, s6, 1
  s_cmp_lt_u32 s6, 200000
  s_cbranch_scc1 M_NSPIN
M_NOK:
  s_xor_b32 s87, s86, 0x5bd1e995
  s_cmp_eq_u32 s3, 0
  s_cselect_b32 s59, 3, 99
  s_mov_b64 s[72:73], 0xff
  s_branch M_HOOK_RET
M_SIGX:
  s_lshl_b32 s7, s33, 9
  s_add_u32 s7, s7, 121634816
  s_lshl_b32 s6, s32, 3
  v_mov_b32 v136, s86
  v_mov_b32 v137, s87
  v_mov_b32 v138, s6
  s_mov_b64 exec, 1
  buffer_store_dwordx2 v[136:137], v138, s[16:19], s7 offen sc1
  s_mov_b64 exec, -1
M_HOOK_RET:
  s_cmp_eq_u32 s58, 0
  s_cbranch_scc1 M_LOOP_K
  s_branch M_LOOP_V
M_PRE_V:
  ds_read_b64_tr_b16 v[224:225], v8 offset:0
  ds_read_b64_tr_b16 v[226:227], v8 offset:2048
  ds_read_b128 v[32:35], v212 offset:0
  ds_read_b64_tr_b16 v[228:229], v9 offset:0
  ds_read_b64_tr_b16 v[230:231], v9 offset:2048
  ds_read_b128 v[36:39], v213 offset:2048
  ds_read_b128 v[40:43], v212 offset:4096
  ds_read_b64_tr_b16 v[232:233], v10 offset:0
  ds_read_b64_tr_b16 v[234:235], v10 offset:2048
  ds_read_b128 v[44:47], v213 offset:6144
  ds_read_b64_tr_b16 v[236:237], v11 offset:0
  ds_read_b64_tr_b16 v[238:239], v11 offset:2048
  ds_read_b128 v[48:51], v212 offset:8192
  ds_read_b64_tr_b16 v[240:241], v12 offset:0
  ds_read_b64_tr_b16 v[242:243], v12 offset:2048
  ds_read_b128 v[52:55], v213 offset:10240
  ds_read_b128 v[56:59], v212 offset:12288
  ds_read_b64_tr_b16 v[244:245], v13 offset:0
  ds_read_b64_tr_b16 v[246:247], v13 offset:2048
  ds_read_b128 v[60:63], v213 offset:14336
  ds_read_b64_tr_b16 v[248:249], v14 offset:0
  ds_read_b64_tr_b16 v[250:251], v14 offset:2048
  ds_read_b64_tr_b16 v[252:253], v15 offset:0
  ds_read_b64_tr_b16 v[254:255], v15 offset:2048
  s_waitcnt lgkmcnt(15)
  s_waitcnt lgkmcnt(4)
  v_mfma_f32_16x16x32_bf16 a[0:3], v[32:35], v[224:227], 0
  s_add_u32 m0, s56, 102400
  v_mfma_f32_16x16x32_bf16 a[4:7], v[36:39], v[224:227], 0
  buffer_load_dwordx4 v28, s[12:15], s54 offen offset:0 sc1 lds
  v_mfma_f32_16x16x32_bf16 a[64:67], v[40:43], v[224:227], 0
  v_mfma_f32_16x16x32_bf16 a[68:71], v[44:47], v[224:227], 0
  v_mfma_f32_16x16x32_bf16 a[128:131], v[48:51], v[224:227], 0
  buffer_load_dwordx4 v29, s[12:15], s54 offen offset:1024 sc1 lds
  v_mfma_f32_16x16x32_bf16 a[132:135], v[52:55], v[224:227], 0
  v_mfma_f32_16x16x32_bf16 a[192:195], v[56:59], v[224:227], 0
  v_mfma_f32_16x16x32_bf16 a[196:199], v[60:63], v[224:227], 0
  ds_read_b64_tr_b16 v[224:225], v8 offset:16384
  v_mfma_f32_16x16x32_bf16 a[8:11], v[32:35], v[228:231], 0
  ds_read_b64_tr_b16 v[226:227], v8 offset:18432
  v_mfma_f32_16x16x32_bf16 a[12:15], v[36:39], v[228:231], 0
  buffer_load_dwordx4 v30, s[12:15], s54 offen offset:2048 sc1 lds
  v_mfma_f32_16x16x32_bf16 a[72:75], v[40:43], v[228:231], 0
  ds_read_b128 v[64:67], v213 offset:0
  v_mfma_f32_16x16x32_bf16 a[76:79], v[44:47], v[228:231], 0
  v_mfma_f32_16x16x32_bf16 a[136:139], v[48:51], v[228:231], 0
  buffer_load_dwordx4 v31, s[12:15], s54 offen offset:3072 sc1 lds
  s_add_u32 s54, s54, 0x80000
  v_mfma_f32_16x16x32_bf16 a[140:143], v[52:55], v[228:231], 0
  v_mfma_f32_16x16x32_bf16 a[200:203], v[56:59], v[228:231], 0
  v_mfma_f32_16x16x32_bf16 a[204:207], v[60:63], v[228:231], 0
  ds_read_b64_tr_b16 v[228:229], v9 offset:16384
  v_mfma_f32_16x16x32_bf16 a[16:19], v[32:35], v[232:235], 0
  ds_read_b64_tr_b16 v[230:231], v9 offset:18432
  v_mfma_f32_16x16x32_bf16 a[20:23], v[36:39], v[232:235], 0
  ds_read_b128 v[68:71], v212 offset:2048
  v_mfma_f32_16x16x32_bf16 a[80:83], v[40:43], v[232:235], 0
  v_mfma_f32_16x16x32_bf16 a[84:87], v[44:47], v[232:235], 0
  v_mfma_f32_16x16x32_bf16 a[144:147], v[48:51], v[232:235], 0
  v_mfma_f32_16x16x32_bf16 a[148:151], v[52:55], v[232:235], 0
  v_mfma_f32_16x16x32_bf16 a[208:211], v[56:59], v[232:235], 0
  ds_read_b128 v[72:75], v213 offset:4096
  v_mfma_f32_16x16x32_bf16 a[212:215], v[60:63], v[232:235], 0
  ds_read_b64_tr_b16 v[232:233], v10 offset:16384
  v_mfma_f32_16x16x32_bf16 a[24:27], v[32:35], v[236:239], 0
  ds_read_b64_tr_b16 v[234:235], v10 offset:18432
  v_mfma_f32_16x16x32_bf16 a[28:31], v[36:39], v[236:239], 0
  v_mfma_f32_16x16x32_bf16 a[88:91], v[40:43], v[236:239], 0
  v_mfma_f32_16x16x32_bf16 a[92:95], v[44:47], v[236:239], 0
  v_mfma_f32_16x16x32_bf16 a[152:155], v[48:51], v[236:239], 0
  ds_read_b128 v[76:79], v212 offset:6144
  v_mfma_f32_16x16x32_bf16 a[156:159], v[52:55], v[236:239], 0
  v_mfma_f32_16x16x32_bf16 a[216:219], v[56:59], v[236:239], 0
  v_mfma_f32_16x16x32_bf16 a[220:223], v[60:63], v[236:239], 0
  ds_read_b64_tr_b16 v[236:237], v11 offset:16384
  v_mfma_f32_16x16x32_bf16 a[32:35], v[32:35], v[240:243], 0
  ds_read_b64_tr_b16 v[238:239], v11 offset:18432
  v_mfma_f32_16x16x32_bf16 a[36:39], v[36:39], v[240:243], 0
  v_mfma_f32_16x16x32_bf16 a[96:99], v[40:43], v[240:243], 0
  ds_read_b128 v[80:83], v213 offset:8192
  v_mfma_f32_16x16x32_bf16 a[100:103], v[44:47], v[240:243], 0
  v_mfma_f32_16x16x32_bf16 a[160:163], v[48:51], v[240:243], 0
  buffer_load_dword v2, v3, s[8:11], s53 offen
  v_mfma_f32_16x16x32_bf16 a[164:167], v[52:55], v[240:243], 0
  v_mfma_f32_16x16x32_bf16 a[224:227], v[56:59], v[240:243], 0
  v_mfma_f32_16x16x32_bf16 a[228:231], v[60:63], v[240:243], 0
  ds_read_b64_tr_b16 v[240:241], v12 offset:16384
  v_mfma_f32_16x16x32_bf16 a[40:43], v[32:35], v[244:247], 0
  ds_read_b64_tr_b16 v[242:243], v12 offset:18432
  v_mfma_f32_16x16x32_bf16 a[44:47], v[36:39], v[244:247], 0
  ds_read_b128 v[84:87], v212 offset:10240
  v_mfma_f32_16x16x32_bf16 a[104:107], v[40:43], v[244:247], 0
  v_mfma_f32_16x16x32_bf16 a[108:111], v[44:47], v[244:247], 0
  v_mfma_f32_16x16x32_bf16 a[168:171], v[48:51], v[244:247], 0
  buffer_load_dword v2, v4, s[12:15], s54 offen
  v_mfma_f32_16x16x32_bf16 a[172:175], v[52:55], v[244:247], 0
  v_mfma_f32_16x16x32_bf16 a[232:235], v[56:59], v[244:247], 0
  ds_read_b128 v[88:91], v213 offset:12288
  v_mfma_f32_16x16x32_bf16 a[236:239], v[60:63], v[244:247], 0
  s_waitcnt lgkmcnt(15)
  ds_read_b64_tr_b16 v[244:245], v13 offset:16384
  v_mfma_f32_16x16x32_bf16 a[48:51], v[32:35], v[248:251], 0
  ds_read_b64_tr_b16 v[246:247], v13 offset:18432
  v_mfma_f32_16x16x32_bf16 a[52:55], v[36:39], v[248:251], 0
  v_mfma_f32_16x16x32_bf16 a[112:115], v[40:43], v[248:251], 0
  v_mfma_f32_16x16x32_bf16 a[116:119], v[44:47], v[248:251], 0
  v_mfma_f32_16x16x32_bf16 a[176:179], v[48:51], v[248:251], 0
  ds_read_b128 v[92:95], v212 offset:14336
  v_mfma_f32_16x16x32_bf16 a[180:183], v[52:55], v[248:251], 0
  v_mfma_f32_16x16x32_bf16 a[240:243], v[56:59], v[248:251], 0
  v_mfma_f32_16x16x32_bf16 a[244:247], v[60:63], v[248:251], 0
  ds_read_b64_tr_b16 v[248:249], v14 offset:16384
  v_mfma_f32_16x16x32_bf16 a[56:59], v[32:35], v[252:255], 0
  ds_read_b64_tr_b16 v[250:251], v14 offset:18432
  v_mfma_f32_16x16x32_bf16 a[60:63], v[36:39], v[252:255], 0
  v_mfma_f32_16x16x32_bf16 a[120:123], v[40:43], v[252:255], 0
  v_mfma_f32_16x16x32_bf16 a[124:127], v[44:47], v[252:255], 0
  v_mfma_f32_16x16x32_bf16 a[184:187], v[48:51], v[252:255], 0
  v_mfma_f32_16x16x32_bf16 a[188:191], v[52:55], v[252:255], 0
  v_mfma_f32_16x16x32_bf16 a[248:251], v[56:59], v[252:255], 0
  v_mfma_f32_16x16x32_bf16 a[252:255], v[60:63], v[252:255], 0
  ds_read_b64_tr_b16 v[252:253], v15 offset:16384
  ds_read_b64_tr_b16 v[254:255], v15 offset:18432
  s_waitcnt lgkmcnt(4)
  v_mfma_f32_16x16x32_bf16 a[0:3], v[64:67], v[224:227], a[0:3]
  v_mfma_f32_16x16x32_bf16 a[4:7], v[68:71], v[224:227], a[4:7]
  v_mfma_f32_16x16x32_bf16 a[64:67], v[72:75], v[224:227], a[64:67]
  v_mfma_f32_16x16x32_bf16 a[68:71], v[76:79], v[224:227], a[68:71]
  v_mfma_f32_16x16x32_bf16 a[128:131], v[80:83], v[224:227], a[128:131]
  v_mfma_f32_16x16x32_bf16 a[132:135], v[84:87], v[224:227], a[132:135]
  v_mfma_f32_16x16x32_bf16 a[192:195], v[88:91], v[224:227], a[192:195]
  v_mfma_f32_16x16x32_bf16 a[196:199], v[92:95], v[224:227], a[196:199]
  s_waitcnt vmcnt(2)
  s_waitcnt lgkmcnt(0)
  s_barrier
  ds_read_b64_tr_b16 v[224:225], v8 offset:32768
  v_mfma_f32_16x16x32_bf16 a[8:11], v[64:67], v[228:231], a[8:11]
  ds_read_b64_tr_b16 v[226:227], v8 offset:34816
  v_mfma_f32_16x16x32_bf16 a[12:15], v[68:71], v[228:231], a[12:15]
  v_mfma_f32_16x16x32_bf16 a[72:75], v[72:75], v[228:231], a[72:75]
  ds_read_b128 v[32:35], v212 offset:32768
  s_add_u32 m0, s56, 0
  v_mfma_f32_16x16x32_bf16 a[76:79], v[76:79], v[228:231], a[76:79]
  buffer_load_dwordx4 v16, s[8:11], s53 offen offset:0 sc1 lds
  v_mfma_f32_16x16x32_bf16 a[136:139], v[80:83], v[228:231], a[136:139]
  v_mfma_f32_16x16x32_bf16 a[140:143], v[84:87], v[228:231], a[140:143]
  v_mfma_f32_16x16x32_bf16 a[200:203], v[88:91], v[228:231], a[200:203]
  v_mfma_f32_16x16x32_bf16 a[204:207], v[92:95], v[228:231], a[204:207]
  ds_read_b64_tr_b16 v[228:229], v9 offset:32768
  v_mfma_f32_16x16x32_bf16 a[16:19], v[64:67], v[232:235], a[16:19]
  buffer_load_dwordx4 v17, s[8:11], s53 offen offset:1024 sc1 lds
  v_mfma_f32_16x16x32_bf16 a[20:23], v[68:71], v[232:235], a[20:23]
  ds_read_b64_tr_b16 v[230:231], v9 offset:34816
  v_mfma_f32_16x16x32_bf16 a[80:83], v[72:75], v[232:235], a[80:83]
  ds_read_b128 v[36:39], v213 offset:34816
  v_mfma_f32_16x16x32_bf16 a[84:87], v[76:79], v[232:235], a[84:87]
  buffer_load_dwordx4 v18, s[8:11], s53 offen offset:2048 sc1 lds
  v_mfma_f32_16x16x32_bf16 a[144:147], v[80:83], v[232:235], a[144:147]
  v_mfma_f32_16x16x32_bf16 a[148:151], v[84:87], v[232:235], a[148:151]
  v_mfma_f32_16x16x32_bf16 a[208:211], v[88:91], v[232:235], a[208:211]
  ds_read_b128 v[40:43], v212 offset:36864
  v_mfma_f32_16x16x32_bf16 a[212:215], v[92:95], v[232:235], a[212:215]
  ds_read_b64_tr_b16 v[232:233], v10 offset:32768
  v_mfma_f32_16x16x32_bf16 a[24:27], v[64:67], v[236:239], a[24:27]
  buffer_load_dwordx4 v19, s[8:11], s53 offen offset:3072 sc1 lds
  v_mfma_f32_16x16x32_bf16 a[28:31], v[68:71], v[236:239], a[28:31]
  ds_read_b64_tr_b16 v[234:235], v10 offset:34816
  v_mfma_f32_16x16x32_bf16 a[88:91], v[72:75], v[236:239], a[88:91]
  v_mfma_f32_16x16x32_bf16 a[92:95], v[76:79], v[236:239], a[92:95]
  s_add_u32 m0, s56, 4096
  v_mfma_f32_16x16x32_bf16 a[152:155], v[80:83], v[236:239], a[152:155]
  ds_read_b128 v[44:47], v213 offset:38912
  v_mfma_f32_16x16x32_bf16 a[156:159], v[84:87], v[236:239], a[156:159]
  buffer_load_dwordx4 v20, s[8:11], s53 offen offset:0 sc1 lds
  v_mfma_f32_16x16x32_bf16 a[216:219], v[88:91], v[236:239], a[216:219]
  v_mfma_f32_16x16x32_bf16 a[220:223], v[92:95], v[236:239], a[220:223]
  ds_read_b64_tr_b16 v[236:237], v11 offset:32768
  v_mfma_f32_16x16x32_bf16 a[32:35], v[64:67], v[240:243], a[32:35]
  ds_read_b64_tr_b16 v[238:239], v11 offset:34816
  v_mfma_f32_16x16x32_bf16 a[36:39], v[68:71], v[240:243], a[36:39]
  buffer_load_dwordx4 v21, s[8:11], s53 offen offset:1024 sc1 lds
  v_mfma_f32_16x16x32_bf16 a[96:99], v[72:75], v[240:243], a[96:99]
  ds_read_b128 v[48:51], v212 offset:40960
  v_mfma_f32_16x16x32_bf16 a[100:103], v[76:79], v[240:243], a[100:103]
  v_mfma_f32_16x16x32_bf16 a[160:163], v[80:83], v[240:243], a[160:163]
  buffer_load_dwordx4 v22, s[8:11], s53 offen offset:2048 sc1 lds
  v_mfma_f32_16x16x32_bf16 a[164:167], v[84:87], v[240:243], a[164:167]
  v_mfma_f32_16x16x32_bf16 a[224:227], v[88:91], v[240:243], a[224:227]
  v_mfma_f32_16x16x32_bf16 a[228:231], v[92:95], v[240:243], a[228:231]
  ds_read_b64_tr_b16 v[240:241], v12 offset:32768
  v_mfma_f32_16x16x32_bf16 a[40:43], v[64:67], v[244:247], a[40:43]
  ds_read_b64_tr_b16 v[242:243], v12 offset:34816
  v_mfma_f32_16x16x32_bf16 a[44:47], v[68:71], v[244:247], a[44:47]
  ds_read_b128 v[52:55], v213 offset:43008
  v_mfma_f32_16x16x32_bf16 a[104:107], v[72:75], v[244:247], a[104:107]
  buffer_load_dwordx4 v23, s[8:11], s53 offen offset:3072 sc1 lds
  s_add_u32 s53, s53, 128
  v_mfma_f32_16x16x32_bf16 a[108:111], v[76:79], v[244:247], a[108:111]
  v_mfma_f32_16x16x32_bf16 a[168:171], v[80:83], v[244:247], a[168:171]
  s_add_u32 m0, s56, 65536
  v_mfma_f32_16x16x32_bf16 a[172:175], v[84:87], v[244:247], a[172:175]
  buffer_load_dwordx4 v24, s[12:15], s54 offen offset:0 sc1 lds
  v_mfma_f32_16x16x32_bf16 a[232:235], v[88:91], v[244:247], a[232:235]
  ds_read_b128 v[56:59], v212 offset:45056
  v_mfma_f32_16x16x32_bf16 a[236:239], v[92:95], v[244:247], a[236:239]
  ds_read_b64_tr_b16 v[244:245], v13 offset:32768
  v_mfma_f32_16x16x32_bf16 a[48:51], v[64:67], v[248:251], a[48:51]
  ds_read_b64_tr_b16 v[246:247], v13 offset:34816
  v_mfma_f32_16x16x32_bf16 a[52:55], v[68:71], v[248:251], a[52:55]
  buffer_load_dwordx4 v25, s[12:15], s54 offen offset:1024 sc1 lds
  v_mfma_f32_16x16x32_bf16 a[112:115], v[72:75], v[248:251], a[112:115]
  v_mfma_f32_16x16x32_bf16 a[116:119], v[76:79], v[248:251], a[116:119]
  v_mfma_f32_16x16x32_bf16 a[176:179], v[80:83], v[248:251], a[176:179]
  ds_read_b128 v[60:63], v213 offset:47104
  v_mfma_f32_16x16x32_bf16 a[180:183], v[84:87], v[248:251], a[180:183]
  buffer_load_dwordx4 v26, s[12:15], s54 offen offset:2048 sc1 lds
  v_mfma_f32_16x16x32_bf16 a[240:243], v[88:91], v[248:251], a[240:243]
  v_mfma_f32_16x16x32_bf16 a[244:247], v[92:95], v[248:251], a[244:247]
  ds_read_b64_tr_b16 v[248:249], v14 offset:32768
  v_mfma_f32_16x16x32_bf16 a[56:59], v[64:67], v[252:255], a[56:59]
  ds_read_b64_tr_b16 v[250:251], v14 offset:34816
  v_mfma_f32_16x16x32_bf16 a[60:63], v[68:71], v[252:255], a[60:63]
  buffer_load_dwordx4 v27, s[12:15], s54 offen offset:3072 sc1 lds
  v_mfma_f32_16x16x32_bf16 a[120:123], v[72:75], v[252:255], a[120:123]
  v_mfma_f32_16x16x32_bf16 a[124:127], v[76:79], v[252:255], a[124:127]
  v_mfma_f32_16x16x32_bf16 a[184:187], v[80:83], v[252:255], a[184:187]
  v_mfma_f32_16x16x32_bf16 a[188:191], v[84:87], v[252:255], a[188:191]
  v_mfma_f32_16x16x32_bf16 a[248:251], v[88:91], v[252:255], a[248:251]
  v_mfma_f32_16x16x32_bf16 a[252:255], v[92:95], v[252:255], a[252:255]
  ds_read_b64_tr_b16 v[252:253], v15 offset:32768
  ds_read_b64_tr_b16 v[254:255], v15 offset:34816
  s_waitcnt lgkmcnt(15)
  s_waitcnt lgkmcnt(4)
  v_mfma_f32_16x16x32_bf16 a[0:3], v[32:35], v[224:227], a[0:3]
  v_mfma_f32_16x16x32_bf16 a[4:7], v[36:39], v[224:227], a[4:7]
  s_add_u32 m0, s56, 69632
  v_mfma_f32_16x16x32_bf16 a[64:67], v[40:43], v[224:227], a[64:67]
  buffer_load_dwordx4 v28, s[12:15], s54 offen offset:0 sc1 lds
  v_mfma_f32_16x16x32_bf16 a[68:71], v[44:47], v[224:227], a[68:71]
  v_mfma_f32_16x16x32_bf16 a[128:131], v[48:51], v[224:227], a[128:131]
  v_mfma_f32_16x16x32_bf16 a[132:135], v[52:55], v[224:227], a[132:135]
  buffer_load_dwordx4 v29, s[12:15], s54 offen offset:1024 sc1 lds
  v_mfma_f32_16x16x32_bf16 a[192:195], v[56:59], v[224:227], a[192:195]
  v_mfma_f32_16x16x32_bf16 a[196:199], v[60:63], v[224:227], a[196:199]
  ds_read_b64_tr_b16 v[224:225], v8 offset:49152
  v_mfma_f32_16x16x32_bf16 a[8:11], v[32:35], v[228:231], a[8:11]
  ds_read_b64_tr_b16 v[226:227], v8 offset:51200
  v_mfma_f32_16x16x32_bf16 a[12:15], v[36:39], v[228:231], a[12:15]
  buffer_load_dwordx4 v30, s[12:15], s54 offen offset:2048 sc1 lds
  v_mfma_f32_16x16x32_bf16 a[72:75], v[40:43], v[228:231], a[72:75]
  ds_read_b128 v[64:67], v213 offset:32768
  v_mfma_f32_16x16x32_bf16 a[76:79], v[44:47], v[228:231], a[76:79]
  v_mfma_f32_16x16x32_bf16 a[136:139], v[48:51], v[228:231], a[136:139]
  buffer_load_dwordx4 v31, s[12:15], s54 offen offset:3072 sc1 lds
  s_add_u32 s54, s54, 0x80000
  v_mfma_f32_16x16x32_bf16 a[140:143], v[52:55], v[228:231], a[140:143]
  v_mfma_f32_16x16x32_bf16 a[200:203], v[56:59], v[228:231], a[200:203]
  v_mfma_f32_16x16x32_bf16 a[204:207], v[60:63], v[228:231], a[204:207]
  ds_read_b64_tr_b16 v[228:229], v9 offset:49152
  v_mfma_f32_16x16x32_bf16 a[16:19], v[32:35], v[232:235], a[16:19]
  ds_read_b64_tr_b16 v[230:231], v9 offset:51200
  v_mfma_f32_16x16x32_bf16 a[20:23], v[36:39], v[232:235], a[20:23]
  ds_read_b128 v[68:71], v212 offset:34816
  v_mfma_f32_16x16x32_bf16 a[80:83], v[40:43], v[232:235], a[80:83]
  s_lshl_b32 s63, s3, 8
  v_mfma_f32_16x16x32_bf16 a[84:87], v[44:47], v[232:235], a[84:87]
  s_add_u32 s61, s63, 128
  v_mfma_f32_16x16x32_bf16 a[144:147], v[48:51], v[232:235], a[144:147]
  v_mfma_f32_16x16x32_bf16 a[148:151], v[52:55], v[232:235], a[148:151]
  s_cmp_eq_u32 s3, 3
  s_cselect_b32 s61, 0, s61
  v_mfma_f32_16x16x32_bf16 a[208:211], v[56:59], v[232:235], a[208:211]
  ds_read_b128 v[72:75], v213 offset:36864
  v_mfma_f32_16x16x32_bf16 a[212:215], v[60:63], v[232:235], a[212:215]
  ds_read_b64_tr_b16 v[232:233], v10 offset:49152
  v_mfma_f32_16x16x32_bf16 a[24:27], v[32:35], v[236:239], a[24:27]
  ds_read_b64_tr_b16 v[234:235], v10 offset:51200
  v_mfma_f32_16x16x32_bf16 a[28:31], v[36:39], v[236:239], a[28:31]
  v_mfma_f32_16x16x32_bf16 a[88:91], v[40:43], v[236:239], a[88:91]
  s_lshl_b32 s7, s33, 7
  v_mfma_f32_16x16x32_bf16 a[92:95], v[44:47], v[236:239], a[92:95]
  s_lshl_b32 s6, s32, 3
  v_mfma_f32_16x16x32_bf16 a[152:155], v[48:51], v[236:239], a[152:155]
  ds_read_b128 v[76:79], v212 offset:38912
  v_mfma_f32_16x16x32_bf16 a[156:159], v[52:55], v[236:239], a[156:159]
  s_add_u32 s7, s7, s6
  v_mfma_f32_16x16x32_bf16 a[216:219], v[56:59], v[236:239], a[216:219]
  v_lshrrev_b32 v6, 3, v0
  v_mfma_f32_16x16x32_bf16 a[220:223], v[60:63], v[236:239], a[220:223]
  ds_read_b64_tr_b16 v[236:237], v11 offset:49152
  v_mfma_f32_16x16x32_bf16 a[32:35], v[32:35], v[240:243], a[32:35]
  ds_read_b64_tr_b16 v[238:239], v11 offset:51200
  v_mfma_f32_16x16x32_bf16 a[36:39], v[36:39], v[240:243], a[36:39]
  v_add_u32 v6, s7, v6
  v_mfma_f32_16x16x32_bf16 a[96:99], v[40:43], v[240:243], a[96:99]
  ds_read_b128 v[80:83], v213 offset:40960
  v_mfma_f32_16x16x32_bf16 a[100:103], v[44:47], v[240:243], a[100:103]
  v_mfma_f32_16x16x32_bf16 a[160:163], v[48:51], v[240:243], a[160:163]
  buffer_load_dword v2, v3, s[8:11], s53 offen
  v_mfma_f32_16x16x32_bf16 a[164:167], v[52:55], v[240:243], a[164:167]
  v_mul_u32_u24 v6, 896, v6
  v_mfma_f32_16x16x32_bf16 a[224:227], v[56:59], v[240:243], a[224:227]
  v_and_b32 v7, 7, v0
  v_mfma_f32_16x16x32_bf16 a[228:231], v[60:63], v[240:243], a[228:231]
  ds_read_b64_tr_b16 v[240:241], v12 offset:49152
  v_mfma_f32_16x16x32_bf16 a[40:43], v[32:35], v[244:247], a[40:43]
  ds_read_b64_tr_b16 v[242:243], v12 offset:51200
  v_mfma_f32_16x16x32_bf16 a[44:47], v[36:39], v[244:247], a[44:47]
  ds_read_b128 v[84:87], v212 offset:43008
  v_mfma_f32_16x16x32_bf16 a[104:107], v[40:43], v[244:247], a[104:107]
  v_lshl_add_u32 v132, v7, 4, v6
  v_mfma_f32_16x16x32_bf16 a[108:111], v[44:47], v[244:247], a[108:111]
  v_mov_b32 v137, 0
  v_mfma_f32_16x16x32_bf16 a[168:171], v[48:51], v[244:247], a[168:171]
  buffer_load_dword v2, v4, s[12:15], s54 offen
  v_mfma_f32_16x16x32_bf16 a[172:175], v[52:55], v[244:247], a[172:175]
  buffer_load_dwordx4 v[96:99], v132, s[20:23], 0 offen offset:0
  v_mfma_f32_16x16x32_bf16 a[232:235], v[56:59], v[244:247], a[232:235]
  ds_read_b128 v[88:91], v213 offset:45056
  v_mfma_f32_16x16x32_bf16 a[236:239], v[60:63], v[244:247], a[236:239]
  s_waitcnt lgkmcnt(15)
  ds_read_b64_tr_b16 v[244:245], v13 offset:49152
  v_mfma_f32_16x16x32_bf16 a[48:51], v[32:35], v[248:251], a[48:51]
  ds_read_b64_tr_b16 v[246:247], v13 offset:51200
  v_mfma_f32_16x16x32_bf16 a[52:55], v[36:39], v[248:251], a[52:55]
  v_mfma_f32_16x16x32_bf16 a[112:115], v[40:43], v[248:251], a[112:115]
  buffer_load_dwordx4 v[100:103], v132, s[20:23], 0 offen offset:128
  v_mfma_f32_16x16x32_bf16 a[116:119], v[44:47], v[248:251], a[116:119]
  buffer_load_dwordx4 v[104:107], v132, s[20:23], 0 offen offset:256
  v_mfma_f32_16x16x32_bf16 a[176:179], v[48:51], v[248:251], a[176:179]
  ds_read_b128 v[92:95], v212 offset:47104
  v_mfma_f32_16x16x32_bf16 a[180:183], v[52:55], v[248:251], a[180:183]
  buffer_load_dwordx4 v[108:111], v132, s[20:23], 0 offen offset:384
  v_mfma_f32_16x16x32_bf16 a[240:243], v[56:59], v[248:251], a[240:243]
  buffer_load_dwordx4 v[112:115], v132, s[20:23], 0 offen offset:512
  v_mfma_f32_16x16x32_bf16 a[244:247], v[60:63], v[248:251], a[244:247]
  ds_read_b64_tr_b16 v[248:249], v14 offset:49152
  v_mfma_f32_16x16x32_bf16 a[56:59], v[32:35], v[252:255], a[56:59]
  ds_read_b64_tr_b16 v[250:251], v14 offset:51200
  v_mfma_f32_16x16x32_bf16 a[60:63], v[36:39], v[252:255], a[60:63]
  buffer_load_dwordx4 v[116:119], v132, s[20:23], 0 offen offset:640
  v_mfma_f32_16x16x32_bf16 a[120:123], v[40:43], v[252:255], a[120:123]
  buffer_load_dwordx4 v[120:123], v132, s[20:23], 0 offen offset:768
  v_mfma_f32_16x16x32_bf16 a[124:127], v[44:47], v[252:255], a[124:127]
  v_mfma_f32_16x16x32_bf16 a[184:187], v[48:51], v[252:255], a[184:187]
  buffer_load_dwordx4 v[124:127], v132, s[20:23], s63 offen
  v_mfma_f32_16x16x32_bf16 a[188:191], v[52:55], v[252:255], a[188:191]
  buffer_load_dwordx4 v[128:131], v132, s[20:23], s61 offen
  v_mfma_f32_16x16x32_bf16 a[248:251], v[56:59], v[252:255], a[248:251]
  global_load_dword v139, v137, s[84:85]
  v_mfma_f32_16x16x32_bf16 a[252:255], v[60:63], v[252:255], a[252:255]
  ds_read_b64_tr_b16 v[252:253], v15 offset:49152
  ds_read_b64_tr_b16 v[254:255], v15 offset:51200
  s_waitcnt lgkmcnt(4)
  v_mfma_f32_16x16x32_bf16 a[0:3], v[64:67], v[224:227], a[0:3]
  v_mfma_f32_16x16x32_bf16 a[4:7], v[68:71], v[224:227], a[4:7]
  v_mfma_f32_16x16x32_bf16 a[64:67], v[72:75], v[224:227], a[64:67]
  v_mfma_f32_16x16x32_bf16 a[68:71], v[76:79], v[224:227], a[68:71]
  v_mfma_f32_16x16x32_bf16 a[128:131], v[80:83], v[224:227], a[128:131]
  v_mfma_f32_16x16x32_bf16 a[132:135], v[84:87], v[224:227], a[132:135]
  v_mfma_f32_16x16x32_bf16 a[192:195], v[88:91], v[224:227], a[192:195]
  v_mfma_f32_16x16x32_bf16 a[196:199], v[92:95], v[224:227], a[196:199]
  s_waitcnt vmcnt(12)
  s_waitcnt lgkmcnt(0)
  s_barrier
  ds_read_b64_tr_b16 v[224:225], v8 offset:0
  v_mfma_f32_16x16x32_bf16 a[8:11], v[64:67], v[228:231], a[8:11]
  ds_read_b64_tr_b16 v[226:227], v8 offset:2048
  v_mfma_f32_16x16x32_bf16 a[12:15], v[68:71], v[228:231], a[12:15]
  v_mfma_f32_16x16x32_bf16 a[72:75], v[72:75], v[228:231], a[72:75]
  ds_read_b128 v[32:35], v212 offset:0
  s_add_u32 m0, s56, 32768
  v_mfma_f32_16x16x32_bf16 a[76:79], v[76:79], v[228:231], a[76:79]
  buffer_load_dwordx4 v16, s[8:11], s53 offen offset:0 sc1 lds
  v_mfma_f32_16x16x32_bf16 a[136:139], v[80:83], v[228:231], a[136:139]
  v_mfma_f32_16x16x32_bf16 a[140:143], v[84:87], v[228:231], a[140:143]
  v_mfma_f32_16x16x32_bf16 a[200:203], v[88:91], v[228:231], a[200:203]
  v_mfma_f32_16x16x32_bf16 a[204:207], v[92:95], v[228:231], a[204:207]
  ds_read_b64_tr_b16 v[228:229], v9 offset:0
  v_mfma_f32_16x16x32_bf16 a[16:19], v[64:67], v[232:235], a[16:19]
  buffer_load_dwordx4 v17, s[8:11], s53 offen offset:1024 sc1 lds
  v_mfma_f32_16x16x32_bf16 a[20:23], v[68:71], v[232:235], a[20:23]
  ds_read_b64_tr_b16 v[230:231], v9 offset:2048
  v_mfma_f32_16x16x32_bf16 a[80:83], v[72:75], v[232:235], a[80:83]
  ds_read_b128 v[36:39], v213 offset:2048
  v_mfma_f32_16x16x32_bf16 a[84:87], v[76:79], v[232:235], a[84:87]
  buffer_load_dwordx4 v18, s[8:11], s53 offen offset:2048 sc1 lds
  v_mfma_f32_16x16x32_bf16 a[144:147], v[80:83], v[232:235], a[144:147]
  v_mfma_f32_16x16x32_bf16 a[148:151], v[84:87], v[232:235], a[148:151]
  v_mfma_f32_16x16x32_bf16 a[208:211], v[88:91], v[232:235], a[208:211]
  ds_read_b128 v[40:43], v212 offset:4096
  v_mfma_f32_16x16x32_bf16 a[212:215], v[92:95], v[232:235], a[212:215]
  ds_read_b64_tr_b16 v[232:233], v10 offset:0
  v_mfma_f32_16x16x32_bf16 a[24:27], v[64:67], v[236:239], a[24:27]
  buffer_load_dwordx4 v19, s[8:11], s53 offen offset:3072 sc1 lds
  v_mfma_f32_16x16x32_bf16 a[28:31], v[68:71], v[236:239], a[28:31]
  ds_read_b64_tr_b16 v[234:235], v10 offset:2048
  v_mfma_f32_16x16x32_bf16 a[88:91], v[72:75], v[236:239], a[88:91]
  v_mfma_f32_16x16x32_bf16 a[92:95], v[76:79], v[236:239], a[92:95]
  s_add_u32 m0, s56, 36864
  v_mfma_f32_16x16x32_bf16 a[152:155], v[80:83], v[236:239], a[152:155]
  ds_read_b128 v[44:47], v213 offset:6144
  v_mfma_f32_16x16x32_bf16 a[156:159], v[84:87], v[236:239], a[156:159]
  buffer_load_dwordx4 v20, s[8:11], s53 offen offset:0 sc1 lds
  v_mfma_f32_16x16x32_bf16 a[216:219], v[88:91], v[236:239], a[216:219]
  v_mfma_f32_16x16x32_bf16 a[220:223], v[92:95], v[236:239], a[220:223]
  ds_read_b64_tr_b16 v[236:237], v11 offset:0
  v_mfma_f32_16x16x32_bf16 a[32:35], v[64:67], v[240:243], a[32:35]
  ds_read_b64_tr_b16 v[238:239], v11 offset:2048
  v_mfma_f32_16x16x32_bf16 a[36:39], v[68:71], v[240:243], a[36:39]
  buffer_load_dwordx4 v21, s[8:11], s53 offen offset:1024 sc1 lds
  v_mfma_f32_16x16x32_bf16 a[96:99], v[72:75], v[240:243], a[96:99]
  ds_read_b128 v[48:51], v212 offset:8192
  v_mfma_f32_16x16x32_bf16 a[100:103], v[76:79], v[240:243], a[100:103]
  v_mfma_f32_16x16x32_bf16 a[160:163], v[80:83], v[240:243], a[160:163]
  buffer_load_dwordx4 v22, s[8:11], s53 offen offset:2048 sc1 lds
  v_mfma_f32_16x16x32_bf16 a[164:167], v[84:87], v[240:243], a[164:167]
  v_mfma_f32_16x16x32_bf16 a[224:227], v[88:91], v[240:243], a[224:227]
  v_mfma_f32_16x16x32_bf16 a[228:231], v[92:95], v[240:243], a[228:231]
  ds_read_b64_tr_b16 v[240:241], v12 offset:0
  v_mfma_f32_16x16x32_bf16 a[40:43], v[64:67], v[244:247], a[40:43]
  ds_read_b64_tr_b16 v[242:243], v12 offset:2048
  v_mfma_f32_16x16x32_bf16 a[44:47], v[68:71], v[244:247], a[44:47]
  ds_read_b128 v[52:55], v213 offset:10240
  v_mfma_f32_16x16x32_bf16 a[104:107], v[72:75], v[244:247], a[104:107]
  buffer_load_dwordx4 v23, s[8:11], s53 offen offset:3072 sc1 lds
  s_add_u32 s53, s53, 128
  v_mfma_f32_16x16x32_bf16 a[108:111], v[76:79], v[244:247], a[108:111]
  v_mfma_f32_16x16x32_bf16 a[168:171], v[80:83], v[244:247], a[168:171]
  s_add_u32 m0, s56, 98304
  v_mfma_f32_16x16x32_bf16 a[172:175], v[84:87], v[244:247], a[172:175]
  buffer_load_dwordx4 v24, s[12:15], s54 offen offset:0 sc1 lds
  v_mfma_f32_16x16x32_bf16 a[232:235], v[88:91], v[244:247], a[232:235]
  ds_read_b128 v[56:59], v212 offset:12288
  v_mfma_f32_16x16x32_bf16 a[236:239], v[92:95], v[244:247], a[236:239]
  ds_read_b64_tr_b16 v[244:245], v13 offset:0
  v_mfma_f32_16x16x32_bf16 a[48:51], v[64:67], v[248:251], a[48:51]
  ds_read_b64_tr_b16 v[246:247], v13 offset:2048
  v_mfma_f32_16x16x32_bf16 a[52:55], v[68:71], v[248:251], a[52:55]
  buffer_load_dwordx4 v25, s[12:15], s54 offen offset:1024 sc1 lds
  v_mfma_f32_16x16x32_bf16 a[112:115], v[72:75], v[248:251], a[112:115]
  v_mfma_f32_16x16x32_bf16 a[116:119], v[76:79], v[248:251], a[116:119]
  v_mfma_f32_16x16x32_bf16 a[176:179], v[80:83], v[248:251], a[176:179]
  ds_read_b128 v[60:63], v213 offset:14336
  v_mfma_f32_16x16x32_bf16 a[180:183], v[84:87], v[248:251], a[180:183]
  buffer_load_dwordx4 v26, s[12:15], s54 offen offset:2048 sc1 lds
  v_mfma_f32_16x16x32_bf16 a[240:243], v[88:91], v[248:251], a[240:243]
  v_mfma_f32_16x16x32_bf16 a[244:247], v[92:95], v[248:251], a[244:247]
  ds_read_b64_tr_b16 v[248:249], v14 offset:0
  v_mfma_f32_16x16x32_bf16 a[56:59], v[64:67], v[252:255], a[56:59]
  ds_read_b64_tr_b16 v[250:251], v14 offset:2048
  v_mfma_f32_16x16x32_bf16 a[60:63], v[68:71], v[252:255], a[60:63]
  buffer_load_dwordx4 v27, s[12:15], s54 offen offset:3072 sc1 lds
  v_mfma_f32_16x16x32_bf16 a[120:123], v[72:75], v[252:255], a[120:123]
  v_mfma_f32_16x16x32_bf16 a[124:127], v[76:79], v[252:255], a[124:127]
  v_mfma_f32_16x16x32_bf16 a[184:187], v[80:83], v[252:255], a[184:187]
  v_mfma_f32_16x16x32_bf16 a[188:191], v[84:87], v[252:255], a[188:191]
  v_mfma_f32_16x16x32_bf16 a[248:251], v[88:91], v[252:255], a[248:251]
  v_mfma_f32_16x16x32_bf16 a[252:255], v[92:95], v[252:255], a[252:255]
  ds_read_b64_tr_b16 v[252:253], v15 offset:0
  ds_read_b64_tr_b16 v[254:255], v15 offset:2048
  s_waitcnt lgkmcnt(15)
  s_waitcnt lgkmcnt(4)
  v_mfma_f32_16x16x32_bf16 a[0:3], v[32:35], v[224:227], a[0:3]
  v_mfma_f32_16x16x32_bf16 a[4:7], v[36:39], v[224:227], a[4:7]
  s_add_u32 m0, s56, 102400
  v_mfma_f32_16x16x32_bf16 a[64:67], v[40:43], v[224:227], a[64:67]
  buffer_load_dwordx4 v28, s[12:15], s54 offen offset:0 sc1 lds
  v_mfma_f32_16x16x32_bf16 a[68:71], v[44:47], v[224:227], a[68:71]
  v_mfma_f32_16x16x32_bf16 a[128:131], v[48:51], v[224:227], a[128:131]
  v_mfma_f32_16x16x32_bf16 a[132:135], v[52:55], v[224:227], a[132:135]
  buffer_load_dwordx4 v29, s[12:15], s54 offen offset:1024 sc1 lds
  v_mfma_f32_16x16x32_bf16 a[192:195], v[56:59], v[224:227], a[192:195]
  v_mfma_f32_16x16x32_bf16 a[196:199], v[60:63], v[224:227], a[196:199]
  ds_read_b64_tr_b16 v[224:225], v8 offset:16384
  v_mfma_f32_16x16x32_bf16 a[8:11], v[32:35], v[228:231], a[8:11]
  ds_read_b64_tr_b16 v[226:227], v8 offset:18432
  v_mfma_f32_16x16x32_bf16 a[12:15], v[36:39], v[228:231], a[12:15]
  buffer_load_dwordx4 v30, s[12:15], s54 offen offset:2048 sc1 lds
  v_mfma_f32_16x16x32_bf16 a[72:75], v[40:43], v[228:231], a[72:75]
  ds_read_b128 v[64:67], v213 offset:0
  v_mfma_f32_16x16x32_bf16 a[76:79], v[44:47], v[228:231], a[76:79]
  v_mfma_f32_16x16x32_bf16 a[136:139], v[48:51], v[228:231], a[136:139]
  buffer_load_dwordx4 v31, s[12:15], s54 offen offset:3072 sc1 lds
  s_add_u32 s54, s54, 0x80000
  v_mfma_f32_16x16x32_bf16 a[140:143], v[52:55], v[228:231], a[140:143]
  v_mfma_f32_16x16x32_bf16 a[200:203], v[56:59], v[228:231], a[200:203]
  v_mfma_f32_16x16x32_bf16 a[204:207], v[60:63], v[228:231], a[204:207]
  ds_read_b64_tr_b16 v[228:229], v9 offset:16384
  v_mfma_f32_16x16x32_bf16 a[16:19], v[32:35], v[232:235], a[16:19]
  ds_read_b64_tr_b16 v[230:231], v9 offset:18432
  v_mfma_f32_16x16x32_bf16 a[20:23], v[36:39], v[232:235], a[20:23]
  ds_read_b128 v[68:71], v212 offset:2048
  v_mfma_f32_16x16x32_bf16 a[80:83], v[40:43], v[232:235], a[80:83]
  v_mfma_f32_16x16x32_bf16 a[84:87], v[44:47], v[232:235], a[84:87]
  v_mfma_f32_16x16x32_bf16 a[144:147], v[48:51], v[232:235], a[144:147]
  s_lshr_b32 s5, s32, 2
  s_lshl_b32 s6, s33, 2
  v_mfma_f32_16x16x32_bf16 a[148:151], v[52:55], v[232:235], a[148:151]
  s_add_u32 s5, s5, s6
  v_mfma_f32_16x16x32_bf16 a[208:211], v[56:59], v[232:235], a[208:211]
  ds_read_b128 v[72:75], v213 offset:4096
  s_mul_i32 s5, s5, 28672
  v_mfma_f32_16x16x32_bf16 a[212:215], v[60:63], v[232:235], a[212:215]
  ds_read_b64_tr_b16 v[232:233], v10 offset:16384
  v_mfma_f32_16x16x32_bf16 a[24:27], v[32:35], v[236:239], a[24:27]
  ds_read_b64_tr_b16 v[234:235], v10 offset:18432
  v_mfma_f32_16x16x32_bf16 a[28:31], v[36:39], v[236:239], a[28:31]
  s_add_u32 s5, s5, 117440512
  s_lshl_b32 s63, s63, 5
  v_mfma_f32_16x16x32_bf16 a[88:91], v[40:43], v[236:239], a[88:91]
  s_lshl_b32 s61, s61, 5
  s_add_u32 s63, s63, s5
  v_mfma_f32_16x16x32_bf16 a[92:95], v[44:47], v[236:239], a[92:95]
  s_add_u32 s61, s61, s5
  v_mfma_f32_16x16x32_bf16 a[152:155], v[48:51], v[236:239], a[152:155]
  ds_read_b128 v[76:79], v212 offset:6144
  s_bfe_u32 s6, s32, 0x10001
  v_mfma_f32_16x16x32_bf16 a[156:159], v[52:55], v[236:239], a[156:159]
  s_lshl_b32 s6, s6, 10
  v_mfma_f32_16x16x32_bf16 a[216:219], v[56:59], v[236:239], a[216:219]
  s_and_b32 s5, s32, 1
  s_lshl_b32 s5, s5, 7
  v_mfma_f32_16x16x32_bf16 a[220:223], v[60:63], v[236:239], a[220:223]
  ds_read_b64_tr_b16 v[236:237], v11 offset:16384
  v_mfma_f32_16x16x32_bf16 a[32:35], v[32:35], v[240:243], a[32:35]
  ds_read_b64_tr_b16 v[238:239], v11 offset:18432
  s_add_u32 s6, s6, s5
  v_mfma_f32_16x16x32_bf16 a[36:39], v[36:39], v[240:243], a[36:39]
  v_lshrrev_b32 v6, 3, v0
  v_mfma_f32_16x16x32_bf16 a[96:99], v[40:43], v[240:243], a[96:99]
  ds_read_b128 v[80:83], v213 offset:8192
  v_lshlrev_b32 v6, 4, v6
  v_mfma_f32_16x16x32_bf16 a[100:103], v[44:47], v[240:243], a[100:103]
  v_and_b32 v7, 3, v0
  v_mfma_f32_16x16x32_bf16 a[160:163], v[48:51], v[240:243], a[160:163]
  buffer_load_dword v2, v3, s[8:11], s53 offen
  v_lshl_add_u32 v6, v7, 8, v6
  v_mfma_f32_16x16x32_bf16 a[164:167], v[52:55], v[240:243], a[164:167]
  v_bfe_u32 v7, v0, 2, 1
  v_lshl_add_u32 v6, v7, 11, v6
  v_mfma_f32_16x16x32_bf16 a[224:227], v[56:59], v[240:243], a[224:227]
  v_add_u32 v133, s6, v6
  v_mfma_f32_16x16x32_bf16 a[228:231], v[60:63], v[240:243], a[228:231]
  ds_read_b64_tr_b16 v[240:241], v12 offset:16384
  v_mfma_f32_16x16x32_bf16 a[40:43], v[32:35], v[244:247], a[40:43]
  ds_read_b64_tr_b16 v[242:243], v12 offset:18432
  s_mov_b32 s7, 0x3f803f80
  v_mfma_f32_16x16x32_bf16 a[44:47], v[36:39], v[244:247], a[44:47]
  ds_read_b128 v[84:87], v212 offset:10240
  v_mov_b32 v148, 0
  v_mfma_f32_16x16x32_bf16 a[104:107], v[40:43], v[244:247], a[104:107]
  v_mov_b32 v149, 0
  v_mfma_f32_16x16x32_bf16 a[108:111], v[44:47], v[244:247], a[108:111]
  v_mov_b32 v150, 0
  v_mov_b32 v151, 0
  v_mfma_f32_16x16x32_bf16 a[168:171], v[48:51], v[244:247], a[168:171]
  buffer_load_dword v2, v4, s[12:15], s54 offen
  v_mfma_f32_16x16x32_bf16 a[172:175], v[52:55], v[244:247], a[172:175]
  v_mov_b32 v152, 0
  v_mov_b32 v153, 0
  v_mfma_f32_16x16x32_bf16 a[232:235], v[56:59], v[244:247], a[232:235]
  ds_read_b128 v[88:91], v213 offset:12288
  v_mov_b32 v154, 0
  v_mfma_f32_16x16x32_bf16 a[236:239], v[60:63], v[244:247], a[236:239]
  s_waitcnt lgkmcnt(15)
  ds_read_b64_tr_b16 v[244:245], v13 offset:16384
  v_mfma_f32_16x16x32_bf16 a[48:51], v[32:35], v[248:251], a[48:51]
  ds_read_b64_tr_b16 v[246:247], v13 offset:18432
  v_mfma_f32_16x16x32_bf16 a[52:55], v[36:39], v[248:251], a[52:55]
  v_mov_b32 v155, 0
  s_waitcnt vmcnt(27)
  v_lshlrev_b32 v156, 16, v96
  v_mfma_f32_16x16x32_bf16 a[112:115], v[40:43], v[248:251], a[112:115]
  v_and_b32 v157, 0xffff0000, v96
  v_mfma_f32_16x16x32_bf16 a[116:119], v[44:47], v[248:251], a[116:119]
  v_add_f32 v148, v148, v156
  v_add_f32 v149, v149, v157
  v_mfma_f32_16x16x32_bf16 a[176:179], v[48:51], v[248:251], a[176:179]
  ds_read_b128 v[92:95], v212 offset:14336
  v_fmac_f32 v152, v156, v156
  v_mfma_f32_16x16x32_bf16 a[180:183], v[52:55], v[248:251], a[180:183]
  v_fmac_f32 v153, v157, v157
  v_mfma_f32_16x16x32_bf16 a[240:243], v[56:59], v[248:251], a[240:243]
  v_lshlrev_b32 v158, 16, v97
  v_and_b32 v159, 0xffff0000, v97
  v_mfma_f32_16x16x32_bf16 a[244:247], v[60:63], v[248:251], a[244:247]
  ds_read_b64_tr_b16 v[248:249], v14 offset:16384
  v_mfma_f32_16x16x32_bf16 a[56:59], v[32:35], v[252:255], a[56:59]
  ds_read_b64_tr_b16 v[250:251], v14 offset:18432
  v_mfma_f32_16x16x32_bf16 a[60:63], v[36:39], v[252:255], a[60:63]
  v_add_f32 v150, v150, v158
  v_add_f32 v151, v151, v159
  v_mfma_f32_16x16x32_bf16 a[120:123], v[40:43], v[252:255], a[120:123]
  v_fmac_f32 v154, v158, v158
  v_fmac_f32 v155, v159, v159
  v_mfma_f32_16x16x32_bf16 a[124:127], v[44:47], v[252:255], a[124:127]
  v_lshlrev_b32 v160, 16, v98
  v_mfma_f32_16x16x32_bf16 a[184:187], v[48:51], v[252:255], a[184:187]
  v_and_b32 v161, 0xffff0000, v98
  v_add_f32 v148, v148, v160
  v_mfma_f32_16x16x32_bf16 a[188:191], v[52:55], v[252:255], a[188:191]
  v_add_f32 v149, v149, v161
  v_mfma_f32_16x16x32_bf16 a[248:251], v[56:59], v[252:255], a[248:251]
  v_fmac_f32 v152, v160, v160
  v_fmac_f32 v153, v161, v161
  v_mfma_f32_16x16x32_bf16 a[252:255], v[60:63], v[252:255], a[252:255]
  ds_read_b64_tr_b16 v[252:253], v15 offset:16384
  ds_read_b64_tr_b16 v[254:255], v15 offset:18432
  s_waitcnt lgkmcnt(4)
  v_mfma_f32_16x16x32_bf16 a[0:3], v[64:67], v[224:227], a[0:3]
  v_lshlrev_b32 v162, 16, v99
  v_and_b32 v163, 0xffff0000, v99
  v_mfma_f32_16x16x32_bf16 a[4:7], v[68:71], v[224:227], a[4:7]
  v_add_f32 v150, v150, v162
  v_add_f32 v151, v151, v163
  v_mfma_f32_16x16x32_bf16 a[64:67], v[72:75], v[224:227], a[64:67]
  v_fmac_f32 v154, v162, v162
  v_fmac_f32 v155, v163, v163
  v_mfma_f32_16x16x32_bf16 a[68:71], v[76:79], v[224:227], a[68:71]
  s_waitcnt vmcnt(26)
  v_lshlrev_b32 v156, 16, v100
  v_mfma_f32_16x16x32_bf16 a[128:131], v[80:83], v[224:227], a[128:131]
  v_and_b32 v157, 0xffff0000, v100
  v_add_f32 v148, v148, v156
  v_mfma_f32_16x16x32_bf16 a[132:135], v[84:87], v[224:227], a[132:135]
  v_add_f32 v149, v149, v157
  v_fmac_f32 v152, v156, v156
  v_mfma_f32_16x16x32_bf16 a[192:195], v[88:91], v[224:227], a[192:195]
  v_fmac_f32 v153, v157, v157
  v_lshlrev_b32 v158, 16, v101
  v_mfma_f32_16x16x32_bf16 a[196:199], v[92:95], v[224:227], a[196:199]
  s_waitcnt vmcnt(2)
  s_waitcnt lgkmcnt(0)
  s_barrier
  ds_read_b64_tr_b16 v[224:225], v8 offset:32768
  v_mfma_f32_16x16x32_bf16 a[8:11], v[64:67], v[228:231], a[8:11]
  ds_read_b64_tr_b16 v[226:227], v8 offset:34816
  v_and_b32 v159, 0xffff0000, v101
  v_mfma_f32_16x16x32_bf16 a[12:15], v[68:71], v[228:231], a[12:15]
  v_add_f32 v150, v150, v158
  v_add_f32 v151, v151, v159
  v_mfma_f32_16x16x32_bf16 a[72:75], v[72:75], v[228:231], a[72:75]
  ds_read_b128 v[32:35], v212 offset:32768
  s_add_u32 m0, s56, 0
  v_mfma_f32_16x16x32_bf16 a[76:79], v[76:79], v[228:231], a[76:79]
  buffer_load_dwordx4 v16, s[8:11], s53 offen offset:0 sc1 lds
  v_fmac_f32 v154, v158, v158
  v_mfma_f32_16x16x32_bf16 a[136:139], v[80:83], v[228:231], a[136:139]
  v_fmac_f32 v155, v159, v159
  v_lshlrev_b32 v160, 16, v102
  v_mfma_f32_16x16x32_bf16 a[140:143], v[84:87], v[228:231], a[140:143]
  v_and_b32 v161, 0xffff0000, v102
  v_mfma_f32_16x16x32_bf16 a[200:203], v[88:91], v[228:231], a[200:203]
  v_add_f32 v148, v148, v160
  v_add_f32 v149, v149, v161
  v_mfma_f32_16x16x32_bf16 a[204:207], v[92:95], v[228:231], a[204:207]
  ds_read_b64_tr_b16 v[228:229], v9 offset:32768
  v_mfma_f32_16x16x32_bf16 a[16:19], v[64:67], v[232:235], a[16:19]
  buffer_load_dwordx4 v17, s[8:11], s53 offen offset:1024 sc1 lds
  v_fmac_f32 v152, v160, v160
  v_mfma_f32_16x16x32_bf16 a[20:23], v[68:71], v[232:235], a[20:23]
  ds_read_b64_tr_b16 v[230:231], v9 offset:34816
  v_fmac_f32 v153, v161, v161
  v_mfma_f32_16x16x32_bf16 a[80:83], v[72:75], v[232:235], a[80:83]
  ds_read_b128 v[36:39], v213 offset:34816
  v_lshlrev_b32 v162, 16, v103
  v_mfma_f32_16x16x32_bf16 a[84:87], v[76:79], v[232:235], a[84:87]
  buffer_load_dwordx4 v18, s[8:11], s53 offen offset:2048 sc1 lds
  v_and_b32 v163, 0xffff0000, v103
  v_mfma_f32_16x16x32_bf16 a[144:147], v[80:83], v[232:235], a[144:147]
  v_add_f32 v150, v150, v162
  v_add_f32 v151, v151, v163
  v_mfma_f32_16x16x32_bf16 a[148:151], v[84:87], v[232:235], a[148:151]
  v_fmac_f32 v154, v162, v162
  v_fmac_f32 v155, v163, v163
  v_mfma_f32_16x16x32_bf16 a[208:211], v[88:91], v[232:235], a[208:211]
  ds_read_b128 v[40:43], v212 offset:36864
  v_mfma_f32_16x16x32_bf16 a[212:215], v[92:95], v[232:235], a[212:215]
  ds_read_b64_tr_b16 v[232:233], v10 offset:32768
  v_mfma_f32_16x16x32_bf16 a[24:27], v[64:67], v[236:239], a[24:27]
  buffer_load_dwordx4 v19, s[8:11], s53 offen offset:3072 sc1 lds
  v_lshlrev_b32 v156, 16, v104
  v_mfma_f32_16x16x32_bf16 a[28:31], v[68:71], v[236:239], a[28:31]
  ds_read_b64_tr_b16 v[234:235], v10 offset:34816
  v_and_b32 v157, 0xffff0000, v104
  v_mfma_f32_16x16x32_bf16 a[88:91], v[72:75], v[236:239], a[88:91]
  v_add_f32 v148, v148, v156
  v_add_f32 v149, v149, v157
  v_mfma_f32_16x16x32_bf16 a[92:95], v[76:79], v[236:239], a[92:95]
  s_add_u32 m0, s56, 4096
  v_fmac_f32 v152, v156, v156
  v_mfma_f32_16x16x32_bf16 a[152:155], v[80:83], v[236:239], a[152:155]
  ds_read_b128 v[44:47], v213 offset:38912
  v_fmac_f32 v153, v157, v157
  v_mfma_f32_16x16x32_bf16 a[156:159], v[84:87], v[236:239], a[156:159]
  buffer_load_dwordx4 v20, s[8:11], s53 offen offset:0 sc1 lds
  v_lshlrev_b32 v158, 16, v105
  v_mfma_f32_16x16x32_bf16 a[216:219], v[88:91], v[236:239], a[216:219]
  v_and_b32 v159, 0xffff0000, v105
  v_add_f32 v150, v150, v158
  v_mfma_f32_16x16x32_bf16 a[220:223], v[92:95], v[236:239], a[220:223]
  ds_read_b64_tr_b16 v[236:237], v11 offset:32768
  v_mfma_f32_16x16x32_bf16 a[32:35], v[64:67], v[240:243], a[32:35]
  ds_read_b64_tr_b16 v[238:239], v11 offset:34816
  v_mfma_f32_16x16x32_bf16 a[36:39], v[68:71], v[240:243], a[36:39]
  buffer_load_dwordx4 v21, s[8:11], s53 offen offset:1024 sc1 lds
  v_add_f32 v151, v151, v159
  v_mfma_f32_16x16x32_bf16 a[96:99], v[72:75], v[240:243], a[96:99]
  ds_read_b128 v[48:51], v212 offset:40960
  v_fmac_f32 v154, v158, v158
  v_mfma_f32_16x16x32_bf16 a[100:103], v[76:79], v[240:243], a[100:103]
  v_fmac_f32 v155, v159, v159
  v_lshlrev_b32 v160, 16, v106
  v_mfma_f32_16x16x32_bf16 a[160:163], v[80:83], v[240:243], a[160:163]
  buffer_load_dwordx4 v22, s[8:11], s53 offen offset:2048 sc1 lds
  v_and_b32 v161, 0xffff0000, v106
  v_mfma_f32_16x16x32_bf16 a[164:167], v[84:87], v[240:243], a[164:167]
  v_add_f32 v148, v148, v160
  v_add_f32 v149, v149, v161
  v_mfma_f32_16x16x32_bf16 a[224:227], v[88:91], v[240:243], a[224:227]
  v_fmac_f32 v152, v160, v160
  v_fmac_f32 v153, v161, v161
  v_mfma_f32_16x16x32_bf16 a[228:231], v[92:95], v[240:243], a[228:231]
  ds_read_b64_tr_b16 v[240:241], v12 offset:32768
  v_mfma_f32_16x16x32_bf16 a[40:43], v[64:67], v[244:247], a[40:43]
  ds_read_b64_tr_b16 v[242:243], v12 offset:34816
  v_mfma_f32_16x16x32_bf16 a[44:47], v[68:71], v[244:247], a[44:47]
  ds_read_b128 v[52:55], v213 offset:43008
  v_lshlrev_b32 v162, 16, v107
  v_mfma_f32_16x16x32_bf16 a[104:107], v[72:75], v[244:247], a[104:107]
  buffer_load_dwordx4 v23, s[8:11], s53 offen offset:3072 sc1 lds
  s_add_u32 s53, s53, 128
  v_mfma_f32_16x16x32_bf16 a[108:111], v[76:79], v[244:247], a[108:111]
  v_and_b32 v163, 0xffff0000, v107
  v_add_f32 v150, v150, v162
  v_mfma_f32_16x16x32_bf16 a[168:171], v[80:83], v[244:247], a[168:171]
  s_add_u32 m0, s56, 65536
  v_add_f32 v151, v151, v163
  v_mfma_f32_16x16x32_bf16 a[172:175], v[84:87], v[244:247], a[172:175]
  buffer_load_dwordx4 v24, s[12:15], s54 offen offset:0 sc1 lds
  v_fmac_f32 v154, v162, v162
  v_mfma_f32_16x16x32_bf16 a[232:235], v[88:91], v[244:247], a[232:235]
  ds_read_b128 v[56:59], v212 offset:45056
  v_fmac_f32 v155, v163, v163
  v_mfma_f32_16x16x32_bf16 a[236:239], v[92:95], v[244:247], a[236:239]
  ds_read_b64_tr_b16 v[244:245], v13 offset:32768
  v_mfma_f32_16x16x32_bf16 a[48:51], v[64:67], v[248:251], a[48:51]
  ds_read_b64_tr_b16 v[246:247], v13 offset:34816
  v_lshlrev_b32 v156, 16, v108
  v_mfma_f32_16x16x32_bf16 a[52:55], v[68:71], v[248:251], a[52:55]
  buffer_load_dwordx4 v25, s[12:15], s54 offen offset:1024 sc1 lds
  v_and_b32 v157, 0xffff0000, v108
  v_mfma_f32_16x16x32_bf16 a[112:115], v[72:75], v[248:251], a[112:115]
  v_add_f32 v148, v148, v156
  v_mfma_f32_16x16x32_bf16 a[116:119], v[76:79], v[248:251], a[116:119]
  v_add_f32 v149, v149, v157
  v_fmac_f32 v152, v156, v156
  v_mfma_f32_16x16x32_bf16 a[176:179], v[80:83], v[248:251], a[176:179]
  ds_read_b128 v[60:63], v213 offset:47104
  v_fmac_f32 v153, v157, v157
  v_mfma_f32_16x16x32_bf16 a[180:183], v[84:87], v[248:251], a[180:183]
  buffer_load_dwordx4 v26, s[12:15], s54 offen offset:2048 sc1 lds
  v_lshlrev_b32 v158, 16, v109
  v_mfma_f32_16x16x32_bf16 a[240:243], v[88:91], v[248:251], a[240:243]
  v_and_b32 v159, 0xffff0000, v109
  v_add_f32 v150, v150, v158
  v_mfma_f32_16x16x32_bf16 a[244:247], v[92:95], v[248:251], a[244:247]
  ds_read_b64_tr_b16 v[248:249], v14 offset:32768
  v_mfma_f32_16x16x32_bf16 a[56:59], v[64:67], v[252:255], a[56:59]
  ds_read_b64_tr_b16 v[250:251], v14 offset:34816
  v_add_f32 v151, v151, v159
  v_mfma_f32_16x16x32_bf16 a[60:63], v[68:71], v[252:255], a[60:63]
  buffer_load_dwordx4 v27, s[12:15], s54 offen offset:3072 sc1 lds
  v_fmac_f32 v154, v158, v158
  v_mfma_f32_16x16x32_bf16 a[120:123], v[72:75], v[252:255], a[120:123]
  v_fmac_f32 v155, v159, v159
  v_lshlrev_b32 v160, 16, v110
  v_mfma_f32_16x16x32_bf16 a[124:127], v[76:79], v[252:255], a[124:127]
  v_and_b32 v161, 0xffff0000, v110
  v_mfma_f32_16x16x32_bf16 a[184:187], v[80:83], v[252:255], a[184:187]
  v_add_f32 v148, v148, v160
  v_add_f32 v149, v149, v161
  v_mfma_f32_16x16x32_bf16 a[188:191], v[84:87], v[252:255], a[188:191]
  v_fmac_f32 v152, v160, v160
  v_fmac_f32 v153, v161, v161
  v_mfma_f32_16x16x32_bf16 a[248:251], v[88:91], v[252:255], a[248:251]
  v_lshlrev_b32 v162, 16, v111
  v_and_b32 v163, 0xffff0000, v111
  v_mfma_f32_16x16x32_bf16 a[252:255], v[92:95], v[252:255], a[252:255]
  ds_read_b64_tr_b16 v[252:253], v15 offset:32768
  ds_read_b64_tr_b16 v[254:255], v15 offset:34816
  s_waitcnt lgkmcnt(15)
  s_waitcnt lgkmcnt(4)
  v_mfma_f32_16x16x32_bf16 a[0:3], v[32:35], v[224:227], a[0:3]
  v_add_f32 v150, v150, v162
  v_add_f32 v151, v151, v163
  v_mfma_f32_16x16x32_bf16 a[4:7], v[36:39], v[224:227], a[4:7]
  s_add_u32 m0, s56, 69632
  v_mfma_f32_16x16x32_bf16 a[64:67], v[40:43], v[224:227], a[64:67]
  buffer_load_dwordx4 v28, s[12:15], s54 offen offset:0 sc1 lds
  v_fmac_f32 v154, v162, v162
  v_mfma_f32_16x16x32_bf16 a[68:71], v[44:47], v[224:227], a[68:71]
  v_fmac_f32 v155, v163, v163
  v_lshlrev_b32 v156, 16, v112
  v_mfma_f32_16x16x32_bf16 a[128:131], v[48:51], v[224:227], a[128:131]
  v_and_b32 v157, 0xffff0000, v112
  v_add_f32 v148, v148, v156
  v_mfma_f32_16x16x32_bf16 a[132:135], v[52:55], v[224:227], a[132:135]
  buffer_load_dwordx4 v29, s[12:15], s54 offen offset:1024 sc1 lds
  v_mfma_f32_16x16x32_bf16 a[192:195], v[56:59], v[224:227], a[192:195]
  v_add_f32 v149, v149, v157
  v_fmac_f32 v152, v156, v156
  v_mfma_f32_16x16x32_bf16 a[196:199], v[60:63], v[224:227], a[196:199]
  ds_read_b64_tr_b16 v[224:225], v8 offset:49152
  v_mfma_f32_16x16x32_bf16 a[8:11], v[32:35], v[228:231], a[8:11]
  ds_read_b64_tr_b16 v[226:227], v8 offset:51200
  v_fmac_f32 v153, v157, v157
  v_mfma_f32_16x16x32_bf16 a[12:15], v[36:39], v[228:231], a[12:15]
  buffer_load_dwordx4 v30, s[12:15], s54 offen offset:2048 sc1 lds
  v_lshlrev_b32 v158, 16, v113
  v_mfma_f32_16x16x32_bf16 a[72:75], v[40:43], v[228:231], a[72:75]
  ds_read_b128 v[64:67], v213 offset:32768
  v_mfma_f32_16x16x32_bf16 a[76:79], v[44:47], v[228:231], a[76:79]
  v_and_b32 v159, 0xffff0000, v113
  v_add_f32 v150, v150, v158
  v_mfma_f32_16x16x32_bf16 a[136:139], v[48:51], v[228:231], a[136:139]
  buffer_load_dwordx4 v31, s[12:15], s54 offen offset:3072 sc1 lds
  s_add_u32 s54, s54, 0x80000
  v_mfma_f32_16x16x32_bf16 a[140:143], v[52:55], v[228:231], a[140:143]
  v_add_f32 v151, v151, v159
  v_fmac_f32 v154, v158, v158
  v_mfma_f32_16x16x32_bf16 a[200:203], v[56:59], v[228:231], a[200:203]
  v_fmac_f32 v155, v159, v159
  v_lshlrev_b32 v160, 16, v114
  v_mfma_f32_16x16x32_bf16 a[204:207], v[60:63], v[228:231], a[204:207]
  ds_read_b64_tr_b16 v[228:229], v9 offset:49152
  v_mfma_f32_16x16x32_bf16 a[16:19], v[32:35], v[232:235], a[16:19]
  ds_read_b64_tr_b16 v[230:231], v9 offset:51200
  v_mfma_f32_16x16x32_bf16 a[20:23], v[36:39], v[232:235], a[20:23]
  ds_read_b128 v[68:71], v212 offset:34816
  v_and_b32 v161, 0xffff0000, v114
  v_mfma_f32_16x16x32_bf16 a[80:83], v[40:43], v[232:235], a[80:83]
  v_add_f32 v148, v148, v160
  v_add_f32 v149, v149, v161
  v_mfma_f32_16x16x32_bf16 a[84:87], v[44:47], v[232:235], a[84:87]
  v_fmac_f32 v152, v160, v160
  v_fmac_f32 v153, v161, v161
  v_mfma_f32_16x16x32_bf16 a[144:147], v[48:51], v[232:235], a[144:147]
  v_lshlrev_b32 v162, 16, v115
  v_mfma_f32_16x16x32_bf16 a[148:151], v[52:55], v[232:235], a[148:151]
  v_and_b32 v163, 0xffff0000, v115
  v_add_f32 v150, v150, v162
  v_mfma_f32_16x16x32_bf16 a[208:211], v[56:59], v[232:235], a[208:211]
  ds_read_b128 v[72:75], v213 offset:36864
  v_add_f32 v151, v151, v163
  v_mfma_f32_16x16x32_bf16 a[212:215], v[60:63], v[232:235], a[212:215]
  ds_read_b64_tr_b16 v[232:233], v10 offset:49152
  v_mfma_f32_16x16x32_bf16 a[24:27], v[32:35], v[236:239], a[24:27]
  ds_read_b64_tr_b16 v[234:235], v10 offset:51200
  v_fmac_f32 v154, v162, v162
  v_mfma_f32_16x16x32_bf16 a[28:31], v[36:39], v[236:239], a[28:31]
  v_fmac_f32 v155, v163, v163
  v_mfma_f32_16x16x32_bf16 a[88:91], v[40:43], v[236:239], a[88:91]
  v_lshlrev_b32 v156, 16, v116
  v_and_b32 v157, 0xffff0000, v116
  v_mfma_f32_16x16x32_bf16 a[92:95], v[44:47], v[236:239], a[92:95]
  v_add_f32 v148, v148, v156
  v_add_f32 v149, v149, v157
  v_mfma_f32_16x16x32_bf16 a[152:155], v[48:51], v[236:239], a[152:155]
  ds_read_b128 v[76:79], v212 offset:38912
  v_fmac_f32 v152, v156, v156
  v_mfma_f32_16x16x32_bf16 a[156:159], v[52:55], v[236:239], a[156:159]
  v_fmac_f32 v153, v157, v157
  v_mfma_f32_16x16x32_bf16 a[216:219], v[56:59], v[236:239], a[216:219]
  v_lshlrev_b32 v158, 16, v117
  v_and_b32 v159, 0xffff0000, v117
  v_mfma_f32_16x16x32_bf16 a[220:223], v[60:63], v[236:239], a[220:223]
  ds_read_b64_tr_b16 v[236:237], v11 offset:49152
  v_mfma_f32_16x16x32_bf16 a[32:35], v[32:35], v[240:243], a[32:35]
  ds_read_b64_tr_b16 v[238:239], v11 offset:51200
  v_add_f32 v150, v150, v158
  v_mfma_f32_16x16x32_bf16 a[36:39], v[36:39], v[240:243], a[36:39]
  v_add_f32 v151, v151, v159
  v_fmac_f32 v154, v158, v158
  v_mfma_f32_16x16x32_bf16 a[96:99], v[40:43], v[240:243], a[96:99]
  ds_read_b128 v[80:83], v213 offset:40960
  v_mfma_f32_16x16x32_bf16 a[100:103], v[44:47], v[240:243], a[100:103]
  v_fmac_f32 v155, v159, v159
  v_lshlrev_b32 v160, 16, v118
  v_mfma_f32_16x16x32_bf16 a[160:163], v[48:51], v[240:243], a[160:163]
  buffer_load_dword v2, v3, s[8:11], s53 offen
  v_and_b32 v161, 0xffff0000, v118
  v_mfma_f32_16x16x32_bf16 a[164:167], v[52:55], v[240:243], a[164:167]
  v_add_f32 v148, v148, v160
  v_add_f32 v149, v149, v161
  v_mfma_f32_16x16x32_bf16 a[224:227], v[56:59], v[240:243], a[224:227]
  v_fmac_f32 v152, v160, v160
  v_mfma_f32_16x16x32_bf16 a[228:231], v[60:63], v[240:243], a[228:231]
  ds_read_b64_tr_b16 v[240:241], v12 offset:49152
  v_mfma_f32_16x16x32_bf16 a[40:43], v[32:35], v[244:247], a[40:43]
  ds_read_b64_tr_b16 v[242:243], v12 offset:51200
  v_fmac_f32 v153, v161, v161
  v_mfma_f32_16x16x32_bf16 a[44:47], v[36:39], v[244:247], a[44:47]
  ds_read_b128 v[84:87], v212 offset:43008
  v_lshlrev_b32 v162, 16, v119
  v_mfma_f32_16x16x32_bf16 a[104:107], v[40:43], v[244:247], a[104:107]
  v_and_b32 v163, 0xffff0000, v119
  v_add_f32 v150, v150, v162
  v_mfma_f32_16x16x32_bf16 a[108:111], v[44:47], v[244:247], a[108:111]
  v_add_f32 v151, v151, v163
  v_mfma_f32_16x16x32_bf16 a[168:171], v[48:51], v[244:247], a[168:171]
  buffer_load_dword v2, v4, s[12:15], s54 offen
  v_fmac_f32 v154, v162, v162
  v_mfma_f32_16x16x32_bf16 a[172:175], v[52:55], v[244:247], a[172:175]
  v_fmac_f32 v155, v163, v163
  v_lshlrev_b32 v156, 16, v120
  v_mfma_f32_16x16x32_bf16 a[232:235], v[56:59], v[244:247], a[232:235]
  ds_read_b128 v[88:91], v213 offset:45056
  v_and_b32 v157, 0xffff0000, v120
  v_mfma_f32_16x16x32_bf16 a[236:239], v[60:63], v[244:247], a[236:239]
  s_waitcnt lgkmcnt(15)
  ds_read_b64_tr_b16 v[244:245], v13 offset:49152
  v_mfma_f32_16x16x32_bf16 a[48:51], v[32:35], v[248:251], a[48:51]
  ds_read_b64_tr_b16 v[246:247], v13 offset:51200
  v_mfma_f32_16x16x32_bf16 a[52:55], v[36:39], v[248:251], a[52:55]
  v_add_f32 v148, v148, v156
  v_add_f32 v149, v149, v157
  v_mfma_f32_16x16x32_bf16 a[112:115], v[40:43], v[248:251], a[112:115]
  v_fmac_f32 v152, v156, v156
  v_fmac_f32 v153, v157, v157
  v_mfma_f32_16x16x32_bf16 a[116:119], v[44:47], v[248:251], a[116:119]
  v_lshlrev_b32 v158, 16, v121
  v_and_b32 v159, 0xffff0000, v121
  v_mfma_f32_16x16x32_bf16 a[176:179], v[48:51], v[248:251], a[176:179]
  ds_read_b128 v[92:95], v212 offset:47104
  v_mfma_f32_16x16x32_bf16 a[180:183], v[52:55], v[248:251], a[180:183]
  v_add_f32 v150, v150, v158
  v_add_f32 v151, v151, v159
  v_mfma_f32_16x16x32_bf16 a[240:243], v[56:59], v[248:251], a[240:243]
  v_fmac_f32 v154, v158, v158
  v_fmac_f32 v155, v159, v159
  v_mfma_f32_16x16x32_bf16 a[244:247], v[60:63], v[248:251], a[244:247]
  ds_read_b64_tr_b16 v[248:249], v14 offset:49152
  v_mfma_f32_16x16x32_bf16 a[56:59], v[32:35], v[252:255], a[56:59]
  ds_read_b64_tr_b16 v[250:251], v14 offset:51200
  v_lshlrev_b32 v160, 16, v122
  v_mfma_f32_16x16x32_bf16 a[60:63], v[36:39], v[252:255], a[60:63]
  v_and_b32 v161, 0xffff0000, v122
  v_mfma_f32_16x16x32_bf16 a[120:123], v[40:43], v[252:255], a[120:123]
  v_add_f32 v148, v148, v160
  v_add_f32 v149, v149, v161
  v_mfma_f32_16x16x32_bf16 a[124:127], v[44:47], v[252:255], a[124:127]
  v_fmac_f32 v152, v160, v160
  v_fmac_f32 v153, v161, v161
  v_mfma_f32_16x16x32_bf16 a[184:187], v[48:51], v[252:255], a[184:187]
  v_lshlrev_b32 v162, 16, v123
  v_and_b32 v163, 0xffff0000, v123
  v_mfma_f32_16x16x32_bf16 a[188:191], v[52:55], v[252:255], a[188:191]
  v_add_f32 v150, v150, v162
  v_mfma_f32_16x16x32_bf16 a[248:251], v[56:59], v[252:255], a[248:251]
  v_add_f32 v151, v151, v163
  v_fmac_f32 v154, v162, v162
  v_mfma_f32_16x16x32_bf16 a[252:255], v[60:63], v[252:255], a[252:255]
  ds_read_b64_tr_b16 v[252:253], v15 offset:49152
  ds_read_b64_tr_b16 v[254:255], v15 offset:51200
  s_waitcnt lgkmcnt(4)
  v_mfma_f32_16x16x32_bf16 a[0:3], v[64:67], v[224:227], a[0:3]
  v_fmac_f32 v155, v163, v163
  s_nop 3
  v_mfma_f32_16x16x32_bf16 a[4:7], v[68:71], v[224:227], a[4:7]
  v_add_f32 v148, v148, v149
  v_add_f32 v150, v150, v151
  v_mfma_f32_16x16x32_bf16 a[64:67], v[72:75], v[224:227], a[64:67]
  v_add_f32 v152, v152, v153
  v_add_f32 v154, v154, v155
  v_mfma_f32_16x16x32_bf16 a[68:71], v[76:79], v[224:227], a[68:71]
  v_add_f32 v148, v148, v150
  v_add_f32 v152, v152, v154
  v_mfma_f32_16x16x32_bf16 a[128:131], v[80:83], v[224:227], a[128:131]
  s_nop 1
  v_add_f32_dpp v148, v148, v148 quad_perm:[1,0,3,2] row_mask:0xf bank_mask:0xf
  v_mfma_f32_16x16x32_bf16 a[132:135], v[84:87], v[224:227], a[132:135]
  v_add_f32_dpp v152, v152, v152 quad_perm:[1,0,3,2] row_mask:0xf bank_mask:0xf
  s_nop 1
  v_mfma_f32_16x16x32_bf16 a[192:195], v[88:91], v[224:227], a[192:195]
  v_add_f32_dpp v148, v148, v148 quad_perm:[2,3,0,1] row_mask:0xf bank_mask:0xf
  v_mfma_f32_16x16x32_bf16 a[196:199], v[92:95], v[224:227], a[196:199]
  s_waitcnt vmcnt(2)
  s_waitcnt lgkmcnt(0)
  s_barrier
  ds_read_b64_tr_b16 v[224:225], v8 offset:0
  v_mfma_f32_16x16x32_bf16 a[8:11], v[64:67], v[228:231], a[8:11]
  ds_read_b64_tr_b16 v[226:227], v8 offset:2048
  v_add_f32_dpp v152, v152, v152 quad_perm:[2,3,0,1] row_mask:0xf bank_mask:0xf
  v_mfma_f32_16x16x32_bf16 a[12:15], v[68:71], v[228:231], a[12:15]
  s_nop 1
  v_add_f32_dpp v148, v148, v148 row_half_mirror row_mask:0xf bank_mask:0xf
  v_mfma_f32_16x16x32_bf16 a[72:75], v[72:75], v[228:231], a[72:75]
  ds_read_b128 v[32:35], v212 offset:0
  s_add_u32 m0, s56, 32768
  v_mfma_f32_16x16x32_bf16 a[76:79], v[76:79], v[228:231], a[76:79]
  buffer_load_dwordx4 v16, s[8:11], s53 offen offset:0 sc1 lds
  v_add_f32_dpp v152, v152, v152 row_half_mirror row_mask:0xf bank_mask:0xf
  v_mfma_f32_16x16x32_bf16 a[136:139], v[80:83], v[228:231], a[136:139]
  v_mul_f32 v148, 0x3b124925, v148
  v_mul_f32 v152, 0x3b124925, v152
  v_mfma_f32_16x16x32_bf16 a[140:143], v[84:87], v[228:231], a[140:143]
  v_fma_f32 v152, -v148, v148, v152
  v_max_f32 v152, 0, v152
  v_mfma_f32_16x16x32_bf16 a[200:203], v[88:91], v[228:231], a[200:203]
  v_add_f32 v152, 0x3727c5ac, v152
  v_mfma_f32_16x16x32_bf16 a[204:207], v[92:95], v[228:231], a[204:207]
  ds_read_b64_tr_b16 v[228:229], v9 offset:0
  v_mfma_f32_16x16x32_bf16 a[16:19], v[64:67], v[232:235], a[16:19]
  buffer_load_dwordx4 v17, s[8:11], s53 offen offset:1024 sc1 lds
  v_rsq_f32 v152, v152
  v_mfma_f32_16x16x32_bf16 a[20:23], v[68:71], v[232:235], a[20:23]
  ds_read_b64_tr_b16 v[230:231], v9 offset:2048
  v_mul_f32 v152, 0x3db8aa3b, v152
  v_mfma_f32_16x16x32_bf16 a[80:83], v[72:75], v[232:235], a[80:83]
  ds_read_b128 v[36:39], v213 offset:2048
  v_mul_f32 v148, v148, v152
  v_mfma_f32_16x16x32_bf16 a[84:87], v[76:79], v[232:235], a[84:87]
  buffer_load_dwordx4 v18, s[8:11], s53 offen offset:2048 sc1 lds
  v_mov_b32 v153, v152
  v_mfma_f32_16x16x32_bf16 a[144:147], v[80:83], v[232:235], a[144:147]
  v_sub_f32 v148, 0, v148
  v_mov_b32 v149, v148
  v_mfma_f32_16x16x32_bf16 a[148:151], v[84:87], v[232:235], a[148:151]
  v_lshlrev_b32 v164, 16, v124
  v_and_b32 v165, 0xffff0000, v124
  v_mfma_f32_16x16x32_bf16 a[208:211], v[88:91], v[232:235], a[208:211]
  ds_read_b128 v[40:43], v212 offset:4096
  v_mfma_f32_16x16x32_bf16 a[212:215], v[92:95], v[232:235], a[212:215]
  ds_read_b64_tr_b16 v[232:233], v10 offset:0
  v_mfma_f32_16x16x32_bf16 a[24:27], v[64:67], v[236:239], a[24:27]
  buffer_load_dwordx4 v19, s[8:11], s53 offen offset:3072 sc1 lds
  v_fma_f32 v164, v164, v152, v148
  v_mfma_f32_16x16x32_bf16 a[28:31], v[68:71], v[236:239], a[28:31]
  ds_read_b64_tr_b16 v[234:235], v10 offset:2048
  v_fma_f32 v165, v165, v152, v148
  v_mfma_f32_16x16x32_bf16 a[88:91], v[72:75], v[236:239], a[88:91]
  v_cvt_pk_bf16_f32 v124, v164, v165
  v_lshlrev_b32 v166, 16, v125
  v_mfma_f32_16x16x32_bf16 a[92:95], v[76:79], v[236:239], a[92:95]
  s_add_u32 m0, s56, 36864
  v_and_b32 v167, 0xffff0000, v125
  v_mfma_f32_16x16x32_bf16 a[152:155], v[80:83], v[236:239], a[152:155]
  ds_read_b128 v[44:47], v213 offset:6144
  v_fma_f32 v166, v166, v152, v148
  v_mfma_f32_16x16x32_bf16 a[156:159], v[84:87], v[236:239], a[156:159]
  buffer_load_dwordx4 v20, s[8:11], s53 offen offset:0 sc1 lds
  v_fma_f32 v167, v167, v152, v148
  v_mfma_f32_16x16x32_bf16 a[216:219], v[88:91], v[236:239], a[216:219]
  v_cvt_pk_bf16_f32 v125, v166, v167
  v_lshlrev_b32 v168, 16, v126
  v_mfma_f32_16x16x32_bf16 a[220:223], v[92:95], v[236:239], a[220:223]
  ds_read_b64_tr_b16 v[236:237], v11 offset:0
  v_mfma_f32_16x16x32_bf16 a[32:35], v[64:67], v[240:243], a[32:35]
  ds_read_b64_tr_b16 v[238:239], v11 offset:2048
  v_and_b32 v169, 0xffff0000, v126
  v_mfma_f32_16x16x32_bf16 a[36:39], v[68:71], v[240:243], a[36:39]
  buffer_load_dwordx4 v21, s[8:11], s53 offen offset:1024 sc1 lds
  v_fma_f32 v168, v168, v152, v148
  v_mfma_f32_16x16x32_bf16 a[96:99], v[72:75], v[240:243], a[96:99]
  ds_read_b128 v[48:51], v212 offset:8192
  v_fma_f32 v169, v169, v152, v148
  v_mfma_f32_16x16x32_bf16 a[100:103], v[76:79], v[240:243], a[100:103]
  v_cvt_pk_bf16_f32 v126, v168, v169
  v_lshlrev_b32 v170, 16, v127
  v_mfma_f32_16x16x32_bf16 a[160:163], v[80:83], v[240:243], a[160:163]
  buffer_load_dwordx4 v22, s[8:11], s53 offen offset:2048 sc1 lds
  v_mfma_f32_16x16x32_bf16 a[164:167], v[84:87], v[240:243], a[164:167]
  v_and_b32 v171, 0xffff0000, v127
  v_fma_f32 v170, v170, v152, v148
  v_mfma_f32_16x16x32_bf16 a[224:227], v[88:91], v[240:243], a[224:227]
  v_fma_f32 v171, v171, v152, v148
  v_cvt_pk_bf16_f32 v127, v170, v171
  v_mfma_f32_16x16x32_bf16 a[228:231], v[92:95], v[240:243], a[228:231]
  ds_read_b64_tr_b16 v[240:241], v12 offset:0
  v_mfma_f32_16x16x32_bf16 a[40:43], v[64:67], v[244:247], a[40:43]
  ds_read_b64_tr_b16 v[242:243], v12 offset:2048
  v_lshlrev_b32 v156, 16, v128
  v_mfma_f32_16x16x32_bf16 a[44:47], v[68:71], v[244:247], a[44:47]
  ds_read_b128 v[52:55], v213 offset:10240
  v_and_b32 v157, 0xffff0000, v128
  v_mfma_f32_16x16x32_bf16 a[104:107], v[72:75], v[244:247], a[104:107]
  buffer_load_dwordx4 v23, s[8:11], s53 offen offset:3072 sc1 lds
  s_add_u32 s53, s53, 128
  v_mfma_f32_16x16x32_bf16 a[108:111], v[76:79], v[244:247], a[108:111]
  v_fma_f32 v156, v156, v152, v148
  v_fma_f32 v157, v157, v152, v148
  v_mfma_f32_16x16x32_bf16 a[168:171], v[80:83], v[244:247], a[168:171]
  s_add_u32 m0, s56, 98304
  v_cvt_pk_bf16_f32 v128, v156, v157
  v_mfma_f32_16x16x32_bf16 a[172:175], v[84:87], v[244:247], a[172:175]
  buffer_load_dwordx4 v24, s[12:15], s54 offen offset:0 sc1 lds
  v_lshlrev_b32 v158, 16, v129
  v_mfma_f32_16x16x32_bf16 a[232:235], v[88:91], v[244:247], a[232:235]
  ds_read_b128 v[56:59], v212 offset:12288
  v_and_b32 v159, 0xffff0000, v129
  v_mfma_f32_16x16x32_bf16 a[236:239], v[92:95], v[244:247], a[236:239]
  ds_read_b64_tr_b16 v[244:245], v13 offset:0
  v_mfma_f32_16x16x32_bf16 a[48:51], v[64:67], v[248:251], a[48:51]
  ds_read_b64_tr_b16 v[246:247], v13 offset:2048
  v_fma_f32 v158, v158, v152, v148
  v_mfma_f32_16x16x32_bf16 a[52:55], v[68:71], v[248:251], a[52:55]
  buffer_load_dwordx4 v25, s[12:15], s54 offen offset:1024 sc1 lds
  v_fma_f32 v159, v159, v152, v148
  v_mfma_f32_16x16x32_bf16 a[112:115], v[72:75], v[248:251], a[112:115]
  v_cvt_pk_bf16_f32 v129, v158, v159
  v_lshlrev_b32 v160, 16, v130
  v_mfma_f32_16x16x32_bf16 a[116:119], v[76:79], v[248:251], a[116:119]
  v_and_b32 v161, 0xffff0000, v130
  v_fma_f32 v160, v160, v152, v148
  v_mfma_f32_16x16x32_bf16 a[176:179], v[80:83], v[248:251], a[176:179]
  ds_read_b128 v[60:63], v213 offset:14336
  v_mfma_f32_16x16x32_bf16 a[180:183], v[84:87], v[248:251], a[180:183]
  buffer_load_dwordx4 v26, s[12:15], s54 offen offset:2048 sc1 lds
  v_fma_f32 v161, v161, v152, v148
  v_mfma_f32_16x16x32_bf16 a[240:243], v[88:91], v[248:251], a[240:243]
  v_cvt_pk_bf16_f32 v130, v160, v161
  v_lshlrev_b32 v162, 16, v131
  v_mfma_f32_16x16x32_bf16 a[244:247], v[92:95], v[248:251], a[244:247]
  ds_read_b64_tr_b16 v[248:249], v14 offset:0
  v_mfma_f32_16x16x32_bf16 a[56:59], v[64:67], v[252:255], a[56:59]
  ds_read_b64_tr_b16 v[250:251], v14 offset:2048
  v_and_b32 v163, 0xffff0000, v131
  v_mfma_f32_16x16x32_bf16 a[60:63], v[68:71], v[252:255], a[60:63]
  buffer_load_dwordx4 v27, s[12:15], s54 offen offset:3072 sc1 lds
  v_fma_f32 v162, v162, v152, v148
  v_mfma_f32_16x16x32_bf16 a[120:123], v[72:75], v[252:255], a[120:123]
  v_fma_f32 v163, v163, v152, v148
  v_cvt_pk_bf16_f32 v131, v162, v163
  v_mfma_f32_16x16x32_bf16 a[124:127], v[76:79], v[252:255], a[124:127]
  buffer_store_dwordx4 v[124:127], v133, s[16:19], s63 offen sc1
  buffer_store_dwordx4 v[128:131], v133, s[16:19], s61 offen sc1
  v_mfma_f32_16x16x32_bf16 a[184:187], v[80:83], v[252:255], a[184:187]
  v_mfma_f32_16x16x32_bf16 a[188:191], v[84:87], v[252:255], a[188:191]
  v_mfma_f32_16x16x32_bf16 a[248:251], v[88:91], v[252:255], a[248:251]
  v_mfma_f32_16x16x32_bf16 a[252:255], v[92:95], v[252:255], a[252:255]
  ds_read_b64_tr_b16 v[252:253], v15 offset:0
  ds_read_b64_tr_b16 v[254:255], v15 offset:2048
  s_branch M_HOOK
M_LOOP_V:
  s_waitcnt lgkmcnt(15)
  s_waitcnt lgkmcnt(4)
  v_mfma_f32_16x16x32_bf16 a[0:3], v[32:35], v[224:227], a[0:3]
  v_mfma_f32_16x16x32_bf16 a[4:7], v[36:39], v[224:227], a[4:7]
  s_add_u32 m0, s56, 102400
  v_mfma_f32_16x16x32_bf16 a[64:67], v[40:43], v[224:227], a[64:67]
  buffer_load_dwordx4 v28, s[12:15], s54 offen offset:0 sc1 lds
  v_mfma_f32_16x16x32_bf16 a[68:71], v[44:47], v[224:227], a[68:71]
  v_mfma_f32_16x16x32_bf16 a[128:131], v[48:51], v[224:227], a[128:131]
  v_mfma_f32_16x16x32_bf16 a[132:135], v[52:55], v[224:227], a[132:135]
  buffer_load_dwordx4 v29, s[12:15], s54 offen offset:1024 sc1 lds
  v_mfma_f32_16x16x32_bf16 a[192:195], v[56:59], v[224:227], a[192:195]
  v_mfma_f32_16x16x32_bf16 a[196:199], v[60:63], v[224:227], a[196:199]
  ds_read_b64_tr_b16 v[224:225], v8 offset:16384
  v_mfma_f32_16x16x32_bf16 a[8:11], v[32:35], v[228:231], a[8:11]
  ds_read_b64_tr_b16 v[226:227], v8 offset:18432
  v_mfma_f32_16x16x32_bf16 a[12:15], v[36:39], v[228:231], a[12:15]
  buffer_load_dwordx4 v30, s[12:15], s54 offen offset:2048 sc1 lds
  v_mfma_f32_16x16x32_bf16 a[72:75], v[40:43], v[228:231], a[72:75]
  ds_read_b128 v[64:67], v213 offset:0
  v_mfma_f32_16x16x32_bf16 a[76:79], v[44:47], v[228:231], a[76:79]
  v_mfma_f32_16x16x32_bf16 a[136:139], v[48:51], v[228:231], a[136:139]
  buffer_load_dwordx4 v31, s[12:15], s54 offen offset:3072 sc1 lds
  s_add_u32 s54, s54, 0x80000
  v_mfma_f32_16x16x32_bf16 a[140:143], v[52:55], v[228:231], a[140:143]
  v_mfma_f32_16x16x32_bf16 a[200:203], v[56:59], v[228:231], a[200:203]
  v_mfma_f32_16x16x32_bf16 a[204:207], v[60:63], v[228:231], a[204:207]
  ds_read_b64_tr_b16 v[228:229], v9 offset:16384
  v_mfma_f32_16x16x32_bf16 a[16:19], v[32:35], v[232:235], a[16:19]
  ds_read_b64_tr_b16 v[230:231], v9 offset:18432
  v_mfma_f32_16x16x32_bf16 a[20:23], v[36:39], v[232:235], a[20:23]
  ds_read_b128 v[68:71], v212 offset:2048
  v_mfma_f32_16x16x32_bf16 a[80:83], v[40:43], v[232:235], a[80:83]
  v_mfma_f32_16x16x32_bf16 a[84:87], v[44:47], v[232:235], a[84:87]
  v_mfma_f32_16x16x32_bf16 a[144:147], v[48:51], v[232:235], a[144:147]
  v_mfma_f32_16x16x32_bf16 a[148:151], v[52:55], v[232:235], a[148:151]
  v_mfma_f32_16x16x32_bf16 a[208:211], v[56:59], v[232:235], a[208:211]
  ds_read_b128 v[72:75], v213 offset:4096
  v_mfma_f32_16x16x32_bf16 a[212:215], v[60:63], v[232:235], a[212:215]
  ds_read_b64_tr_b16 v[232:233], v10 offset:16384
  v_mfma_f32_16x16x32_bf16 a[24:27], v[32:35], v[236:239], a[24:27]
  ds_read_b64_tr_b16 v[234:235], v10 offset:18432
  v_mfma_f32_16x16x32_bf16 a[28:31], v[36:39], v[236:239], a[28:31]
  v_mfma_f32_16x16x32_bf16 a[88:91], v[40:43], v[236:239], a[88:91]
  v_mfma_f32_16x16x32_bf16 a[92:95], v[44:47], v[236:239], a[92:95]
  v_mfma_f32_16x16x32_bf16 a[152:155], v[48:51], v[236:239], a[152:155]
  ds_read_b128 v[76:79], v212 offset:6144
  v_mfma_f32_16x16x32_bf16 a[156:159], v[52:55], v[236:239], a[156:159]
  v_mfma_f32_16x16x32_bf16 a[216:219], v[56:59], v[236:239], a[216:219]
  v_mfma_f32_16x16x32_bf16 a[220:223], v[60:63], v[236:239], a[220:223]
  ds_read_b64_tr_b16 v[236:237], v11 offset:16384
  v_mfma_f32_16x16x32_bf16 a[32:35], v[32:35], v[240:243], a[32:35]
  ds_read_b64_tr_b16 v[238:239], v11 offset:18432
  v_mfma_f32_16x16x32_bf16 a[36:39], v[36:39], v[240:243], a[36:39]
  v_mfma_f32_16x16x32_bf16 a[96:99], v[40:43], v[240:243], a[96:99]
  ds_read_b128 v[80:83], v213 offset:8192
  v_mfma_f32_16x16x32_bf16 a[100:103], v[44:47], v[240:243], a[100:103]
  v_mfma_f32_16x16x32_bf16 a[160:163], v[48:51], v[240:243], a[160:163]
  buffer_load_dword v2, v3, s[8:11], s53 offen
  v_mfma_f32_16x16x32_bf16 a[164:167], v[52:55], v[240:243], a[164:167]
  v_mfma_f32_16x16x32_bf16 a[224:227], v[56:59], v[240:243], a[224:227]
  v_mfma_f32_16x16x32_bf16 a[228:231], v[60:63], v[240:243], a[228:231]
  ds_read_b64_tr_b16 v[240:241], v12 offset:16384
  v_mfma_f32_16x16x32_bf16 a[40:43], v[32:35], v[244:247], a[40:43]
  ds_read_b64_tr_b16 v[242:243], v12 offset:18432
  v_mfma_f32_16x16x32_bf16 a[44:47], v[36:39], v[244:247], a[44:47]
  ds_read_b128 v[84:87], v212 offset:10240
  v_mfma_f32_16x16x32_bf16 a[104:107], v[40:43], v[244:247], a[104:107]
  v_mfma_f32_16x16x32_bf16 a[108:111], v[44:47], v[244:247], a[108:111]
  v_mfma_f32_16x16x32_bf16 a[168:171], v[48:51], v[244:247], a[168:171]
  buffer_load_dword v2, v4, s[12:15], s54 offen
  v_mfma_f32_16x16x32_bf16 a[172:175], v[52:55], v[244:247], a[172:175]
  v_mfma_f32_16x16x32_bf16 a[232:235], v[56:59], v[244:247], a[232:235]
  ds_read_b128 v[88:91], v213 offset:12288
  v_mfma_f32_16x16x32_bf16 a[236:239], v[60:63], v[244:247], a[236:239]
  s_waitcnt lgkmcnt(15)
  ds_read_b64_tr_b16 v[244:245], v13 offset:16384
  v_mfma_f32_16x16x32_bf16 a[48:51], v[32:35], v[248:251], a[48:51]
  ds_read_b64_tr_b16 v[246:247], v13 offset:18432
  v_mfma_f32_16x16x32_bf16 a[52:55], v[36:39], v[248:251], a[52:55]
  v_mfma_f32_16x16x32_bf16 a[112:115], v[40:43], v[248:251], a[112:115]
  v_mfma_f32_16x16x32_bf16 a[116:119], v[44:47], v[248:251], a[116:119]
  s_mov_b64 exec, s[72:73]
  global_load_dword v2, v[142:143], off
  global_load_dword v2, v[176:177], off
  s_mov_b64 exec, -1
  v_mfma_f32_16x16x32_bf16 a[176:179], v[48:51], v[248:251], a[176:179]
  ds_read_b128 v[92:95], v212 offset:14336
  v_mfma_f32_16x16x32_bf16 a[180:183], v[52:55], v[248:251], a[180:183]
  v_mfma_f32_16x16x32_bf16 a[240:243], v[56:59], v[248:251], a[240:243]
  s_lshl_b64 s[72:73], s[72:73], 8
  s_or_b32 s72, s72, 1
  v_mfma_f32_16x16x32_bf16 a[244:247], v[60:63], v[248:251], a[244:247]
  ds_read_b64_tr_b16 v[248:249], v14 offset:16384
  v_mfma_f32_16x16x32_bf16 a[56:59], v[32:35], v[252:255], a[56:59]
  ds_read_b64_tr_b16 v[250:251], v14 offset:18432
  v_mfma_f32_16x16x32_bf16 a[60:63], v[36:39], v[252:255], a[60:63]
  v_mfma_f32_16x16x32_bf16 a[120:123], v[40:43], v[252:255], a[120:123]
  v_mfma_f32_16x16x32_bf16 a[124:127], v[44:47], v[252:255], a[124:127]
  v_mfma_f32_16x16x32_bf16 a[184:187], v[48:51], v[252:255], a[184:187]
  v_mfma_f32_16x16x32_bf16 a[188:191], v[52:55], v[252:255], a[188:191]
  v_mfma_f32_16x16x32_bf16 a[248:251], v[56:59], v[252:255], a[248:251]
  v_mfma_f32_16x16x32_bf16 a[252:255], v[60:63], v[252:255], a[252:255]
  ds_read_b64_tr_b16 v[252:253], v15 offset:16384
  ds_read_b64_tr_b16 v[254:255], v15 offset:18432
  s_waitcnt lgkmcnt(4)
  v_mfma_f32_16x16x32_bf16 a[0:3], v[64:67], v[224:227], a[0:3]
  v_mfma_f32_16x16x32_bf16 a[4:7], v[68:71], v[224:227], a[4:7]
  v_mfma_f32_16x16x32_bf16 a[64:67], v[72:75], v[224:227], a[64:67]
  v_mfma_f32_16x16x32_bf16 a[68:71], v[76:79], v[224:227], a[68:71]
  v_mfma_f32_16x16x32_bf16 a[128:131], v[80:83], v[224:227], a[128:131]
  v_mfma_f32_16x16x32_bf16 a[132:135], v[84:87], v[224:227], a[132:135]
  v_mfma_f32_16x16x32_bf16 a[192:195], v[88:91], v[224:227], a[192:195]
  v_mfma_f32_16x16x32_bf16 a[196:199], v[92:95], v[224:227], a[196:199]
  s_waitcnt vmcnt(4) lgkmcnt(0)
  s_barrier
  ds_read_b64_tr_b16 v[224:225], v8 offset:32768
  v_mfma_f32_16x16x32_bf16 a[8:11], v[64:67], v[228:231], a[8:11]
  ds_read_b64_tr_b16 v[226:227], v8 offset:34816
  v_mfma_f32_16x16x32_bf16 a[12:15], v[68:71], v[228:231], a[12:15]
  v_mfma_f32_16x16x32_bf16 a[72:75], v[72:75], v[228:231], a[72:75]
  ds_read_b128 v[32:35], v212 offset:32768
  s_add_u32 m0, s56, 0
  v_mfma_f32_16x16x32_bf16 a[76:79], v[76:79], v[228:231], a[76:79]
  buffer_load_dwordx4 v16, s[8:11], s53 offen offset:0 sc1 lds
  v_mfma_f32_16x16x32_bf16 a[136:139], v[80:83], v[228:231], a[136:139]
  v_mfma_f32_16x16x32_bf16 a[140:143], v[84:87], v[228:231], a[140:143]
  v_mfma_f32_16x16x32_bf16 a[200:203], v[88:91], v[228:231], a[200:203]
  v_mfma_f32_16x16x32_bf16 a[204:207], v[92:95], v[228:231], a[204:207]
  ds_read_b64_tr_b16 v[228:229], v9 offset:32768
  v_mfma_f32_16x16x32_bf16 a[16:19], v[64:67], v[232:235], a[16:19]
  buffer_load_dwordx4 v17, s[8:11], s53 offen offset:1024 sc1 lds
  v_mfma_f32_16x16x32_bf16 a[20:23], v[68:71], v[232:235], a[20:23]
  ds_read_b64_tr_b16 v[230:231], v9 offset:34816
  v_mfma_f32_16x16x32_bf16 a[80:83], v[72:75], v[232:235], a[80:83]
  ds_read_b128 v[36:39], v213 offset:34816
  v_mfma_f32_16x16x32_bf16 a[84:87], v[76:79], v[232:235], a[84:87]
  buffer_load_dwordx4 v18, s[8:11], s53 offen offset:2048 sc1 lds
  v_mfma_f32_16x16x32_bf16 a[144:147], v[80:83], v[232:235], a[144:147]
  v_mfma_f32_16x16x32_bf16 a[148:151], v[84:87], v[232:235], a[148:151]
  v_mfma_f32_16x16x32_bf16 a[208:211], v[88:91], v[232:235], a[208:211]
  ds_read_b128 v[40:43], v212 offset:36864
  v_mfma_f32_16x16x32_bf16 a[212:215], v[92:95], v[232:235], a[212:215]
  ds_read_b64_tr_b16 v[232:233], v10 offset:32768
  v_mfma_f32_16x16x32_bf16 a[24:27], v[64:67], v[236:239], a[24:27]
  buffer_load_dwordx4 v19, s[8:11], s53 offen offset:3072 sc1 lds
  v_mfma_f32_16x16x32_bf16 a[28:31], v[68:71], v[236:239], a[28:31]
  ds_read_b64_tr_b16 v[234:235], v10 offset:34816
  v_mfma_f32_16x16x32_bf16 a[88:91], v[72:75], v[236:239], a[88:91]
  v_mfma_f32_16x16x32_bf16 a[92:95], v[76:79], v[236:239], a[92:95]
  s_add_u32 m0, s56, 4096
  v_mfma_f32_16x16x32_bf16 a[152:155], v[80:83], v[236:239], a[152:155]
  ds_read_b128 v[44:47], v213 offset:38912
  v_mfma_f32_16x16x32_bf16 a[156:159], v[84:87], v[236:239], a[156:159]
  buffer_load_dwordx4 v20, s[8:11], s53 offen offset:0 sc1 lds
  v_mfma_f32_16x16x32_bf16 a[216:219], v[88:91], v[236:239], a[216:219]
  v_mfma_f32_16x16x32_bf16 a[220:223], v[92:95], v[236:239], a[220:223]
  ds_read_b64_tr_b16 v[236:237], v11 offset:32768
  v_mfma_f32_16x16x32_bf16 a[32:35], v[64:67], v[240:243], a[32:35]
  ds_read_b64_tr_b16 v[238:239], v11 offset:34816
  v_mfma_f32_16x16x32_bf16 a[36:39], v[68:71], v[240:243], a[36:39]
  buffer_load_dwordx4 v21, s[8:11], s53 offen offset:1024 sc1 lds
  v_mfma_f32_16x16x32_bf16 a[96:99], v[72:75], v[240:243], a[96:99]
  ds_read_b128 v[48:51], v212 offset:40960
  v_mfma_f32_16x16x32_bf16 a[100:103], v[76:79], v[240:243], a[100:103]
  v_mfma_f32_16x16x32_bf16 a[160:163], v[80:83], v[240:243], a[160:163]
  buffer_load_dwordx4 v22, s[8:11], s53 offen offset:2048 sc1 lds
  v_mfma_f32_16x16x32_bf16 a[164:167], v[84:87], v[240:243], a[164:167]
  v_mfma_f32_16x16x32_bf16 a[224:227], v[88:91], v[240:243], a[224:227]
  v_mfma_f32_16x16x32_bf16 a[228:231], v[92:95], v[240:243], a[228:231]
  ds_read_b64_tr_b16 v[240:241], v12 offset:32768
  v_mfma_f32_16x16x32_bf16 a[40:43], v[64:67], v[244:247], a[40:43]
  ds_read_b64_tr_b16 v[242:243], v12 offset:34816
  v_mfma_f32_16x16x32_bf16 a[44:47], v[68:71], v[244:247], a[44:47]
  ds_read_b128 v[52:55], v213 offset:43008
  v_mfma_f32_16x16x32_bf16 a[104:107], v[72:75], v[244:247], a[104:107]
  buffer_load_dwordx4 v23, s[8:11], s53 offen offset:3072 sc1 lds
  s_add_u32 s53, s53, 128
  v_mfma_f32_16x16x32_bf16 a[108:111], v[76:79], v[244:247], a[108:111]
  v_mfma_f32_16x16x32_bf16 a[168:171], v[80:83], v[244:247], a[168:171]
  s_add_u32 m0, s56, 65536
  v_mfma_f32_16x16x32_bf16 a[172:175], v[84:87], v[244:247], a[172:175]
  buffer_load_dwordx4 v24, s[12:15], s54 offen offset:0 sc1 lds
  v_mfma_f32_16x16x32_bf16 a[232:235], v[88:91], v[244:247], a[232:235]
  ds_read_b128 v[56:59], v212 offset:45056
  v_mfma_f32_16x16x32_bf16 a[236:239], v[92:95], v[244:247], a[236:239]
  ds_read_b64_tr_b16 v[244:245], v13 offset:32768
  v_mfma_f32_16x16x32_bf16 a[48:51], v[64:67], v[248:251], a[48:51]
  ds_read_b64_tr_b16 v[246:247], v13 offset:34816
  v_mfma_f32_16x16x32_bf16 a[52:55], v[68:71], v[248:251], a[52:55]
  buffer_load_dwordx4 v25, s[12:15], s54 offen offset:1024 sc1 lds
  v_mfma_f32_16x16x32_bf16 a[112:115], v[72:75], v[248:251], a[112:115]
  v_mfma_f32_16x16x32_bf16 a[116:119], v[76:79], v[248:251], a[116:119]
  v_mfma_f32_16x16x32_bf16 a[176:179], v[80:83], v[248:251], a[176:179]
  ds_read_b128 v[60:63], v213 offset:47104
  v_mfma_f32_16x16x32_bf16 a[180:183], v[84:87], v[248:251], a[180:183]
  buffer_load_dwordx4 v26, s[12:15], s54 offen offset:2048 sc1 lds
  v_mfma_f32_16x16x32_bf16 a[240:243], v[88:91], v[248:251], a[240:243]
  v_mfma_f32_16x16x32_bf16 a[244:247], v[92:95], v[248:251], a[244:247]
  ds_read_b64_tr_b16 v[248:249], v14 offset:32768
  v_mfma_f32_16x16x32_bf16 a[56:59], v[64:67], v[252:255], a[56:59]
  ds_read_b64_tr_b16 v[250:251], v14 offset:34816
  v_mfma_f32_16x16x32_bf16 a[60:63], v[68:71], v[252:255], a[60:63]
  buffer_load_dwordx4 v27, s[12:15], s54 offen offset:3072 sc1 lds
  v_mfma_f32_16x16x32_bf16 a[120:123], v[72:75], v[252:255], a[120:123]
  v_mfma_f32_16x16x32_bf16 a[124:127], v[76:79], v[252:255], a[124:127]
  v_mfma_f32_16x16x32_bf16 a[184:187], v[80:83], v[252:255], a[184:187]
  v_mfma_f32_16x16x32_bf16 a[188:191], v[84:87], v[252:255], a[188:191]
  v_mfma_f32_16x16x32_bf16 a[248:251], v[88:91], v[252:255], a[248:251]
  v_mfma_f32_16x16x32_bf16 a[252:255], v[92:95], v[252:255], a[252:255]
  ds_read_b64_tr_b16 v[252:253], v15 offset:32768
  ds_read_b64_tr_b16 v[254:255], v15 offset:34816
  s_waitcnt lgkmcnt(15)
  s_waitcnt lgkmcnt(4)
  v_mfma_f32_16x16x32_bf16 a[0:3], v[32:35], v[224:227], a[0:3]
  v_mfma_f32_16x16x32_bf16 a[4:7], v[36:39], v[224:227], a[4:7]
  s_add_u32 m0, s56, 69632
  v_mfma_f32_16x16x32_bf16 a[64:67], v[40:43], v[224:227], a[64:67]
  buffer_load_dwordx4 v28, s[12:15], s54 offen offset:0 sc1 lds
  v_mfma_f32_16x16x32_bf16 a[68:71], v[44:47], v[224:227], a[68:71]
  v_mfma_f32_16x16x32_bf16 a[128:131], v[48:51], v[224:227], a[128:131]
  v_mfma_f32_16x16x32_bf16 a[132:135], v[52:55], v[224:227], a[132:135]
  buffer_load_dwordx4 v29, s[12:15], s54 offen offset:1024 sc1 lds
  v_mfma_f32_16x16x32_bf16 a[192:195], v[56:59], v[224:227], a[192:195]
  v_mfma_f32_16x16x32_bf16 a[196:199], v[60:63], v[224:227], a[196:199]
  ds_read_b64_tr_b16 v[224:225], v8 offset:49152
  v_mfma_f32_16x16x32_bf16 a[8:11], v[32:35], v[228:231], a[8:11]
  ds_read_b64_tr_b16 v[226:227], v8 offset:51200
  v_mfma_f32_16x16x32_bf16 a[12:15], v[36:39], v[228:231], a[12:15]
  buffer_load_dwordx4 v30, s[12:15], s54 offen offset:2048 sc1 lds
  v_mfma_f32_16x16x32_bf16 a[72:75], v[40:43], v[228:231], a[72:75]
  ds_read_b128 v[64:67], v213 offset:32768
  v_mfma_f32_16x16x32_bf16 a[76:79], v[44:47], v[228:231], a[76:79]
  v_mfma_f32_16x16x32_bf16 a[136:139], v[48:51], v[228:231], a[136:139]
  buffer_load_dwordx4 v31, s[12:15], s54 offen offset:3072 sc1 lds
  s_add_u32 s54, s54, 0x80000
  v_mfma_f32_16x16x32_bf16 a[140:143], v[52:55], v[228:231], a[140:143]
  v_mfma_f32_16x16x32_bf16 a[200:203], v[56:59], v[228:231], a[200:203]
  v_mfma_f32_16x16x32_bf16 a[204:207], v[60:63], v[228:231], a[204:207]
  ds_read_b64_tr_b16 v[228:229], v9 offset:49152
  v_mfma_f32_16x16x32_bf16 a[16:19], v[32:35], v[232:235], a[16:19]
  ds_read_b64_tr_b16 v[230:231], v9 offset:51200
  v_mfma_f32_16x16x32_bf16 a[20:23], v[36:39], v[232:235], a[20:23]
  ds_read_b128 v[68:71], v212 offset:34816
  v_mfma_f32_16x16x32_bf16 a[80:83], v[40:43], v[232:235], a[80:83]
  v_mfma_f32_16x16x32_bf16 a[84:87], v[44:47], v[232:235], a[84:87]
  v_mfma_f32_16x16x32_bf16 a[144:147], v[48:51], v[232:235], a[144:147]
  v_mfma_f32_16x16x32_bf16 a[148:151], v[52:55], v[232:235], a[148:151]
  v_mfma_f32_16x16x32_bf16 a[208:211], v[56:59], v[232:235], a[208:211]
  ds_read_b128 v[72:75], v213 offset:36864
  v_mfma_f32_16x16x32_bf16 a[212:215], v[60:63], v[232:235], a[212:215]
  ds_read_b64_tr_b16 v[232:233], v10 offset:49152
  v_mfma_f32_16x16x32_bf16 a[24:27], v[32:35], v[236:239], a[24:27]
  ds_read_b64_tr_b16 v[234:235], v10 offset:51200
  v_mfma_f32_16x16x32_bf16 a[28:31], v[36:39], v[236:239], a[28:31]
  v_mfma_f32_16x16x32_bf16 a[88:91], v[40:43], v[236:239], a[88:91]
  v_mfma_f32_16x16x32_bf16 a[92:95], v[44:47], v[236:239], a[92:95]
  v_mfma_f32_16x16x32_bf16 a[152:155], v[48:51], v[236:239], a[152:155]
  ds_read_b128 v[76:79], v212 offset:38912
  v_mfma_f32_16x16x32_bf16 a[156:159], v[52:55], v[236:239], a[156:159]
  v_mfma_f32_16x16x32_bf16 a[216:219], v[56:59], v[236:239], a[216:219]
  v_mfma_f32_16x16x32_bf16 a[220:223], v[60:63], v[236:239], a[220:223]
  ds_read_b64_tr_b16 v[236:237], v11 offset:49152
  v_mfma_f32_16x16x32_bf16 a[32:35], v[32:35], v[240:243], a[32:35]
  ds_read_b64_tr_b16 v[238:239], v11 offset:51200
  v_mfma_f32_16x16x32_bf16 a[36:39], v[36:39], v[240:243], a[36:39]
  v_mfma_f32_16x16x32_bf16 a[96:99], v[40:43], v[240:243], a[96:99]
  ds_read_b128 v[80:83], v213 offset:40960
  v_mfma_f32_16x16x32_bf16 a[100:103], v[44:47], v[240:243], a[100:103]
  v_mfma_f32_16x16x32_bf16 a[160:163], v[48:51], v[240:243], a[160:163]
  buffer_load_dword v2, v3, s[8:11], s53 offen
  v_mfma_f32_16x16x32_bf16 a[164:167], v[52:55], v[240:243], a[164:167]
  v_mfma_f32_16x16x32_bf16 a[224:227], v[56:59], v[240:243], a[224:227]
  v_mfma_f32_16x16x32_bf16 a[228:231], v[60:63], v[240:243], a[228:231]
  ds_read_b64_tr_b16 v[240:241], v12 offset:49152
  v_mfma_f32_16x16x32_bf16 a[40:43], v[32:35], v[244:247], a[40:43]
  ds_read_b64_tr_b16 v[242:243], v12 offset:51200
  v_mfma_f32_16x16x32_bf16 a[44:47], v[36:39], v[244:247], a[44:47]
  ds_read_b128 v[84:87], v212 offset:43008
  v_mfma_f32_16x16x32_bf16 a[104:107], v[40:43], v[244:247], a[104:107]
  v_mfma_f32_16x16x32_bf16 a[108:111], v[44:47], v[244:247], a[108:111]
  v_mfma_f32_16x16x32_bf16 a[168:171], v[48:51], v[244:247], a[168:171]
  buffer_load_dword v2, v4, s[12:15], s54 offen
  v_mfma_f32_16x16x32_bf16 a[172:175], v[52:55], v[244:247], a[172:175]
  v_mfma_f32_16x16x32_bf16 a[232:235], v[56:59], v[244:247], a[232:235]
  ds_read_b128 v[88:91], v213 offset:45056
  v_mfma_f32_16x16x32_bf16 a[236:239], v[60:63], v[244:247], a[236:239]
  s_waitcnt lgkmcnt(15)
  ds_read_b64_tr_b16 v[244:245], v13 offset:49152
  v_mfma_f32_16x16x32_bf16 a[48:51], v[32:35], v[248:251], a[48:51]
  ds_read_b64_tr_b16 v[246:247], v13 offset:51200
  v_mfma_f32_16x16x32_bf16 a[52:55], v[36:39], v[248:251], a[52:55]
  v_mfma_f32_16x16x32_bf16 a[112:115], v[40:43], v[248:251], a[112:115]
  v_mfma_f32_16x16x32_bf16 a[116:119], v[44:47], v[248:251], a[116:119]
  s_mov_b64 exec, s[72:73]
  global_load_dword v2, v[142:143], off
  global_load_dword v2, v[176:177], off
  s_mov_b64 exec, -1
  v_mfma_f32_16x16x32_bf16 a[176:179], v[48:51], v[248:251], a[176:179]
  ds_read_b128 v[92:95], v212 offset:47104
  v_mfma_f32_16x16x32_bf16 a[180:183], v[52:55], v[248:251], a[180:183]
  v_mfma_f32_16x16x32_bf16 a[240:243], v[56:59], v[248:251], a[240:243]
  s_lshl_b64 s[72:73], s[72:73], 8
  s_or_b32 s72, s72, 1
  v_mfma_f32_16x16x32_bf16 a[244:247], v[60:63], v[248:251], a[244:247]
  ds_read_b64_tr_b16 v[248:249], v14 offset:49152
  v_mfma_f32_16x16x32_bf16 a[56:59], v[32:35], v[252:255], a[56:59]
  ds_read_b64_tr_b16 v[250:251], v14 offset:51200
  v_mfma_f32_16x16x32_bf16 a[60:63], v[36:39], v[252:255], a[60:63]
  v_mfma_f32_16x16x32_bf16 a[120:123], v[40:43], v[252:255], a[120:123]
  v_mfma_f32_16x16x32_bf16 a[124:127], v[44:47], v[252:255], a[124:127]
  v_mfma_f32_16x16x32_bf16 a[184:187], v[48:51], v[252:255], a[184:187]
  v_mfma_f32_16x16x32_bf16 a[188:191], v[52:55], v[252:255], a[188:191]
  v_mfma_f32_16x16x32_bf16 a[248:251], v[56:59], v[252:255], a[248:251]
  v_mfma_f32_16x16x32_bf16 a[252:255], v[60:63], v[252:255], a[252:255]
  ds_read_b64_tr_b16 v[252:253], v15 offset:49152
  ds_read_b64_tr_b16 v[254:255], v15 offset:51200
  s_waitcnt lgkmcnt(4)
  v_mfma_f32_16x16x32_bf16 a[0:3], v[64:67], v[224:227], a[0:3]
  v_mfma_f32_16x16x32_bf16 a[4:7], v[68:71], v[224:227], a[4:7]
  v_mfma_f32_16x16x32_bf16 a[64:67], v[72:75], v[224:227], a[64:67]
  v_mfma_f32_16x16x32_bf16 a[68:71], v[76:79], v[224:227], a[68:71]
  v_mfma_f32_16x16x32_bf16 a[128:131], v[80:83], v[224:227], a[128:131]
  v_mfma_f32_16x16x32_bf16 a[132:135], v[84:87], v[224:227], a[132:135]
  v_mfma_f32_16x16x32_bf16 a[192:195], v[88:91], v[224:227], a[192:195]
  v_mfma_f32_16x16x32_bf16 a[196:199], v[92:95], v[224:227], a[196:199]
  s_waitcnt vmcnt(4) lgkmcnt(0)
  s_barrier
  ds_read_b64_tr_b16 v[224:225], v8 offset:0
  v_mfma_f32_16x16x32_bf16 a[8:11], v[64:67], v[228:231], a[8:11]
  ds_read_b64_tr_b16 v[226:227], v8 offset:2048
  v_mfma_f32_16x16x32_bf16 a[12:15], v[68:71], v[228:231], a[12:15]
  v_mfma_f32_16x16x32_bf16 a[72:75], v[72:75], v[228:231], a[72:75]
  ds_read_b128 v[32:35], v212 offset:0
  s_add_u32 m0, s56, 32768
  v_mfma_f32_16x16x32_bf16 a[76:79], v[76:79], v[228:231], a[76:79]
  buffer_load_dwordx4 v16, s[8:11], s53 offen offset:0 sc1 lds
  v_mfma_f32_16x16x32_bf16 a[136:139], v[80:83], v[228:231], a[136:139]
  v_mfma_f32_16x16x32_bf16 a[140:143], v[84:87], v[228:231], a[140:143]
  v_mfma_f32_16x16x32_bf16 a[200:203], v[88:91], v[228:231], a[200:203]
  v_mfma_f32_16x16x32_bf16 a[204:207], v[92:95], v[228:231], a[204:207]
  ds_read_b64_tr_b16 v[228:229], v9 offset:0
  v_mfma_f32_16x16x32_bf16 a[16:19], v[64:67], v[232:235], a[16:19]
  buffer_load_dwordx4 v17, s[8:11], s53 offen offset:1024 sc1 lds
  v_mfma_f32_16x16x32_bf16 a[20:23], v[68:71], v[232:235], a[20:23]
  ds_read_b64_tr_b16 v[230:231], v9 offset:2048
  v_mfma_f32_16x16x32_bf16 a[80:83], v[72:75], v[232:235], a[80:83]
  ds_read_b128 v[36:39], v213 offset:2048
  v_mfma_f32_16x16x32_bf16 a[84:87], v[76:79], v[232:235], a[84:87]
  buffer_load_dwordx4 v18, s[8:11], s53 offen offset:2048 sc1 lds
  v_mfma_f32_16x16x32_bf16 a[144:147], v[80:83], v[232:235], a[144:147]
  v_mfma_f32_16x16x32_bf16 a[148:151], v[84:87], v[232:235], a[148:151]
  v_mfma_f32_16x16x32_bf16 a[208:211], v[88:91], v[232:235], a[208:211]
  ds_read_b128 v[40:43], v212 offset:4096
  v_mfma_f32_16x16x32_bf16 a[212:215], v[92:95], v[232:235], a[212:215]
  ds_read_b64_tr_b16 v[232:233], v10 offset:0
  v_mfma_f32_16x16x32_bf16 a[24:27], v[64:67], v[236:239], a[24:27]
  buffer_load_dwordx4 v19, s[8:11], s53 offen offset:3072 sc1 lds
  v_mfma_f32_16x16x32_bf16 a[28:31], v[68:71], v[236:239], a[28:31]
  ds_read_b64_tr_b16 v[234:235], v10 offset:2048
  v_mfma_f32_16x16x32_bf16 a[88:91], v[72:75], v[236:239], a[88:91]
  v_mfma_f32_16x16x32_bf16 a[92:95], v[76:79], v[236:239], a[92:95]
  s_add_u32 m0, s56, 36864
  v_mfma_f32_16x16x32_bf16 a[152:155], v[80:83], v[236:239], a[152:155]
  ds_read_b128 v[44:47], v213 offset:6144
  v_mfma_f32_16x16x32_bf16 a[156:159], v[84:87], v[236:239], a[156:159]
  buffer_load_dwordx4 v20, s[8:11], s53 offen offset:0 sc1 lds
  v_mfma_f32_16x16x32_bf16 a[216:219], v[88:91], v[236:239], a[216:219]
  v_mfma_f32_16x16x32_bf16 a[220:223], v[92:95], v[236:239], a[220:223]
  ds_read_b64_tr_b16 v[236:237], v11 offset:0
  v_mfma_f32_16x16x32_bf16 a[32:35], v[64:67], v[240:243], a[32:35]
  ds_read_b64_tr_b16 v[238:239], v11 offset:2048
  v_mfma_f32_16x16x32_bf16 a[36:39], v[68:71], v[240:243], a[36:39]
  buffer_load_dwordx4 v21, s[8:11], s53 offen offset:1024 sc1 lds
  v_mfma_f32_16x16x32_bf16 a[96:99], v[72:75], v[240:243], a[96:99]
  ds_read_b128 v[48:51], v212 offset:8192
  v_mfma_f32_16x16x32_bf16 a[100:103], v[76:79], v[240:243], a[100:103]
  v_mfma_f32_16x16x32_bf16 a[160:163], v[80:83], v[240:243], a[160:163]
  buffer_load_dwordx4 v22, s[8:11], s53 offen offset:2048 sc1 lds
  v_mfma_f32_16x16x32_bf16 a[164:167], v[84:87], v[240:243], a[164:167]
  v_mfma_f32_16x16x32_bf16 a[224:227], v[88:91], v[240:243], a[224:227]
  v_mfma_f32_16x16x32_bf16 a[228:231], v[92:95], v[240:243], a[228:231]
  ds_read_b64_tr_b16 v[240:241], v12 offset:0
  v_mfma_f32_16x16x32_bf16 a[40:43], v[64:67], v[244:247], a[40:43]
  ds_read_b64_tr_b16 v[242:243], v12 offset:2048
  v_mfma_f32_16x16x32_bf16 a[44:47], v[68:71], v[244:247], a[44:47]
  ds_read_b128 v[52:55], v213 offset:10240
  v_mfma_f32_16x16x32_bf16 a[104:107], v[72:75], v[244:247], a[104:107]
  buffer_load_dwordx4 v23, s[8:11], s53 offen offset:3072 sc1 lds
  s_add_u32 s53, s53, 128
  v_mfma_f32_16x16x32_bf16 a[108:111], v[76:79], v[244:247], a[108:111]
  v_mfma_f32_16x16x32_bf16 a[168:171], v[80:83], v[244:247], a[168:171]
  s_add_u32 m0, s56, 98304
  v_mfma_f32_16x16x32_bf16 a[172:175], v[84:87], v[244:247], a[172:175]
  buffer_load_dwordx4 v24, s[12:15], s54 offen offset:0 sc1 lds
  v_mfma_f32_16x16x32_bf16 a[232:235], v[88:91], v[244:247], a[232:235]
  ds_read_b128 v[56:59], v212 offset:12288
  v_mfma_f32_16x16x32_bf16 a[236:239], v[92:95], v[244:247], a[236:239]
  ds_read_b64_tr_b16 v[244:245], v13 offset:0
  v_mfma_f32_16x16x32_bf16 a[48:51], v[64:67], v[248:251], a[48:51]
  ds_read_b64_tr_b16 v[246:247], v13 offset:2048
  v_mfma_f32_16x16x32_bf16 a[52:55], v[68:71], v[248:251], a[52:55]
  buffer_load_dwordx4 v25, s[12:15], s54 offen offset:1024 sc1 lds
  v_mfma_f32_16x16x32_bf16 a[112:115], v[72:75], v[248:251], a[112:115]
  v_mfma_f32_16x16x32_bf16 a[116:119], v[76:79], v[248:251], a[116:119]
  v_mfma_f32_16x16x32_bf16 a[176:179], v[80:83], v[248:251], a[176:179]
  ds_read_b128 v[60:63], v213 offset:14336
  v_mfma_f32_16x16x32_bf16 a[180:183], v[84:87], v[248:251], a[180:183]
  buffer_load_dwordx4 v26, s[12:15], s54 offen offset:2048 sc1 lds
  v_mfma_f32_16x16x32_bf16 a[240:243], v[88:91], v[248:251], a[240:243]
  v_mfma_f32_16x16x32_bf16 a[244:247], v[92:95], v[248:251], a[244:247]
  ds_read_b64_tr_b16 v[248:249], v14 offset:0
  v_mfma_f32_16x16x32_bf16 a[56:59], v[64:67], v[252:255], a[56:59]
  ds_read_b64_tr_b16 v[250:251], v14 offset:2048
  v_mfma_f32_16x16x32_bf16 a[60:63], v[68:71], v[252:255], a[60:63]
  buffer_load_dwordx4 v27, s[12:15], s54 offen offset:3072 sc1 lds
  v_mfma_f32_16x16x32_bf16 a[120:123], v[72:75], v[252:255], a[120:123]
  v_mfma_f32_16x16x32_bf16 a[124:127], v[76:79], v[252:255], a[124:127]
  v_mfma_f32_16x16x32_bf16 a[184:187], v[80:83], v[252:255], a[184:187]
  v_mfma_f32_16x16x32_bf16 a[188:191], v[84:87], v[252:255], a[188:191]
  v_mfma_f32_16x16x32_bf16 a[248:251], v[88:91], v[252:255], a[248:251]
  v_mfma_f32_16x16x32_bf16 a[252:255], v[92:95], v[252:255], a[252:255]
  ds_read_b64_tr_b16 v[252:253], v15 offset:0
  ds_read_b64_tr_b16 v[254:255], v15 offset:2048
  s_add_u32 s55, s55, 1
  s_cmp_eq_u32 s55, s59
  s_cbranch_scc1 M_SIGX
  s_cmp_lg_u32 s55, 5
  s_cbranch_scc1 M_NOPOLL_V
  s_lshl_b32 s7, s33, 9
  s_add_u32 s7, s7, 121634816
  buffer_load_dwordx2 v[6:7], v5, s[16:19], s7 offen sc1
M_NOPOLL_V:
  s_cmp_lt_u32 s55, 6
  s_cbranch_scc1 M_LOOP_V
M_TAIL1:
  v_cmp_eq_u32 vcc, s86, v6
  v_cmp_eq_u32 s[4:5], s87, v7
  s_nop 0
  s_and_b64 vcc, vcc, s[4:5]
  s_cmp_eq_u64 vcc, exec
  s_cselect_b32 s67, 1, 0
  s_waitcnt lgkmcnt(15)
  s_waitcnt lgkmcnt(4)
  v_mfma_f32_16x16x32_bf16 a[0:3], v[32:35], v[224:227], a[0:3]
  v_mfma_f32_16x16x32_bf16 a[4:7], v[36:39], v[224:227], a[4:7]
  s_add_u32 m0, s56, 102400
  v_mfma_f32_16x16x32_bf16 a[64:67], v[40:43], v[224:227], a[64:67]
  buffer_load_dwordx4 v28, s[12:15], s54 offen offset:0 sc1 lds
  v_mfma_f32_16x16x32_bf16 a[68:71], v[44:47], v[224:227], a[68:71]
  v_mfma_f32_16x16x32_bf16 a[128:131], v[48:51], v[224:227], a[128:131]
  v_mfma_f32_16x16x32_bf16 a[132:135], v[52:55], v[224:227], a[132:135]
  buffer_load_dwordx4 v29, s[12:15], s54 offen offset:1024 sc1 lds
  v_mfma_f32_16x16x32_bf16 a[192:195], v[56:59], v[224:227], a[192:195]
  v_mfma_f32_16x16x32_bf16 a[196:199], v[60:63], v[224:227], a[196:199]
  ds_read_b64_tr_b16 v[224:225], v8 offset:16384
  v_mfma_f32_16x16x32_bf16 a[8:11], v[32:35], v[228:231], a[8:11]
  ds_read_b64_tr_b16 v[226:227], v8 offset:18432
  v_mfma_f32_16x16x32_bf16 a[12:15], v[36:39], v[228:231], a[12:15]
  buffer_load_dwordx4 v30, s[12:15], s54 offen offset:2048 sc1 lds
  v_mfma_f32_16x16x32_bf16 a[72:75], v[40:43], v[228:231], a[72:75]
  ds_read_b128 v[64:67], v213 offset:0
  v_mfma_f32_16x16x32_bf16 a[76:79], v[44:47], v[228:231], a[76:79]
  v_mfma_f32_16x16x32_bf16 a[136:139], v[48:51], v[228:231], a[136:139]
  buffer_load_dwordx4 v31, s[12:15], s54 offen offset:3072 sc1 lds
  s_add_u32 s54, s54, 0x80000
  v_mfma_f32_16x16x32_bf16 a[140:143], v[52:55], v[228:231], a[140:143]
  v_mfma_f32_16x16x32_bf16 a[200:203], v[56:59], v[228:231], a[200:203]
  v_mfma_f32_16x16x32_bf16 a[204:207], v[60:63], v[228:231], a[204:207]
  ds_read_b64_tr_b16 v[228:229], v9 offset:16384
  v_mfma_f32_16x16x32_bf16 a[16:19], v[32:35], v[232:235], a[16:19]
  ds_read_b64_tr_b16 v[230:231], v9 offset:18432
  v_mfma_f32_16x16x32_bf16 a[20:23], v[36:39], v[232:235], a[20:23]
  ds_read_b128 v[68:71], v212 offset:2048
  v_mfma_f32_16x16x32_bf16 a[80:83], v[40:43], v[232:235], a[80:83]
  buffer_load_dwordx4 v[96:99], v1, s[16:19], s66 offen offset:0 sc1
  v_mfma_f32_16x16x32_bf16 a[84:87], v[44:47], v[232:235], a[84:87]
  v_mfma_f32_16x16x32_bf16 a[144:147], v[48:51], v[232:235], a[144:147]
  v_mfma_f32_16x16x32_bf16 a[148:151], v[52:55], v[232:235], a[148:151]
  v_mfma_f32_16x16x32_bf16 a[208:211], v[56:59], v[232:235], a[208:211]
  ds_read_b128 v[72:75], v213 offset:4096
  v_mfma_f32_16x16x32_bf16 a[212:215], v[60:63], v[232:235], a[212:215]
  buffer_load_dwordx4 v[100:103], v1, s[16:19], s66 offen offset:1024 sc1
  v_mfma_f32_16x16x32_bf16 a[24:27], v[32:35], v[236:239], a[24:27]
  ds_read_b64_tr_b16 v[232:233], v10 offset:16384
  v_mfma_f32_16x16x32_bf16 a[28:31], v[36:39], v[236:239], a[28:31]
  ds_read_b64_tr_b16 v[234:235], v10 offset:18432
  v_mfma_f32_16x16x32_bf16 a[88:91], v[40:43], v[236:239], a[88:91]
  v_mfma_f32_16x16x32_bf16 a[92:95], v[44:47], v[236:239], a[92:95]
  buffer_load_dwordx4 v[104:107], v1, s[16:19], s66 offen offset:2048 sc1
  v_mfma_f32_16x16x32_bf16 a[152:155], v[48:51], v[236:239], a[152:155]
  ds_read_b128 v[76:79], v212 offset:6144
  v_mfma_f32_16x16x32_bf16 a[156:159], v[52:55], v[236:239], a[156:159]
  v_mfma_f32_16x16x32_bf16 a[216:219], v[56:59], v[236:239], a[216:219]
  v_mfma_f32_16x16x32_bf16 a[220:223], v[60:63], v[236:239], a[220:223]
  ds_read_b64_tr_b16 v[236:237], v11 offset:16384
  v_mfma_f32_16x16x32_bf16 a[32:35], v[32:35], v[240:243], a[32:35]
  buffer_load_dwordx4 v[108:111], v1, s[16:19], s66 offen offset:3072 sc1
  v_mfma_f32_16x16x32_bf16 a[36:39], v[36:39], v[240:243], a[36:39]
  ds_read_b64_tr_b16 v[238:239], v11 offset:18432
  v_mfma_f32_16x16x32_bf16 a[96:99], v[40:43], v[240:243], a[96:99]
  ds_read_b128 v[80:83], v213 offset:8192
  v_mfma_f32_16x16x32_bf16 a[100:103], v[44:47], v[240:243], a[100:103]
  s_add_u32 s66, s66, 4096
  v_mfma_f32_16x16x32_bf16 a[160:163], v[48:51], v[240:243], a[160:163]
  buffer_load_dwordx4 v[112:115], v1, s[16:19], s66 offen offset:0 sc1
  v_mfma_f32_16x16x32_bf16 a[164:167], v[52:55], v[240:243], a[164:167]
  v_mfma_f32_16x16x32_bf16 a[224:227], v[56:59], v[240:243], a[224:227]
  v_mfma_f32_16x16x32_bf16 a[228:231], v[60:63], v[240:243], a[228:231]
  ds_read_b64_tr_b16 v[240:241], v12 offset:16384
  v_mfma_f32_16x16x32_bf16 a[40:43], v[32:35], v[244:247], a[40:43]
  ds_read_b64_tr_b16 v[242:243], v12 offset:18432
  v_mfma_f32_16x16x32_bf16 a[44:47], v[36:39], v[244:247], a[44:47]
  ds_read_b128 v[84:87], v212 offset:10240
  v_mfma_f32_16x16x32_bf16 a[104:107], v[40:43], v[244:247], a[104:107]
  buffer_load_dwordx4 v[116:119], v1, s[16:19], s66 offen offset:1024 sc1
  v_mfma_f32_16x16x32_bf16 a[108:111], v[44:47], v[244:247], a[108:111]
  v_mfma_f32_16x16x32_bf16 a[168:171], v[48:51], v[244:247], a[168:171]
  v_mfma_f32_16x16x32_bf16 a[172:175], v[52:55], v[244:247], a[172:175]
  buffer_load_dwordx4 v[120:123], v1, s[16:19], s66 offen offset:2048 sc1
  v_mfma_f32_16x16x32_bf16 a[232:235], v[56:59], v[244:247], a[232:235]
  ds_read_b128 v[88:91], v213 offset:12288
  v_mfma_f32_16x16x32_bf16 a[236:239], v[60:63], v[244:247], a[236:239]
  s_waitcnt lgkmcnt(15)
  ds_read_b64_tr_b16 v[244:245], v13 offset:16384
  v_mfma_f32_16x16x32_bf16 a[48:51], v[32:35], v[248:251], a[48:51]
  ds_read_b64_tr_b16 v[246:247], v13 offset:18432
  v_mfma_f32_16x16x32_bf16 a[52:55], v[36:39], v[248:251], a[52:55]
  buffer_load_dwordx4 v[124:127], v1, s[16:19], s66 offen offset:3072 sc1
  v_mfma_f32_16x16x32_bf16 a[112:115], v[40:43], v[248:251], a[112:115]
  v_mfma_f32_16x16x32_bf16 a[116:119], v[44:47], v[248:251], a[116:119]
  v_mfma_f32_16x16x32_bf16 a[176:179], v[48:51], v[248:251], a[176:179]
  ds_read_b128 v[92:95], v212 offset:14336
  v_mfma_f32_16x16x32_bf16 a[180:183], v[52:55], v[248:251], a[180:183]
  s_add_u32 s66, s66, 4096
  v_mfma_f32_16x16x32_bf16 a[240:243], v[56:59], v[248:251], a[240:243]
  buffer_load_dwordx4 v[128:131], v1, s[16:19], s66 offen offset:0 sc1
  v_mfma_f32_16x16x32_bf16 a[244:247], v[60:63], v[248:251], a[244:247]
  ds_read_b64_tr_b16 v[248:249], v14 offset:16384
  v_mfma_f32_16x16x32_bf16 a[56:59], v[32:35], v[252:255], a[56:59]
  ds_read_b64_tr_b16 v[250:251], v14 offset:18432
  v_mfma_f32_16x16x32_bf16 a[60:63], v[36:39], v[252:255], a[60:63]
  v_mfma_f32_16x16x32_bf16 a[120:123], v[40:43], v[252:255], a[120:123]
  buffer_load_dwordx4 v[132:135], v1, s[16:19], s66 offen offset:1024 sc1
  v_mfma_f32_16x16x32_bf16 a[124:127], v[44:47], v[252:255], a[124:127]
  v_mfma_f32_16x16x32_bf16 a[184:187], v[48:51], v[252:255], a[184:187]
  v_mfma_f32_16x16x32_bf16 a[188:191], v[52:55], v[252:255], a[188:191]
  v_mfma_f32_16x16x32_bf16 a[248:251], v[56:59], v[252:255], a[248:251]
  v_mfma_f32_16x16x32_bf16 a[252:255], v[60:63], v[252:255], a[252:255]
  ds_read_b64_tr_b16 v[252:253], v15 offset:16384
  ds_read_b64_tr_b16 v[254:255], v15 offset:18432
  s_waitcnt lgkmcnt(4)
  v_mfma_f32_16x16x32_bf16 a[0:3], v[64:67], v[224:227], a[0:3]
  v_mfma_f32_16x16x32_bf16 a[4:7], v[68:71], v[224:227], a[4:7]
  v_mfma_f32_16x16x32_bf16 a[64:67], v[72:75], v[224:227], a[64:67]
  v_mfma_f32_16x16x32_bf16 a[68:71], v[76:79], v[224:227], a[68:71]
  v_mfma_f32_16x16x32_bf16 a[128:131], v[80:83], v[224:227], a[128:131]
  v_mfma_f32_16x16x32_bf16 a[132:135], v[84:87], v[224:227], a[132:135]
  v_mfma_f32_16x16x32_bf16 a[192:195], v[88:91], v[224:227], a[192:195]
  v_mfma_f32_16x16x32_bf16 a[196:199], v[92:95], v[224:227], a[196:199]
  s_waitcnt vmcnt(10)
  s_waitcnt lgkmcnt(0)
  s_barrier
  ds_read_b64_tr_b16 v[224:225], v8 offset:32768
  v_mfma_f32_16x16x32_bf16 a[8:11], v[64:67], v[228:231], a[8:11]
  ds_read_b64_tr_b16 v[226:227], v8 offset:34816
  v_mfma_f32_16x16x32_bf16 a[12:15], v[68:71], v[228:231], a[12:15]
  v_mfma_f32_16x16x32_bf16 a[72:75], v[72:75], v[228:231], a[72:75]
  ds_read_b128 v[32:35], v212 offset:32768
  s_add_u32 m0, s56, 0
  v_mfma_f32_16x16x32_bf16 a[76:79], v[76:79], v[228:231], a[76:79]
  buffer_load_dwordx4 v16, s[8:11], s53 offen offset:0 sc1 lds
  v_mfma_f32_16x16x32_bf16 a[136:139], v[80:83], v[228:231], a[136:139]
  v_mfma_f32_16x16x32_bf16 a[140:143], v[84:87], v[228:231], a[140:143]
  buffer_load_dwordx4 v[136:139], v1, s[16:19], s66 offen offset:2048 sc1
  v_mfma_f32_16x16x32_bf16 a[200:203], v[88:91], v[228:231], a[200:203]
  v_mfma_f32_16x16x32_bf16 a[204:207], v[92:95], v[228:231], a[204:207]
  ds_read_b64_tr_b16 v[228:229], v9 offset:32768
  v_mfma_f32_16x16x32_bf16 a[16:19], v[64:67], v[232:235], a[16:19]
  buffer_load_dwordx4 v17, s[8:11], s53 offen offset:1024 sc1 lds
  v_mfma_f32_16x16x32_bf16 a[20:23], v[68:71], v[232:235], a[20:23]
  ds_read_b64_tr_b16 v[230:231], v9 offset:34816
  v_mfma_f32_16x16x32_bf16 a[80:83], v[72:75], v[232:235], a[80:83]
  ds_read_b128 v[36:39], v213 offset:34816
  v_mfma_f32_16x16x32_bf16 a[84:87], v[76:79], v[232:235], a[84:87]
  buffer_load_dwordx4 v18, s[8:11], s53 offen offset:2048 sc1 lds
  v_mfma_f32_16x16x32_bf16 a[144:147], v[80:83], v[232:235], a[144:147]
  v_mfma_f32_16x16x32_bf16 a[148:151], v[84:87], v[232:235], a[148:151]
  v_mfma_f32_16x16x32_bf16 a[208:211], v[88:91], v[232:235], a[208:211]
  ds_read_b128 v[40:43], v212 offset:36864
  v_mfma_f32_16x16x32_bf16 a[212:215], v[92:95], v[232:235], a[212:215]
  ds_read_b64_tr_b16 v[232:233], v10 offset:32768
  v_mfma_f32_16x16x32_bf16 a[24:27], v[64:67], v[236:239], a[24:27]
  buffer_load_dwordx4 v19, s[8:11], s53 offen offset:3072 sc1 lds
  v_mfma_f32_16x16x32_bf16 a[28:31], v[68:71], v[236:239], a[28:31]
  ds_read_b64_tr_b16 v[234:235], v10 offset:34816
  v_mfma_f32_16x16x32_bf16 a[88:91], v[72:75], v[236:239], a[88:91]
  buffer_load_dwordx4 v[140:143], v1, s[16:19], s66 offen offset:3072 sc1
  v_mfma_f32_16x16x32_bf16 a[92:95], v[76:79], v[236:239], a[92:95]
  s_add_u32 m0, s56, 4096
  v_mfma_f32_16x16x32_bf16 a[152:155], v[80:83], v[236:239], a[152:155]
  ds_read_b128 v[44:47], v213 offset:38912
  v_mfma_f32_16x16x32_bf16 a[156:159], v[84:87], v[236:239], a[156:159]
  buffer_load_dwordx4 v20, s[8:11], s53 offen offset:0 sc1 lds
  v_mfma_f32_16x16x32_bf16 a[216:219], v[88:91], v[236:239], a[216:219]
  v_mfma_f32_16x16x32_bf16 a[220:223], v[92:95], v[236:239], a[220:223]
  ds_read_b64_tr_b16 v[236:237], v11 offset:32768
  v_mfma_f32_16x16x32_bf16 a[32:35], v[64:67], v[240:243], a[32:35]
  ds_read_b64_tr_b16 v[238:239], v11 offset:34816
  v_mfma_f32_16x16x32_bf16 a[36:39], v[68:71], v[240:243], a[36:39]
  buffer_load_dwordx4 v21, s[8:11], s53 offen offset:1024 sc1 lds
  v_mfma_f32_16x16x32_bf16 a[96:99], v[72:75], v[240:243], a[96:99]
  ds_read_b128 v[48:51], v212 offset:40960
  v_mfma_f32_16x16x32_bf16 a[100:103], v[76:79], v[240:243], a[100:103]
  v_mfma_f32_16x16x32_bf16 a[160:163], v[80:83], v[240:243], a[160:163]
  buffer_load_dwordx4 v22, s[8:11], s53 offen offset:2048 sc1 lds
  v_mfma_f32_16x16x32_bf16 a[164:167], v[84:87], v[240:243], a[164:167]
  v_mfma_f32_16x16x32_bf16 a[224:227], v[88:91], v[240:243], a[224:227]
  s_add_u32 s66, s66, 4096
  v_mfma_f32_16x16x32_bf16 a[228:231], v[92:95], v[240:243], a[228:231]
  ds_read_b64_tr_b16 v[240:241], v12 offset:32768
  v_mfma_f32_16x16x32_bf16 a[40:43], v[64:67], v[244:247], a[40:43]
  buffer_load_dwordx4 v[144:147], v1, s[16:19], s66 offen offset:0 sc1
  v_mfma_f32_16x16x32_bf16 a[44:47], v[68:71], v[244:247], a[44:47]
  ds_read_b64_tr_b16 v[242:243], v12 offset:34816
  v_mfma_f32_16x16x32_bf16 a[104:107], v[72:75], v[244:247], a[104:107]
  ds_read_b128 v[52:55], v213 offset:43008
  v_mfma_f32_16x16x32_bf16 a[108:111], v[76:79], v[244:247], a[108:111]
  buffer_load_dwordx4 v23, s[8:11], s53 offen offset:3072 sc1 lds
  s_add_u32 s53, s53, 128
  v_mfma_f32_16x16x32_bf16 a[168:171], v[80:83], v[244:247], a[168:171]
  s_add_u32 m0, s56, 65536
  v_mfma_f32_16x16x32_bf16 a[172:175], v[84:87], v[244:247], a[172:175]
  buffer_load_dwordx4 v24, s[12:15], s54 offen offset:0 sc1 lds
  v_mfma_f32_16x16x32_bf16 a[232:235], v[88:91], v[244:247], a[232:235]
  ds_read_b128 v[56:59], v212 offset:45056
  v_mfma_f32_16x16x32_bf16 a[236:239], v[92:95], v[244:247], a[236:239]
  ds_read_b64_tr_b16 v[244:245], v13 offset:32768
  v_mfma_f32_16x16x32_bf16 a[48:51], v[64:67], v[248:251], a[48:51]
  ds_read_b64_tr_b16 v[246:247], v13 offset:34816
  v_mfma_f32_16x16x32_bf16 a[52:55], v[68:71], v[248:251], a[52:55]
  buffer_load_dwordx4 v25, s[12:15], s54 offen offset:1024 sc1 lds
  v_mfma_f32_16x16x32_bf16 a[112:115], v[72:75], v[248:251], a[112:115]
  v_mfma_f32_16x16x32_bf16 a[116:119], v[76:79], v[248:251], a[116:119]
  v_mfma_f32_16x16x32_bf16 a[176:179], v[80:83], v[248:251], a[176:179]
  ds_read_b128 v[60:63], v213 offset:47104
  v_mfma_f32_16x16x32_bf16 a[180:183], v[84:87], v[248:251], a[180:183]
  buffer_load_dwordx4 v[148:151], v1, s[16:19], s66 offen offset:1024 sc1
  v_mfma_f32_16x16x32_bf16 a[240:243], v[88:91], v[248:251], a[240:243]
  buffer_load_dwordx4 v26, s[12:15], s54 offen offset:2048 sc1 lds
  v_mfma_f32_16x16x32_bf16 a[244:247], v[92:95], v[248:251], a[244:247]
  ds_read_b64_tr_b16 v[248:249], v14 offset:32768
  v_mfma_f32_16x16x32_bf16 a[56:59], v[64:67], v[252:255], a[56:59]
  ds_read_b64_tr_b16 v[250:251], v14 offset:34816
  v_mfma_f32_16x16x32_bf16 a[60:63], v[68:71], v[252:255], a[60:63]
  buffer_load_dwordx4 v27, s[12:15], s54 offen offset:3072 sc1 lds
  v_mfma_f32_16x16x32_bf16 a[120:123], v[72:75], v[252:255], a[120:123]
  v_mfma_f32_16x16x32_bf16 a[124:127], v[76:79], v[252:255], a[124:127]
  v_mfma_f32_16x16x32_bf16 a[184:187], v[80:83], v[252:255], a[184:187]
  v_mfma_f32_16x16x32_bf16 a[188:191], v[84:87], v[252:255], a[188:191]
  v_mfma_f32_16x16x32_bf16 a[248:251], v[88:91], v[252:255], a[248:251]
  v_mfma_f32_16x16x32_bf16 a[252:255], v[92:95], v[252:255], a[252:255]
  ds_read_b64_tr_b16 v[252:253], v15 offset:32768
  ds_read_b64_tr_b16 v[254:255], v15 offset:34816
  s_waitcnt lgkmcnt(15)
  s_waitcnt lgkmcnt(4)
  v_mfma_f32_16x16x32_bf16 a[0:3], v[32:35], v[224:227], a[0:3]
  v_mfma_f32_16x16x32_bf16 a[4:7], v[36:39], v[224:227], a[4:7]
  s_add_u32 m0, s56, 69632
  v_mfma_f32_16x16x32_bf16 a[64:67], v[40:43], v[224:227], a[64:67]
  buffer_load_dwordx4 v28, s[12:15], s54 offen offset:0 sc1 lds
  v_mfma_f32_16x16x32_bf16 a[68:71], v[44:47], v[224:227], a[68:71]
  v_mfma_f32_16x16x32_bf16 a[128:131], v[48:51], v[224:227], a[128:131]
  v_mfma_f32_16x16x32_bf16 a[132:135], v[52:55], v[224:227], a[132:135]
  buffer_load_dwordx4 v29, s[12:15], s54 offen offset:1024 sc1 lds
  v_mfma_f32_16x16x32_bf16 a[192:195], v[56:59], v[224:227], a[192:195]
  v_mfma_f32_16x16x32_bf16 a[196:199], v[60:63], v[224:227], a[196:199]
  ds_read_b64_tr_b16 v[224:225], v8 offset:49152
  v_mfma_f32_16x16x32_bf16 a[8:11], v[32:35], v[228:231], a[8:11]
  ds_read_b64_tr_b16 v[226:227], v8 offset:51200
  v_mfma_f32_16x16x32_bf16 a[12:15], v[36:39], v[228:231], a[12:15]
  buffer_load_dwordx4 v30, s[12:15], s54 offen offset:2048 sc1 lds
  v_mfma_f32_16x16x32_bf16 a[72:75], v[40:43], v[228:231], a[72:75]
  ds_read_b128 v[64:67], v213 offset:32768
  v_mfma_f32_16x16x32_bf16 a[76:79], v[44:47], v[228:231], a[76:79]
  v_mfma_f32_16x16x32_bf16 a[136:139], v[48:51], v[228:231], a[136:139]
  buffer_load_dwordx4 v31, s[12:15], s54 offen offset:3072 sc1 lds
  s_add_u32 s54, s54, 0x80000
  v_mfma_f32_16x16x32_bf16 a[140:143], v[52:55], v[228:231], a[140:143]
  v_mfma_f32_16x16x32_bf16 a[200:203], v[56:59], v[228:231], a[200:203]
  v_mfma_f32_16x16x32_bf16 a[204:207], v[60:63], v[228:231], a[204:207]
  ds_read_b64_tr_b16 v[228:229], v9 offset:49152
  v_mfma_f32_16x16x32_bf16 a[16:19], v[32:35], v[232:235], a[16:19]
  ds_read_b64_tr_b16 v[230:231], v9 offset:51200
  v_mfma_f32_16x16x32_bf16 a[20:23], v[36:39], v[232:235], a[20:23]
  ds_read_b128 v[68:71], v212 offset:34816
  v_mfma_f32_16x16x32_bf16 a[80:83], v[40:43], v[232:235], a[80:83]
  buffer_load_dwordx4 v[152:155], v1, s[16:19], s66 offen offset:2048 sc1
  v_mfma_f32_16x16x32_bf16 a[84:87], v[44:47], v[232:235], a[84:87]
  v_mfma_f32_16x16x32_bf16 a[144:147], v[48:51], v[232:235], a[144:147]
  v_mfma_f32_16x16x32_bf16 a[148:151], v[52:55], v[232:235], a[148:151]
  v_mfma_f32_16x16x32_bf16 a[208:211], v[56:59], v[232:235], a[208:211]
  ds_read_b128 v[72:75], v213 offset:36864
  v_mfma_f32_16x16x32_bf16 a[212:215], v[60:63], v[232:235], a[212:215]
  buffer_load_dwordx4 v[156:159], v1, s[16:19], s66 offen offset:3072 sc1
  v_mfma_f32_16x16x32_bf16 a[24:27], v[32:35], v[236:239], a[24:27]
  ds_read_b64_tr_b16 v[232:233], v10 offset:49152
  v_mfma_f32_16x16x32_bf16 a[28:31], v[36:39], v[236:239], a[28:31]
  ds_read_b64_tr_b16 v[234:235], v10 offset:51200
  v_mfma_f32_16x16x32_bf16 a[88:91], v[40:43], v[236:239], a[88:91]
  s_add_u32 s66, s66, 4096
  v_mfma_f32_16x16x32_bf16 a[92:95], v[44:47], v[236:239], a[92:95]
  buffer_load_dwordx4 v[160:163], v1, s[16:19], s66 offen offset:0 sc1
  v_mfma_f32_16x16x32_bf16 a[152:155], v[48:51], v[236:239], a[152:155]
  ds_read_b128 v[76:79], v212 offset:38912
  v_mfma_f32_16x16x32_bf16 a[156:159], v[52:55], v[236:239], a[156:159]
  v_mfma_f32_16x16x32_bf16 a[216:219], v[56:59], v[236:239], a[216:219]
  v_mfma_f32_16x16x32_bf16 a[220:223], v[60:63], v[236:239], a[220:223]
  ds_read_b64_tr_b16 v[236:237], v11 offset:49152
  v_mfma_f32_16x16x32_bf16 a[32:35], v[32:35], v[240:243], a[32:35]
  buffer_load_dwordx4 v[164:167], v1, s[16:19], s66 offen offset:1024 sc1
  v_mfma_f32_16x16x32_bf16 a[36:39], v[36:39], v[240:243], a[36:39]
  ds_read_b64_tr_b16 v[238:239], v11 offset:51200
  v_mfma_f32_16x16x32_bf16 a[96:99], v[40:43], v[240:243], a[96:99]
  ds_read_b128 v[80:83], v213 offset:40960
  v_mfma_f32_16x16x32_bf16 a[100:103], v[44:47], v[240:243], a[100:103]
  v_mfma_f32_16x16x32_bf16 a[160:163], v[48:51], v[240:243], a[160:163]
  buffer_load_dwordx4 v[168:171], v1, s[16:19], s66 offen offset:2048 sc1
  v_mfma_f32_16x16x32_bf16 a[164:167], v[52:55], v[240:243], a[164:167]
  v_mfma_f32_16x16x32_bf16 a[224:227], v[56:59], v[240:243], a[224:227]
  v_mfma_f32_16x16x32_bf16 a[228:231], v[60:63], v[240:243], a[228:231]
  ds_read_b64_tr_b16 v[240:241], v12 offset:49152
  v_mfma_f32_16x16x32_bf16 a[40:43], v[32:35], v[244:247], a[40:43]
  ds_read_b64_tr_b16 v[242:243], v12 offset:51200
  v_mfma_f32_16x16x32_bf16 a[44:47], v[36:39], v[244:247], a[44:47]
  ds_read_b128 v[84:87], v212 offset:43008
  v_mfma_f32_16x16x32_bf16 a[104:107], v[40:43], v[244:247], a[104:107]
  buffer_load_dwordx4 v[172:175], v1, s[16:19], s66 offen offset:3072 sc1
  v_mfma_f32_16x16x32_bf16 a[108:111], v[44:47], v[244:247], a[108:111]
  v_mfma_f32_16x16x32_bf16 a[168:171], v[48:51], v[244:247], a[168:171]
  s_add_u32 s66, s66, 4096
  v_mfma_f32_16x16x32_bf16 a[172:175], v[52:55], v[244:247], a[172:175]
  buffer_load_dwordx4 v[176:179], v1, s[16:19], s66 offen offset:0 sc1
  v_mfma_f32_16x16x32_bf16 a[232:235], v[56:59], v[244:247], a[232:235]
  ds_read_b128 v[88:91], v213 offset:45056
  v_mfma_f32_16x16x32_bf16 a[236:239], v[60:63], v[244:247], a[236:239]
  s_waitcnt lgkmcnt(15)
  ds_read_b64_tr_b16 v[244:245], v13 offset:49152
  v_mfma_f32_16x16x32_bf16 a[48:51], v[32:35], v[248:251], a[48:51]
  ds_read_b64_tr_b16 v[246:247], v13 offset:51200
  v_mfma_f32_16x16x32_bf16 a[52:55], v[36:39], v[248:251], a[52:55]
  buffer_load_dwordx4 v[180:183], v1, s[16:19], s66 offen offset:1024 sc1
  v_mfma_f32_16x16x32_bf16 a[112:115], v[40:43], v[248:251], a[112:115]
  v_mfma_f32_16x16x32_bf16 a[116:119], v[44:47], v[248:251], a[116:119]
  v_mfma_f32_16x16x32_bf16 a[176:179], v[48:51], v[248:251], a[176:179]
  ds_read_b128 v[92:95], v212 offset:47104
  v_mfma_f32_16x16x32_bf16 a[180:183], v[52:55], v[248:251], a[180:183]
  v_mfma_f32_16x16x32_bf16 a[240:243], v[56:59], v[248:251], a[240:243]
  buffer_load_dwordx4 v[184:187], v1, s[16:19], s66 offen offset:2048 sc1
  v_mfma_f32_16x16x32_bf16 a[244:247], v[60:63], v[248:251], a[244:247]
  ds_read_b64_tr_b16 v[248:249], v14 offset:49152
  v_mfma_f32_16x16x32_bf16 a[56:59], v[32:35], v[252:255], a[56:59]
  ds_read_b64_tr_b16 v[250:251], v14 offset:51200
  v_mfma_f32_16x16x32_bf16 a[60:63], v[36:39], v[252:255], a[60:63]
  v_mfma_f32_16x16x32_bf16 a[120:123], v[40:43], v[252:255], a[120:123]
  buffer_load_dwordx4 v[188:191], v1, s[16:19], s66 offen offset:3072 sc1
  v_mfma_f32_16x16x32_bf16 a[124:127], v[44:47], v[252:255], a[124:127]
  v_mfma_f32_16x16x32_bf16 a[184:187], v[48:51], v[252:255], a[184:187]
  v_mfma_f32_16x16x32_bf16 a[188:191], v[52:55], v[252:255], a[188:191]
  v_mfma_f32_16x16x32_bf16 a[248:251], v[56:59], v[252:255], a[248:251]
  v_mfma_f32_16x16x32_bf16 a[252:255], v[60:63], v[252:255], a[252:255]
  ds_read_b64_tr_b16 v[252:253], v15 offset:49152
  ds_read_b64_tr_b16 v[254:255], v15 offset:51200
  s_waitcnt lgkmcnt(4)
  v_mfma_f32_16x16x32_bf16 a[0:3], v[64:67], v[224:227], a[0:3]
  v_mfma_f32_16x16x32_bf16 a[4:7], v[68:71], v[224:227], a[4:7]
  v_mfma_f32_16x16x32_bf16 a[64:67], v[72:75], v[224:227], a[64:67]
  v_mfma_f32_16x16x32_bf16 a[68:71], v[76:79], v[224:227], a[68:71]
  v_mfma_f32_16x16x32_bf16 a[128:131], v[80:83], v[224:227], a[128:131]
  v_mfma_f32_16x16x32_bf16 a[132:135], v[84:87], v[224:227], a[132:135]
  v_mfma_f32_16x16x32_bf16 a[192:195], v[88:91], v[224:227], a[192:195]
  v_mfma_f32_16x16x32_bf16 a[196:199], v[92:95], v[224:227], a[196:199]
  s_waitcnt vmcnt(10)
  s_waitcnt lgkmcnt(0)
  s_barrier
  ds_read_b64_tr_b16 v[224:225], v8 offset:0
  v_mfma_f32_16x16x32_bf16 a[8:11], v[64:67], v[228:231], a[8:11]
  ds_read_b64_tr_b16 v[226:227], v8 offset:2048
  v_mfma_f32_16x16x32_bf16 a[12:15], v[68:71], v[228:231], a[12:15]
  v_mfma_f32_16x16x32_bf16 a[72:75], v[72:75], v[228:231], a[72:75]
  ds_read_b128 v[32:35], v212 offset:0
  s_add_u32 m0, s56, 32768
  v_mfma_f32_16x16x32_bf16 a[76:79], v[76:79], v[228:231], a[76:79]
  buffer_load_dwordx4 v16, s[8:11], s53 offen offset:0 sc1 lds
  v_mfma_f32_16x16x32_bf16 a[136:139], v[80:83], v[228:231], a[136:139]
  s_add_u32 s66, s66, 4096
  v_mfma_f32_16x16x32_bf16 a[140:143], v[84:87], v[228:231], a[140:143]
  buffer_load_dwordx4 v[192:195], v1, s[16:19], s66 offen offset:0 sc1
  v_mfma_f32_16x16x32_bf16 a[200:203], v[88:91], v[228:231], a[200:203]
  v_mfma_f32_16x16x32_bf16 a[204:207], v[92:95], v[228:231], a[204:207]
  ds_read_b64_tr_b16 v[228:229], v9 offset:0
  v_mfma_f32_16x16x32_bf16 a[16:19], v[64:67], v[232:235], a[16:19]
  buffer_load_dwordx4 v17, s[8:11], s53 offen offset:1024 sc1 lds
  v_mfma_f32_16x16x32_bf16 a[20:23], v[68:71], v[232:235], a[20:23]
  ds_read_b64_tr_b16 v[230:231], v9 offset:2048
  v_mfma_f32_16x16x32_bf16 a[80:83], v[72:75], v[232:235], a[80:83]
  ds_read_b128 v[36:39], v213 offset:2048
  v_mfma_f32_16x16x32_bf16 a[84:87], v[76:79], v[232:235], a[84:87]
  buffer_load_dwordx4 v18, s[8:11], s53 offen offset:2048 sc1 lds
  v_mfma_f32_16x16x32_bf16 a[144:147], v[80:83], v[232:235], a[144:147]
  v_mfma_f32_16x16x32_bf16 a[148:151], v[84:87], v[232:235], a[148:151]
  v_mfma_f32_16x16x32_bf16 a[208:211], v[88:91], v[232:235], a[208:211]
  ds_read_b128 v[40:43], v212 offset:4096
  v_mfma_f32_16x16x32_bf16 a[212:215], v[92:95], v[232:235], a[212:215]
  ds_read_b64_tr_b16 v[232:233], v10 offset:0
  v_mfma_f32_16x16x32_bf16 a[24:27], v[64:67], v[236:239], a[24:27]
  buffer_load_dwordx4 v19, s[8:11], s53 offen offset:3072 sc1 lds
  v_mfma_f32_16x16x32_bf16 a[28:31], v[68:71], v[236:239], a[28:31]
  ds_read_b64_tr_b16 v[234:235], v10 offset:2048
  v_mfma_f32_16x16x32_bf16 a[88:91], v[72:75], v[236:239], a[88:91]
  buffer_load_dwordx4 v[196:199], v1, s[16:19], s66 offen offset:1024 sc1
  v_mfma_f32_16x16x32_bf16 a[92:95], v[76:79], v[236:239], a[92:95]
  s_add_u32 m0, s56, 36864
  v_mfma_f32_16x16x32_bf16 a[152:155], v[80:83], v[236:239], a[152:155]
  ds_read_b128 v[44:47], v213 offset:6144
  v_mfma_f32_16x16x32_bf16 a[156:159], v[84:87], v[236:239], a[156:159]
  buffer_load_dwordx4 v20, s[8:11], s53 offen offset:0 sc1 lds
  v_mfma_f32_16x16x32_bf16 a[216:219], v[88:91], v[236:239], a[216:219]
  v_mfma_f32_16x16x32_bf16 a[220:223], v[92:95], v[236:239], a[220:223]
  ds_read_b64_tr_b16 v[236:237], v11 offset:0
  v_mfma_f32_16x16x32_bf16 a[32:35], v[64:67], v[240:243], a[32:35]
  ds_read_b64_tr_b16 v[238:239], v11 offset:2048
  v_mfma_f32_16x16x32_bf16 a[36:39], v[68:71], v[240:243], a[36:39]
  buffer_load_dwordx4 v21, s[8:11], s53 offen offset:1024 sc1 lds
  v_mfma_f32_16x16x32_bf16 a[96:99], v[72:75], v[240:243], a[96:99]
  ds_read_b128 v[48:51], v212 offset:8192
  v_mfma_f32_16x16x32_bf16 a[100:103], v[76:79], v[240:243], a[100:103]
  v_mfma_f32_16x16x32_bf16 a[160:163], v[80:83], v[240:243], a[160:163]
  buffer_load_dwordx4 v22, s[8:11], s53 offen offset:2048 sc1 lds
  v_mfma_f32_16x16x32_bf16 a[164:167], v[84:87], v[240:243], a[164:167]
  v_mfma_f32_16x16x32_bf16 a[224:227], v[88:91], v[240:243], a[224:227]
  v_mfma_f32_16x16x32_bf16 a[228:231], v[92:95], v[240:243], a[228:231]
  ds_read_b64_tr_b16 v[240:241], v12 offset:0
  v_mfma_f32_16x16x32_bf16 a[40:43], v[64:67], v[244:247], a[40:43]
  buffer_load_dwordx4 v[200:203], v1, s[16:19], s66 offen offset:2048 sc1
  v_mfma_f32_16x16x32_bf16 a[44:47], v[68:71], v[244:247], a[44:47]
  ds_read_b64_tr_b16 v[242:243], v12 offset:2048
  v_mfma_f32_16x16x32_bf16 a[104:107], v[72:75], v[244:247], a[104:107]
  ds_read_b128 v[52:55], v213 offset:10240
  v_mfma_f32_16x16x32_bf16 a[108:111], v[76:79], v[244:247], a[108:111]
  buffer_load_dwordx4 v23, s[8:11], s53 offen offset:3072 sc1 lds
  s_add_u32 s53, s53, 128
  v_mfma_f32_16x16x32_bf16 a[168:171], v[80:83], v[244:247], a[168:171]
  s_add_u32 m0, s56, 98304
  v_mfma_f32_16x16x32_bf16 a[172:175], v[84:87], v[244:247], a[172:175]
  buffer_load_dwordx4 v24, s[12:15], s54 offen offset:0 sc1 lds
  v_mfma_f32_16x16x32_bf16 a[232:235], v[88:91], v[244:247], a[232:235]
  ds_read_b128 v[56:59], v212 offset:12288
  v_mfma_f32_16x16x32_bf16 a[236:239], v[92:95], v[244:247], a[236:239]
  ds_read_b64_tr_b16 v[244:245], v13 offset:0
  v_mfma_f32_16x16x32_bf16 a[48:51], v[64:67], v[248:251], a[48:51]
  ds_read_b64_tr_b16 v[246:247], v13 offset:2048
  v_mfma_f32_16x16x32_bf16 a[52:55], v[68:71], v[248:251], a[52:55]
  buffer_load_dwordx4 v25, s[12:15], s54 offen offset:1024 sc1 lds
  v_mfma_f32_16x16x32_bf16 a[112:115], v[72:75], v[248:251], a[112:115]
  v_mfma_f32_16x16x32_bf16 a[116:119], v[76:79], v[248:251], a[116:119]
  v_mfma_f32_16x16x32_bf16 a[176:179], v[80:83], v[248:251], a[176:179]
  ds_read_b128 v[60:63], v213 offset:14336
  v_mfma_f32_16x16x32_bf16 a[180:183], v[84:87], v[248:251], a[180:183]
  buffer_load_dwordx4 v[204:207], v1, s[16:19], s66 offen offset:3072 sc1
  v_mfma_f32_16x16x32_bf16 a[240:243], v[88:91], v[248:251], a[240:243]
  buffer_load_dwordx4 v26, s[12:15], s54 offen offset:2048 sc1 lds
  v_mfma_f32_16x16x32_bf16 a[244:247], v[92:95], v[248:251], a[244:247]
  ds_read_b64_tr_b16 v[248:249], v14 offset:0
  v_mfma_f32_16x16x32_bf16 a[56:59], v[64:67], v[252:255], a[56:59]
  ds_read_b64_tr_b16 v[250:251], v14 offset:2048
  v_mfma_f32_16x16x32_bf16 a[60:63], v[68:71], v[252:255], a[60:63]
  buffer_load_dwordx4 v27, s[12:15], s54 offen offset:3072 sc1 lds
  v_mfma_f32_16x16x32_bf16 a[120:123], v[72:75], v[252:255], a[120:123]
  v_mfma_f32_16x16x32_bf16 a[124:127], v[76:79], v[252:255], a[124:127]
  v_mfma_f32_16x16x32_bf16 a[184:187], v[80:83], v[252:255], a[184:187]
  v_mfma_f32_16x16x32_bf16 a[188:191], v[84:87], v[252:255], a[188:191]
  v_mfma_f32_16x16x32_bf16 a[248:251], v[88:91], v[252:255], a[248:251]
  v_mfma_f32_16x16x32_bf16 a[252:255], v[92:95], v[252:255], a[252:255]
  ds_read_b64_tr_b16 v[252:253], v15 offset:0
  ds_read_b64_tr_b16 v[254:255], v15 offset:2048
  s_waitcnt lgkmcnt(15)
  s_waitcnt lgkmcnt(4)
  v_mfma_f32_16x16x32_bf16 a[0:3], v[32:35], v[224:227], a[0:3]
  v_mfma_f32_16x16x32_bf16 a[4:7], v[36:39], v[224:227], a[4:7]
  s_add_u32 m0, s56, 102400
  v_mfma_f32_16x16x32_bf16 a[64:67], v[40:43], v[224:227], a[64:67]
  buffer_load_dwordx4 v28, s[12:15], s54 offen offset:0 sc1 lds
  v_mfma_f32_16x16x32_bf16 a[68:71], v[44:47], v[224:227], a[68:71]
  v_mfma_f32_16x16x32_bf16 a[128:131], v[48:51], v[224:227], a[128:131]
  v_mfma_f32_16x16x32_bf16 a[132:135], v[52:55], v[224:227], a[132:135]
  v_mfma_f32_16x16x32_bf16 a[192:195], v[56:59], v[224:227], a[192:195]
  buffer_load_dwordx4 v29, s[12:15], s54 offen offset:1024 sc1 lds
  v_mfma_f32_16x16x32_bf16 a[196:199], v[60:63], v[224:227], a[196:199]
  ds_read_b64_tr_b16 v[224:225], v8 offset:16384
  v_mfma_f32_16x16x32_bf16 a[8:11], v[32:35], v[228:231], a[8:11]
  ds_read_b64_tr_b16 v[226:227], v8 offset:18432
  v_mfma_f32_16x16x32_bf16 a[12:15], v[36:39], v[228:231], a[12:15]
  v_mfma_f32_16x16x32_bf16 a[72:75], v[40:43], v[228:231], a[72:75]
  ds_read_b128 v[64:67], v213 offset:0
  v_mfma_f32_16x16x32_bf16 a[76:79], v[44:47], v[228:231], a[76:79]
  buffer_load_dwordx4 v30, s[12:15], s54 offen offset:2048 sc1 lds
  v_mfma_f32_16x16x32_bf16 a[136:139], v[48:51], v[228:231], a[136:139]
  v_mfma_f32_16x16x32_bf16 a[140:143], v[52:55], v[228:231], a[140:143]
  v_mfma_f32_16x16x32_bf16 a[200:203], v[56:59], v[228:231], a[200:203]
  v_mfma_f32_16x16x32_bf16 a[204:207], v[60:63], v[228:231], a[204:207]
  ds_read_b64_tr_b16 v[228:229], v9 offset:16384
  v_mfma_f32_16x16x32_bf16 a[16:19], v[32:35], v[232:235], a[16:19]
  buffer_load_dwordx4 v31, s[12:15], s54 offen offset:3072 sc1 lds
  s_add_u32 s54, s54, 0x80000
  v_mfma_f32_16x16x32_bf16 a[20:23], v[36:39], v[232:235], a[20:23]
  ds_read_b64_tr_b16 v[230:231], v9 offset:18432
  v_mfma_f32_16x16x32_bf16 a[80:83], v[40:43], v[232:235], a[80:83]
  ds_read_b128 v[68:71], v212 offset:2048
  v_mfma_f32_16x16x32_bf16 a[84:87], v[44:47], v[232:235], a[84:87]
  s_add_u32 m0, s43, 131072
  s_mov_b32 s59, 0
  v_mfma_f32_16x16x32_bf16 a[144:147], v[48:51], v[232:235], a[144:147]
  buffer_load_dwordx4 v208, s[24:27], s59 offen offset:0 sc1 lds
  v_mfma_f32_16x16x32_bf16 a[148:151], v[52:55], v[232:235], a[148:151]
  v_mfma_f32_16x16x32_bf16 a[208:211], v[56:59], v[232:235], a[208:211]
  ds_read_b128 v[72:75], v213 offset:4096
  v_mfma_f32_16x16x32_bf16 a[212:215], v[60:63], v[232:235], a[212:215]
  ds_read_b64_tr_b16 v[232:233], v10 offset:16384
  v_mfma_f32_16x16x32_bf16 a[24:27], v[32:35], v[236:239], a[24:27]
  ds_read_b64_tr_b16 v[234:235], v10 offset:18432
  v_mfma_f32_16x16x32_bf16 a[28:31], v[36:39], v[236:239], a[28:31]
  buffer_load_dwordx4 v209, s[24:27], s59 offen offset:1024 sc1 lds
  v_mfma_f32_16x16x32_bf16 a[88:91], v[40:43], v[236:239], a[88:91]
  v_mfma_f32_16x16x32_bf16 a[92:95], v[44:47], v[236:239], a[92:95]
  v_mfma_f32_16x16x32_bf16 a[152:155], v[48:51], v[236:239], a[152:155]
  ds_read_b128 v[76:79], v212 offset:6144
  v_mfma_f32_16x16x32_bf16 a[156:159], v[52:55], v[236:239], a[156:159]
  buffer_load_dwordx4 v210, s[24:27], s59 offen offset:2048 sc1 lds
  v_mfma_f32_16x16x32_bf16 a[216:219], v[56:59], v[236:239], a[216:219]
  v_mfma_f32_16x16x32_bf16 a[220:223], v[60:63], v[236:239], a[220:223]
  ds_read_b64_tr_b16 v[236:237], v11 offset:16384
  v_mfma_f32_16x16x32_bf16 a[32:35], v[32:35], v[240:243], a[32:35]
  ds_read_b64_tr_b16 v[238:239], v11 offset:18432
  v_mfma_f32_16x16x32_bf16 a[36:39], v[36:39], v[240:243], a[36:39]
  buffer_load_dwordx4 v211, s[24:27], s59 offen offset:3072 sc1 lds
  v_mfma_f32_16x16x32_bf16 a[96:99], v[40:43], v[240:243], a[96:99]
  ds_read_b128 v[80:83], v213 offset:8192
  v_mfma_f32_16x16x32_bf16 a[100:103], v[44:47], v[240:243], a[100:103]
  v_mfma_f32_16x16x32_bf16 a[160:163], v[48:51], v[240:243], a[160:163]
  v_mfma_f32_16x16x32_bf16 a[164:167], v[52:55], v[240:243], a[164:167]
  s_add_u32 m0, s43, 147456
  s_mov_b32 s59, 524288
  v_mfma_f32_16x16x32_bf16 a[224:227], v[56:59], v[240:243], a[224:227]
  buffer_load_dwordx4 v208, s[24:27], s59 offen offset:0 sc1 lds
  v_mfma_f32_16x16x32_bf16 a[228:231], v[60:63], v[240:243], a[228:231]
  ds_read_b64_tr_b16 v[240:241], v12 offset:16384
  v_mfma_f32_16x16x32_bf16 a[40:43], v[32:35], v[244:247], a[40:43]
  ds_read_b64_tr_b16 v[242:243], v12 offset:18432
  v_mfma_f32_16x16x32_bf16 a[44:47], v[36:39], v[244:247], a[44:47]
  ds_read_b128 v[84:87], v212 offset:10240
  v_mfma_f32_16x16x32_bf16 a[104:107], v[40:43], v[244:247], a[104:107]
  buffer_load_dwordx4 v209, s[24:27], s59 offen offset:1024 sc1 lds
  v_mfma_f32_16x16x32_bf16 a[108:111], v[44:47], v[244:247], a[108:111]
  v_mfma_f32_16x16x32_bf16 a[168:171], v[48:51], v[244:247], a[168:171]
  v_mfma_f32_16x16x32_bf16 a[172:175], v[52:55], v[244:247], a[172:175]
  v_mfma_f32_16x16x32_bf16 a[232:235], v[56:59], v[244:247], a[232:235]
  ds_read_b128 v[88:91], v213 offset:12288
  v_mfma_f32_16x16x32_bf16 a[236:239], v[60:63], v[244:247], a[236:239]
  s_waitcnt lgkmcnt(15)
  ds_read_b64_tr_b16 v[244:245], v13 offset:16384
  v_mfma_f32_16x16x32_bf16 a[48:51], v[32:35], v[248:251], a[48:51]
  buffer_load_dwordx4 v210, s[24:27], s59 offen offset:2048 sc1 lds
  v_mfma_f32_16x16x32_bf16 a[52:55], v[36:39], v[248:251], a[52:55]
  ds_read_b64_tr_b16 v[246:247], v13 offset:18432
  v_mfma_f32_16x16x32_bf16 a[112:115], v[40:43], v[248:251], a[112:115]
  v_mfma_f32_16x16x32_bf16 a[116:119], v[44:47], v[248:251], a[116:119]
  buffer_load_dwordx4 v211, s[24:27], s59 offen offset:3072 sc1 lds
  v_mfma_f32_16x16x32_bf16 a[176:179], v[48:51], v[248:251], a[176:179]
  ds_read_b128 v[92:95], v212 offset:14336
  v_mfma_f32_16x16x32_bf16 a[180:183], v[52:55], v[248:251], a[180:183]
  v_mfma_f32_16x16x32_bf16 a[240:243], v[56:59], v[248:251], a[240:243]
  v_mfma_f32_16x16x32_bf16 a[244:247], v[60:63], v[248:251], a[244:247]
  ds_read_b64_tr_b16 v[248:249], v14 offset:16384
  v_mfma_f32_16x16x32_bf16 a[56:59], v[32:35], v[252:255], a[56:59]
  ds_read_b64_tr_b16 v[250:251], v14 offset:18432
  v_mfma_f32_16x16x32_bf16 a[60:63], v[36:39], v[252:255], a[60:63]
  v_mfma_f32_16x16x32_bf16 a[120:123], v[40:43], v[252:255], a[120:123]
  v_mfma_f32_16x16x32_bf16 a[124:127], v[44:47], v[252:255], a[124:127]
  v_mfma_f32_16x16x32_bf16 a[184:187], v[48:51], v[252:255], a[184:187]
  v_mfma_f32_16x16x32_bf16 a[188:191], v[52:55], v[252:255], a[188:191]
  v_mfma_f32_16x16x32_bf16 a[248:251], v[56:59], v[252:255], a[248:251]
  v_mfma_f32_16x16x32_bf16 a[252:255], v[60:63], v[252:255], a[252:255]
  ds_read_b64_tr_b16 v[252:253], v15 offset:16384
  ds_read_b64_tr_b16 v[254:255], v15 offset:18432
  s_waitcnt lgkmcnt(4)
  v_mfma_f32_16x16x32_bf16 a[0:3], v[64:67], v[224:227], a[0:3]
  v_mfma_f32_16x16x32_bf16 a[4:7], v[68:71], v[224:227], a[4:7]
  v_mfma_f32_16x16x32_bf16 a[64:67], v[72:75], v[224:227], a[64:67]
  v_mfma_f32_16x16x32_bf16 a[68:71], v[76:79], v[224:227], a[68:71]
  v_mfma_f32_16x16x32_bf16 a[128:131], v[80:83], v[224:227], a[128:131]
  v_mfma_f32_16x16x32_bf16 a[132:135], v[84:87], v[224:227], a[132:135]
  v_mfma_f32_16x16x32_bf16 a[192:195], v[88:91], v[224:227], a[192:195]
  v_mfma_f32_16x16x32_bf16 a[196:199], v[92:95], v[224:227], a[196:199]
  s_waitcnt vmcnt(8)
  s_waitcnt lgkmcnt(0)
  s_barrier
  ds_read_b64_tr_b16 v[224:225], v8 offset:32768
  v_mfma_f32_16x16x32_bf16 a[8:11], v[64:67], v[228:231], a[8:11]
  ds_read_b64_tr_b16 v[226:227], v8 offset:34816
  v_mfma_f32_16x16x32_bf16 a[12:15], v[68:71], v[228:231], a[12:15]
  v_mfma_f32_16x16x32_bf16 a[72:75], v[72:75], v[228:231], a[72:75]
  ds_read_b128 v[32:35], v212 offset:32768
  s_add_u32 m0, s43, 0
  s_mov_b32 s59, 1048576
  v_mfma_f32_16x16x32_bf16 a[76:79], v[76:79], v[228:231], a[76:79]
  buffer_load_dwordx4 v208, s[24:27], s59 offen offset:0 sc1 lds
  v_mfma_f32_16x16x32_bf16 a[136:139], v[80:83], v[228:231], a[136:139]
  v_mfma_f32_16x16x32_bf16 a[140:143], v[84:87], v[228:231], a[140:143]
  v_mfma_f32_16x16x32_bf16 a[200:203], v[88:91], v[228:231], a[200:203]
  v_mfma_f32_16x16x32_bf16 a[204:207], v[92:95], v[228:231], a[204:207]
  ds_read_b64_tr_b16 v[228:229], v9 offset:32768
  v_mfma_f32_16x16x32_bf16 a[16:19], v[64:67], v[232:235], a[16:19]
  buffer_load_dwordx4 v209, s[24:27], s59 offen offset:1024 sc1 lds
  v_mfma_f32_16x16x32_bf16 a[20:23], v[68:71], v[232:235], a[20:23]
  ds_read_b64_tr_b16 v[230:231], v9 offset:34816
  v_mfma_f32_16x16x32_bf16 a[80:83], v[72:75], v[232:235], a[80:83]
  ds_read_b128 v[36:39], v213 offset:34816
  v_mfma_f32_16x16x32_bf16 a[84:87], v[76:79], v[232:235], a[84:87]
  buffer_load_dwordx4 v210, s[24:27], s59 offen offset:2048 sc1 lds
  v_mfma_f32_16x16x32_bf16 a[144:147], v[80:83], v[232:235], a[144:147]
  v_mfma_f32_16x16x32_bf16 a[148:151], v[84:87], v[232:235], a[148:151]
  v_mfma_f32_16x16x32_bf16 a[208:211], v[88:91], v[232:235], a[208:211]
  ds_read_b128 v[40:43], v212 offset:36864
  v_mfma_f32_16x16x32_bf16 a[212:215], v[92:95], v[232:235], a[212:215]
  ds_read_b64_tr_b16 v[232:233], v10 offset:32768
  v_mfma_f32_16x16x32_bf16 a[24:27], v[64:67], v[236:239], a[24:27]
  buffer_load_dwordx4 v211, s[24:27], s59 offen offset:3072 sc1 lds
  v_mfma_f32_16x16x32_bf16 a[28:31], v[68:71], v[236:239], a[28:31]
  ds_read_b64_tr_b16 v[234:235], v10 offset:34816
  v_mfma_f32_16x16x32_bf16 a[88:91], v[72:75], v[236:239], a[88:91]
  v_mfma_f32_16x16x32_bf16 a[92:95], v[76:79], v[236:239], a[92:95]
  s_add_u32 m0, s43, 16384
  s_mov_b32 s59, 1572864
  v_mfma_f32_16x16x32_bf16 a[152:155], v[80:83], v[236:239], a[152:155]
  ds_read_b128 v[44:47], v213 offset:38912
  v_mfma_f32_16x16x32_bf16 a[156:159], v[84:87], v[236:239], a[156:159]
  buffer_load_dwordx4 v208, s[24:27], s59 offen offset:0 sc1 lds
  v_mfma_f32_16x16x32_bf16 a[216:219], v[88:91], v[236:239], a[216:219]
  v_mfma_f32_16x16x32_bf16 a[220:223], v[92:95], v[236:239], a[220:223]
  ds_read_b64_tr_b16 v[236:237], v11 offset:32768
  v_mfma_f32_16x16x32_bf16 a[32:35], v[64:67], v[240:243], a[32:35]
  ds_read_b64_tr_b16 v[238:239], v11 offset:34816
  v_mfma_f32_16x16x32_bf16 a[36:39], v[68:71], v[240:243], a[36:39]
  buffer_load_dwordx4 v209, s[24:27], s59 offen offset:1024 sc1 lds
  v_mfma_f32_16x16x32_bf16 a[96:99], v[72:75], v[240:243], a[96:99]
  ds_read_b128 v[48:51], v212 offset:40960
  v_mfma_f32_16x16x32_bf16 a[100:103], v[76:79], v[240:243], a[100:103]
  v_mfma_f32_16x16x32_bf16 a[160:163], v[80:83], v[240:243], a[160:163]
  buffer_load_dwordx4 v210, s[24:27], s59 offen offset:2048 sc1 lds
  v_mfma_f32_16x16x32_bf16 a[164:167], v[84:87], v[240:243], a[164:167]
  v_mfma_f32_16x16x32_bf16 a[224:227], v[88:91], v[240:243], a[224:227]
  v_mfma_f32_16x16x32_bf16 a[228:231], v[92:95], v[240:243], a[228:231]
  ds_read_b64_tr_b16 v[240:241], v12 offset:32768
  v_mfma_f32_16x16x32_bf16 a[40:43], v[64:67], v[244:247], a[40:43]
  ds_read_b64_tr_b16 v[242:243], v12 offset:34816
  v_mfma_f32_16x16x32_bf16 a[44:47], v[68:71], v[244:247], a[44:47]
  ds_read_b128 v[52:55], v213 offset:43008
  v_mfma_f32_16x16x32_bf16 a[104:107], v[72:75], v[244:247], a[104:107]
  buffer_load_dwordx4 v211, s[24:27], s59 offen offset:3072 sc1 lds
  v_mfma_f32_16x16x32_bf16 a[108:111], v[76:79], v[244:247], a[108:111]
  v_mfma_f32_16x16x32_bf16 a[168:171], v[80:83], v[244:247], a[168:171]
  s_add_u32 m0, s43, 65536
  s_mov_b32 s59, 2097152
  v_mfma_f32_16x16x32_bf16 a[172:175], v[84:87], v[244:247], a[172:175]
  buffer_load_dwordx4 v208, s[24:27], s59 offen offset:0 sc1 lds
  v_mfma_f32_16x16x32_bf16 a[232:235], v[88:91], v[244:247], a[232:235]
  ds_read_b128 v[56:59], v212 offset:45056
  v_mfma_f32_16x16x32_bf16 a[236:239], v[92:95], v[244:247], a[236:239]
  ds_read_b64_tr_b16 v[244:245], v13 offset:32768
  v_mfma_f32_16x16x32_bf16 a[48:51], v[64:67], v[248:251], a[48:51]
  ds_read_b64_tr_b16 v[246:247], v13 offset:34816
  v_mfma_f32_16x16x32_bf16 a[52:55], v[68:71], v[248:251], a[52:55]
  buffer_load_dwordx4 v209, s[24:27], s59 offen offset:1024 sc1 lds
  v_mfma_f32_16x16x32_bf16 a[112:115], v[72:75], v[248:251], a[112:115]
  v_mfma_f32_16x16x32_bf16 a[116:119], v[76:79], v[248:251], a[116:119]
  v_mfma_f32_16x16x32_bf16 a[176:179], v[80:83], v[248:251], a[176:179]
  ds_read_b128 v[60:63], v213 offset:47104
  v_mfma_f32_16x16x32_bf16 a[180:183], v[84:87], v[248:251], a[180:183]
  buffer_load_dwordx4 v210, s[24:27], s59 offen offset:2048 sc1 lds
  v_mfma_f32_16x16x32_bf16 a[240:243], v[88:91], v[248:251], a[240:243]
  v_mfma_f32_16x16x32_bf16 a[244:247], v[92:95], v[248:251], a[244:247]
  ds_read_b64_tr_b16 v[248:249], v14 offset:32768
  v_mfma_f32_16x16x32_bf16 a[56:59], v[64:67], v[252:255], a[56:59]
  ds_read_b64_tr_b16 v[250:251], v14 offset:34816
  v_mfma_f32_16x16x32_bf16 a[60:63], v[68:71], v[252:255], a[60:63]
  buffer_load_dwordx4 v211, s[24:27], s59 offen offset:3072 sc1 lds
  v_mfma_f32_16x16x32_bf16 a[120:123], v[72:75], v[252:255], a[120:123]
  v_mfma_f32_16x16x32_bf16 a[124:127], v[76:79], v[252:255], a[124:127]
  v_mfma_f32_16x16x32_bf16 a[184:187], v[80:83], v[252:255], a[184:187]
  v_mfma_f32_16x16x32_bf16 a[188:191], v[84:87], v[252:255], a[188:191]
  v_mfma_f32_16x16x32_bf16 a[248:251], v[88:91], v[252:255], a[248:251]
  v_mfma_f32_16x16x32_bf16 a[252:255], v[92:95], v[252:255], a[252:255]
  ds_read_b64_tr_b16 v[252:253], v15 offset:32768
  ds_read_b64_tr_b16 v[254:255], v15 offset:34816
  s_waitcnt lgkmcnt(15)
  s_waitcnt lgkmcnt(4)
  v_mfma_f32_16x16x32_bf16 a[0:3], v[32:35], v[224:227], a[0:3]
  v_mfma_f32_16x16x32_bf16 a[4:7], v[36:39], v[224:227], a[4:7]
  s_add_u32 m0, s43, 81920
  s_mov_b32 s59, 2621440
  v_mfma_f32_16x16x32_bf16 a[64:67], v[40:43], v[224:227], a[64:67]
  buffer_load_dwordx4 v208, s[24:27], s59 offen offset:0 sc1 lds
  v_mfma_f32_16x16x32_bf16 a[68:71], v[44:47], v[224:227], a[68:71]
  v_mfma_f32_16x16x32_bf16 a[128:131], v[48:51], v[224:227], a[128:131]
  v_mfma_f32_16x16x32_bf16 a[132:135], v[52:55], v[224:227], a[132:135]
  buffer_load_dwordx4 v209, s[24:27], s59 offen offset:1024 sc1 lds
  v_mfma_f32_16x16x32_bf16 a[192:195], v[56:59], v[224:227], a[192:195]
  v_mfma_f32_16x16x32_bf16 a[196:199], v[60:63], v[224:227], a[196:199]
  ds_read_b64_tr_b16 v[224:225], v8 offset:49152
  v_mfma_f32_16x16x32_bf16 a[8:11], v[32:35], v[228:231], a[8:11]
  ds_read_b64_tr_b16 v[226:227], v8 offset:51200
  v_mfma_f32_16x16x32_bf16 a[12:15], v[36:39], v[228:231], a[12:15]
  buffer_load_dwordx4 v210, s[24:27], s59 offen offset:2048 sc1 lds
  v_mfma_f32_16x16x32_bf16 a[72:75], v[40:43], v[228:231], a[72:75]
  ds_read_b128 v[64:67], v213 offset:32768
  v_mfma_f32_16x16x32_bf16 a[76:79], v[44:47], v[228:231], a[76:79]
  v_mfma_f32_16x16x32_bf16 a[136:139], v[48:51], v[228:231], a[136:139]
  buffer_load_dwordx4 v211, s[24:27], s59 offen offset:3072 sc1 lds
  v_mfma_f32_16x16x32_bf16 a[140:143], v[52:55], v[228:231], a[140:143]
  v_mfma_f32_16x16x32_bf16 a[200:203], v[56:59], v[228:231], a[200:203]
  v_mfma_f32_16x16x32_bf16 a[204:207], v[60:63], v[228:231], a[204:207]
  ds_read_b64_tr_b16 v[228:229], v9 offset:49152
  v_mfma_f32_16x16x32_bf16 a[16:19], v[32:35], v[232:235], a[16:19]
  ds_read_b64_tr_b16 v[230:231], v9 offset:51200
  v_mfma_f32_16x16x32_bf16 a[20:23], v[36:39], v[232:235], a[20:23]
  ds_read_b128 v[68:71], v212 offset:34816
  v_mfma_f32_16x16x32_bf16 a[80:83], v[40:43], v[232:235], a[80:83]
  v_mfma_f32_16x16x32_bf16 a[84:87], v[44:47], v[232:235], a[84:87]
  v_mfma_f32_16x16x32_bf16 a[144:147], v[48:51], v[232:235], a[144:147]
  v_mfma_f32_16x16x32_bf16 a[148:151], v[52:55], v[232:235], a[148:151]
  v_mfma_f32_16x16x32_bf16 a[208:211], v[56:59], v[232:235], a[208:211]
  ds_read_b128 v[72:75], v213 offset:36864
  v_mfma_f32_16x16x32_bf16 a[212:215], v[60:63], v[232:235], a[212:215]
  ds_read_b64_tr_b16 v[232:233], v10 offset:49152
  v_mfma_f32_16x16x32_bf16 a[24:27], v[32:35], v[236:239], a[24:27]
  ds_read_b64_tr_b16 v[234:235], v10 offset:51200
  v_mfma_f32_16x16x32_bf16 a[28:31], v[36:39], v[236:239], a[28:31]
  v_mfma_f32_16x16x32_bf16 a[88:91], v[40:43], v[236:239], a[88:91]
  v_mfma_f32_16x16x32_bf16 a[92:95], v[44:47], v[236:239], a[92:95]
  v_mfma_f32_16x16x32_bf16 a[152:155], v[48:51], v[236:239], a[152:155]
  ds_read_b128 v[76:79], v212 offset:38912
  v_mfma_f32_16x16x32_bf16 a[156:159], v[52:55], v[236:239], a[156:159]
  v_mfma_f32_16x16x32_bf16 a[216:219], v[56:59], v[236:239], a[216:219]
  v_mfma_f32_16x16x32_bf16 a[220:223], v[60:63], v[236:239], a[220:223]
  ds_read_b64_tr_b16 v[236:237], v11 offset:49152
  v_mfma_f32_16x16x32_bf16 a[32:35], v[32:35], v[240:243], a[32:35]
  ds_read_b64_tr_b16 v[238:239], v11 offset:51200
  v_mfma_f32_16x16x32_bf16 a[36:39], v[36:39], v[240:243], a[36:39]
  v_mfma_f32_16x16x32_bf16 a[96:99], v[40:43], v[240:243], a[96:99]
  ds_read_b128 v[80:83], v213 offset:40960
  v_mfma_f32_16x16x32_bf16 a[100:103], v[44:47], v[240:243], a[100:103]
  v_mfma_f32_16x16x32_bf16 a[160:163], v[48:51], v[240:243], a[160:163]
  v_mfma_f32_16x16x32_bf16 a[164:167], v[52:55], v[240:243], a[164:167]
  v_mfma_f32_16x16x32_bf16 a[224:227], v[56:59], v[240:243], a[224:227]
  v_mfma_f32_16x16x32_bf16 a[228:231], v[60:63], v[240:243], a[228:231]
  ds_read_b64_tr_b16 v[240:241], v12 offset:49152
  v_mfma_f32_16x16x32_bf16 a[40:43], v[32:35], v[244:247], a[40:43]
  ds_read_b64_tr_b16 v[242:243], v12 offset:51200
  v_mfma_f32_16x16x32_bf16 a[44:47], v[36:39], v[244:247], a[44:47]
  ds_read_b128 v[84:87], v212 offset:43008
  v_mfma_f32_16x16x32_bf16 a[104:107], v[40:43], v[244:247], a[104:107]
  v_mfma_f32_16x16x32_bf16 a[108:111], v[44:47], v[244:247], a[108:111]
  v_mfma_f32_16x16x32_bf16 a[168:171], v[48:51], v[244:247], a[168:171]
  v_mfma_f32_16x16x32_bf16 a[172:175], v[52:55], v[244:247], a[172:175]
  v_mfma_f32_16x16x32_bf16 a[232:235], v[56:59], v[244:247], a[232:235]
  ds_read_b128 v[88:91], v213 offset:45056
  v_mfma_f32_16x16x32_bf16 a[236:239], v[60:63], v[244:247], a[236:239]
  s_waitcnt lgkmcnt(15)
  ds_read_b64_tr_b16 v[244:245], v13 offset:49152
  v_mfma_f32_16x16x32_bf16 a[48:51], v[32:35], v[248:251], a[48:51]
  ds_read_b64_tr_b16 v[246:247], v13 offset:51200
  v_mfma_f32_16x16x32_bf16 a[52:55], v[36:39], v[248:251], a[52:55]
  v_mfma_f32_16x16x32_bf16 a[112:115], v[40:43], v[248:251], a[112:115]
  v_mfma_f32_16x16x32_bf16 a[116:119], v[44:47], v[248:251], a[116:119]
  v_mfma_f32_16x16x32_bf16 a[176:179], v[48:51], v[248:251], a[176:179]
  ds_read_b128 v[92:95], v212 offset:47104
  v_mfma_f32_16x16x32_bf16 a[180:183], v[52:55], v[248:251], a[180:183]
  v_mfma_f32_16x16x32_bf16 a[240:243], v[56:59], v[248:251], a[240:243]
  v_mfma_f32_16x16x32_bf16 a[244:247], v[60:63], v[248:251], a[244:247]
  ds_read_b64_tr_b16 v[248:249], v14 offset:49152
  v_mfma_f32_16x16x32_bf16 a[56:59], v[32:35], v[252:255], a[56:59]
  ds_read_b64_tr_b16 v[250:251], v14 offset:51200
  v_mfma_f32_16x16x32_bf16 a[60:63], v[36:39], v[252:255], a[60:63]
  v_mfma_f32_16x16x32_bf16 a[120:123], v[40:43], v[252:255], a[120:123]
  v_mfma_f32_16x16x32_bf16 a[124:127], v[44:47], v[252:255], a[124:127]
  v_mfma_f32_16x16x32_bf16 a[184:187], v[48:51], v[252:255], a[184:187]
  v_mfma_f32_16x16x32_bf16 a[188:191], v[52:55], v[252:255], a[188:191]
  v_mfma_f32_16x16x32_bf16 a[248:251], v[56:59], v[252:255], a[248:251]
  v_mfma_f32_16x16x32_bf16 a[252:255], v[60:63], v[252:255], a[252:255]
  ds_read_b64_tr_b16 v[252:253], v15 offset:49152
  ds_read_b64_tr_b16 v[254:255], v15 offset:51200
  s_waitcnt lgkmcnt(4)
  v_mfma_f32_16x16x32_bf16 a[0:3], v[64:67], v[224:227], a[0:3]
  v_mfma_f32_16x16x32_bf16 a[4:7], v[68:71], v[224:227], a[4:7]
  v_mfma_f32_16x16x32_bf16 a[64:67], v[72:75], v[224:227], a[64:67]
  v_mfma_f32_16x16x32_bf16 a[68:71], v[76:79], v[224:227], a[68:71]
  v_mfma_f32_16x16x32_bf16 a[128:131], v[80:83], v[224:227], a[128:131]
  v_mfma_f32_16x16x32_bf16 a[132:135], v[84:87], v[224:227], a[132:135]
  v_mfma_f32_16x16x32_bf16 a[192:195], v[88:91], v[224:227], a[192:195]
  v_mfma_f32_16x16x32_bf16 a[196:199], v[92:95], v[224:227], a[196:199]
  s_waitcnt lgkmcnt(0)
  s_barrier
  v_mfma_f32_16x16x32_bf16 a[8:11], v[64:67], v[228:231], a[8:11]
  v_mfma_f32_16x16x32_bf16 a[12:15], v[68:71], v[228:231], a[12:15]
  v_mfma_f32_16x16x32_bf16 a[72:75], v[72:75], v[228:231], a[72:75]
  s_add_u32 m0, s43, 32768
  s_mov_b32 s59, 3145728
  v_mfma_f32_16x16x32_bf16 a[76:79], v[76:79], v[228:231], a[76:79]
  buffer_load_dwordx4 v208, s[24:27], s59 offen offset:0 sc1 lds
  v_mfma_f32_16x16x32_bf16 a[136:139], v[80:83], v[228:231], a[136:139]
  v_mfma_f32_16x16x32_bf16 a[140:143], v[84:87], v[228:231], a[140:143]
  v_mfma_f32_16x16x32_bf16 a[200:203], v[88:91], v[228:231], a[200:203]
  v_mfma_f32_16x16x32_bf16 a[204:207], v[92:95], v[228:231], a[204:207]
  buffer_load_dwordx4 v209, s[24:27], s59 offen offset:1024 sc1 lds
  v_mfma_f32_16x16x32_bf16 a[16:19], v[64:67], v[232:235], a[16:19]
  v_mfma_f32_16x16x32_bf16 a[20:23], v[68:71], v[232:235], a[20:23]
  v_mfma_f32_16x16x32_bf16 a[80:83], v[72:75], v[232:235], a[80:83]
  v_mfma_f32_16x16x32_bf16 a[84:87], v[76:79], v[232:235], a[84:87]
  buffer_load_dwordx4 v210, s[24:27], s59 offen offset:2048 sc1 lds
  v_mfma_f32_16x16x32_bf16 a[144:147], v[80:83], v[232:235], a[144:147]
  v_mfma_f32_16x16x32_bf16 a[148:151], v[84:87], v[232:235], a[148:151]
  v_mfma_f32_16x16x32_bf16 a[208:211], v[88:91], v[232:235], a[208:211]
  v_mfma_f32_16x16x32_bf16 a[212:215], v[92:95], v[232:235], a[212:215]
  buffer_load_dwordx4 v211, s[24:27], s59 offen offset:3072 sc1 lds
  v_mfma_f32_16x16x32_bf16 a[24:27], v[64:67], v[236:239], a[24:27]
  v_mfma_f32_16x16x32_bf16 a[28:31], v[68:71], v[236:239], a[28:31]
  v_mfma_f32_16x16x32_bf16 a[88:91], v[72:75], v[236:239], a[88:91]
  v_mfma_f32_16x16x32_bf16 a[92:95], v[76:79], v[236:239], a[92:95]
  s_add_u32 m0, s43, 49152
  s_mov_b32 s59, 256
  v_mfma_f32_16x16x32_bf16 a[152:155], v[80:83], v[236:239], a[152:155]
  buffer_load_dwordx4 v208, s[24:27], s59 offen offset:0 sc1 lds
  v_mfma_f32_16x16x32_bf16 a[156:159], v[84:87], v[236:239], a[156:159]
  v_mfma_f32_16x16x32_bf16 a[216:219], v[88:91], v[236:239], a[216:219]
  v_mfma_f32_16x16x32_bf16 a[220:223], v[92:95], v[236:239], a[220:223]
  v_mfma_f32_16x16x32_bf16 a[32:35], v[64:67], v[240:243], a[32:35]
  buffer_load_dwordx4 v209, s[24:27], s59 offen offset:1024 sc1 lds
  v_mfma_f32_16x16x32_bf16 a[36:39], v[68:71], v[240:243], a[36:39]
  v_mfma_f32_16x16x32_bf16 a[96:99], v[72:75], v[240:243], a[96:99]
  v_mfma_f32_16x16x32_bf16 a[100:103], v[76:79], v[240:243], a[100:103]
  v_mfma_f32_16x16x32_bf16 a[160:163], v[80:83], v[240:243], a[160:163]
  buffer_load_dwordx4 v210, s[24:27], s59 offen offset:2048 sc1 lds
  v_mfma_f32_16x16x32_bf16 a[164:167], v[84:87], v[240:243], a[164:167]
  v_mfma_f32_16x16x32_bf16 a[224:227], v[88:91], v[240:243], a[224:227]
  v_mfma_f32_16x16x32_bf16 a[228:231], v[92:95], v[240:243], a[228:231]
  v_mfma_f32_16x16x32_bf16 a[40:43], v[64:67], v[244:247], a[40:43]
  buffer_load_dwordx4 v211, s[24:27], s59 offen offset:3072 sc1 lds
  v_mfma_f32_16x16x32_bf16 a[44:47], v[68:71], v[244:247], a[44:47]
  v_mfma_f32_16x16x32_bf16 a[104:107], v[72:75], v[244:247], a[104:107]
  v_mfma_f32_16x16x32_bf16 a[108:111], v[76:79], v[244:247], a[108:111]
  v_mfma_f32_16x16x32_bf16 a[168:171], v[80:83], v[244:247], a[168:171]
  s_add_u32 m0, s43, 98304
  s_mov_b32 s59, 524544
  v_mfma_f32_16x16x32_bf16 a[172:175], v[84:87], v[244:247], a[172:175]
  buffer_load_dwordx4 v208, s[24:27], s59 offen offset:0 sc1 lds
  v_mfma_f32_16x16x32_bf16 a[232:235], v[88:91], v[244:247], a[232:235]
  v_mfma_f32_16x16x32_bf16 a[236:239], v[92:95], v[244:247], a[236:239]
  v_mfma_f32_16x16x32_bf16 a[48:51], v[64:67], v[248:251], a[48:51]
  v_mfma_f32_16x16x32_bf16 a[52:55], v[68:71], v[248:251], a[52:55]
  buffer_load_dwordx4 v209, s[24:27], s59 offen offset:1024 sc1 lds
  v_mfma_f32_16x16x32_bf16 a[112:115], v[72:75], v[248:251], a[112:115]
  v_mfma_f32_16x16x32_bf16 a[116:119], v[76:79], v[248:251], a[116:119]
  v_mfma_f32_16x16x32_bf16 a[176:179], v[80:83], v[248:251], a[176:179]
  v_mfma_f32_16x16x32_bf16 a[180:183], v[84:87], v[248:251], a[180:183]
  buffer_load_dwordx4 v210, s[24:27], s59 offen offset:2048 sc1 lds
  v_mfma_f32_16x16x32_bf16 a[240:243], v[88:91], v[248:251], a[240:243]
  v_mfma_f32_16x16x32_bf16 a[244:247], v[92:95], v[248:251], a[244:247]
  v_mfma_f32_16x16x32_bf16 a[56:59], v[64:67], v[252:255], a[56:59]
  v_mfma_f32_16x16x32_bf16 a[60:63], v[68:71], v[252:255], a[60:63]
  buffer_load_dwordx4 v211, s[24:27], s59 offen offset:3072 sc1 lds
  v_mfma_f32_16x16x32_bf16 a[120:123], v[72:75], v[252:255], a[120:123]
  v_mfma_f32_16x16x32_bf16 a[124:127], v[76:79], v[252:255], a[124:127]
  v_mfma_f32_16x16x32_bf16 a[184:187], v[80:83], v[252:255], a[184:187]
  v_mfma_f32_16x16x32_bf16 a[188:191], v[84:87], v[252:255], a[188:191]
  v_mfma_f32_16x16x32_bf16 a[248:251], v[88:91], v[252:255], a[248:251]
  v_mfma_f32_16x16x32_bf16 a[252:255], v[92:95], v[252:255], a[252:255]
M_B:
  s_cmp_lt_u32 s67, 1
  s_cbranch_scc1 M_FB
M_FB_RET:
  s_mov_b32 s8, s74
  s_mov_b32 s9, s75
  s_mov_b32 s10, 0x380000
  s_mov_b32 s11, 0x20000
  s_mov_b32 s12, s80
  s_mov_b32 s13, s81
  s_mov_b32 s14, 0x188000
  s_mov_b32 s15, 0x20000
  v_lshlrev_b32 v1, 4, v0
  v_add_u32 v3, s43, v1
  v_add_u32 v4, 0x4000, v3
  v_mov_b32 v212, v214
  v_add_u32 v213, 13312, v214
  v_add_u32 v214, 26624, v215
  v_add_u32 v215, 39936, v215
  s_waitcnt vmcnt(28)
  s_barrier
  ds_read_b64_tr_b16 v[32:33], v216 offset:32768
  ds_read_b64_tr_b16 v[34:35], v216 offset:33792
  ds_read_b64_tr_b16 v[36:37], v217 offset:32768
  ds_read_b64_tr_b16 v[38:39], v217 offset:33792
  ds_read_b64_tr_b16 v[40:41], v218 offset:32768
  ds_read_b64_tr_b16 v[42:43], v218 offset:33792
  ds_read_b64_tr_b16 v[44:45], v219 offset:32768
  ds_read_b64_tr_b16 v[46:47], v219 offset:33792
  ds_read_b64_tr_b16 v[48:49], v220 offset:32768
  ds_read_b64_tr_b16 v[50:51], v220 offset:33792
  ds_read_b64_tr_b16 v[52:53], v221 offset:32768
  ds_read_b64_tr_b16 v[54:55], v221 offset:33792
  ds_read_b64_tr_b16 v[56:57], v222 offset:32768
  ds_read_b64_tr_b16 v[58:59], v222 offset:33792
  s_waitcnt lgkmcnt(10)
  v_mfma_f32_16x16x32_bf16 v[64:67], v[32:35], v[96:99], 0
  s_add_u32 m0, s43, 114688
  s_mov_b32 s59, 1048832
  ds_read_b64_tr_b16 v[60:61], v223 offset:32768
  v_mfma_f32_16x16x32_bf16 v[72:75], v[32:35], v[100:103], 0
  ds_read_b64_tr_b16 v[62:63], v223 offset:33792
  v_mfma_f32_16x16x32_bf16 v[68:71], v[36:39], v[96:99], 0
  s_waitcnt lgkmcnt(8)
  buffer_load_dwordx4 v208, s[24:27], s59 offen offset:0 sc1 lds
  v_mfma_f32_16x16x32_bf16 v[76:79], v[36:39], v[100:103], 0
  ds_read_b64_tr_b16 v[32:33], v216 offset:40960
  ds_read_b64_tr_b16 v[34:35], v216 offset:41984
  v_mfma_f32_16x16x32_bf16 v[80:83], v[40:43], v[96:99], 0
  s_add_u32 s61, s60, 0
  ds_read_b64_tr_b16 v[36:37], v217 offset:40960
  ds_read_b64_tr_b16 v[38:39], v217 offset:41984
  v_mfma_f32_16x16x32_bf16 v[88:91], v[40:43], v[100:103], 0
  v_accvgpr_read_b32 v8, a0
  v_accvgpr_read_b32 v9, a1
  v_mfma_f32_16x16x32_bf16 v[84:87], v[44:47], v[96:99], 0
  s_waitcnt lgkmcnt(8)
  v_accvgpr_read_b32 v10, a2
  v_accvgpr_read_b32 v11, a3
  v_mfma_f32_16x16x32_bf16 v[92:95], v[44:47], v[100:103], 0
  ds_read_b64_tr_b16 v[40:41], v218 offset:40960
  ds_read_b64_tr_b16 v[42:43], v218 offset:41984
  v_mfma_f32_16x16x32_bf16 v[224:227], v[48:51], v[96:99], 0
  buffer_load_dwordx4 v209, s[24:27], s59 offen offset:1024 sc1 lds
  v_accvgpr_read_b32 v12, a4
  v_mfma_f32_16x16x32_bf16 v[232:235], v[48:51], v[100:103], 0
  ds_read_b64_tr_b16 v[44:45], v219 offset:40960
  ds_read_b64_tr_b16 v[46:47], v219 offset:41984
  v_mfma_f32_16x16x32_bf16 v[228:231], v[52:55], v[96:99], 0
  s_waitcnt lgkmcnt(8)
  v_accvgpr_read_b32 v13, a5
  v_accvgpr_read_b32 v14, a6
  v_mfma_f32_16x16x32_bf16 v[236:239], v[52:55], v[100:103], 0
  ds_read_b64_tr_b16 v[48:49], v220 offset:40960
  ds_read_b64_tr_b16 v[50:51], v220 offset:41984
  v_mfma_f32_16x16x32_bf16 v[240:243], v[56:59], v[96:99], 0
  v_accvgpr_read_b32 v15, a7
  v_cvt_pk_bf16_f32 v16, v8, v9
  v_mfma_f32_16x16x32_bf16 v[248:251], v[56:59], v[100:103], 0
  ds_read_b64_tr_b16 v[52:53], v221 offset:40960
  ds_read_b64_tr_b16 v[54:55], v221 offset:41984
  v_mfma_f32_16x16x32_bf16 v[244:247], v[60:63], v[96:99], 0
  s_waitcnt lgkmcnt(8)
  v_cvt_pk_bf16_f32 v17, v10, v11
  v_cvt_pk_bf16_f32 v18, v12, v13
  v_mfma_f32_16x16x32_bf16 v[252:255], v[60:63], v[100:103], 0
  ds_read_b64_tr_b16 v[56:57], v222 offset:40960
  ds_read_b64_tr_b16 v[58:59], v222 offset:41984
  v_mfma_f32_16x16x32_bf16 v[64:67], v[32:35], v[104:107], v[64:67]
  buffer_load_dwordx4 v210, s[24:27], s59 offen offset:2048 sc1 lds
  v_cvt_pk_bf16_f32 v19, v14, v15
  v_mfma_f32_16x16x32_bf16 v[72:75], v[32:35], v[108:111], v[72:75]
  ds_read_b64_tr_b16 v[60:61], v223 offset:40960
  ds_read_b64_tr_b16 v[62:63], v223 offset:41984
  v_mfma_f32_16x16x32_bf16 v[68:71], v[36:39], v[104:107], v[68:71]
  s_waitcnt lgkmcnt(8)
  ds_read_b64_tr_b16 v[32:33], v216 offset:49152
  ds_read_b64_tr_b16 v[34:35], v216 offset:50176
  v_mfma_f32_16x16x32_bf16 v[76:79], v[36:39], v[108:111], v[76:79]
  buffer_store_dwordx4 v[16:19], v1, s[16:19], s61 offen offset:0 sc1
  v_accvgpr_read_b32 v8, a8
  v_mfma_f32_16x16x32_bf16 v[80:83], v[40:43], v[104:107], v[80:83]
  v_accvgpr_read_b32 v9, a9
  v_accvgpr_read_b32 v10, a10
  v_accvgpr_read_b32 v11, a11
  v_mfma_f32_16x16x32_bf16 v[88:91], v[40:43], v[108:111], v[88:91]
  ds_read_b64_tr_b16 v[36:37], v217 offset:49152
  ds_read_b64_tr_b16 v[38:39], v217 offset:50176
  v_mfma_f32_16x16x32_bf16 v[84:87], v[44:47], v[104:107], v[84:87]
  s_waitcnt lgkmcnt(8)
  v_accvgpr_read_b32 v12, a12
  v_accvgpr_read_b32 v13, a13
  v_mfma_f32_16x16x32_bf16 v[92:95], v[44:47], v[108:111], v[92:95]
  ds_read_b64_tr_b16 v[40:41], v218 offset:49152
  ds_read_b64_tr_b16 v[42:43], v218 offset:50176
  v_mfma_f32_16x16x32_bf16 v[224:227], v[48:51], v[104:107], v[224:227]
  buffer_load_dwordx4 v211, s[24:27], s59 offen offset:3072 sc1 lds
  v_accvgpr_read_b32 v14, a14
  v_mfma_f32_16x16x32_bf16 v[232:235], v[48:51], v[108:111], v[232:235]
  ds_read_b64_tr_b16 v[44:45], v219 offset:49152
  ds_read_b64_tr_b16 v[46:47], v219 offset:50176
  v_mfma_f32_16x16x32_bf16 v[228:231], v[52:55], v[104:107], v[228:231]
  s_waitcnt lgkmcnt(8)
  v_accvgpr_read_b32 v15, a15
  v_cvt_pk_bf16_f32 v16, v8, v9
  v_mfma_f32_16x16x32_bf16 v[236:239], v[52:55], v[108:111], v[236:239]
  ds_read_b64_tr_b16 v[48:49], v220 offset:49152
  ds_read_b64_tr_b16 v[50:51], v220 offset:50176
  v_mfma_f32_16x16x32_bf16 v[240:243], v[56:59], v[104:107], v[240:243]
  v_cvt_pk_bf16_f32 v17, v10, v11
  v_cvt_pk_bf16_f32 v18, v12, v13
  v_mfma_f32_16x16x32_bf16 v[248:251], v[56:59], v[108:111], v[248:251]
  ds_read_b64_tr_b16 v[52:53], v221 offset:49152
  ds_read_b64_tr_b16 v[54:55], v221 offset:50176
  v_mfma_f32_16x16x32_bf16 v[244:247], v[60:63], v[104:107], v[244:247]
  s_waitcnt lgkmcnt(8)
  ds_read_b64_tr_b16 v[56:57], v222 offset:49152
  v_cvt_pk_bf16_f32 v19, v14, v15
  v_mfma_f32_16x16x32_bf16 v[252:255], v[60:63], v[108:111], v[252:255]
  ds_read_b64_tr_b16 v[58:59], v222 offset:50176
  buffer_store_dwordx4 v[16:19], v1, s[16:19], s61 offen offset:1024 sc1
  v_mfma_f32_16x16x32_bf16 v[64:67], v[32:35], v[112:115], v[64:67]
  v_accvgpr_read_b32 v8, a16
  v_accvgpr_read_b32 v9, a17
  v_mfma_f32_16x16x32_bf16 v[72:75], v[32:35], v[116:119], v[72:75]
  ds_read_b64_tr_b16 v[60:61], v223 offset:49152
  ds_read_b64_tr_b16 v[62:63], v223 offset:50176
  v_mfma_f32_16x16x32_bf16 v[68:71], v[36:39], v[112:115], v[68:71]
  s_waitcnt lgkmcnt(8)
  v_accvgpr_read_b32 v10, a18
  v_accvgpr_read_b32 v11, a19
  v_mfma_f32_16x16x32_bf16 v[76:79], v[36:39], v[116:119], v[76:79]
  ds_read_b64_tr_b16 v[32:33], v216 offset:57344
  ds_read_b64_tr_b16 v[34:35], v216 offset:58368
  v_mfma_f32_16x16x32_bf16 v[80:83], v[40:43], v[112:115], v[80:83]
  v_accvgpr_read_b32 v12, a20
  v_accvgpr_read_b32 v13, a21
  v_mfma_f32_16x16x32_bf16 v[88:91], v[40:43], v[116:119], v[88:91]
  ds_read_b64_tr_b16 v[36:37], v217 offset:57344
  ds_read_b64_tr_b16 v[38:39], v217 offset:58368
  v_mfma_f32_16x16x32_bf16 v[84:87], v[44:47], v[112:115], v[84:87]
  s_waitcnt lgkmcnt(8)
  v_accvgpr_read_b32 v14, a22
  v_accvgpr_read_b32 v15, a23
  v_mfma_f32_16x16x32_bf16 v[92:95], v[44:47], v[116:119], v[92:95]
  ds_read_b64_tr_b16 v[40:41], v218 offset:57344
  ds_read_b64_tr_b16 v[42:43], v218 offset:58368
  v_mfma_f32_16x16x32_bf16 v[224:227], v[48:51], v[112:115], v[224:227]
  v_cvt_pk_bf16_f32 v16, v8, v9
  v_cvt_pk_bf16_f32 v17, v10, v11
  v_mfma_f32_16x16x32_bf16 v[232:235], v[48:51], v[116:119], v[232:235]
  ds_read_b64_tr_b16 v[44:45], v219 offset:57344
  ds_read_b64_tr_b16 v[46:47], v219 offset:58368
  v_mfma_f32_16x16x32_bf16 v[228:231], v[52:55], v[112:115], v[228:231]
  s_waitcnt lgkmcnt(8)
  v_cvt_pk_bf16_f32 v18, v12, v13
  v_cvt_pk_bf16_f32 v19, v14, v15
  v_mfma_f32_16x16x32_bf16 v[236:239], v[52:55], v[116:119], v[236:239]
  ds_read_b64_tr_b16 v[48:49], v220 offset:57344
  ds_read_b64_tr_b16 v[50:51], v220 offset:58368
  v_mfma_f32_16x16x32_bf16 v[240:243], v[56:59], v[112:115], v[240:243]
  ds_read_b64_tr_b16 v[52:53], v221 offset:57344
  ds_read_b64_tr_b16 v[54:55], v221 offset:58368
  buffer_store_dwordx4 v[16:19], v1, s[16:19], s61 offen offset:2048 sc1
  v_mfma_f32_16x16x32_bf16 v[248:251], v[56:59], v[116:119], v[248:251]
  v_accvgpr_read_b32 v8, a24
  v_accvgpr_read_b32 v9, a25
  v_mfma_f32_16x16x32_bf16 v[244:247], v[60:63], v[112:115], v[244:247]
  s_waitcnt lgkmcnt(8)
  v_accvgpr_read_b32 v10, a26
  v_accvgpr_read_b32 v11, a27
  v_mfma_f32_16x16x32_bf16 v[252:255], v[60:63], v[116:119], v[252:255]
  ds_read_b64_tr_b16 v[56:57], v222 offset:57344
  ds_read_b64_tr_b16 v[58:59], v222 offset:58368
  v_mfma_f32_16x16x32_bf16 v[64:67], v[32:35], v[120:123], v[64:67]
  v_accvgpr_read_b32 v12, a28
  v_accvgpr_read_b32 v13, a29
  v_mfma_f32_16x16x32_bf16 v[72:75], v[32:35], v[124:127], v[72:75]
  ds_read_b64_tr_b16 v[60:61], v223 offset:57344
  ds_read_b64_tr_b16 v[62:63], v223 offset:58368
  v_mfma_f32_16x16x32_bf16 v[68:71], v[36:39], v[120:123], v[68:71]
  s_waitcnt vmcnt(27)
  s_barrier
  v_subrev_u32 v216, 0x18000, v216
  v_mfma_f32_16x16x32_bf16 v[76:79], v[36:39], v[124:127], v[76:79]
  s_waitcnt lgkmcnt(8)
  ds_read_b64_tr_b16 v[32:33], v216 offset:0
  ds_read_b64_tr_b16 v[34:35], v216 offset:1024
  v_mfma_f32_16x16x32_bf16 v[80:83], v[40:43], v[120:123], v[80:83]
  v_subrev_u32 v217, 0x18000, v217
  v_accvgpr_read_b32 v14, a30
  v_mfma_f32_16x16x32_bf16 v[88:91], v[40:43], v[124:127], v[88:91]
  ds_read_b64_tr_b16 v[36:37], v217 offset:0
  ds_read_b64_tr_b16 v[38:39], v217 offset:1024
  v_mfma_f32_16x16x32_bf16 v[84:87], v[44:47], v[120:123], v[84:87]
  s_waitcnt lgkmcnt(8)
  v_subrev_u32 v218, 0x18000, v218
  v_accvgpr_read_b32 v15, a31
  v_mfma_f32_16x16x32_bf16 v[92:95], v[44:47], v[124:127], v[92:95]
  ds_read_b64_tr_b16 v[40:41], v218 offset:0
  ds_read_b64_tr_b16 v[42:43], v218 offset:1024
  v_mfma_f32_16x16x32_bf16 v[224:227], v[48:51], v[120:123], v[224:227]
  v_subrev_u32 v219, 0x18000, v219
  v_cvt_pk_bf16_f32 v16, v8, v9
  v_mfma_f32_16x16x32_bf16 v[232:235], v[48:51], v[124:127], v[232:235]
  ds_read_b64_tr_b16 v[44:45], v219 offset:0
  ds_read_b64_tr_b16 v[46:47], v219 offset:1024
  v_mfma_f32_16x16x32_bf16 v[228:231], v[52:55], v[120:123], v[228:231]
  s_waitcnt lgkmcnt(8)
  v_subrev_u32 v220, 0x18000, v220
  v_cvt_pk_bf16_f32 v17, v10, v11
  v_mfma_f32_16x16x32_bf16 v[236:239], v[52:55], v[124:127], v[236:239]
  ds_read_b64_tr_b16 v[48:49], v220 offset:0
  ds_read_b64_tr_b16 v[50:51], v220 offset:1024
  v_mfma_f32_16x16x32_bf16 v[240:243], v[56:59], v[120:123], v[240:243]
  v_subrev_u32 v221, 0x18000, v221
  v_cvt_pk_bf16_f32 v18, v12, v13
  v_mfma_f32_16x16x32_bf16 v[248:251], v[56:59], v[124:127], v[248:251]
  ds_read_b64_tr_b16 v[52:53], v221 offset:0
  ds_read_b64_tr_b16 v[54:55], v221 offset:1024
  v_mfma_f32_16x16x32_bf16 v[244:247], v[60:63], v[120:123], v[244:247]
  s_waitcnt lgkmcnt(8)
  v_subrev_u32 v222, 0x18000, v222
  v_cvt_pk_bf16_f32 v19, v14, v15
  v_mfma_f32_16x16x32_bf16 v[252:255], v[60:63], v[124:127], v[252:255]
  ds_read_b64_tr_b16 v[56:57], v222 offset:0
  ds_read_b64_tr_b16 v[58:59], v222 offset:1024
  v_mfma_f32_16x16x32_bf16 v[64:67], v[32:35], v[128:131], v[64:67]
  v_subrev_u32 v223, 0x18000, v223
  ds_read_b64_tr_b16 v[60:61], v223 offset:0
  v_mfma_f32_16x16x32_bf16 v[72:75], v[32:35], v[132:135], v[72:75]
  ds_read_b64_tr_b16 v[62:63], v223 offset:1024
  buffer_store_dwordx4 v[16:19], v1, s[16:19], s61 offen offset:3072 sc1
  s_add_u32 s61, s60, 4096
  v_mfma_f32_16x16x32_bf16 v[68:71], v[36:39], v[128:131], v[68:71]
  s_waitcnt lgkmcnt(8)
  v_accvgpr_read_b32 v8, a32
  v_accvgpr_read_b32 v9, a33
  v_mfma_f32_16x16x32_bf16 v[76:79], v[36:39], v[132:135], v[76:79]
  ds_read_b64_tr_b16 v[32:33], v216 offset:8192
  ds_read_b64_tr_b16 v[34:35], v216 offset:9216
  v_mfma_f32_16x16x32_bf16 v[80:83], v[40:43], v[128:131], v[80:83]
  v_accvgpr_read_b32 v10, a34
  v_accvgpr_read_b32 v11, a35
  v_mfma_f32_16x16x32_bf16 v[88:91], v[40:43], v[132:135], v[88:91]
  ds_read_b64_tr_b16 v[36:37], v217 offset:8192
  ds_read_b64_tr_b16 v[38:39], v217 offset:9216
  v_mfma_f32_16x16x32_bf16 v[84:87], v[44:47], v[128:131], v[84:87]
  s_waitcnt lgkmcnt(8)
  v_accvgpr_read_b32 v12, a36
  v_accvgpr_read_b32 v13, a37
  v_mfma_f32_16x16x32_bf16 v[92:95], v[44:47], v[132:135], v[92:95]
  ds_read_b64_tr_b16 v[40:41], v218 offset:8192
  ds_read_b64_tr_b16 v[42:43], v218 offset:9216
  v_mfma_f32_16x16x32_bf16 v[224:227], v[48:51], v[128:131], v[224:227]
  v_accvgpr_read_b32 v14, a38
  v_accvgpr_read_b32 v15, a39
  v_cvt_pk_bf16_f32 v16, v8, v9
  v_mfma_f32_16x16x32_bf16 v[232:235], v[48:51], v[132:135], v[232:235]
  ds_read_b64_tr_b16 v[44:45], v219 offset:8192
  ds_read_b64_tr_b16 v[46:47], v219 offset:9216
  v_mfma_f32_16x16x32_bf16 v[228:231], v[52:55], v[128:131], v[228:231]
  s_waitcnt lgkmcnt(8)
  v_cvt_pk_bf16_f32 v17, v10, v11
  v_cvt_pk_bf16_f32 v18, v12, v13
  v_mfma_f32_16x16x32_bf16 v[236:239], v[52:55], v[132:135], v[236:239]
  ds_read_b64_tr_b16 v[48:49], v220 offset:8192
  ds_read_b64_tr_b16 v[50:51], v220 offset:9216
  v_mfma_f32_16x16x32_bf16 v[240:243], v[56:59], v[128:131], v[240:243]
  ds_read_b64_tr_b16 v[52:53], v221 offset:8192
  v_cvt_pk_bf16_f32 v19, v14, v15
  v_mfma_f32_16x16x32_bf16 v[248:251], v[56:59], v[132:135], v[248:251]
  ds_read_b64_tr_b16 v[54:55], v221 offset:9216
  buffer_store_dwordx4 v[16:19], v1, s[16:19], s61 offen offset:0 sc1
  v_mfma_f32_16x16x32_bf16 v[244:247], v[60:63], v[128:131], v[244:247]
  s_waitcnt lgkmcnt(8)
  v_accvgpr_read_b32 v8, a40
  v_accvgpr_read_b32 v9, a41
  v_mfma_f32_16x16x32_bf16 v[252:255], v[60:63], v[132:135], v[252:255]
  ds_read_b64_tr_b16 v[56:57], v222 offset:8192
  ds_read_b64_tr_b16 v[58:59], v222 offset:9216
  v_mfma_f32_16x16x32_bf16 v[64:67], v[32:35], v[136:139], v[64:67]
  v_accvgpr_read_b32 v10, a42
  v_accvgpr_read_b32 v11, a43
  v_mfma_f32_16x16x32_bf16 v[72:75], v[32:35], v[140:143], v[72:75]
  ds_read_b64_tr_b16 v[60:61], v223 offset:8192
  ds_read_b64_tr_b16 v[62:63], v223 offset:9216
  v_mfma_f32_16x16x32_bf16 v[68:71], v[36:39], v[136:139], v[68:71]
  s_waitcnt lgkmcnt(8)
  v_accvgpr_read_b32 v12, a44
  v_accvgpr_read_b32 v13, a45
  v_mfma_f32_16x16x32_bf16 v[76:79], v[36:39], v[140:143], v[76:79]
  ds_read_b64_tr_b16 v[32:33], v216 offset:16384
  ds_read_b64_tr_b16 v[34:35], v216 offset:17408
  v_mfma_f32_16x16x32_bf16 v[80:83], v[40:43], v[136:139], v[80:83]
  v_accvgpr_read_b32 v14, a46
  v_accvgpr_read_b32 v15, a47
  v_mfma_f32_16x16x32_bf16 v[88:91], v[40:43], v[140:143], v[88:91]
  ds_read_b64_tr_b16 v[36:37], v217 offset:16384
  ds_read_b64_tr_b16 v[38:39], v217 offset:17408
  v_mfma_f32_16x16x32_bf16 v[84:87], v[44:47], v[136:139], v[84:87]
  s_waitcnt lgkmcnt(8)
  v_cvt_pk_bf16_f32 v16, v8, v9
  v_cvt_pk_bf16_f32 v17, v10, v11
  v_mfma_f32_16x16x32_bf16 v[92:95], v[44:47], v[140:143], v[92:95]
  ds_read_b64_tr_b16 v[40:41], v218 offset:16384
  ds_read_b64_tr_b16 v[42:43], v218 offset:17408
  v_mfma_f32_16x16x32_bf16 v[224:227], v[48:51], v[136:139], v[224:227]
  v_cvt_pk_bf16_f32 v18, v12, v13
  v_cvt_pk_bf16_f32 v19, v14, v15
  v_mfma_f32_16x16x32_bf16 v[232:235], v[48:51], v[140:143], v[232:235]
  ds_read_b64_tr_b16 v[44:45], v219 offset:16384
  ds_read_b64_tr_b16 v[46:47], v219 offset:17408
  v_mfma_f32_16x16x32_bf16 v[228:231], v[52:55], v[136:139], v[228:231]
  s_waitcnt lgkmcnt(8)
  ds_read_b64_tr_b16 v[48:49], v220 offset:16384
  ds_read_b64_tr_b16 v[50:51], v220 offset:17408
  v_mfma_f32_16x16x32_bf16 v[236:239], v[52:55], v[140:143], v[236:239]
  buffer_store_dwordx4 v[16:19], v1, s[16:19], s61 offen offset:1024 sc1
  v_accvgpr_read_b32 v8, a48
  v_mfma_f32_16x16x32_bf16 v[240:243], v[56:59], v[136:139], v[240:243]
  v_accvgpr_read_b32 v9, a49
  v_accvgpr_read_b32 v10, a50
  v_mfma_f32_16x16x32_bf16 v[248:251], v[56:59], v[140:143], v[248:251]
  ds_read_b64_tr_b16 v[52:53], v221 offset:16384
  ds_read_b64_tr_b16 v[54:55], v221 offset:17408
  v_mfma_f32_16x16x32_bf16 v[244:247], v[60:63], v[136:139], v[244:247]
  s_waitcnt lgkmcnt(8)
  v_accvgpr_read_b32 v11, a51
  v_accvgpr_read_b32 v12, a52
  v_mfma_f32_16x16x32_bf16 v[252:255], v[60:63], v[140:143], v[252:255]
  ds_read_b64_tr_b16 v[56:57], v222 offset:16384
  ds_read_b64_tr_b16 v[58:59], v222 offset:17408
  v_mfma_f32_16x16x32_bf16 v[64:67], v[32:35], v[144:147], v[64:67]
  v_accvgpr_read_b32 v13, a53
  v_accvgpr_read_b32 v14, a54
  v_accvgpr_read_b32 v15, a55
  v_mfma_f32_16x16x32_bf16 v[72:75], v[32:35], v[148:151], v[72:75]
  ds_read_b64_tr_b16 v[60:61], v223 offset:16384
  ds_read_b64_tr_b16 v[62:63], v223 offset:17408
  v_mfma_f32_16x16x32_bf16 v[68:71], v[36:39], v[144:147], v[68:71]
  s_waitcnt lgkmcnt(8)
  v_cvt_pk_bf16_f32 v16, v8, v9
  v_cvt_pk_bf16_f32 v17, v10, v11
  v_mfma_f32_16x16x32_bf16 v[76:79], v[36:39], v[148:151], v[76:79]
  ds_read_b64_tr_b16 v[32:33], v216 offset:24576
  ds_read_b64_tr_b16 v[34:35], v216 offset:25600
  v_mfma_f32_16x16x32_bf16 v[80:83], v[40:43], v[144:147], v[80:83]
  v_cvt_pk_bf16_f32 v18, v12, v13
  v_cvt_pk_bf16_f32 v19, v14, v15
  v_mfma_f32_16x16x32_bf16 v[88:91], v[40:43], v[148:151], v[88:91]
  ds_read_b64_tr_b16 v[36:37], v217 offset:24576
  ds_read_b64_tr_b16 v[38:39], v217 offset:25600
  v_mfma_f32_16x16x32_bf16 v[84:87], v[44:47], v[144:147], v[84:87]
  s_waitcnt lgkmcnt(8)
  ds_read_b64_tr_b16 v[40:41], v218 offset:24576
  ds_read_b64_tr_b16 v[42:43], v218 offset:25600
  v_mfma_f32_16x16x32_bf16 v[92:95], v[44:47], v[148:151], v[92:95]
  buffer_store_dwordx4 v[16:19], v1, s[16:19], s61 offen offset:2048 sc1
  v_accvgpr_read_b32 v8, a56
  v_mfma_f32_16x16x32_bf16 v[224:227], v[48:51], v[144:147], v[224:227]
  v_accvgpr_read_b32 v9, a57
  v_accvgpr_read_b32 v10, a58
  v_mfma_f32_16x16x32_bf16 v[232:235], v[48:51], v[148:151], v[232:235]
  ds_read_b64_tr_b16 v[44:45], v219 offset:24576
  ds_read_b64_tr_b16 v[46:47], v219 offset:25600
  v_mfma_f32_16x16x32_bf16 v[228:231], v[52:55], v[144:147], v[228:231]
  s_waitcnt lgkmcnt(8)
  v_accvgpr_read_b32 v11, a59
  v_accvgpr_read_b32 v12, a60
  v_mfma_f32_16x16x32_bf16 v[236:239], v[52:55], v[148:151], v[236:239]
  ds_read_b64_tr_b16 v[48:49], v220 offset:24576
  ds_read_b64_tr_b16 v[50:51], v220 offset:25600
  v_mfma_f32_16x16x32_bf16 v[240:243], v[56:59], v[144:147], v[240:243]
  v_accvgpr_read_b32 v13, a61
  v_accvgpr_read_b32 v14, a62
  v_mfma_f32_16x16x32_bf16 v[248:251], v[56:59], v[148:151], v[248:251]
  ds_read_b64_tr_b16 v[52:53], v221 offset:24576
  ds_read_b64_tr_b16 v[54:55], v221 offset:25600
  v_mfma_f32_16x16x32_bf16 v[244:247], v[60:63], v[144:147], v[244:247]
  s_waitcnt lgkmcnt(8)
  v_accvgpr_read_b32 v15, a63
  v_cvt_pk_bf16_f32 v16, v8, v9
  v_mfma_f32_16x16x32_bf16 v[252:255], v[60:63], v[148:151], v[252:255]
  ds_read_b64_tr_b16 v[56:57], v222 offset:24576
  ds_read_b64_tr_b16 v[58:59], v222 offset:25600
  v_mfma_f32_16x16x32_bf16 v[64:67], v[32:35], v[152:155], v[64:67]
  v_cvt_pk_bf16_f32 v17, v10, v11
  v_cvt_pk_bf16_f32 v18, v12, v13
  v_mfma_f32_16x16x32_bf16 v[72:75], v[32:35], v[156:159], v[72:75]
  ds_read_b64_tr_b16 v[60:61], v223 offset:24576
  ds_read_b64_tr_b16 v[62:63], v223 offset:25600
  v_mfma_f32_16x16x32_bf16 v[68:71], v[36:39], v[152:155], v[68:71]
  s_waitcnt vmcnt(23)
  s_barrier
  v_add_u32 v216, 0x8000, v216
  v_mfma_f32_16x16x32_bf16 v[76:79], v[36:39], v[156:159], v[76:79]
  s_waitcnt lgkmcnt(8)
  ds_read_b64_tr_b16 v[32:33], v216 offset:32768
  ds_read_b64_tr_b16 v[34:35], v216 offset:33792
  v_mfma_f32_16x16x32_bf16 v[80:83], v[40:43], v[152:155], v[80:83]
  s_add_u32 m0, s43, 131072
  s_mov_b32 s59, 1573120
  v_add_u32 v217, 0x8000, v217
  v_cvt_pk_bf16_f32 v19, v14, v15
  v_mfma_f32_16x16x32_bf16 v[88:91], v[40:43], v[156:159], v[88:91]
  ds_read_b64_tr_b16 v[36:37], v217 offset:32768
  ds_read_b64_tr_b16 v[38:39], v217 offset:33792
  v_mfma_f32_16x16x32_bf16 v[84:87], v[44:47], v[152:155], v[84:87]
  s_waitcnt lgkmcnt(8)
  buffer_load_dwordx4 v208, s[24:27], s59 offen offset:0 sc1 lds
  v_add_u32 v218, 0x8000, v218
  v_mfma_f32_16x16x32_bf16 v[92:95], v[44:47], v[156:159], v[92:95]
  ds_read_b64_tr_b16 v[40:41], v218 offset:32768
  ds_read_b64_tr_b16 v[42:43], v218 offset:33792
  v_mfma_f32_16x16x32_bf16 v[224:227], v[48:51], v[152:155], v[224:227]
  v_add_u32 v219, 0x8000, v219
  ds_read_b64_tr_b16 v[44:45], v219 offset:32768
  v_mfma_f32_16x16x32_bf16 v[232:235], v[48:51], v[156:159], v[232:235]
  s_add_u32 s60, s60, s57
  ds_read_b64_tr_b16 v[46:47], v219 offset:33792
  buffer_store_dwordx4 v[16:19], v1, s[16:19], s61 offen offset:3072 sc1
  v_mfma_f32_16x16x32_bf16 v[228:231], v[52:55], v[152:155], v[228:231]
  s_waitcnt lgkmcnt(8)
  v_add_u32 v220, 0x8000, v220
  ds_read_b64_tr_b16 v[48:49], v220 offset:32768
  v_mfma_f32_16x16x32_bf16 v[236:239], v[52:55], v[156:159], v[236:239]
  s_add_u32 s61, s60, 0
  ds_read_b64_tr_b16 v[50:51], v220 offset:33792
  v_accvgpr_read_b32 v8, a64
  v_mfma_f32_16x16x32_bf16 v[240:243], v[56:59], v[152:155], v[240:243]
  buffer_load_dwordx4 v209, s[24:27], s59 offen offset:1024 sc1 lds
  v_add_u32 v221, 0x8000, v221
  v_mfma_f32_16x16x32_bf16 v[248:251], v[56:59], v[156:159], v[248:251]
  ds_read_b64_tr_b16 v[52:53], v221 offset:32768
  ds_read_b64_tr_b16 v[54:55], v221 offset:33792
  v_mfma_f32_16x16x32_bf16 v[244:247], v[60:63], v[152:155], v[244:247]
  s_waitcnt lgkmcnt(8)
  v_add_u32 v222, 0x8000, v222
  v_accvgpr_read_b32 v9, a65
  v_mfma_f32_16x16x32_bf16 v[252:255], v[60:63], v[156:159], v[252:255]
  ds_read_b64_tr_b16 v[56:57], v222 offset:32768
  ds_read_b64_tr_b16 v[58:59], v222 offset:33792
  v_mfma_f32_16x16x32_bf16 v[64:67], v[32:35], v[160:163], v[64:67]
  v_add_u32 v223, 0x8000, v223
  v_accvgpr_read_b32 v10, a66
  v_mfma_f32_16x16x32_bf16 v[72:75], v[32:35], v[164:167], v[72:75]
  ds_read_b64_tr_b16 v[60:61], v223 offset:32768
  ds_read_b64_tr_b16 v[62:63], v223 offset:33792
  v_mfma_f32_16x16x32_bf16 v[68:71], v[36:39], v[160:163], v[68:71]
  s_waitcnt lgkmcnt(8)
  buffer_load_dwordx4 v210, s[24:27], s59 offen offset:2048 sc1 lds
  v_accvgpr_read_b32 v11, a67
  v_mfma_f32_16x16x32_bf16 v[76:79], v[36:39], v[164:167], v[76:79]
  ds_read_b64_tr_b16 v[32:33], v216 offset:40960
  ds_read_b64_tr_b16 v[34:35], v216 offset:41984
  v_mfma_f32_16x16x32_bf16 v[80:83], v[40:43], v[160:163], v[80:83]
  v_accvgpr_read_b32 v12, a68
  v_accvgpr_read_b32 v13, a69
  v_mfma_f32_16x16x32_bf16 v[88:91], v[40:43], v[164:167], v[88:91]
  ds_read_b64_tr_b16 v[36:37], v217 offset:40960
  ds_read_b64_tr_b16 v[38:39], v217 offset:41984
  v_mfma_f32_16x16x32_bf16 v[84:87], v[44:47], v[160:163], v[84:87]
  s_waitcnt lgkmcnt(8)
  v_accvgpr_read_b32 v14, a70
  v_accvgpr_read_b32 v15, a71
  v_mfma_f32_16x16x32_bf16 v[92:95], v[44:47], v[164:167], v[92:95]
  ds_read_b64_tr_b16 v[40:41], v218 offset:40960
  ds_read_b64_tr_b16 v[42:43], v218 offset:41984
  v_mfma_f32_16x16x32_bf16 v[224:227], v[48:51], v[160:163], v[224:227]
  buffer_load_dwordx4 v211, s[24:27], s59 offen offset:3072 sc1 lds
  v_cvt_pk_bf16_f32 v16, v8, v9
  v_mfma_f32_16x16x32_bf16 v[232:235], v[48:51], v[164:167], v[232:235]
  ds_read_b64_tr_b16 v[44:45], v219 offset:40960
  ds_read_b64_tr_b16 v[46:47], v219 offset:41984
  v_mfma_f32_16x16x32_bf16 v[228:231], v[52:55], v[160:163], v[228:231]
  s_waitcnt lgkmcnt(8)
  v_cvt_pk_bf16_f32 v17, v10, v11
  v_cvt_pk_bf16_f32 v18, v12, v13
  v_mfma_f32_16x16x32_bf16 v[236:239], v[52:55], v[164:167], v[236:239]
  ds_read_b64_tr_b16 v[48:49], v220 offset:40960
  ds_read_b64_tr_b16 v[50:51], v220 offset:41984
  v_mfma_f32_16x16x32_bf16 v[240:243], v[56:59], v[160:163], v[240:243]
  s_add_u32 m0, s43, 147456
  s_mov_b32 s59, 2097408
  ds_read_b64_tr_b16 v[52:53], v221 offset:40960
  v_cvt_pk_bf16_f32 v19, v14, v15
  v_mfma_f32_16x16x32_bf16 v[248:251], v[56:59], v[164:167], v[248:251]
  ds_read_b64_tr_b16 v[54:55], v221 offset:41984
  buffer_store_dwordx4 v[16:19], v1, s[16:19], s61 offen offset:0 sc1
  v_mfma_f32_16x16x32_bf16 v[244:247], v[60:63], v[160:163], v[244:247]
  s_waitcnt lgkmcnt(8)
  buffer_load_dwordx4 v208, s[24:27], s59 offen offset:0 sc1 lds
  v_accvgpr_read_b32 v8, a72
  v_mfma_f32_16x16x32_bf16 v[252:255], v[60:63], v[164:167], v[252:255]
  ds_read_b64_tr_b16 v[56:57], v222 offset:40960
  ds_read_b64_tr_b16 v[58:59], v222 offset:41984
  v_mfma_f32_16x16x32_bf16 v[64:67], v[32:35], v[168:171], v[64:67]
  v_accvgpr_read_b32 v9, a73
  v_accvgpr_read_b32 v10, a74
  v_mfma_f32_16x16x32_bf16 v[72:75], v[32:35], v[172:175], v[72:75]
  ds_read_b64_tr_b16 v[60:61], v223 offset:40960
  ds_read_b64_tr_b16 v[62:63], v223 offset:41984
  v_mfma_f32_16x16x32_bf16 v[68:71], v[36:39], v[168:171], v[68:71]
  s_waitcnt lgkmcnt(8)
  v_accvgpr_read_b32 v11, a75
  v_accvgpr_read_b32 v12, a76
  v_mfma_f32_16x16x32_bf16 v[76:79], v[36:39], v[172:175], v[76:79]
  ds_read_b64_tr_b16 v[32:33], v216 offset:49152
  ds_read_b64_tr_b16 v[34:35], v216 offset:50176
  v_mfma_f32_16x16x32_bf16 v[80:83], v[40:43], v[168:171], v[80:83]
  buffer_load_dwordx4 v209, s[24:27], s59 offen offset:1024 sc1 lds
  v_accvgpr_read_b32 v13, a77
  v_mfma_f32_16x16x32_bf16 v[88:91], v[40:43], v[172:175], v[88:91]
  ds_read_b64_tr_b16 v[36:37], v217 offset:49152
  ds_read_b64_tr_b16 v[38:39], v217 offset:50176
  v_mfma_f32_16x16x32_bf16 v[84:87], v[44:47], v[168:171], v[84:87]
  s_waitcnt lgkmcnt(8)
  v_accvgpr_read_b32 v14, a78
  v_accvgpr_read_b32 v15, a79
  v_mfma_f32_16x16x32_bf16 v[92:95], v[44:47], v[172:175], v[92:95]
  ds_read_b64_tr_b16 v[40:41], v218 offset:49152
  ds_read_b64_tr_b16 v[42:43], v218 offset:50176
  v_mfma_f32_16x16x32_bf16 v[224:227], v[48:51], v[168:171], v[224:227]
  v_cvt_pk_bf16_f32 v16, v8, v9
  v_cvt_pk_bf16_f32 v17, v10, v11
  v_cvt_pk_bf16_f32 v18, v12, v13
  v_mfma_f32_16x16x32_bf16 v[232:235], v[48:51], v[172:175], v[232:235]
  ds_read_b64_tr_b16 v[44:45], v219 offset:49152
  ds_read_b64_tr_b16 v[46:47], v219 offset:50176
  v_mfma_f32_16x16x32_bf16 v[228:231], v[52:55], v[168:171], v[228:231]
  s_waitcnt lgkmcnt(8)
  buffer_load_dwordx4 v210, s[24:27], s59 offen offset:2048 sc1 lds
  v_cvt_pk_bf16_f32 v19, v14, v15
  v_mfma_f32_16x16x32_bf16 v[236:239], v[52:55], v[172:175], v[236:239]
  ds_read_b64_tr_b16 v[48:49], v220 offset:49152
  ds_read_b64_tr_b16 v[50:51], v220 offset:50176
  v_mfma_f32_16x16x32_bf16 v[240:243], v[56:59], v[168:171], v[240:243]
  ds_read_b64_tr_b16 v[52:53], v221 offset:49152
  ds_read_b64_tr_b16 v[54:55], v221 offset:50176
  v_mfma_f32_16x16x32_bf16 v[248:251], v[56:59], v[172:175], v[248:251]
  buffer_store_dwordx4 v[16:19], v1, s[16:19], s61 offen offset:1024 sc1
  v_accvgpr_read_b32 v8, a80
  v_mfma_f32_16x16x32_bf16 v[244:247], v[60:63], v[168:171], v[244:247]
  s_waitcnt lgkmcnt(8)
  v_accvgpr_read_b32 v9, a81
  v_accvgpr_read_b32 v10, a82
  v_mfma_f32_16x16x32_bf16 v[252:255], v[60:63], v[172:175], v[252:255]
  ds_read_b64_tr_b16 v[56:57], v222 offset:49152
  ds_read_b64_tr_b16 v[58:59], v222 offset:50176
  v_mfma_f32_16x16x32_bf16 v[64:67], v[32:35], v[176:179], v[64:67]
  buffer_load_dwordx4 v211, s[24:27], s59 offen offset:3072 sc1 lds
  v_accvgpr_read_b32 v11, a83
  v_mfma_f32_16x16x32_bf16 v[72:75], v[32:35], v[180:183], v[72:75]
  ds_read_b64_tr_b16 v[60:61], v223 offset:49152
  ds_read_b64_tr_b16 v[62:63], v223 offset:50176
  v_mfma_f32_16x16x32_bf16 v[68:71], v[36:39], v[176:179], v[68:71]
  s_waitcnt lgkmcnt(8)
  v_accvgpr_read_b32 v12, a84
  v_accvgpr_read_b32 v13, a85
  v_mfma_f32_16x16x32_bf16 v[76:79], v[36:39], v[180:183], v[76:79]
  ds_read_b64_tr_b16 v[32:33], v216 offset:57344
  ds_read_b64_tr_b16 v[34:35], v216 offset:58368
  v_mfma_f32_16x16x32_bf16 v[80:83], v[40:43], v[176:179], v[80:83]
  v_accvgpr_read_b32 v14, a86
  v_accvgpr_read_b32 v15, a87
  v_mfma_f32_16x16x32_bf16 v[88:91], v[40:43], v[180:183], v[88:91]
  ds_read_b64_tr_b16 v[36:37], v217 offset:57344
  ds_read_b64_tr_b16 v[38:39], v217 offset:58368
  v_mfma_f32_16x16x32_bf16 v[84:87], v[44:47], v[176:179], v[84:87]
  s_waitcnt lgkmcnt(8)
  v_cvt_pk_bf16_f32 v16, v8, v9
  v_cvt_pk_bf16_f32 v17, v10, v11
  v_mfma_f32_16x16x32_bf16 v[92:95], v[44:47], v[180:183], v[92:95]
  ds_read_b64_tr_b16 v[40:41], v218 offset:57344
  ds_read_b64_tr_b16 v[42:43], v218 offset:58368
  v_mfma_f32_16x16x32_bf16 v[224:227], v[48:51], v[176:179], v[224:227]
  v_cvt_pk_bf16_f32 v18, v12, v13
  v_cvt_pk_bf16_f32 v19, v14, v15
  v_mfma_f32_16x16x32_bf16 v[232:235], v[48:51], v[180:183], v[232:235]
  ds_read_b64_tr_b16 v[44:45], v219 offset:57344
  ds_read_b64_tr_b16 v[46:47], v219 offset:58368
  v_mfma_f32_16x16x32_bf16 v[228:231], v[52:55], v[176:179], v[228:231]
  s_waitcnt lgkmcnt(8)
  ds_read_b64_tr_b16 v[48:49], v220 offset:57344
  ds_read_b64_tr_b16 v[50:51], v220 offset:58368
  v_mfma_f32_16x16x32_bf16 v[236:239], v[52:55], v[180:183], v[236:239]
  buffer_store_dwordx4 v[16:19], v1, s[16:19], s61 offen offset:2048 sc1
  v_accvgpr_read_b32 v8, a88
  v_mfma_f32_16x16x32_bf16 v[240:243], v[56:59], v[176:179], v[240:243]
  v_accvgpr_read_b32 v9, a89
  v_accvgpr_read_b32 v10, a90
  v_mfma_f32_16x16x32_bf16 v[248:251], v[56:59], v[180:183], v[248:251]
  ds_read_b64_tr_b16 v[52:53], v221 offset:57344
  ds_read_b64_tr_b16 v[54:55], v221 offset:58368
  v_mfma_f32_16x16x32_bf16 v[244:247], v[60:63], v[176:179], v[244:247]
  s_waitcnt lgkmcnt(8)
  v_accvgpr_read_b32 v11, a91
  v_accvgpr_read_b32 v12, a92
  v_mfma_f32_16x16x32_bf16 v[252:255], v[60:63], v[180:183], v[252:255]
  ds_read_b64_tr_b16 v[56:57], v222 offset:57344
  ds_read_b64_tr_b16 v[58:59], v222 offset:58368
  v_mfma_f32_16x16x32_bf16 v[64:67], v[32:35], v[184:187], v[64:67]
  v_accvgpr_read_b32 v13, a93
  v_accvgpr_read_b32 v14, a94
  v_accvgpr_read_b32 v15, a95
  v_mfma_f32_16x16x32_bf16 v[72:75], v[32:35], v[188:191], v[72:75]
  ds_read_b64_tr_b16 v[60:61], v223 offset:57344
  ds_read_b64_tr_b16 v[62:63], v223 offset:58368
  v_mfma_f32_16x16x32_bf16 v[68:71], v[36:39], v[184:187], v[68:71]
  s_waitcnt vmcnt(27)
  s_barrier
  s_waitcnt lgkmcnt(8)
  v_mfma_f32_16x16x32_bf16 v[76:79], v[36:39], v[188:191], v[76:79]
  ds_read_b64_tr_b16 v[32:33], v216 offset:0
  ds_read_b64_tr_b16 v[34:35], v216 offset:1024
  v_mfma_f32_16x16x32_bf16 v[80:83], v[40:43], v[184:187], v[80:83]
  s_add_u32 m0, s43, 0
  s_mov_b32 s59, 2621696
  v_cvt_pk_bf16_f32 v16, v8, v9
  v_mfma_f32_16x16x32_bf16 v[88:91], v[40:43], v[188:191], v[88:91]
  ds_read_b64_tr_b16 v[36:37], v217 offset:0
  ds_read_b64_tr_b16 v[38:39], v217 offset:1024
  v_mfma_f32_16x16x32_bf16 v[84:87], v[44:47], v[184:187], v[84:87]
  s_waitcnt lgkmcnt(8)
  buffer_load_dwordx4 v208, s[24:27], s59 offen offset:0 sc1 lds
  v_cvt_pk_bf16_f32 v17, v10, v11
  v_mfma_f32_16x16x32_bf16 v[92:95], v[44:47], v[188:191], v[92:95]
  ds_read_b64_tr_b16 v[40:41], v218 offset:0
  ds_read_b64_tr_b16 v[42:43], v218 offset:1024
  v_mfma_f32_16x16x32_bf16 v[224:227], v[48:51], v[184:187], v[224:227]
  v_cvt_pk_bf16_f32 v18, v12, v13
  v_cvt_pk_bf16_f32 v19, v14, v15
  v_mfma_f32_16x16x32_bf16 v[232:235], v[48:51], v[188:191], v[232:235]
  ds_read_b64_tr_b16 v[44:45], v219 offset:0
  ds_read_b64_tr_b16 v[46:47], v219 offset:1024
  v_mfma_f32_16x16x32_bf16 v[228:231], v[52:55], v[184:187], v[228:231]
  s_waitcnt lgkmcnt(8)
  ds_read_b64_tr_b16 v[48:49], v220 offset:0
  ds_read_b64_tr_b16 v[50:51], v220 offset:1024
  v_mfma_f32_16x16x32_bf16 v[236:239], v[52:55], v[188:191], v[236:239]
  buffer_store_dwordx4 v[16:19], v1, s[16:19], s61 offen offset:3072 sc1
  s_add_u32 s61, s60, 4096
  v_accvgpr_read_b32 v8, a96
  v_mfma_f32_16x16x32_bf16 v[240:243], v[56:59], v[184:187], v[240:243]
  buffer_load_dwordx4 v209, s[24:27], s59 offen offset:1024 sc1 lds
  v_accvgpr_read_b32 v9, a97
  v_mfma_f32_16x16x32_bf16 v[248:251], v[56:59], v[188:191], v[248:251]
  ds_read_b64_tr_b16 v[52:53], v221 offset:0
  ds_read_b64_tr_b16 v[54:55], v221 offset:1024
  v_mfma_f32_16x16x32_bf16 v[244:247], v[60:63], v[184:187], v[244:247]
  s_waitcnt lgkmcnt(8)
  v_accvgpr_read_b32 v10, a98
  v_accvgpr_read_b32 v11, a99
  v_mfma_f32_16x16x32_bf16 v[252:255], v[60:63], v[188:191], v[252:255]
  ds_read_b64_tr_b16 v[56:57], v222 offset:0
  ds_read_b64_tr_b16 v[58:59], v222 offset:1024
  v_mfma_f32_16x16x32_bf16 v[64:67], v[32:35], v[192:195], v[64:67]
  v_accvgpr_read_b32 v12, a100
  v_accvgpr_read_b32 v13, a101
  v_accvgpr_read_b32 v14, a102
  v_mfma_f32_16x16x32_bf16 v[72:75], v[32:35], v[196:199], v[72:75]
  ds_read_b64_tr_b16 v[60:61], v223 offset:0
  ds_read_b64_tr_b16 v[62:63], v223 offset:1024
  v_mfma_f32_16x16x32_bf16 v[68:71], v[36:39], v[192:195], v[68:71]
  s_waitcnt lgkmcnt(8)
  buffer_load_dwordx4 v210, s[24:27], s59 offen offset:2048 sc1 lds
  v_accvgpr_read_b32 v15, a103
  v_mfma_f32_16x16x32_bf16 v[76:79], v[36:39], v[196:199], v[76:79]
  ds_read_b64_tr_b16 v[32:33], v216 offset:8192
  ds_read_b64_tr_b16 v[34:35], v216 offset:9216
  v_mfma_f32_16x16x32_bf16 v[80:83], v[40:43], v[192:195], v[80:83]
  v_cvt_pk_bf16_f32 v16, v8, v9
  v_cvt_pk_bf16_f32 v17, v10, v11
  v_mfma_f32_16x16x32_bf16 v[88:91], v[40:43], v[196:199], v[88:91]
  ds_read_b64_tr_b16 v[36:37], v217 offset:8192
  ds_read_b64_tr_b16 v[38:39], v217 offset:9216
  v_mfma_f32_16x16x32_bf16 v[84:87], v[44:47], v[192:195], v[84:87]
  s_waitcnt lgkmcnt(8)
  v_cvt_pk_bf16_f32 v18, v12, v13
  v_cvt_pk_bf16_f32 v19, v14, v15
  v_mfma_f32_16x16x32_bf16 v[92:95], v[44:47], v[196:199], v[92:95]
  ds_read_b64_tr_b16 v[40:41], v218 offset:8192
  ds_read_b64_tr_b16 v[42:43], v218 offset:9216
  v_mfma_f32_16x16x32_bf16 v[224:227], v[48:51], v[192:195], v[224:227]
  buffer_load_dwordx4 v211, s[24:27], s59 offen offset:3072 sc1 lds
  ds_read_b64_tr_b16 v[44:45], v219 offset:8192
  v_mfma_f32_16x16x32_bf16 v[232:235], v[48:51], v[196:199], v[232:235]
  ds_read_b64_tr_b16 v[46:47], v219 offset:9216
  buffer_store_dwordx4 v[16:19], v1, s[16:19], s61 offen offset:0 sc1
  v_mfma_f32_16x16x32_bf16 v[228:231], v[52:55], v[192:195], v[228:231]
  s_waitcnt lgkmcnt(8)
  v_accvgpr_read_b32 v8, a104
  v_accvgpr_read_b32 v9, a105
  v_mfma_f32_16x16x32_bf16 v[236:239], v[52:55], v[196:199], v[236:239]
  ds_read_b64_tr_b16 v[48:49], v220 offset:8192
  ds_read_b64_tr_b16 v[50:51], v220 offset:9216
  v_mfma_f32_16x16x32_bf16 v[240:243], v[56:59], v[192:195], v[240:243]
  s_add_u32 m0, s43, 16384
  s_mov_b32 s59, 3145984
  v_accvgpr_read_b32 v10, a106
  v_accvgpr_read_b32 v11, a107
  v_mfma_f32_16x16x32_bf16 v[248:251], v[56:59], v[196:199], v[248:251]
  ds_read_b64_tr_b16 v[52:53], v221 offset:8192
  ds_read_b64_tr_b16 v[54:55], v221 offset:9216
  v_mfma_f32_16x16x32_bf16 v[244:247], v[60:63], v[192:195], v[244:247]
  s_waitcnt lgkmcnt(8)
  buffer_load_dwordx4 v208, s[24:27], s59 offen offset:0 sc1 lds
  v_accvgpr_read_b32 v12, a108
  v_mfma_f32_16x16x32_bf16 v[252:255], v[60:63], v[196:199], v[252:255]
  ds_read_b64_tr_b16 v[56:57], v222 offset:8192
  ds_read_b64_tr_b16 v[58:59], v222 offset:9216
  v_mfma_f32_16x16x32_bf16 v[64:67], v[32:35], v[200:203], v[64:67]
  v_accvgpr_read_b32 v13, a109
  v_accvgpr_read_b32 v14, a110
  v_mfma_f32_16x16x32_bf16 v[72:75], v[32:35], v[204:207], v[72:75]
  ds_read_b64_tr_b16 v[60:61], v223 offset:8192
  ds_read_b64_tr_b16 v[62:63], v223 offset:9216
  v_mfma_f32_16x16x32_bf16 v[68:71], v[36:39], v[200:203], v[68:71]
  s_waitcnt lgkmcnt(8)
  v_accvgpr_read_b32 v15, a111
  v_cvt_pk_bf16_f32 v16, v8, v9
  v_mfma_f32_16x16x32_bf16 v[76:79], v[36:39], v[204:207], v[76:79]
  ds_read_b64_tr_b16 v[32:33], v216 offset:16384
  ds_read_b64_tr_b16 v[34:35], v216 offset:17408
  v_mfma_f32_16x16x32_bf16 v[80:83], v[40:43], v[200:203], v[80:83]
  buffer_load_dwordx4 v209, s[24:27], s59 offen offset:1024 sc1 lds
  v_cvt_pk_bf16_f32 v17, v10, v11
  v_mfma_f32_16x16x32_bf16 v[88:91], v[40:43], v[204:207], v[88:91]
  ds_read_b64_tr_b16 v[36:37], v217 offset:16384
  ds_read_b64_tr_b16 v[38:39], v217 offset:17408
  v_mfma_f32_16x16x32_bf16 v[84:87], v[44:47], v[200:203], v[84:87]
  s_waitcnt lgkmcnt(8)
  v_cvt_pk_bf16_f32 v18, v12, v13
  v_cvt_pk_bf16_f32 v19, v14, v15
  v_mfma_f32_16x16x32_bf16 v[92:95], v[44:47], v[204:207], v[92:95]
  ds_read_b64_tr_b16 v[40:41], v218 offset:16384
  ds_read_b64_tr_b16 v[42:43], v218 offset:17408
  v_mfma_f32_16x16x32_bf16 v[224:227], v[48:51], v[200:203], v[224:227]
  ds_read_b64_tr_b16 v[44:45], v219 offset:16384
  ds_read_b64_tr_b16 v[46:47], v219 offset:17408
  v_mfma_f32_16x16x32_bf16 v[232:235], v[48:51], v[204:207], v[232:235]
  buffer_store_dwordx4 v[16:19], v1, s[16:19], s61 offen offset:1024 sc1
  v_accvgpr_read_b32 v8, a112
  v_mfma_f32_16x16x32_bf16 v[228:231], v[52:55], v[200:203], v[228:231]
  s_waitcnt lgkmcnt(8)
  buffer_load_dwordx4 v210, s[24:27], s59 offen offset:2048 sc1 lds
  v_accvgpr_read_b32 v9, a113
  v_mfma_f32_16x16x32_bf16 v[236:239], v[52:55], v[204:207], v[236:239]
  ds_read_b64_tr_b16 v[48:49], v220 offset:16384
  ds_read_b64_tr_b16 v[50:51], v220 offset:17408
  v_mfma_f32_16x16x32_bf16 v[240:243], v[56:59], v[200:203], v[240:243]
  v_accvgpr_read_b32 v10, a114
  v_accvgpr_read_b32 v11, a115
  v_mfma_f32_16x16x32_bf16 v[248:251], v[56:59], v[204:207], v[248:251]
  ds_read_b64_tr_b16 v[52:53], v221 offset:16384
  ds_read_b64_tr_b16 v[54:55], v221 offset:17408
  v_mfma_f32_16x16x32_bf16 v[244:247], v[60:63], v[200:203], v[244:247]
  s_waitcnt lgkmcnt(8)
  v_accvgpr_read_b32 v12, a116
  v_accvgpr_read_b32 v13, a117
  v_mfma_f32_16x16x32_bf16 v[252:255], v[60:63], v[204:207], v[252:255]
  ds_read_b64_tr_b16 v[56:57], v222 offset:16384
  ds_read_b64_tr_b16 v[58:59], v222 offset:17408
  v_mfma_f32_16x16x32_bf16 a[0:3], v[32:35], v[96:99], 0
  buffer_load_dwordx4 v211, s[24:27], s59 offen offset:3072 sc1 lds
  v_accvgpr_read_b32 v14, a118
  v_mfma_f32_16x16x32_bf16 a[8:11], v[32:35], v[100:103], 0
  ds_read_b64_tr_b16 v[60:61], v223 offset:16384
  ds_read_b64_tr_b16 v[62:63], v223 offset:17408
  v_mfma_f32_16x16x32_bf16 a[4:7], v[36:39], v[96:99], 0
  s_waitcnt lgkmcnt(8)
  v_accvgpr_read_b32 v15, a119
  v_cvt_pk_bf16_f32 v16, v8, v9
  v_mfma_f32_16x16x32_bf16 a[12:15], v[36:39], v[100:103], 0
  ds_read_b64_tr_b16 v[32:33], v216 offset:24576
  ds_read_b64_tr_b16 v[34:35], v216 offset:25600
  v_mfma_f32_16x16x32_bf16 a[16:19], v[40:43], v[96:99], 0
  v_cvt_pk_bf16_f32 v17, v10, v11
  v_cvt_pk_bf16_f32 v18, v12, v13
  v_cvt_pk_bf16_f32 v19, v14, v15
  v_mfma_f32_16x16x32_bf16 a[24:27], v[40:43], v[100:103], 0
  ds_read_b64_tr_b16 v[36:37], v217 offset:24576
  ds_read_b64_tr_b16 v[38:39], v217 offset:25600
  v_mfma_f32_16x16x32_bf16 a[20:23], v[44:47], v[96:99], 0
  s_waitcnt lgkmcnt(8)
  ds_read_b64_tr_b16 v[40:41], v218 offset:24576
  ds_read_b64_tr_b16 v[42:43], v218 offset:25600
  v_mfma_f32_16x16x32_bf16 a[28:31], v[44:47], v[100:103], 0
  buffer_store_dwordx4 v[16:19], v1, s[16:19], s61 offen offset:2048 sc1
  v_accvgpr_read_b32 v8, a120
  v_mfma_f32_16x16x32_bf16 a[32:35], v[48:51], v[96:99], 0
  v_accvgpr_read_b32 v9, a121
  v_accvgpr_read_b32 v10, a122
  v_mfma_f32_16x16x32_bf16 a[40:43], v[48:51], v[100:103], 0
  ds_read_b64_tr_b16 v[44:45], v219 offset:24576
  ds_read_b64_tr_b16 v[46:47], v219 offset:25600
  v_mfma_f32_16x16x32_bf16 a[36:39], v[52:55], v[96:99], 0
  s_waitcnt lgkmcnt(8)
  v_accvgpr_read_b32 v11, a123
  v_accvgpr_read_b32 v12, a124
  v_mfma_f32_16x16x32_bf16 a[44:47], v[52:55], v[100:103], 0
  ds_read_b64_tr_b16 v[48:49], v220 offset:24576
  ds_read_b64_tr_b16 v[50:51], v220 offset:25600
  v_mfma_f32_16x16x32_bf16 a[48:51], v[56:59], v[96:99], 0
  v_accvgpr_read_b32 v13, a125
  v_accvgpr_read_b32 v14, a126
  v_mfma_f32_16x16x32_bf16 a[56:59], v[56:59], v[100:103], 0
  ds_read_b64_tr_b16 v[52:53], v221 offset:24576
  ds_read_b64_tr_b16 v[54:55], v221 offset:25600
  v_mfma_f32_16x16x32_bf16 a[52:55], v[60:63], v[96:99], 0
  s_waitcnt lgkmcnt(8)
  v_accvgpr_read_b32 v15, a127
  v_cvt_pk_bf16_f32 v16, v8, v9
  v_mfma_f32_16x16x32_bf16 a[60:63], v[60:63], v[100:103], 0
  ds_read_b64_tr_b16 v[56:57], v222 offset:24576
  ds_read_b64_tr_b16 v[58:59], v222 offset:25600
  v_mfma_f32_16x16x32_bf16 a[0:3], v[32:35], v[104:107], a[0:3]
  v_cvt_pk_bf16_f32 v17, v10, v11
  v_cvt_pk_bf16_f32 v18, v12, v13
  v_mfma_f32_16x16x32_bf16 a[8:11], v[32:35], v[108:111], a[8:11]
  ds_read_b64_tr_b16 v[60:61], v223 offset:24576
  ds_read_b64_tr_b16 v[62:63], v223 offset:25600
  v_mfma_f32_16x16x32_bf16 a[4:7], v[36:39], v[104:107], a[4:7]
  s_waitcnt vmcnt(30)
  s_barrier
  v_add_u32 v216, 0x10000, v216
  v_mfma_f32_16x16x32_bf16 a[12:15], v[36:39], v[108:111], a[12:15]
  s_waitcnt lgkmcnt(8)
  ds_read_b64_tr_b16 v[32:33], v216 offset:0
  ds_read_b64_tr_b16 v[34:35], v216 offset:1024
  v_mfma_f32_16x16x32_bf16 a[16:19], v[40:43], v[104:107], a[16:19]
  s_add_u32 m0, s43, 65536
  s_mov_b32 s59, 0
  v_add_u32 v217, 0x10000, v217
  v_cvt_pk_bf16_f32 v19, v14, v15
  v_mfma_f32_16x16x32_bf16 a[24:27], v[40:43], v[108:111], a[24:27]
  ds_read_b64_tr_b16 v[36:37], v217 offset:0
  ds_read_b64_tr_b16 v[38:39], v217 offset:1024
  v_mfma_f32_16x16x32_bf16 a[20:23], v[44:47], v[104:107], a[20:23]
  s_waitcnt lgkmcnt(8)
  buffer_load_dwordx4 v212, s[28:31], s59 offen offset:0 sc1 lds
  v_add_u32 v218, 0x10000, v218
  v_mfma_f32_16x16x32_bf16 a[28:31], v[44:47], v[108:111], a[28:31]
  ds_read_b64_tr_b16 v[40:41], v218 offset:0
  ds_read_b64_tr_b16 v[42:43], v218 offset:1024
  v_mfma_f32_16x16x32_bf16 a[32:35], v[48:51], v[104:107], a[32:35]
  v_add_u32 v219, 0x10000, v219
  ds_read_b64_tr_b16 v[44:45], v219 offset:0
  v_mfma_f32_16x16x32_bf16 a[40:43], v[48:51], v[108:111], a[40:43]
  ds_read_b64_tr_b16 v[46:47], v219 offset:1024
  buffer_store_dwordx4 v[16:19], v1, s[16:19], s61 offen offset:3072 sc1
  v_mfma_f32_16x16x32_bf16 a[36:39], v[52:55], v[104:107], a[36:39]
  s_waitcnt lgkmcnt(8)
  v_add_u32 v220, 0x10000, v220
  v_mfma_f32_16x16x32_bf16 a[44:47], v[52:55], v[108:111], a[44:47]
  ds_read_b64_tr_b16 v[48:49], v220 offset:0
  ds_read_b64_tr_b16 v[50:51], v220 offset:1024
  v_mfma_f32_16x16x32_bf16 a[48:51], v[56:59], v[104:107], a[48:51]
  buffer_load_dwordx4 v213, s[28:31], s59 offen offset:1024 sc1 lds
  v_add_u32 v221, 0x10000, v221
  v_mfma_f32_16x16x32_bf16 a[56:59], v[56:59], v[108:111], a[56:59]
  ds_read_b64_tr_b16 v[52:53], v221 offset:0
  ds_read_b64_tr_b16 v[54:55], v221 offset:1024
  v_mfma_f32_16x16x32_bf16 a[52:55], v[60:63], v[104:107], a[52:55]
  s_waitcnt lgkmcnt(8)
  v_add_u32 v222, 0x10000, v222
  v_mfma_f32_16x16x32_bf16 a[60:63], v[60:63], v[108:111], a[60:63]
  ds_read_b64_tr_b16 v[56:57], v222 offset:0
  ds_read_b64_tr_b16 v[58:59], v222 offset:1024
  v_mfma_f32_16x16x32_bf16 a[0:3], v[32:35], v[112:115], a[0:3]
  v_add_u32 v223, 0x10000, v223
  ds_read_b64_tr_b16 v[60:61], v223 offset:0
  v_mfma_f32_16x16x32_bf16 a[8:11], v[32:35], v[116:119], a[8:11]
  ds_read_b64_tr_b16 v[62:63], v223 offset:1024
  v_mfma_f32_16x16x32_bf16 a[4:7], v[36:39], v[112:115], a[4:7]
  s_waitcnt lgkmcnt(8)
  buffer_load_dwordx4 v214, s[28:31], s59 offen offset:2048 sc1 lds
  v_mfma_f32_16x16x32_bf16 a[12:15], v[36:39], v[116:119], a[12:15]
  ds_read_b64_tr_b16 v[32:33], v216 offset:8192
  ds_read_b64_tr_b16 v[34:35], v216 offset:9216
  v_mfma_f32_16x16x32_bf16 a[16:19], v[40:43], v[112:115], a[16:19]
  ds_read_b64_tr_b16 v[36:37], v217 offset:8192
  ds_read_b64_tr_b16 v[38:39], v217 offset:9216
  v_mfma_f32_16x16x32_bf16 a[24:27], v[40:43], v[116:119], a[24:27]
  s_add_u32 s63, s62, 0
  v_cvt_pk_bf16_f32 v28, v64, v65
  v_mfma_f32_16x16x32_bf16 a[20:23], v[44:47], v[112:115], a[20:23]
  s_waitcnt lgkmcnt(8)
  v_cvt_pk_bf16_f32 v29, v66, v67
  v_mfma_f32_16x16x32_bf16 a[28:31], v[44:47], v[116:119], a[28:31]
  ds_read_b64_tr_b16 v[40:41], v218 offset:8192
  ds_read_b64_tr_b16 v[42:43], v218 offset:9216
  v_mfma_f32_16x16x32_bf16 a[32:35], v[48:51], v[112:115], a[32:35]
  buffer_load_dwordx4 v215, s[28:31], s59 offen offset:3072 sc1 lds
  v_cvt_pk_bf16_f32 v30, v68, v69
  v_mfma_f32_16x16x32_bf16 a[40:43], v[48:51], v[116:119], a[40:43]
  ds_read_b64_tr_b16 v[44:45], v219 offset:8192
  ds_read_b64_tr_b16 v[46:47], v219 offset:9216
  v_mfma_f32_16x16x32_bf16 a[36:39], v[52:55], v[112:115], a[36:39]
  s_waitcnt lgkmcnt(8)
  v_cvt_pk_bf16_f32 v31, v70, v71
  v_mfma_f32_16x16x32_bf16 a[44:47], v[52:55], v[116:119], a[44:47]
  ds_read_b64_tr_b16 v[48:49], v220 offset:8192
  ds_read_b64_tr_b16 v[50:51], v220 offset:9216
  v_mfma_f32_16x16x32_bf16 a[48:51], v[56:59], v[112:115], a[48:51]
  s_add_u32 m0, s43, 81920
  s_mov_b32 s59, 229376
  ds_read_b64_tr_b16 v[52:53], v221 offset:8192
  v_mfma_f32_16x16x32_bf16 a[56:59], v[56:59], v[116:119], a[56:59]
  ds_read_b64_tr_b16 v[54:55], v221 offset:9216
  v_mfma_f32_16x16x32_bf16 a[52:55], v[60:63], v[112:115], a[52:55]
  s_waitcnt lgkmcnt(8)
  buffer_load_dwordx4 v212, s[28:31], s59 offen offset:0 sc1 lds
  ds_read_b64_tr_b16 v[56:57], v222 offset:8192
  v_mfma_f32_16x16x32_bf16 a[60:63], v[60:63], v[116:119], a[60:63]
  ds_read_b64_tr_b16 v[58:59], v222 offset:9216
  buffer_store_dwordx4 v[28:31], v1, s[68:71], s63 offen offset:0 sc1
  v_mfma_f32_16x16x32_bf16 a[0:3], v[32:35], v[120:123], a[0:3]
  ds_read_b64_tr_b16 v[60:61], v223 offset:8192
  v_accvgpr_write_b32 a64, v28
  v_mfma_f32_16x16x32_bf16 a[8:11], v[32:35], v[124:127], a[8:11]
  ds_read_b64_tr_b16 v[62:63], v223 offset:9216
  v_mfma_f32_16x16x32_bf16 a[4:7], v[36:39], v[120:123], a[4:7]
  s_waitcnt lgkmcnt(8)
  v_accvgpr_write_b32 a65, v29
  v_mfma_f32_16x16x32_bf16 a[12:15], v[36:39], v[124:127], a[12:15]
  ds_read_b64_tr_b16 v[32:33], v216 offset:16384
  ds_read_b64_tr_b16 v[34:35], v216 offset:17408
  v_mfma_f32_16x16x32_bf16 a[16:19], v[40:43], v[120:123], a[16:19]
  buffer_load_dwordx4 v213, s[28:31], s59 offen offset:1024 sc1 lds
  ds_read_b64_tr_b16 v[36:37], v217 offset:16384
  v_mfma_f32_16x16x32_bf16 a[24:27], v[40:43], v[124:127], a[24:27]
  ds_read_b64_tr_b16 v[38:39], v217 offset:17408
  v_mfma_f32_16x16x32_bf16 a[20:23], v[44:47], v[120:123], a[20:23]
  s_waitcnt lgkmcnt(8)
  v_accvgpr_write_b32 a66, v30
  v_mfma_f32_16x16x32_bf16 a[28:31], v[44:47], v[124:127], a[28:31]
  ds_read_b64_tr_b16 v[40:41], v218 offset:16384
  ds_read_b64_tr_b16 v[42:43], v218 offset:17408
  v_mfma_f32_16x16x32_bf16 a[32:35], v[48:51], v[120:123], a[32:35]
  v_accvgpr_write_b32 a67, v31
  v_cvt_pk_bf16_f32 v28, v72, v73
  v_mfma_f32_16x16x32_bf16 a[40:43], v[48:51], v[124:127], a[40:43]
  ds_read_b64_tr_b16 v[44:45], v219 offset:16384
  ds_read_b64_tr_b16 v[46:47], v219 offset:17408
  v_mfma_f32_16x16x32_bf16 a[36:39], v[52:55], v[120:123], a[36:39]
  s_waitcnt lgkmcnt(8)
  buffer_load_dwordx4 v214, s[28:31], s59 offen offset:2048 sc1 lds
  v_mfma_f32_16x16x32_bf16 a[44:47], v[52:55], v[124:127], a[44:47]
  ds_read_b64_tr_b16 v[48:49], v220 offset:16384
  ds_read_b64_tr_b16 v[50:51], v220 offset:17408
  v_mfma_f32_16x16x32_bf16 a[48:51], v[56:59], v[120:123], a[48:51]
  ds_read_b64_tr_b16 v[52:53], v221 offset:16384
  v_cvt_pk_bf16_f32 v29, v74, v75
  v_mfma_f32_16x16x32_bf16 a[56:59], v[56:59], v[124:127], a[56:59]
  ds_read_b64_tr_b16 v[54:55], v221 offset:17408
  v_mfma_f32_16x16x32_bf16 a[52:55], v[60:63], v[120:123], a[52:55]
  s_waitcnt lgkmcnt(8)
  v_cvt_pk_bf16_f32 v30, v76, v77
  v_mfma_f32_16x16x32_bf16 a[60:63], v[60:63], v[124:127], a[60:63]
  ds_read_b64_tr_b16 v[56:57], v222 offset:16384
  ds_read_b64_tr_b16 v[58:59], v222 offset:17408
  v_mfma_f32_16x16x32_bf16 a[0:3], v[32:35], v[128:131], a[0:3]
  buffer_load_dwordx4 v215, s[28:31], s59 offen offset:3072 sc1 lds
  v_cvt_pk_bf16_f32 v31, v78, v79
  v_mfma_f32_16x16x32_bf16 a[8:11], v[32:35], v[132:135], a[8:11]
  ds_read_b64_tr_b16 v[60:61], v223 offset:16384
  ds_read_b64_tr_b16 v[62:63], v223 offset:17408
  v_mfma_f32_16x16x32_bf16 a[4:7], v[36:39], v[128:131], a[4:7]
  s_waitcnt lgkmcnt(8)
  ds_read_b64_tr_b16 v[32:33], v216 offset:24576
  v_mfma_f32_16x16x32_bf16 a[12:15], v[36:39], v[132:135], a[12:15]
  ds_read_b64_tr_b16 v[34:35], v216 offset:25600
  buffer_store_dwordx4 v[28:31], v1, s[68:71], s63 offen offset:1024 sc1
  v_mfma_f32_16x16x32_bf16 a[16:19], v[40:43], v[128:131], a[16:19]
  ds_read_b64_tr_b16 v[36:37], v217 offset:24576
  v_accvgpr_write_b32 a68, v28
  v_mfma_f32_16x16x32_bf16 a[24:27], v[40:43], v[132:135], a[24:27]
  ds_read_b64_tr_b16 v[38:39], v217 offset:25600
  v_mfma_f32_16x16x32_bf16 a[20:23], v[44:47], v[128:131], a[20:23]
  s_waitcnt lgkmcnt(8)
  v_accvgpr_write_b32 a69, v29
  v_mfma_f32_16x16x32_bf16 a[28:31], v[44:47], v[132:135], a[28:31]
  ds_read_b64_tr_b16 v[40:41], v218 offset:24576
  ds_read_b64_tr_b16 v[42:43], v218 offset:25600
  v_mfma_f32_16x16x32_bf16 a[32:35], v[48:51], v[128:131], a[32:35]
  ds_read_b64_tr_b16 v[44:45], v219 offset:24576
  v_accvgpr_write_b32 a70, v30
  v_mfma_f32_16x16x32_bf16 a[40:43], v[48:51], v[132:135], a[40:43]
  ds_read_b64_tr_b16 v[46:47], v219 offset:25600
  v_mfma_f32_16x16x32_bf16 a[36:39], v[52:55], v[128:131], a[36:39]
  s_waitcnt lgkmcnt(8)
  v_accvgpr_write_b32 a71, v31
  v_cvt_pk_bf16_f32 v28, v80, v81
  v_mfma_f32_16x16x32_bf16 a[44:47], v[52:55], v[132:135], a[44:47]
  ds_read_b64_tr_b16 v[48:49], v220 offset:24576
  ds_read_b64_tr_b16 v[50:51], v220 offset:25600
  v_mfma_f32_16x16x32_bf16 a[48:51], v[56:59], v[128:131], a[48:51]
  ds_read_b64_tr_b16 v[52:53], v221 offset:24576
  v_cvt_pk_bf16_f32 v29, v82, v83
  v_mfma_f32_16x16x32_bf16 a[56:59], v[56:59], v[132:135], a[56:59]
  ds_read_b64_tr_b16 v[54:55], v221 offset:25600
  v_mfma_f32_16x16x32_bf16 a[52:55], v[60:63], v[128:131], a[52:55]
  s_waitcnt lgkmcnt(8)
  v_cvt_pk_bf16_f32 v30, v84, v85
  v_mfma_f32_16x16x32_bf16 a[60:63], v[60:63], v[132:135], a[60:63]
  ds_read_b64_tr_b16 v[56:57], v222 offset:24576
  ds_read_b64_tr_b16 v[58:59], v222 offset:25600
  v_mfma_f32_16x16x32_bf16 a[0:3], v[32:35], v[136:139], a[0:3]
  ds_read_b64_tr_b16 v[60:61], v223 offset:24576
  v_cvt_pk_bf16_f32 v31, v86, v87
  v_mfma_f32_16x16x32_bf16 a[8:11], v[32:35], v[140:143], a[8:11]
  ds_read_b64_tr_b16 v[62:63], v223 offset:25600
  v_mfma_f32_16x16x32_bf16 a[4:7], v[36:39], v[136:139], a[4:7]
  s_waitcnt vmcnt(24)
  s_barrier
  s_waitcnt lgkmcnt(8)
  v_mfma_f32_16x16x32_bf16 a[12:15], v[36:39], v[140:143], a[12:15]
  ds_read_b64_tr_b16 v[32:33], v216 offset:32768
  ds_read_b64_tr_b16 v[34:35], v216 offset:33792
  v_mfma_f32_16x16x32_bf16 a[16:19], v[40:43], v[136:139], a[16:19]
  s_add_u32 m0, s43, 32768
  s_mov_b32 s59, 458752
  ds_read_b64_tr_b16 v[36:37], v217 offset:32768
  v_mfma_f32_16x16x32_bf16 a[24:27], v[40:43], v[140:143], a[24:27]
  ds_read_b64_tr_b16 v[38:39], v217 offset:33792
  buffer_store_dwordx4 v[28:31], v1, s[68:71], s63 offen offset:2048 sc1
  v_mfma_f32_16x16x32_bf16 a[20:23], v[44:47], v[136:139], a[20:23]
  s_waitcnt lgkmcnt(8)
  buffer_load_dwordx4 v212, s[28:31], s59 offen offset:0 sc1 lds
  v_mfma_f32_16x16x32_bf16 a[28:31], v[44:47], v[140:143], a[28:31]
  ds_read_b64_tr_b16 v[40:41], v218 offset:32768
  ds_read_b64_tr_b16 v[42:43], v218 offset:33792
  v_mfma_f32_16x16x32_bf16 a[32:35], v[48:51], v[136:139], a[32:35]
  v_accvgpr_write_b32 a72, v28
  v_accvgpr_write_b32 a73, v29
  v_mfma_f32_16x16x32_bf16 a[40:43], v[48:51], v[140:143], a[40:43]
  ds_read_b64_tr_b16 v[44:45], v219 offset:32768
  ds_read_b64_tr_b16 v[46:47], v219 offset:33792
  v_mfma_f32_16x16x32_bf16 a[36:39], v[52:55], v[136:139], a[36:39]
  s_waitcnt lgkmcnt(8)
  v_accvgpr_write_b32 a74, v30
  v_mfma_f32_16x16x32_bf16 a[44:47], v[52:55], v[140:143], a[44:47]
  ds_read_b64_tr_b16 v[48:49], v220 offset:32768
  ds_read_b64_tr_b16 v[50:51], v220 offset:33792
  v_mfma_f32_16x16x32_bf16 a[48:51], v[56:59], v[136:139], a[48:51]
  buffer_load_dwordx4 v213, s[28:31], s59 offen offset:1024 sc1 lds
  ds_read_b64_tr_b16 v[52:53], v221 offset:32768
  v_mfma_f32_16x16x32_bf16 a[56:59], v[56:59], v[140:143], a[56:59]
  ds_read_b64_tr_b16 v[54:55], v221 offset:33792
  v_mfma_f32_16x16x32_bf16 a[52:55], v[60:63], v[136:139], a[52:55]
  s_waitcnt lgkmcnt(8)
  v_accvgpr_write_b32 a75, v31
  v_mfma_f32_16x16x32_bf16 a[60:63], v[60:63], v[140:143], a[60:63]
  ds_read_b64_tr_b16 v[56:57], v222 offset:32768
  ds_read_b64_tr_b16 v[58:59], v222 offset:33792
  v_mfma_f32_16x16x32_bf16 a[0:3], v[32:35], v[144:147], a[0:3]
  ds_read_b64_tr_b16 v[60:61], v223 offset:32768
  v_cvt_pk_bf16_f32 v28, v88, v89
  v_mfma_f32_16x16x32_bf16 a[8:11], v[32:35], v[148:151], a[8:11]
  s_mov_b32 s24, s16
  ds_read_b64_tr_b16 v[62:63], v223 offset:33792
  v_mfma_f32_16x16x32_bf16 a[4:7], v[36:39], v[144:147], a[4:7]
  s_waitcnt lgkmcnt(8)
  buffer_load_dwordx4 v214, s[28:31], s59 offen offset:2048 sc1 lds
  v_cvt_pk_bf16_f32 v29, v90, v91
  v_mfma_f32_16x16x32_bf16 a[12:15], v[36:39], v[148:151], a[12:15]
  ds_read_b64_tr_b16 v[32:33], v216 offset:40960
  ds_read_b64_tr_b16 v[34:35], v216 offset:41984
  v_mfma_f32_16x16x32_bf16 a[16:19], v[40:43], v[144:147], a[16:19]
  ds_read_b64_tr_b16 v[36:37], v217 offset:40960
  v_cvt_pk_bf16_f32 v30, v92, v93
  v_mfma_f32_16x16x32_bf16 a[24:27], v[40:43], v[148:151], a[24:27]
  s_mov_b32 s25, s17
  ds_read_b64_tr_b16 v[38:39], v217 offset:41984
  s_mov_b32 s27, 0x20000
  v_mfma_f32_16x16x32_bf16 a[20:23], v[44:47], v[144:147], a[20:23]
  s_waitcnt lgkmcnt(8)
  v_cvt_pk_bf16_f32 v31, v94, v95
  v_mfma_f32_16x16x32_bf16 a[28:31], v[44:47], v[148:151], a[28:31]
  ds_read_b64_tr_b16 v[40:41], v218 offset:40960
  ds_read_b64_tr_b16 v[42:43], v218 offset:41984
  v_mfma_f32_16x16x32_bf16 a[32:35], v[48:51], v[144:147], a[32:35]
  buffer_load_dwordx4 v215, s[28:31], s59 offen offset:3072 sc1 lds
  ds_read_b64_tr_b16 v[44:45], v219 offset:40960
  v_mfma_f32_16x16x32_bf16 a[40:43], v[48:51], v[148:151], a[40:43]
  ds_read_b64_tr_b16 v[46:47], v219 offset:41984
  v_mfma_f32_16x16x32_bf16 a[36:39], v[52:55], v[144:147], a[36:39]
  s_waitcnt lgkmcnt(8)
  ds_read_b64_tr_b16 v[48:49], v220 offset:40960
  ds_read_b64_tr_b16 v[50:51], v220 offset:41984
  v_mfma_f32_16x16x32_bf16 a[44:47], v[52:55], v[148:151], a[44:47]
  buffer_store_dwordx4 v[28:31], v1, s[68:71], s63 offen offset:3072 sc1
  s_lshl_b32 s73, s32, 9
  s_add_u32 s73, s73, 121643008
  v_mfma_f32_16x16x32_bf16 a[48:51], v[56:59], v[144:147], a[48:51]
  s_add_u32 m0, s43, 49152
  s_mov_b32 s59, 688128
  v_accvgpr_write_b32 a76, v28
  v_mfma_f32_16x16x32_bf16 a[56:59], v[56:59], v[148:151], a[56:59]
  ds_read_b64_tr_b16 v[52:53], v221 offset:40960
  ds_read_b64_tr_b16 v[54:55], v221 offset:41984
  v_mfma_f32_16x16x32_bf16 a[52:55], v[60:63], v[144:147], a[52:55]
  s_waitcnt lgkmcnt(8)
  buffer_load_dwordx4 v212, s[28:31], s59 offen offset:0 sc1 lds
  v_mfma_f32_16x16x32_bf16 a[60:63], v[60:63], v[148:151], a[60:63]
  ds_read_b64_tr_b16 v[56:57], v222 offset:40960
  ds_read_b64_tr_b16 v[58:59], v222 offset:41984
  v_mfma_f32_16x16x32_bf16 a[0:3], v[32:35], v[152:155], a[0:3]
  v_accvgpr_write_b32 a77, v29
  v_accvgpr_write_b32 a78, v30
  v_mfma_f32_16x16x32_bf16 a[8:11], v[32:35], v[156:159], a[8:11]
  ds_read_b64_tr_b16 v[60:61], v223 offset:40960
  ds_read_b64_tr_b16 v[62:63], v223 offset:41984
  v_mfma_f32_16x16x32_bf16 a[4:7], v[36:39], v[152:155], a[4:7]
  s_waitcnt lgkmcnt(8)
  v_accvgpr_write_b32 a79, v31
  v_mfma_f32_16x16x32_bf16 a[12:15], v[36:39], v[156:159], a[12:15]
  ds_read_b64_tr_b16 v[32:33], v216 offset:49152
  ds_read_b64_tr_b16 v[34:35], v216 offset:50176
  v_mfma_f32_16x16x32_bf16 a[16:19], v[40:43], v[152:155], a[16:19]
  buffer_load_dwordx4 v213, s[28:31], s59 offen offset:1024 sc1 lds
  ds_read_b64_tr_b16 v[36:37], v217 offset:49152
  v_mfma_f32_16x16x32_bf16 a[24:27], v[40:43], v[156:159], a[24:27]
  s_add_u32 s63, s62, 4096
  ds_read_b64_tr_b16 v[38:39], v217 offset:50176
  v_mfma_f32_16x16x32_bf16 a[20:23], v[44:47], v[152:155], a[20:23]
  s_waitcnt lgkmcnt(8)
  v_cvt_pk_bf16_f32 v28, v224, v225
  v_mfma_f32_16x16x32_bf16 a[28:31], v[44:47], v[156:159], a[28:31]
  ds_read_b64_tr_b16 v[40:41], v218 offset:49152
  ds_read_b64_tr_b16 v[42:43], v218 offset:50176
  v_mfma_f32_16x16x32_bf16 a[32:35], v[48:51], v[152:155], a[32:35]
  ds_read_b64_tr_b16 v[44:45], v219 offset:49152
  v_cvt_pk_bf16_f32 v29, v226, v227
  v_mfma_f32_16x16x32_bf16 a[40:43], v[48:51], v[156:159], a[40:43]
  ds_read_b64_tr_b16 v[46:47], v219 offset:50176
  v_mfma_f32_16x16x32_bf16 a[36:39], v[52:55], v[152:155], a[36:39]
  s_waitcnt lgkmcnt(8)
  buffer_load_dwordx4 v214, s[28:31], s59 offen offset:2048 sc1 lds
  v_mfma_f32_16x16x32_bf16 a[44:47], v[52:55], v[156:159], a[44:47]
  ds_read_b64_tr_b16 v[48:49], v220 offset:49152
  ds_read_b64_tr_b16 v[50:51], v220 offset:50176
  v_mfma_f32_16x16x32_bf16 a[48:51], v[56:59], v[152:155], a[48:51]
  v_cvt_pk_bf16_f32 v30, v228, v229
  v_cvt_pk_bf16_f32 v31, v230, v231
  v_mfma_f32_16x16x32_bf16 a[56:59], v[56:59], v[156:159], a[56:59]
  ds_read_b64_tr_b16 v[52:53], v221 offset:49152
  ds_read_b64_tr_b16 v[54:55], v221 offset:50176
  v_mfma_f32_16x16x32_bf16 a[52:55], v[60:63], v[152:155], a[52:55]
  s_waitcnt lgkmcnt(8)
  ds_read_b64_tr_b16 v[56:57], v222 offset:49152
  v_mfma_f32_16x16x32_bf16 a[60:63], v[60:63], v[156:159], a[60:63]
  ds_read_b64_tr_b16 v[58:59], v222 offset:50176
  buffer_store_dwordx4 v[28:31], v1, s[68:71], s63 offen offset:0 sc1
  v_mfma_f32_16x16x32_bf16 a[0:3], v[32:35], v[160:163], a[0:3]
  buffer_load_dwordx4 v215, s[28:31], s59 offen offset:3072 sc1 lds
  ds_read_b64_tr_b16 v[60:61], v223 offset:49152
  v_mfma_f32_16x16x32_bf16 a[8:11], v[32:35], v[164:167], a[8:11]
  ds_read_b64_tr_b16 v[62:63], v223 offset:50176
  s_lshl_b32 s74, s48, 9
  s_add_u32 s74, s74, 121659392
  v_mfma_f32_16x16x32_bf16 a[4:7], v[36:39], v[160:163], a[4:7]
  s_waitcnt lgkmcnt(8)
  v_accvgpr_write_b32 a80, v28
  v_mfma_f32_16x16x32_bf16 a[12:15], v[36:39], v[164:167], a[12:15]
  ds_read_b64_tr_b16 v[32:33], v216 offset:57344
  ds_read_b64_tr_b16 v[34:35], v216 offset:58368
  v_mfma_f32_16x16x32_bf16 a[16:19], v[40:43], v[160:163], a[16:19]
  v_accvgpr_write_b32 a81, v29
  v_accvgpr_write_b32 a82, v30
  v_mfma_f32_16x16x32_bf16 a[24:27], v[40:43], v[164:167], a[24:27]
  ds_read_b64_tr_b16 v[36:37], v217 offset:57344
  ds_read_b64_tr_b16 v[38:39], v217 offset:58368
  v_mfma_f32_16x16x32_bf16 a[20:23], v[44:47], v[160:163], a[20:23]
  s_waitcnt lgkmcnt(8)
  v_accvgpr_write_b32 a83, v31
  v_mfma_f32_16x16x32_bf16 a[28:31], v[44:47], v[164:167], a[28:31]
  ds_read_b64_tr_b16 v[40:41], v218 offset:57344
  ds_read_b64_tr_b16 v[42:43], v218 offset:58368
  v_mfma_f32_16x16x32_bf16 a[32:35], v[48:51], v[160:163], a[32:35]
  ds_read_b64_tr_b16 v[44:45], v219 offset:57344
  v_cvt_pk_bf16_f32 v28, v232, v233
  v_mfma_f32_16x16x32_bf16 a[40:43], v[48:51], v[164:167], a[40:43]
  ds_read_b64_tr_b16 v[46:47], v219 offset:58368
  v_mfma_f32_16x16x32_bf16 a[36:39], v[52:55], v[160:163], a[36:39]
  s_waitcnt lgkmcnt(8)
  v_cvt_pk_bf16_f32 v29, v234, v235
  v_mfma_f32_16x16x32_bf16 a[44:47], v[52:55], v[164:167], a[44:47]
  ds_read_b64_tr_b16 v[48:49], v220 offset:57344
  ds_read_b64_tr_b16 v[50:51], v220 offset:58368
  v_mfma_f32_16x16x32_bf16 a[48:51], v[56:59], v[160:163], a[48:51]
  ds_read_b64_tr_b16 v[52:53], v221 offset:57344
  v_cvt_pk_bf16_f32 v30, v236, v237
  v_mfma_f32_16x16x32_bf16 a[56:59], v[56:59], v[164:167], a[56:59]
  ds_read_b64_tr_b16 v[54:55], v221 offset:58368
  v_mfma_f32_16x16x32_bf16 a[52:55], v[60:63], v[160:163], a[52:55]
  s_waitcnt lgkmcnt(8)
  ds_read_b64_tr_b16 v[56:57], v222 offset:57344
  v_cvt_pk_bf16_f32 v31, v238, v239
  v_mfma_f32_16x16x32_bf16 a[60:63], v[60:63], v[164:167], a[60:63]
  ds_read_b64_tr_b16 v[58:59], v222 offset:58368
  buffer_store_dwordx4 v[28:31], v1, s[68:71], s63 offen offset:1024 sc1
  v_mfma_f32_16x16x32_bf16 a[0:3], v[32:35], v[168:171], a[0:3]
  ds_read_b64_tr_b16 v[60:61], v223 offset:57344
  v_accvgpr_write_b32 a84, v28
  v_mfma_f32_16x16x32_bf16 a[8:11], v[32:35], v[172:175], a[8:11]
  ds_read_b64_tr_b16 v[62:63], v223 offset:58368
  v_mfma_f32_16x16x32_bf16 a[4:7], v[36:39], v[168:171], a[4:7]
  s_waitcnt vmcnt(24)
  s_waitcnt vmcnt(21)
  s_barrier
  s_cmp_eq_u32 s3, 0
  s_cbranch_scc1 M_SKV
M_SKV_RET:
  v_mfma_f32_16x16x32_bf16 a[12:15], v[36:39], v[172:175], a[12:15]
  s_waitcnt lgkmcnt(8)
  v_subrev_u32 v216, 0x18000, v216
  ds_read_b64_tr_b16 v[32:33], v216 offset:0
  ds_read_b64_tr_b16 v[34:35], v216 offset:1024
  v_mfma_f32_16x16x32_bf16 a[16:19], v[40:43], v[168:171], a[16:19]
  s_add_u32 m0, s43, 98304
  s_mov_b32 s59, 917504
  v_subrev_u32 v217, 0x18000, v217
  v_mfma_f32_16x16x32_bf16 a[24:27], v[40:43], v[172:175], a[24:27]
  ds_read_b64_tr_b16 v[36:37], v217 offset:0
  ds_read_b64_tr_b16 v[38:39], v217 offset:1024
  v_mfma_f32_16x16x32_bf16 a[20:23], v[44:47], v[168:171], a[20:23]
  s_waitcnt lgkmcnt(8)
  buffer_load_dwordx4 v212, s[28:31], s59 offen offset:0 sc1 lds
  v_subrev_u32 v218, 0x18000, v218
  v_mfma_f32_16x16x32_bf16 a[28:31], v[44:47], v[172:175], a[28:31]
  ds_read_b64_tr_b16 v[40:41], v218 offset:0
  ds_read_b64_tr_b16 v[42:43], v218 offset:1024
  v_mfma_f32_16x16x32_bf16 a[32:35], v[48:51], v[168:171], a[32:35]
  v_subrev_u32 v219, 0x18000, v219
  ds_read_b64_tr_b16 v[44:45], v219 offset:0
  v_mfma_f32_16x16x32_bf16 a[40:43], v[48:51], v[172:175], a[40:43]
  ds_read_b64_tr_b16 v[46:47], v219 offset:1024
  v_mfma_f32_16x16x32_bf16 a[36:39], v[52:55], v[168:171], a[36:39]
  s_waitcnt lgkmcnt(8)
  v_subrev_u32 v220, 0x18000, v220
  v_mfma_f32_16x16x32_bf16 a[44:47], v[52:55], v[172:175], a[44:47]
  ds_read_b64_tr_b16 v[48:49], v220 offset:0
  ds_read_b64_tr_b16 v[50:51], v220 offset:1024
  v_mfma_f32_16x16x32_bf16 a[48:51], v[56:59], v[168:171], a[48:51]
  buffer_load_dwordx4 v213, s[28:31], s59 offen offset:1024 sc1 lds
  v_subrev_u32 v221, 0x18000, v221
  v_mfma_f32_16x16x32_bf16 a[56:59], v[56:59], v[172:175], a[56:59]
  ds_read_b64_tr_b16 v[52:53], v221 offset:0
  ds_read_b64_tr_b16 v[54:55], v221 offset:1024
  v_mfma_f32_16x16x32_bf16 a[52:55], v[60:63], v[168:171], a[52:55]
  s_waitcnt lgkmcnt(8)
  v_subrev_u32 v222, 0x18000, v222
  v_mfma_f32_16x16x32_bf16 a[60:63], v[60:63], v[172:175], a[60:63]
  ds_read_b64_tr_b16 v[56:57], v222 offset:0
  ds_read_b64_tr_b16 v[58:59], v222 offset:1024
  v_mfma_f32_16x16x32_bf16 a[0:3], v[32:35], v[176:179], a[0:3]
  v_subrev_u32 v223, 0x18000, v223
  v_accvgpr_write_b32 a85, v29
  v_mfma_f32_16x16x32_bf16 a[8:11], v[32:35], v[180:183], a[8:11]
  ds_read_b64_tr_b16 v[60:61], v223 offset:0
  ds_read_b64_tr_b16 v[62:63], v223 offset:1024
  v_mfma_f32_16x16x32_bf16 a[4:7], v[36:39], v[176:179], a[4:7]
  s_waitcnt lgkmcnt(8)
  buffer_load_dwordx4 v214, s[28:31], s59 offen offset:2048 sc1 lds
  v_mfma_f32_16x16x32_bf16 a[12:15], v[36:39], v[180:183], a[12:15]
  ds_read_b64_tr_b16 v[32:33], v216 offset:8192
  ds_read_b64_tr_b16 v[34:35], v216 offset:9216
  v_mfma_f32_16x16x32_bf16 a[16:19], v[40:43], v[176:179], a[16:19]
  ds_read_b64_tr_b16 v[36:37], v217 offset:8192
  v_accvgpr_write_b32 a86, v30
  v_mfma_f32_16x16x32_bf16 a[24:27], v[40:43], v[180:183], a[24:27]
  ds_read_b64_tr_b16 v[38:39], v217 offset:9216
  v_mfma_f32_16x16x32_bf16 a[20:23], v[44:47], v[176:179], a[20:23]
  s_waitcnt lgkmcnt(8)
  v_accvgpr_write_b32 a87, v31
  v_mfma_f32_16x16x32_bf16 a[28:31], v[44:47], v[180:183], a[28:31]
  ds_read_b64_tr_b16 v[40:41], v218 offset:8192
  ds_read_b64_tr_b16 v[42:43], v218 offset:9216
  v_mfma_f32_16x16x32_bf16 a[32:35], v[48:51], v[176:179], a[32:35]
  buffer_load_dwordx4 v215, s[28:31], s59 offen offset:3072 sc1 lds
  v_cvt_pk_bf16_f32 v28, v240, v241
  v_mfma_f32_16x16x32_bf16 a[40:43], v[48:51], v[180:183], a[40:43]
  ds_read_b64_tr_b16 v[44:45], v219 offset:8192
  ds_read_b64_tr_b16 v[46:47], v219 offset:9216
  v_mfma_f32_16x16x32_bf16 a[36:39], v[52:55], v[176:179], a[36:39]
  s_waitcnt lgkmcnt(8)
  v_cvt_pk_bf16_f32 v29, v242, v243
  v_mfma_f32_16x16x32_bf16 a[44:47], v[52:55], v[180:183], a[44:47]
  ds_read_b64_tr_b16 v[48:49], v220 offset:8192
  ds_read_b64_tr_b16 v[50:51], v220 offset:9216
  v_mfma_f32_16x16x32_bf16 a[48:51], v[56:59], v[176:179], a[48:51]
  s_add_u32 m0, s43, 114688
  s_mov_b32 s59, 1146880
  v_cvt_pk_bf16_f32 v30, v244, v245
  v_mfma_f32_16x16x32_bf16 a[56:59], v[56:59], v[180:183], a[56:59]
  ds_read_b64_tr_b16 v[52:53], v221 offset:8192
  ds_read_b64_tr_b16 v[54:55], v221 offset:9216
  v_mfma_f32_16x16x32_bf16 a[52:55], v[60:63], v[176:179], a[52:55]
  s_waitcnt lgkmcnt(8)
  buffer_load_dwordx4 v212, s[28:31], s59 offen offset:0 sc1 lds
  v_mfma_f32_16x16x32_bf16 a[60:63], v[60:63], v[180:183], a[60:63]
  ds_read_b64_tr_b16 v[56:57], v222 offset:8192
  ds_read_b64_tr_b16 v[58:59], v222 offset:9216
  v_mfma_f32_16x16x32_bf16 a[0:3], v[32:35], v[184:187], a[0:3]
  ds_read_b64_tr_b16 v[60:61], v223 offset:8192
  v_cvt_pk_bf16_f32 v31, v246, v247
  v_mfma_f32_16x16x32_bf16 a[8:11], v[32:35], v[188:191], a[8:11]
  s_add_u32 s60, s60, s57
  ds_read_b64_tr_b16 v[62:63], v223 offset:9216
  s_add_u32 s61, s60, 0
  v_accvgpr_read_b32 v8, a128
  v_mfma_f32_16x16x32_bf16 a[4:7], v[36:39], v[184:187], a[4:7]
  s_waitcnt lgkmcnt(8)
  ds_read_b64_tr_b16 v[32:33], v216 offset:16384
  ds_read_b64_tr_b16 v[34:35], v216 offset:17408
  v_mfma_f32_16x16x32_bf16 a[12:15], v[36:39], v[188:191], a[12:15]
  buffer_store_dwordx4 v[28:31], v1, s[68:71], s63 offen offset:2048 sc1
  v_accvgpr_read_b32 v9, a129
  v_accvgpr_read_b32 v10, a130
  v_mfma_f32_16x16x32_bf16 a[16:19], v[40:43], v[184:187], a[16:19]
  buffer_load_dwordx4 v213, s[28:31], s59 offen offset:1024 sc1 lds
  v_accvgpr_read_b32 v11, a131
  v_mfma_f32_16x16x32_bf16 a[24:27], v[40:43], v[188:191], a[24:27]
  ds_read_b64_tr_b16 v[36:37], v217 offset:16384
  ds_read_b64_tr_b16 v[38:39], v217 offset:17408
  v_mfma_f32_16x16x32_bf16 a[20:23], v[44:47], v[184:187], a[20:23]
  v_accvgpr_write_b32 a88, v28
  v_accvgpr_write_b32 a89, v29
  v_accvgpr_read_b32 v12, a132
  v_mfma_f32_16x16x32_bf16 a[28:31], v[44:47], v[188:191], a[28:31]
  s_waitcnt lgkmcnt(8)
  ds_read_b64_tr_b16 v[40:41], v218 offset:16384
  ds_read_b64_tr_b16 v[42:43], v218 offset:17408
  v_mfma_f32_16x16x32_bf16 a[32:35], v[48:51], v[184:187], a[32:35]
  v_accvgpr_write_b32 a90, v30
  v_accvgpr_read_b32 v13, a133
  v_mfma_f32_16x16x32_bf16 a[40:43], v[48:51], v[188:191], a[40:43]
  ds_read_b64_tr_b16 v[44:45], v219 offset:16384
  ds_read_b64_tr_b16 v[46:47], v219 offset:17408
  v_mfma_f32_16x16x32_bf16 a[36:39], v[52:55], v[184:187], a[36:39]
  buffer_load_dwordx4 v214, s[28:31], s59 offen offset:2048 sc1 lds
  v_accvgpr_read_b32 v14, a134
  v_accvgpr_read_b32 v15, a135
  v_mfma_f32_16x16x32_bf16 a[44:47], v[52:55], v[188:191], a[44:47]
  s_waitcnt lgkmcnt(8)
  ds_read_b64_tr_b16 v[48:49], v220 offset:16384
  ds_read_b64_tr_b16 v[50:51], v220 offset:17408
  v_mfma_f32_16x16x32_bf16 a[48:51], v[56:59], v[184:187], a[48:51]
  v_accvgpr_write_b32 a91, v31
  v_cvt_pk_bf16_f32 v16, v8, v9
  v_mfma_f32_16x16x32_bf16 a[56:59], v[56:59], v[188:191], a[56:59]
  ds_read_b64_tr_b16 v[52:53], v221 offset:16384
  ds_read_b64_tr_b16 v[54:55], v221 offset:17408
  v_mfma_f32_16x16x32_bf16 a[52:55], v[60:63], v[184:187], a[52:55]
  v_cvt_pk_bf16_f32 v28, v248, v249
  v_cvt_pk_bf16_f32 v17, v10, v11
  v_cvt_pk_bf16_f32 v18, v12, v13
  v_mfma_f32_16x16x32_bf16 a[60:63], v[60:63], v[188:191], a[60:63]
  s_waitcnt lgkmcnt(8)
  ds_read_b64_tr_b16 v[56:57], v222 offset:16384
  ds_read_b64_tr_b16 v[58:59], v222 offset:17408
  v_mfma_f32_16x16x32_bf16 a[0:3], v[32:35], v[192:195], a[0:3]
  buffer_load_dwordx4 v215, s[28:31], s59 offen offset:3072 sc1 lds
  v_cvt_pk_bf16_f32 v29, v250, v251
  v_mfma_f32_16x16x32_bf16 a[8:11], v[32:35], v[196:199], a[8:11]
  ds_read_b64_tr_b16 v[60:61], v223 offset:16384
  ds_read_b64_tr_b16 v[62:63], v223 offset:17408
  v_mfma_f32_16x16x32_bf16 a[4:7], v[36:39], v[192:195], a[4:7]
  s_waitcnt lgkmcnt(8)
  v_cvt_pk_bf16_f32 v30, v252, v253
  v_cvt_pk_bf16_f32 v19, v14, v15
  v_mfma_f32_16x16x32_bf16 a[12:15], v[36:39], v[196:199], a[12:15]
  ds_read_b64_tr_b16 v[32:33], v216 offset:24576
  ds_read_b64_tr_b16 v[34:35], v216 offset:25600
  buffer_store_dwordx4 v[16:19], v1, s[16:19], s61 offen offset:0 sc1
  v_mfma_f32_16x16x32_bf16 a[16:19], v[40:43], v[192:195], a[16:19]
  v_cvt_pk_bf16_f32 v31, v254, v255
  v_accvgpr_read_b32 v8, a136
  v_mfma_f32_16x16x32_bf16 a[24:27], v[40:43], v[196:199], a[24:27]
  ds_read_b64_tr_b16 v[36:37], v217 offset:24576
  ds_read_b64_tr_b16 v[38:39], v217 offset:25600
  v_mfma_f32_16x16x32_bf16 a[20:23], v[44:47], v[192:195], a[20:23]
  s_waitcnt lgkmcnt(8)
  ds_read_b64_tr_b16 v[40:41], v218 offset:24576
  ds_read_b64_tr_b16 v[42:43], v218 offset:25600
  v_mfma_f32_16x16x32_bf16 a[28:31], v[44:47], v[196:199], a[28:31]
  buffer_store_dwordx4 v[28:31], v1, s[68:71], s63 offen offset:3072 sc1
  v_accvgpr_read_b32 v9, a137
  v_accvgpr_read_b32 v10, a138
  v_mfma_f32_16x16x32_bf16 a[32:35], v[48:51], v[192:195], a[32:35]
  v_accvgpr_write_b32 a92, v28
  v_accvgpr_write_b32 a93, v29
  v_mfma_f32_16x16x32_bf16 a[40:43], v[48:51], v[196:199], a[40:43]
  ds_read_b64_tr_b16 v[44:45], v219 offset:24576
  ds_read_b64_tr_b16 v[46:47], v219 offset:25600
  v_mfma_f32_16x16x32_bf16 a[36:39], v[52:55], v[192:195], a[36:39]
  v_accvgpr_write_b32 a94, v30
  v_accvgpr_read_b32 v11, a139
  v_accvgpr_read_b32 v12, a140
  v_mfma_f32_16x16x32_bf16 a[44:47], v[52:55], v[196:199], a[44:47]
  s_waitcnt lgkmcnt(8)
  ds_read_b64_tr_b16 v[48:49], v220 offset:24576
  ds_read_b64_tr_b16 v[50:51], v220 offset:25600
  v_mfma_f32_16x16x32_bf16 a[48:51], v[56:59], v[192:195], a[48:51]
  v_accvgpr_write_b32 a95, v31
  v_accvgpr_read_b32 v13, a141
  v_mfma_f32_16x16x32_bf16 a[56:59], v[56:59], v[196:199], a[56:59]
  ds_read_b64_tr_b16 v[52:53], v221 offset:24576
  ds_read_b64_tr_b16 v[54:55], v221 offset:25600
  v_mfma_f32_16x16x32_bf16 a[52:55], v[60:63], v[192:195], a[52:55]
  v_accvgpr_read_b32 v14, a142
  v_accvgpr_read_b32 v15, a143
  v_cvt_pk_bf16_f32 v16, v8, v9
  v_mfma_f32_16x16x32_bf16 a[60:63], v[60:63], v[196:199], a[60:63]
  s_waitcnt lgkmcnt(8)
  ds_read_b64_tr_b16 v[56:57], v222 offset:24576
  ds_read_b64_tr_b16 v[58:59], v222 offset:25600
  v_mfma_f32_16x16x32_bf16 a[0:3], v[32:35], v[200:203], a[0:3]
  v_cvt_pk_bf16_f32 v17, v10, v11
  v_cvt_pk_bf16_f32 v18, v12, v13
  v_mfma_f32_16x16x32_bf16 a[8:11], v[32:35], v[204:207], a[8:11]
  ds_read_b64_tr_b16 v[60:61], v223 offset:24576
  ds_read_b64_tr_b16 v[62:63], v223 offset:25600
  v_mfma_f32_16x16x32_bf16 a[4:7], v[36:39], v[200:203], a[4:7]
  s_waitcnt vmcnt(24)
  s_barrier
  v_add_u32 v216, 0x8000, v216
  v_mfma_f32_16x16x32_bf16 a[12:15], v[36:39], v[204:207], a[12:15]
  s_waitcnt lgkmcnt(8)
  ds_read_b64_tr_b16 v[32:33], v216 offset:32768
  ds_read_b64_tr_b16 v[34:35], v216 offset:33792
  v_mfma_f32_16x16x32_bf16 a[16:19], v[40:43], v[200:203], a[16:19]
  s_add_u32 m0, s43, 131072
  s_mov_b32 s59, 1376256
  v_add_u32 v217, 0x8000, v217
  v_cvt_pk_bf16_f32 v19, v14, v15
  v_mfma_f32_16x16x32_bf16 a[24:27], v[40:43], v[204:207], a[24:27]
  ds_read_b64_tr_b16 v[36:37], v217 offset:32768
  ds_read_b64_tr_b16 v[38:39], v217 offset:33792
  v_mfma_f32_16x16x32_bf16 a[20:23], v[44:47], v[200:203], a[20:23]
  s_waitcnt lgkmcnt(8)
  buffer_load_dwordx4 v212, s[28:31], s59 offen offset:0 sc1 lds
  v_add_u32 v218, 0x8000, v218
  v_mfma_f32_16x16x32_bf16 a[28:31], v[44:47], v[204:207], a[28:31]
  ds_read_b64_tr_b16 v[40:41], v218 offset:32768
  ds_read_b64_tr_b16 v[42:43], v218 offset:33792
  buffer_store_dwordx4 v[16:19], v1, s[16:19], s61 offen offset:1024 sc1
  v_mfma_f32_16x16x32_bf16 a[32:35], v[48:51], v[200:203], a[32:35]
  v_add_u32 v219, 0x8000, v219
  v_accvgpr_read_b32 v8, a144
  v_accvgpr_read_b32 v9, a145
  v_mfma_f32_16x16x32_bf16 a[40:43], v[48:51], v[204:207], a[40:43]
  ds_read_b64_tr_b16 v[44:45], v219 offset:32768
  ds_read_b64_tr_b16 v[46:47], v219 offset:33792
  v_mfma_f32_16x16x32_bf16 a[36:39], v[52:55], v[200:203], a[36:39]
  s_waitcnt lgkmcnt(8)
  v_add_u32 v220, 0x8000, v220
  v_accvgpr_read_b32 v10, a146
  v_mfma_f32_16x16x32_bf16 a[44:47], v[52:55], v[204:207], a[44:47]
  ds_read_b64_tr_b16 v[48:49], v220 offset:32768
  ds_read_b64_tr_b16 v[50:51], v220 offset:33792
  v_mfma_f32_16x16x32_bf16 a[48:51], v[56:59], v[200:203], a[48:51]
  v_add_u32 v221, 0x8000, v221
  v_accvgpr_read_b32 v11, a147
  v_accvgpr_read_b32 v12, a148
  v_mfma_f32_16x16x32_bf16 a[56:59], v[56:59], v[204:207], a[56:59]
  ds_read_b64_tr_b16 v[52:53], v221 offset:32768
  ds_read_b64_tr_b16 v[54:55], v221 offset:33792
  v_mfma_f32_16x16x32_bf16 a[52:55], v[60:63], v[200:203], a[52:55]
  s_waitcnt lgkmcnt(8)
  v_add_u32 v222, 0x8000, v222
  v_accvgpr_read_b32 v13, a149
  v_mfma_f32_16x16x32_bf16 a[60:63], v[60:63], v[204:207], a[60:63]
  ds_read_b64_tr_b16 v[56:57], v222 offset:32768
  ds_read_b64_tr_b16 v[58:59], v222 offset:33792
  v_mfma_f32_16x16x32_bf16 v[64:67], v[32:35], v[96:99], 0
  v_accvgpr_read_b32 v14, a150
  v_accvgpr_read_b32 v15, a151
  v_cvt_pk_bf16_f32 v16, v8, v9
  v_mfma_f32_16x16x32_bf16 v[72:75], v[32:35], v[100:103], 0
  ds_read_b64_tr_b16 v[60:61], v216 offset:40960
  ds_read_b64_tr_b16 v[62:63], v216 offset:41984
  v_mfma_f32_16x16x32_bf16 v[68:71], v[36:39], v[96:99], 0
  s_waitcnt lgkmcnt(8)
  buffer_load_dwordx4 v213, s[28:31], s59 offen offset:1024 sc1 lds
  v_cvt_pk_bf16_f32 v17, v10, v11
  v_mfma_f32_16x16x32_bf16 v[76:79], v[36:39], v[100:103], 0
  ds_read_b64_tr_b16 v[32:33], v217 offset:40960
  ds_read_b64_tr_b16 v[34:35], v217 offset:41984
  v_mfma_f32_16x16x32_bf16 v[80:83], v[40:43], v[96:99], 0
  ds_read_b64_tr_b16 v[36:37], v218 offset:40960
  v_cvt_pk_bf16_f32 v18, v12, v13
  v_cvt_pk_bf16_f32 v19, v14, v15
  v_mfma_f32_16x16x32_bf16 v[88:91], v[40:43], v[100:103], 0
  ds_read_b64_tr_b16 v[38:39], v218 offset:41984
  buffer_store_dwordx4 v[16:19], v1, s[16:19], s61 offen offset:2048 sc1
  v_mfma_f32_16x16x32_bf16 v[84:87], v[44:47], v[96:99], 0
  s_waitcnt lgkmcnt(8)
  v_accvgpr_read_b32 v8, a152
  v_accvgpr_read_b32 v9, a153
  v_mfma_f32_16x16x32_bf16 v[92:95], v[44:47], v[100:103], 0
  ds_read_b64_tr_b16 v[40:41], v219 offset:40960
  ds_read_b64_tr_b16 v[42:43], v219 offset:41984
  v_mfma_f32_16x16x32_bf16 v[224:227], v[48:51], v[96:99], 0
  v_accvgpr_read_b32 v10, a154
  v_accvgpr_read_b32 v11, a155
  v_accvgpr_read_b32 v12, a156
  v_mfma_f32_16x16x32_bf16 v[232:235], v[48:51], v[100:103], 0
  ds_read_b64_tr_b16 v[44:45], v220 offset:40960
  ds_read_b64_tr_b16 v[46:47], v220 offset:41984
  v_mfma_f32_16x16x32_bf16 v[228:231], v[52:55], v[96:99], 0
  s_waitcnt lgkmcnt(8)
  ds_read_b64_tr_b16 v[48:49], v221 offset:40960
  ds_read_b64_tr_b16 v[50:51], v221 offset:41984
  v_mfma_f32_16x16x32_bf16 v[236:239], v[52:55], v[100:103], 0
  s_add_u32 s63, s62, 8192
  v_accvgpr_read_b32 v20, a0
  v_accvgpr_read_b32 v21, a1
  v_accvgpr_read_b32 v22, a2
  v_accvgpr_read_b32 v23, a3
  v_accvgpr_read_b32 v24, a4
  v_mfma_f32_16x16x32_bf16 v[240:243], v[56:59], v[96:99], 0
  v_accvgpr_read_b32 v26, a6
  v_accvgpr_read_b32 v27, a7
  v_cvt_pk_bf16_f32 v28, v20, v21
  v_cvt_pk_bf16_f32 v29, v22, v23
  v_mfma_f32_16x16x32_bf16 v[248:251], v[56:59], v[100:103], 0
  ds_read_b64_tr_b16 v[52:53], v222 offset:40960
  ds_read_b64_tr_b16 v[54:55], v222 offset:41984
  v_accvgpr_read_b32 v25, a5
  v_mfma_f32_16x16x32_bf16 v[64:67], v[60:63], v[104:107], v[64:67]
  s_waitcnt lgkmcnt(8)
  buffer_load_dwordx4 v214, s[28:31], s59 offen offset:2048 sc1 lds
  v_cvt_pk_bf16_f32 v30, v24, v25
  v_cvt_pk_bf16_f32 v31, v26, v27
  v_mfma_f32_16x16x32_bf16 v[72:75], v[60:63], v[108:111], v[72:75]
  ds_read_b64_tr_b16 v[56:57], v216 offset:49152
  ds_read_b64_tr_b16 v[58:59], v216 offset:50176
  buffer_store_dwordx4 v[28:31], v1, s[68:71], s63 offen offset:0 sc1
  v_accvgpr_write_b32 a96, v28
  v_mfma_f32_16x16x32_bf16 v[68:71], v[32:35], v[104:107], v[68:71]
  v_accvgpr_write_b32 a99, v31
  v_accvgpr_read_b32 v20, a8
  v_accvgpr_read_b32 v21, a9
  v_accvgpr_read_b32 v22, a10
  v_mfma_f32_16x16x32_bf16 v[76:79], v[32:35], v[108:111], v[76:79]
  ds_read_b64_tr_b16 v[60:61], v217 offset:49152
  ds_read_b64_tr_b16 v[62:63], v217 offset:50176
  v_accvgpr_write_b32 a97, v29
  v_accvgpr_write_b32 a98, v30
  v_mfma_f32_16x16x32_bf16 v[80:83], v[36:39], v[104:107], v[80:83]
  v_accvgpr_read_b32 v24, a12
  v_accvgpr_read_b32 v25, a13
  v_accvgpr_read_b32 v26, a14
  v_accvgpr_read_b32 v27, a15
  v_mfma_f32_16x16x32_bf16 v[88:91], v[36:39], v[108:111], v[88:91]
  s_waitcnt lgkmcnt(8)
  ds_read_b64_tr_b16 v[32:33], v218 offset:49152
  ds_read_b64_tr_b16 v[34:35], v218 offset:50176
  v_accvgpr_read_b32 v23, a11
  v_mfma_f32_16x16x32_bf16 v[84:87], v[40:43], v[104:107], v[84:87]
  v_cvt_pk_bf16_f32 v28, v20, v21
  v_cvt_pk_bf16_f32 v29, v22, v23
  v_cvt_pk_bf16_f32 v30, v24, v25
  v_cvt_pk_bf16_f32 v31, v26, v27
  v_mfma_f32_16x16x32_bf16 v[92:95], v[40:43], v[108:111], v[92:95]
  ds_read_b64_tr_b16 v[36:37], v219 offset:49152
  ds_read_b64_tr_b16 v[38:39], v219 offset:50176
  buffer_store_dwordx4 v[28:31], v1, s[68:71], s63 offen offset:1024 sc1
  v_mfma_f32_16x16x32_bf16 v[224:227], v[44:47], v[104:107], v[224:227]
  v_accvgpr_write_b32 a101, v29
  v_accvgpr_write_b32 a102, v30
  v_accvgpr_write_b32 a103, v31
  v_accvgpr_read_b32 v20, a16
  v_mfma_f32_16x16x32_bf16 v[232:235], v[44:47], v[108:111], v[232:235]
  s_waitcnt lgkmcnt(8)
  ds_read_b64_tr_b16 v[40:41], v220 offset:49152
  ds_read_b64_tr_b16 v[42:43], v220 offset:50176
  v_accvgpr_write_b32 a100, v28
  v_mfma_f32_16x16x32_bf16 v[228:231], v[48:51], v[104:107], v[228:231]
  v_accvgpr_read_b32 v22, a18
  v_accvgpr_read_b32 v23, a19
  v_accvgpr_read_b32 v24, a20
  v_accvgpr_read_b32 v25, a21
  v_mfma_f32_16x16x32_bf16 v[236:239], v[48:51], v[108:111], v[236:239]
  ds_read_b64_tr_b16 v[44:45], v221 offset:49152
  ds_read_b64_tr_b16 v[46:47], v221 offset:50176
  v_accvgpr_read_b32 v21, a17
  v_mfma_f32_16x16x32_bf16 v[240:243], v[52:55], v[104:107], v[240:243]
  s_waitcnt lgkmcnt(8)
  buffer_load_dwordx4 v215, s[28:31], s59 offen offset:3072 sc1 lds
  v_cvt_pk_bf16_f32 v28, v20, v21
  v_cvt_pk_bf16_f32 v29, v22, v23
  v_cvt_pk_bf16_f32 v30, v24, v25
  v_mfma_f32_16x16x32_bf16 v[248:251], v[52:55], v[108:111], v[248:251]
  ds_read_b64_tr_b16 v[48:49], v222 offset:49152
  ds_read_b64_tr_b16 v[50:51], v222 offset:50176
  v_accvgpr_read_b32 v26, a22
  v_accvgpr_read_b32 v27, a23
  v_mfma_f32_16x16x32_bf16 v[64:67], v[56:59], v[112:115], v[64:67]
  ds_read_b64_tr_b16 v[52:53], v216 offset:57344
  ds_read_b64_tr_b16 v[54:55], v216 offset:58368
  v_cvt_pk_bf16_f32 v31, v26, v27
  buffer_store_dwordx4 v[28:31], v1, s[68:71], s63 offen offset:2048 sc1
  v_mfma_f32_16x16x32_bf16 v[72:75], v[56:59], v[116:119], v[72:75]
  v_accvgpr_write_b32 a104, v28
  v_accvgpr_write_b32 a105, v29
  v_accvgpr_write_b32 a106, v30
  v_mfma_f32_16x16x32_bf16 v[68:71], v[60:63], v[112:115], v[68:71]
  v_accvgpr_read_b32 v20, a24
  v_accvgpr_read_b32 v21, a25
  v_accvgpr_read_b32 v22, a26
  v_accvgpr_read_b32 v23, a27
  v_mfma_f32_16x16x32_bf16 v[76:79], v[60:63], v[116:119], v[76:79]
  s_waitcnt lgkmcnt(8)
  ds_read_b64_tr_b16 v[56:57], v217 offset:57344
  ds_read_b64_tr_b16 v[58:59], v217 offset:58368
  v_accvgpr_write_b32 a107, v31
  v_mfma_f32_16x16x32_bf16 v[80:83], v[32:35], v[112:115], v[80:83]
  v_accvgpr_read_b32 v25, a29
  v_accvgpr_read_b32 v26, a30
  v_accvgpr_read_b32 v27, a31
  v_cvt_pk_bf16_f32 v28, v20, v21
  v_mfma_f32_16x16x32_bf16 v[88:91], v[32:35], v[116:119], v[88:91]
  ds_read_b64_tr_b16 v[60:61], v218 offset:57344
  ds_read_b64_tr_b16 v[62:63], v218 offset:58368
  v_accvgpr_read_b32 v24, a28
  buffer_load_dwordx2 v[104:105], v5, s[16:19], s73 offen sc1
  v_mfma_f32_16x16x32_bf16 v[84:87], v[36:39], v[112:115], v[84:87]
  s_waitcnt lgkmcnt(8)
  v_cvt_pk_bf16_f32 v29, v22, v23
  v_cvt_pk_bf16_f32 v30, v24, v25
  v_cvt_pk_bf16_f32 v31, v26, v27
  v_mfma_f32_16x16x32_bf16 v[92:95], v[36:39], v[116:119], v[92:95]
  ds_read_b64_tr_b16 v[32:33], v219 offset:57344
  ds_read_b64_tr_b16 v[34:35], v219 offset:58368
  buffer_store_dwordx4 v[28:31], v1, s[68:71], s63 offen offset:3072 sc1
  v_accvgpr_write_b32 a108, v28
  v_mfma_f32_16x16x32_bf16 v[224:227], v[40:43], v[112:115], v[224:227]
  ds_read_b64_tr_b16 v[36:37], v220 offset:57344
  v_accvgpr_write_b32 a109, v29
  v_accvgpr_write_b32 a110, v30
  v_accvgpr_write_b32 a111, v31
  v_mfma_f32_16x16x32_bf16 v[232:235], v[40:43], v[116:119], v[232:235]
  s_add_u32 s63, s62, 12288
  ds_read_b64_tr_b16 v[38:39], v220 offset:58368
  v_accvgpr_read_b32 v20, a32
  v_accvgpr_read_b32 v21, a33
  v_mfma_f32_16x16x32_bf16 v[228:231], v[44:47], v[112:115], v[228:231]
  s_waitcnt lgkmcnt(8)
  v_accvgpr_read_b32 v24, a36
  v_accvgpr_read_b32 v25, a37
  v_accvgpr_read_b32 v26, a38
  v_accvgpr_read_b32 v27, a39
  v_mfma_f32_16x16x32_bf16 v[236:239], v[44:47], v[116:119], v[236:239]
  ds_read_b64_tr_b16 v[40:41], v221 offset:57344
  ds_read_b64_tr_b16 v[42:43], v221 offset:58368
  v_accvgpr_read_b32 v22, a34
  v_accvgpr_read_b32 v23, a35
  v_mfma_f32_16x16x32_bf16 v[240:243], v[48:51], v[112:115], v[240:243]
  v_cvt_pk_bf16_f32 v28, v20, v21
  v_cvt_pk_bf16_f32 v29, v22, v23
  v_cvt_pk_bf16_f32 v30, v24, v25
  v_cvt_pk_bf16_f32 v31, v26, v27
  v_mfma_f32_16x16x32_bf16 v[248:251], v[48:51], v[116:119], v[248:251]
  ds_read_b64_tr_b16 v[44:45], v222 offset:57344
  ds_read_b64_tr_b16 v[46:47], v222 offset:58368
  buffer_store_dwordx4 v[28:31], v1, s[68:71], s63 offen offset:0 sc1
  v_mfma_f32_16x16x32_bf16 v[64:67], v[52:55], v[120:123], v[64:67]
  s_waitcnt vmcnt(24)
  s_barrier
  v_accvgpr_write_b32 a113, v29
  v_accvgpr_write_b32 a114, v30
  v_mfma_f32_16x16x32_bf16 v[72:75], v[52:55], v[124:127], v[72:75]
  s_waitcnt lgkmcnt(8)
  ds_read_b64_tr_b16 v[48:49], v216 offset:0
  ds_read_b64_tr_b16 v[50:51], v216 offset:1024
  v_accvgpr_write_b32 a112, v28
  v_mfma_f32_16x16x32_bf16 v[68:71], v[56:59], v[120:123], v[68:71]
  v_accvgpr_read_b32 v20, a40
  v_accvgpr_read_b32 v21, a41
  v_accvgpr_read_b32 v22, a42
  v_accvgpr_read_b32 v23, a43
  v_mfma_f32_16x16x32_bf16 v[76:79], v[56:59], v[124:127], v[76:79]
  ds_read_b64_tr_b16 v[52:53], v217 offset:0
  ds_read_b64_tr_b16 v[54:55], v217 offset:1024
  v_accvgpr_write_b32 a115, v31
  v_mfma_f32_16x16x32_bf16 v[80:83], v[60:63], v[120:123], v[80:83]
  v_accvgpr_read_b32 v25, a45
  v_accvgpr_read_b32 v26, a46
  v_accvgpr_read_b32 v27, a47
  v_cvt_pk_bf16_f32 v28, v20, v21
  v_mfma_f32_16x16x32_bf16 v[88:91], v[60:63], v[124:127], v[88:91]
  s_waitcnt lgkmcnt(8)
  ds_read_b64_tr_b16 v[56:57], v218 offset:0
  ds_read_b64_tr_b16 v[58:59], v218 offset:1024
  v_accvgpr_read_b32 v24, a44
  v_mfma_f32_16x16x32_bf16 v[84:87], v[32:35], v[120:123], v[84:87]
  ds_read_b64_tr_b16 v[60:61], v219 offset:0
  v_cvt_pk_bf16_f32 v29, v22, v23
  v_cvt_pk_bf16_f32 v30, v24, v25
  v_cvt_pk_bf16_f32 v31, v26, v27
  v_mfma_f32_16x16x32_bf16 v[92:95], v[32:35], v[124:127], v[92:95]
  ds_read_b64_tr_b16 v[62:63], v219 offset:1024
  buffer_store_dwordx4 v[28:31], v1, s[68:71], s63 offen offset:1024 sc1
  v_accvgpr_write_b32 a116, v28
  v_accvgpr_write_b32 a117, v29
  v_mfma_f32_16x16x32_bf16 v[224:227], v[36:39], v[120:123], v[224:227]
  v_accvgpr_write_b32 a119, v31
  v_accvgpr_read_b32 v20, a48
  v_accvgpr_read_b32 v21, a49
  v_accvgpr_read_b32 v22, a50
  v_mfma_f32_16x16x32_bf16 v[232:235], v[36:39], v[124:127], v[232:235]
  s_waitcnt lgkmcnt(8)
  ds_read_b64_tr_b16 v[32:33], v220 offset:0
  ds_read_b64_tr_b16 v[34:35], v220 offset:1024
  v_accvgpr_write_b32 a118, v30
  v_mfma_f32_16x16x32_bf16 v[228:231], v[40:43], v[120:123], v[228:231]
  v_accvgpr_read_b32 v24, a52
  v_accvgpr_read_b32 v25, a53
  v_accvgpr_read_b32 v26, a54
  v_accvgpr_read_b32 v27, a55
  v_mfma_f32_16x16x32_bf16 v[236:239], v[40:43], v[124:127], v[236:239]
  ds_read_b64_tr_b16 v[36:37], v221 offset:0
  ds_read_b64_tr_b16 v[38:39], v221 offset:1024
  v_accvgpr_read_b32 v23, a51
  v_mfma_f32_16x16x32_bf16 v[240:243], v[44:47], v[120:123], v[240:243]
  v_cvt_pk_bf16_f32 v28, v20, v21
  v_cvt_pk_bf16_f32 v29, v22, v23
  v_cvt_pk_bf16_f32 v30, v24, v25
  v_cvt_pk_bf16_f32 v31, v26, v27
  v_mfma_f32_16x16x32_bf16 v[248:251], v[44:47], v[124:127], v[248:251]
  s_waitcnt lgkmcnt(8)
  ds_read_b64_tr_b16 v[40:41], v222 offset:0
  ds_read_b64_tr_b16 v[42:43], v222 offset:1024
  buffer_store_dwordx4 v[28:31], v1, s[68:71], s63 offen offset:2048 sc1
  v_mfma_f32_16x16x32_bf16 v[64:67], v[48:51], v[128:131], v[64:67]
  v_accvgpr_write_b32 a122, v30
  v_accvgpr_write_b32 a123, v31
  v_accvgpr_read_b32 v20, a56
  v_accvgpr_read_b32 v21, a57
  v_mfma_f32_16x16x32_bf16 v[72:75], v[48:51], v[132:135], v[72:75]
  ds_read_b64_tr_b16 v[44:45], v216 offset:8192
  ds_read_b64_tr_b16 v[46:47], v216 offset:9216
  v_accvgpr_write_b32 a120, v28
  v_accvgpr_write_b32 a121, v29
  v_mfma_f32_16x16x32_bf16 v[68:71], v[52:55], v[128:131], v[68:71]
  v_accvgpr_read_b32 v23, a59
  v_accvgpr_read_b32 v24, a60
  v_accvgpr_read_b32 v25, a61
  v_accvgpr_read_b32 v26, a62
  v_mfma_f32_16x16x32_bf16 v[76:79], v[52:55], v[132:135], v[76:79]
  s_waitcnt lgkmcnt(8)
  ds_read_b64_tr_b16 v[48:49], v217 offset:8192
  ds_read_b64_tr_b16 v[50:51], v217 offset:9216
  v_accvgpr_read_b32 v22, a58
  v_mfma_f32_16x16x32_bf16 v[80:83], v[56:59], v[128:131], v[80:83]
  v_accvgpr_read_b32 v27, a63
  v_cvt_pk_bf16_f32 v29, v22, v23
  v_cvt_pk_bf16_f32 v30, v24, v25
  v_cvt_pk_bf16_f32 v31, v26, v27
  v_mfma_f32_16x16x32_bf16 v[88:91], v[56:59], v[132:135], v[88:91]
  ds_read_b64_tr_b16 v[52:53], v218 offset:8192
  ds_read_b64_tr_b16 v[54:55], v218 offset:9216
  v_cvt_pk_bf16_f32 v28, v20, v21
  v_mfma_f32_16x16x32_bf16 v[84:87], v[60:63], v[128:131], v[84:87]
  s_waitcnt lgkmcnt(8)
  ds_read_b64_tr_b16 v[56:57], v219 offset:8192
  ds_read_b64_tr_b16 v[58:59], v219 offset:9216
  buffer_store_dwordx4 v[28:31], v1, s[68:71], s63 offen offset:3072 sc1
  v_mfma_f32_16x16x32_bf16 v[92:95], v[60:63], v[132:135], v[92:95]
  v_accvgpr_write_b32 a124, v28
  v_accvgpr_write_b32 a125, v29
  v_accvgpr_write_b32 a126, v30
  v_accvgpr_write_b32 a127, v31
  v_mfma_f32_16x16x32_bf16 v[224:227], v[32:35], v[128:131], v[224:227]
  v_accvgpr_read_b32 v13, a157
  v_accvgpr_read_b32 v14, a158
  v_mfma_f32_16x16x32_bf16 v[232:235], v[32:35], v[132:135], v[232:235]
  ds_read_b64_tr_b16 v[60:61], v220 offset:8192
  ds_read_b64_tr_b16 v[62:63], v220 offset:9216
  v_mfma_f32_16x16x32_bf16 v[228:231], v[36:39], v[128:131], v[228:231]
  v_accvgpr_read_b32 v15, a159
  v_cvt_pk_bf16_f32 v16, v8, v9
  v_cvt_pk_bf16_f32 v17, v10, v11
  v_mfma_f32_16x16x32_bf16 v[236:239], v[36:39], v[132:135], v[236:239]
  s_waitcnt lgkmcnt(8)
  ds_read_b64_tr_b16 v[32:33], v221 offset:8192
  ds_read_b64_tr_b16 v[34:35], v221 offset:9216
  v_mfma_f32_16x16x32_bf16 v[240:243], v[40:43], v[128:131], v[240:243]
  v_accvgpr_mov_b32 a0, a64
  v_accvgpr_mov_b32 a1, a65
  v_mfma_f32_16x16x32_bf16 v[248:251], v[40:43], v[132:135], v[248:251]
  ds_read_b64_tr_b16 v[36:37], v222 offset:8192
  ds_read_b64_tr_b16 v[38:39], v222 offset:9216
  v_mfma_f32_16x16x32_bf16 v[64:67], v[44:47], v[136:139], v[64:67]
  v_accvgpr_mov_b32 a2, a66
  v_accvgpr_mov_b32 a3, a67
  v_cvt_pk_bf16_f32 v18, v12, v13
  v_mfma_f32_16x16x32_bf16 v[72:75], v[44:47], v[140:143], v[72:75]
  s_waitcnt lgkmcnt(8)
  ds_read_b64_tr_b16 v[40:41], v216 offset:16384
  ds_read_b64_tr_b16 v[42:43], v216 offset:17408
  v_mfma_f32_16x16x32_bf16 v[68:71], v[48:51], v[136:139], v[68:71]
  v_accvgpr_mov_b32 a4, a68
  v_accvgpr_mov_b32 a5, a69
  v_accvgpr_mov_b32 a6, a70
  v_mfma_f32_16x16x32_bf16 v[76:79], v[48:51], v[140:143], v[76:79]
  ds_read_b64_tr_b16 v[44:45], v217 offset:16384
  ds_read_b64_tr_b16 v[46:47], v217 offset:17408
  v_mfma_f32_16x16x32_bf16 v[80:83], v[52:55], v[136:139], v[80:83]
  s_waitcnt lgkmcnt(8)
  v_accvgpr_mov_b32 a7, a71
  v_accvgpr_mov_b32 a8, a72
  v_mfma_f32_16x16x32_bf16 v[88:91], v[52:55], v[140:143], v[88:91]
  ds_read_b64_tr_b16 v[48:49], v218 offset:16384
  ds_read_b64_tr_b16 v[50:51], v218 offset:17408
  v_mfma_f32_16x16x32_bf16 v[84:87], v[56:59], v[136:139], v[84:87]
  v_accvgpr_mov_b32 a9, a73
  v_accvgpr_mov_b32 a10, a74
  v_cvt_pk_bf16_f32 v19, v14, v15
  v_mfma_f32_16x16x32_bf16 v[92:95], v[56:59], v[140:143], v[92:95]
  ds_read_b64_tr_b16 v[52:53], v219 offset:16384
  ds_read_b64_tr_b16 v[54:55], v219 offset:17408
  v_mfma_f32_16x16x32_bf16 v[224:227], v[60:63], v[136:139], v[224:227]
  s_waitcnt lgkmcnt(8)
  v_accvgpr_mov_b32 a11, a75
  v_accvgpr_mov_b32 a12, a76
  v_mfma_f32_16x16x32_bf16 v[232:235], v[60:63], v[140:143], v[232:235]
  ds_read_b64_tr_b16 v[56:57], v220 offset:16384
  ds_read_b64_tr_b16 v[58:59], v220 offset:17408
  v_mfma_f32_16x16x32_bf16 v[228:231], v[32:35], v[136:139], v[228:231]
  v_accvgpr_mov_b32 a13, a77
  v_accvgpr_mov_b32 a14, a78
  v_accvgpr_mov_b32 a15, a79
  v_mfma_f32_16x16x32_bf16 v[236:239], v[32:35], v[140:143], v[236:239]
  ds_read_b64_tr_b16 v[60:61], v221 offset:16384
  ds_read_b64_tr_b16 v[62:63], v221 offset:17408
  v_mfma_f32_16x16x32_bf16 v[240:243], v[36:39], v[136:139], v[240:243]
  s_waitcnt lgkmcnt(8)
  v_accvgpr_mov_b32 a16, a80
  v_accvgpr_mov_b32 a17, a81
  v_mfma_f32_16x16x32_bf16 v[248:251], v[36:39], v[140:143], v[248:251]
  ds_read_b64_tr_b16 v[32:33], v222 offset:16384
  ds_read_b64_tr_b16 v[34:35], v222 offset:17408
  v_mfma_f32_16x16x32_bf16 v[64:67], v[40:43], v[144:147], v[64:67]
  ds_read_b64_tr_b16 v[36:37], v216 offset:24576
  v_accvgpr_mov_b32 a18, a82
  v_accvgpr_mov_b32 a19, a83
  v_mfma_f32_16x16x32_bf16 v[72:75], v[40:43], v[148:151], v[72:75]
  ds_read_b64_tr_b16 v[38:39], v216 offset:25600
  buffer_store_dwordx4 v[16:19], v1, s[16:19], s61 offen offset:3072 sc1
  v_mfma_f32_16x16x32_bf16 v[68:71], v[44:47], v[144:147], v[68:71]
  s_waitcnt lgkmcnt(8)
  v_accvgpr_mov_b32 a20, a84
  v_accvgpr_mov_b32 a21, a85
  v_mfma_f32_16x16x32_bf16 v[76:79], v[44:47], v[148:151], v[76:79]
  s_add_u32 s61, s60, 4096
  ds_read_b64_tr_b16 v[40:41], v217 offset:24576
  ds_read_b64_tr_b16 v[42:43], v217 offset:25600
  v_mfma_f32_16x16x32_bf16 v[80:83], v[48:51], v[144:147], v[80:83]
  v_accvgpr_mov_b32 a22, a86
  v_accvgpr_mov_b32 a23, a87
  v_accvgpr_mov_b32 a24, a88
  v_mfma_f32_16x16x32_bf16 v[88:91], v[48:51], v[148:151], v[88:91]
  ds_read_b64_tr_b16 v[44:45], v218 offset:24576
  ds_read_b64_tr_b16 v[46:47], v218 offset:25600
  v_mfma_f32_16x16x32_bf16 v[84:87], v[52:55], v[144:147], v[84:87]
  v_accvgpr_mov_b32 a25, a89
  v_accvgpr_mov_b32 a26, a90
  v_accvgpr_read_b32 v8, a160
  v_mfma_f32_16x16x32_bf16 v[92:95], v[52:55], v[148:151], v[92:95]
  s_waitcnt lgkmcnt(8)
  ds_read_b64_tr_b16 v[48:49], v219 offset:24576
  ds_read_b64_tr_b16 v[50:51], v219 offset:25600
  v_mfma_f32_16x16x32_bf16 v[224:227], v[56:59], v[144:147], v[224:227]
  v_accvgpr_mov_b32 a27, a91
  v_accvgpr_mov_b32 a28, a92
  v_mfma_f32_16x16x32_bf16 v[232:235], v[56:59], v[148:151], v[232:235]
  ds_read_b64_tr_b16 v[52:53], v220 offset:24576
  ds_read_b64_tr_b16 v[54:55], v220 offset:25600
  v_mfma_f32_16x16x32_bf16 v[228:231], v[60:63], v[144:147], v[228:231]
  v_accvgpr_mov_b32 a29, a93
  v_accvgpr_mov_b32 a30, a94
  v_accvgpr_read_b32 v9, a161
  v_mfma_f32_16x16x32_bf16 v[236:239], v[60:63], v[148:151], v[236:239]
  s_waitcnt lgkmcnt(8)
  ds_read_b64_tr_b16 v[56:57], v221 offset:24576
  ds_read_b64_tr_b16 v[58:59], v221 offset:25600
  v_mfma_f32_16x16x32_bf16 v[240:243], v[32:35], v[144:147], v[240:243]
  v_accvgpr_mov_b32 a31, a95
  v_accvgpr_mov_b32 a32, a96
  v_mfma_f32_16x16x32_bf16 v[248:251], v[32:35], v[148:151], v[248:251]
  ds_read_b64_tr_b16 v[60:61], v222 offset:24576
  ds_read_b64_tr_b16 v[62:63], v222 offset:25600
  v_mfma_f32_16x16x32_bf16 v[64:67], v[36:39], v[152:155], v[64:67]
  s_waitcnt vmcnt(18)
  s_waitcnt vmcnt(1)
  v_cmp_eq_u32 vcc, s86, v104
  v_cmp_eq_u32 s[4:5], s87, v105
  s_nop 0
  s_and_b64 vcc, vcc, s[4:5]
  s_cmp_eq_u64 vcc, exec
  s_cselect_b32 s72, 1, 0
  s_cselect_b32 s26, 0x10000000, 0
  s_barrier
  s_cmp_eq_u32 s3, 0
  s_cbranch_scc1 M_SQ
M_SQ_RET:
  v_mfma_f32_16x16x32_bf16 v[72:75], v[36:39], v[156:159], v[72:75]
  s_waitcnt lgkmcnt(8)
  v_add_u32 v216, 0x10000, v216
  ds_read_b64_tr_b16 v[32:33], v216 offset:0
  ds_read_b64_tr_b16 v[34:35], v216 offset:1024
  v_mfma_f32_16x16x32_bf16 v[68:71], v[40:43], v[152:155], v[68:71]
  v_add_u32 v217, 0x10000, v217
  v_accvgpr_mov_b32 a33, a97
  v_accvgpr_mov_b32 a34, a98
  v_mfma_f32_16x16x32_bf16 v[76:79], v[40:43], v[156:159], v[76:79]
  ds_read_b64_tr_b16 v[36:37], v217 offset:0
  ds_read_b64_tr_b16 v[38:39], v217 offset:1024
  v_mfma_f32_16x16x32_bf16 v[80:83], v[44:47], v[152:155], v[80:83]
  s_mov_b32 s44, 950272
  s_cmp_gt_u32 s34, 0
  s_cselect_b32 s44, 983040, s44
  s_add_u32 s44, s44, s42
  v_add_u32 v218, 0x10000, v218
  v_accvgpr_read_b32 v10, a162
  v_mfma_f32_16x16x32_bf16 v[88:91], v[44:47], v[156:159], v[88:91]
  s_waitcnt lgkmcnt(8)
  ds_read_b64_tr_b16 v[40:41], v218 offset:0
  ds_read_b64_tr_b16 v[42:43], v218 offset:1024
  v_mfma_f32_16x16x32_bf16 v[84:87], v[48:51], v[152:155], v[84:87]
  s_add_u32 m0, s43, 0
  v_add_u32 v219, 0x10000, v219
  v_accvgpr_mov_b32 a35, a99
  v_mfma_f32_16x16x32_bf16 v[92:95], v[48:51], v[156:159], v[92:95]
  ds_read_b64_tr_b16 v[44:45], v219 offset:0
  ds_read_b64_tr_b16 v[46:47], v219 offset:1024
  v_mfma_f32_16x16x32_bf16 v[224:227], v[52:55], v[152:155], v[224:227]
  s_waitcnt lgkmcnt(8)
  buffer_load_dwordx4 v3, s[24:27], s44 offen offset:0 sc1 lds
  v_add_u32 v220, 0x10000, v220
  v_mfma_f32_16x16x32_bf16 v[232:235], v[52:55], v[156:159], v[232:235]
  ds_read_b64_tr_b16 v[48:49], v220 offset:0
  ds_read_b64_tr_b16 v[50:51], v220 offset:1024
  v_mfma_f32_16x16x32_bf16 v[228:231], v[56:59], v[152:155], v[228:231]
  buffer_load_dwordx4 v3, s[24:27], s44 offen offset:1024 sc1 lds
  v_add_u32 v221, 0x10000, v221
  v_accvgpr_read_b32 v11, a163
  v_mfma_f32_16x16x32_bf16 v[236:239], v[56:59], v[156:159], v[236:239]
  ds_read_b64_tr_b16 v[52:53], v221 offset:0
  ds_read_b64_tr_b16 v[54:55], v221 offset:1024
  v_mfma_f32_16x16x32_bf16 v[240:243], v[60:63], v[152:155], v[240:243]
  s_waitcnt lgkmcnt(8)
  buffer_load_dwordx4 v3, s[24:27], s44 offen offset:2048 sc1 lds
  v_accvgpr_mov_b32 a36, a100
  v_mfma_f32_16x16x32_bf16 v[248:251], v[60:63], v[156:159], v[248:251]
  v_add_u32 v222, 0x10000, v222
  ds_read_b64_tr_b16 v[56:57], v222 offset:0
  ds_read_b64_tr_b16 v[58:59], v222 offset:1024
  v_mfma_f32_16x16x32_bf16 v[64:67], v[32:35], v[160:163], v[64:67]
  buffer_load_dwordx4 v3, s[24:27], s44 offen offset:3072 sc1 lds
  v_accvgpr_mov_b32 a37, a101
  v_accvgpr_read_b32 v12, a164
  v_mfma_f32_16x16x32_bf16 v[72:75], v[32:35], v[164:167], v[72:75]
  ds_read_b64_tr_b16 v[60:61], v216 offset:8192
  ds_read_b64_tr_b16 v[62:63], v216 offset:9216
  v_mfma_f32_16x16x32_bf16 v[68:71], v[36:39], v[160:163], v[68:71]
  s_waitcnt lgkmcnt(8)
  v_accvgpr_mov_b32 a38, a102
  v_accvgpr_mov_b32 a39, a103
  v_mfma_f32_16x16x32_bf16 v[76:79], v[36:39], v[164:167], v[76:79]
  ds_read_b64_tr_b16 v[32:33], v217 offset:8192
  ds_read_b64_tr_b16 v[34:35], v217 offset:9216
  v_mfma_f32_16x16x32_bf16 v[80:83], v[40:43], v[160:163], v[80:83]
  s_add_u32 m0, s43, 65536
  v_accvgpr_mov_b32 a40, a104
  v_accvgpr_mov_b32 a41, a105
  v_mfma_f32_16x16x32_bf16 v[88:91], v[40:43], v[164:167], v[88:91]
  ds_read_b64_tr_b16 v[36:37], v218 offset:8192
  ds_read_b64_tr_b16 v[38:39], v218 offset:9216
  v_mfma_f32_16x16x32_bf16 v[84:87], v[44:47], v[160:163], v[84:87]
  buffer_load_dwordx4 v4, s[24:27], s44 offen offset:0 sc1 lds
  v_accvgpr_mov_b32 a42, a106
  v_accvgpr_read_b32 v13, a165
  v_mfma_f32_16x16x32_bf16 v[92:95], v[44:47], v[164:167], v[92:95]
  s_waitcnt lgkmcnt(8)
  ds_read_b64_tr_b16 v[40:41], v219 offset:8192
  ds_read_b64_tr_b16 v[42:43], v219 offset:9216
  v_mfma_f32_16x16x32_bf16 v[224:227], v[48:51], v[160:163], v[224:227]
  buffer_load_dwordx4 v4, s[24:27], s44 offen offset:1024 sc1 lds
  v_accvgpr_mov_b32 a43, a107
  v_accvgpr_mov_b32 a44, a108
  v_mfma_f32_16x16x32_bf16 v[232:235], v[48:51], v[164:167], v[232:235]
  ds_read_b64_tr_b16 v[44:45], v220 offset:8192
  ds_read_b64_tr_b16 v[46:47], v220 offset:9216
  v_mfma_f32_16x16x32_bf16 v[228:231], v[52:55], v[160:163], v[228:231]
  s_waitcnt lgkmcnt(8)
  buffer_load_dwordx4 v4, s[24:27], s44 offen offset:2048 sc1 lds
  v_accvgpr_mov_b32 a45, a109
  v_mfma_f32_16x16x32_bf16 v[236:239], v[52:55], v[164:167], v[236:239]
  ds_read_b64_tr_b16 v[48:49], v221 offset:8192
  ds_read_b64_tr_b16 v[50:51], v221 offset:9216
  v_mfma_f32_16x16x32_bf16 v[240:243], v[56:59], v[160:163], v[240:243]
  buffer_load_dwordx4 v4, s[24:27], s44 offen offset:3072 sc1 lds
  v_accvgpr_mov_b32 a46, a110
  v_accvgpr_read_b32 v14, a166
  v_mfma_f32_16x16x32_bf16 v[248:251], v[56:59], v[164:167], v[248:251]
  ds_read_b64_tr_b16 v[52:53], v222 offset:8192
  ds_read_b64_tr_b16 v[54:55], v222 offset:9216
  v_mfma_f32_16x16x32_bf16 v[64:67], v[60:63], v[168:171], v[64:67]
  s_waitcnt lgkmcnt(8)
  v_mov_b32 v102, 0
  v_accvgpr_mov_b32 a47, a111
  v_mfma_f32_16x16x32_bf16 v[72:75], v[60:63], v[172:175], v[72:75]
  ds_read_b64_tr_b16 v[56:57], v216 offset:16384
  ds_read_b64_tr_b16 v[58:59], v216 offset:17408
  v_mfma_f32_16x16x32_bf16 v[68:71], v[32:35], v[168:171], v[68:71]
  s_mov_b32 s45, 917504
  s_cmp_gt_u32 s34, 1
  s_cselect_b32 s45, 1015808, s45
  s_add_u32 s45, s45, s42
  ds_read_b64_tr_b16 v[60:61], v217 offset:16384
  ds_read_b64_tr_b16 v[62:63], v217 offset:17408
  v_mfma_f32_16x16x32_bf16 v[76:79], v[32:35], v[172:175], v[76:79]
  s_mov_b32 s75, 0
  buffer_load_dwordx2 v[100:101], v102, s[16:19], s74 offen sc1
  v_accvgpr_read_b32 v15, a167
  v_mfma_f32_16x16x32_bf16 v[80:83], v[36:39], v[168:171], v[80:83]
  s_add_u32 m0, s43, 16384
  v_accvgpr_mov_b32 a48, a112
  v_accvgpr_mov_b32 a49, a113
  v_mfma_f32_16x16x32_bf16 v[88:91], v[36:39], v[172:175], v[88:91]
  s_waitcnt lgkmcnt(8)
  ds_read_b64_tr_b16 v[32:33], v218 offset:16384
  ds_read_b64_tr_b16 v[34:35], v218 offset:17408
  v_mfma_f32_16x16x32_bf16 v[84:87], v[40:43], v[168:171], v[84:87]
  buffer_load_dwordx4 v3, s[24:27], s45 offen offset:0 sc1 lds
  v_accvgpr_mov_b32 a50, a114
  v_mov_b64 v[156:157], 0
  v_mfma_f32_16x16x32_bf16 v[92:95], v[40:43], v[172:175], v[92:95]
  ds_read_b64_tr_b16 v[36:37], v219 offset:16384
  ds_read_b64_tr_b16 v[38:39], v219 offset:17408
  v_mfma_f32_16x16x32_bf16 v[224:227], v[44:47], v[168:171], v[224:227]
  buffer_load_dwordx4 v3, s[24:27], s45 offen offset:1024 sc1 lds
  v_accvgpr_mov_b32 a51, a115
  v_cvt_pk_bf16_f32 v16, v8, v9
  v_mfma_f32_16x16x32_bf16 v[232:235], v[44:47], v[172:175], v[232:235]
  s_waitcnt lgkmcnt(8)
  ds_read_b64_tr_b16 v[40:41], v220 offset:16384
  ds_read_b64_tr_b16 v[42:43], v220 offset:17408
  v_mfma_f32_16x16x32_bf16 v[228:231], v[48:51], v[168:171], v[228:231]
  buffer_load_dwordx4 v3, s[24:27], s45 offen offset:2048 sc1 lds
  v_accvgpr_mov_b32 a52, a116
  v_accvgpr_mov_b32 a53, a117
  v_mfma_f32_16x16x32_bf16 v[236:239], v[48:51], v[172:175], v[236:239]
  ds_read_b64_tr_b16 v[44:45], v221 offset:16384
  ds_read_b64_tr_b16 v[46:47], v221 offset:17408
  v_mfma_f32_16x16x32_bf16 v[240:243], v[52:55], v[168:171], v[240:243]
  s_waitcnt lgkmcnt(8)
  buffer_load_dwordx4 v3, s[24:27], s45 offen offset:3072 sc1 lds
  v_accvgpr_mov_b32 a54, a118
  v_mfma_f32_16x16x32_bf16 v[248:251], v[52:55], v[172:175], v[248:251]
  ds_read_b64_tr_b16 v[48:49], v222 offset:16384
  ds_read_b64_tr_b16 v[50:51], v222 offset:17408
  v_mfma_f32_16x16x32_bf16 v[64:67], v[56:59], v[176:179], v[64:67]
  v_accvgpr_mov_b32 a55, a119
  v_accvgpr_mov_b32 a56, a120
  v_cvt_pk_bf16_f32 v17, v10, v11
  v_mfma_f32_16x16x32_bf16 v[72:75], v[56:59], v[180:183], v[72:75]
  ds_read_b64_tr_b16 v[52:53], v216 offset:24576
  ds_read_b64_tr_b16 v[54:55], v216 offset:25600
  v_mfma_f32_16x16x32_bf16 v[68:71], v[60:63], v[176:179], v[68:71]
  s_add_u32 m0, s43, 81920
  v_accvgpr_mov_b32 a57, a121
  v_accvgpr_mov_b32 a58, a122
  v_mfma_f32_16x16x32_bf16 v[76:79], v[60:63], v[180:183], v[76:79]
  s_waitcnt lgkmcnt(8)
  ds_read_b64_tr_b16 v[56:57], v217 offset:24576
  ds_read_b64_tr_b16 v[58:59], v217 offset:25600
  v_mfma_f32_16x16x32_bf16 v[80:83], v[32:35], v[176:179], v[80:83]
  buffer_load_dwordx4 v4, s[24:27], s45 offen offset:0 sc1 lds
  v_accvgpr_mov_b32 a59, a123
  v_cvt_pk_bf16_f32 v18, v12, v13
  v_mfma_f32_16x16x32_bf16 v[88:91], v[32:35], v[180:183], v[88:91]
  ds_read_b64_tr_b16 v[60:61], v218 offset:24576
  ds_read_b64_tr_b16 v[62:63], v218 offset:25600
  v_mfma_f32_16x16x32_bf16 v[84:87], v[36:39], v[176:179], v[84:87]
  buffer_load_dwordx4 v4, s[24:27], s45 offen offset:1024 sc1 lds
  v_accvgpr_mov_b32 a60, a124
  v_accvgpr_mov_b32 a61, a125
  v_mfma_f32_16x16x32_bf16 v[92:95], v[36:39], v[180:183], v[92:95]
  s_waitcnt lgkmcnt(8)
  ds_read_b64_tr_b16 v[32:33], v219 offset:24576
  ds_read_b64_tr_b16 v[34:35], v219 offset:25600
  v_mfma_f32_16x16x32_bf16 v[224:227], v[40:43], v[176:179], v[224:227]
  buffer_load_dwordx4 v4, s[24:27], s45 offen offset:2048 sc1 lds
  v_accvgpr_mov_b32 a62, a126
  v_mov_b64 v[158:159], 0
  v_mfma_f32_16x16x32_bf16 v[232:235], v[40:43], v[180:183], v[232:235]
  ds_read_b64_tr_b16 v[36:37], v220 offset:24576
  ds_read_b64_tr_b16 v[38:39], v220 offset:25600
  v_mfma_f32_16x16x32_bf16 v[228:231], v[44:47], v[176:179], v[228:231]
  buffer_load_dwordx4 v4, s[24:27], s45 offen offset:3072 sc1 lds
  v_accvgpr_mov_b32 a63, a127
  v_cvt_pk_bf16_f32 v19, v14, v15
  v_mfma_f32_16x16x32_bf16 v[236:239], v[44:47], v[180:183], v[236:239]
  s_waitcnt lgkmcnt(8)
  ds_read_b64_tr_b16 v[40:41], v221 offset:24576
  ds_read_b64_tr_b16 v[42:43], v221 offset:25600
  v_mfma_f32_16x16x32_bf16 v[240:243], v[48:51], v[176:179], v[240:243]
  ds_read_b64_tr_b16 v[44:45], v222 offset:24576
  ds_read_b64_tr_b16 v[46:47], v222 offset:25600
  buffer_store_dwordx4 v[16:19], v1, s[16:19], s61 offen offset:0 sc1
  v_mfma_f32_16x16x32_bf16 v[248:251], v[48:51], v[180:183], v[248:251]
  v_accvgpr_read_b32 v8, a168
  v_mov_b64 v[160:161], 0
  v_mfma_f32_16x16x32_bf16 v[64:67], v[52:55], v[184:187], v[64:67]
  s_barrier
  s_cmp_lt_u32 s33, 8
  s_cbranch_scc1 M_EQ
M_EQ_RET:
  v_mfma_f32_16x16x32_bf16 v[72:75], v[52:55], v[188:191], v[72:75]
  s_waitcnt lgkmcnt(8)
  ds_read_b64_tr_b16 v[48:49], v216 offset:32768
  ds_read_b64_tr_b16 v[50:51], v216 offset:33792
  v_mfma_f32_16x16x32_bf16 v[68:71], v[56:59], v[184:187], v[68:71]
  v_accvgpr_read_b32 v9, a169
  v_accvgpr_read_b32 v10, a170
  v_accvgpr_read_b32 v11, a171
  v_mfma_f32_16x16x32_bf16 v[76:79], v[56:59], v[188:191], v[76:79]
  ds_read_b64_tr_b16 v[52:53], v217 offset:32768
  ds_read_b64_tr_b16 v[54:55], v217 offset:33792
  v_mfma_f32_16x16x32_bf16 v[80:83], v[60:63], v[184:187], v[80:83]
  s_mov_b32 s46, 884736
  s_cmp_gt_u32 s34, 2
  s_cselect_b32 s46, 1048576, s46
  s_add_u32 s46, s46, s42
  v_accvgpr_read_b32 v12, a172
  v_mov_b64 v[168:169], 0
  v_mfma_f32_16x16x32_bf16 v[88:91], v[60:63], v[188:191], v[88:91]
  s_waitcnt lgkmcnt(8)
  ds_read_b64_tr_b16 v[56:57], v218 offset:32768
  ds_read_b64_tr_b16 v[58:59], v218 offset:33792
  v_mfma_f32_16x16x32_bf16 v[84:87], v[32:35], v[184:187], v[84:87]
  s_add_u32 m0, s43, 32768
  v_accvgpr_read_b32 v14, a174
  v_accvgpr_read_b32 v15, a175
  v_mfma_f32_16x16x32_bf16 v[92:95], v[32:35], v[188:191], v[92:95]
  ds_read_b64_tr_b16 v[60:61], v219 offset:32768
  ds_read_b64_tr_b16 v[62:63], v219 offset:33792
  v_accvgpr_read_b32 v13, a173
  v_mfma_f32_16x16x32_bf16 v[224:227], v[36:39], v[184:187], v[224:227]
  v_cvt_pk_bf16_f32 v16, v8, v9
  v_cvt_pk_bf16_f32 v17, v10, v11
  v_mov_b64 v[170:171], 0
  v_mfma_f32_16x16x32_bf16 v[232:235], v[36:39], v[188:191], v[232:235]
  s_waitcnt lgkmcnt(8)
  ds_read_b64_tr_b16 v[32:33], v220 offset:32768
  ds_read_b64_tr_b16 v[34:35], v220 offset:33792
  v_mfma_f32_16x16x32_bf16 v[228:231], v[40:43], v[184:187], v[228:231]
  buffer_load_dwordx4 v3, s[24:27], s46 offen offset:0 sc1 lds
  v_cvt_pk_bf16_f32 v18, v12, v13
  v_cvt_pk_bf16_f32 v19, v14, v15
  v_mfma_f32_16x16x32_bf16 v[236:239], v[40:43], v[188:191], v[236:239]
  ds_read_b64_tr_b16 v[36:37], v221 offset:32768
  ds_read_b64_tr_b16 v[38:39], v221 offset:33792
  v_mfma_f32_16x16x32_bf16 v[240:243], v[44:47], v[184:187], v[240:243]
  s_waitcnt lgkmcnt(8)
  buffer_load_dwordx4 v3, s[24:27], s46 offen offset:1024 sc1 lds
  ds_read_b64_tr_b16 v[40:41], v222 offset:32768
  v_mfma_f32_16x16x32_bf16 v[248:251], v[44:47], v[188:191], v[248:251]
  ds_read_b64_tr_b16 v[42:43], v222 offset:33792
  buffer_store_dwordx4 v[16:19], v1, s[16:19], s61 offen offset:1024 sc1
  v_mov_b64 v[172:173], 0
  v_mfma_f32_16x16x32_bf16 v[64:67], v[48:51], v[192:195], v[64:67]
  v_accvgpr_read_b32 v8, a176
  v_accvgpr_read_b32 v9, a177
  v_accvgpr_read_b32 v10, a178
  v_mfma_f32_16x16x32_bf16 v[72:75], v[48:51], v[196:199], v[72:75]
  ds_read_b64_tr_b16 v[44:45], v216 offset:40960
  ds_read_b64_tr_b16 v[46:47], v216 offset:41984
  v_mfma_f32_16x16x32_bf16 v[68:71], v[52:55], v[192:195], v[68:71]
  buffer_load_dwordx4 v3, s[24:27], s46 offen offset:2048 sc1 lds
  v_accvgpr_read_b32 v11, a179
  v_mov_b64 v[174:175], 0
  v_mfma_f32_16x16x32_bf16 v[76:79], v[52:55], v[196:199], v[76:79]
  s_waitcnt lgkmcnt(8)
  ds_read_b64_tr_b16 v[48:49], v217 offset:40960
  ds_read_b64_tr_b16 v[50:51], v217 offset:41984
  v_mfma_f32_16x16x32_bf16 v[80:83], v[56:59], v[192:195], v[80:83]
  buffer_load_dwordx4 v3, s[24:27], s46 offen offset:3072 sc1 lds
  v_accvgpr_read_b32 v13, a181
  v_mov_b64 v[186:187], 0
  v_mfma_f32_16x16x32_bf16 v[88:91], v[56:59], v[196:199], v[88:91]
  ds_read_b64_tr_b16 v[52:53], v218 offset:40960
  ds_read_b64_tr_b16 v[54:55], v218 offset:41984
  v_accvgpr_read_b32 v12, a180
  v_mfma_f32_16x16x32_bf16 v[84:87], v[60:63], v[192:195], v[84:87]
  v_accvgpr_read_b32 v14, a182
  v_accvgpr_read_b32 v15, a183
  v_mov_b64 v[176:177], 0
  v_mfma_f32_16x16x32_bf16 v[92:95], v[60:63], v[196:199], v[92:95]
  s_waitcnt lgkmcnt(8)
  ds_read_b64_tr_b16 v[56:57], v219 offset:40960
  ds_read_b64_tr_b16 v[58:59], v219 offset:41984
  v_mfma_f32_16x16x32_bf16 v[224:227], v[32:35], v[192:195], v[224:227]
  s_mov_b32 s47, 851968
  s_cmp_gt_u32 s34, 3
  s_cselect_b32 s47, 1081344, s47
  s_add_u32 s47, s47, s42
  v_cvt_pk_bf16_f32 v17, v10, v11
  v_mov_b64 v[188:189], 0
  v_mfma_f32_16x16x32_bf16 v[232:235], v[32:35], v[196:199], v[232:235]
  ds_read_b64_tr_b16 v[60:61], v220 offset:40960
  ds_read_b64_tr_b16 v[62:63], v220 offset:41984
  v_cvt_pk_bf16_f32 v16, v8, v9
  v_mfma_f32_16x16x32_bf16 v[228:231], v[36:39], v[192:195], v[228:231]
  s_add_u32 m0, s43, 49152
  v_cvt_pk_bf16_f32 v18, v12, v13
  v_cvt_pk_bf16_f32 v19, v14, v15
  v_mov_b64 v[184:185], 0
  v_mfma_f32_16x16x32_bf16 v[236:239], v[36:39], v[196:199], v[236:239]
  s_waitcnt lgkmcnt(8)
  ds_read_b64_tr_b16 v[32:33], v221 offset:40960
  ds_read_b64_tr_b16 v[34:35], v221 offset:41984
  v_mfma_f32_16x16x32_bf16 v[240:243], v[40:43], v[192:195], v[240:243]
  ds_read_b64_tr_b16 v[36:37], v222 offset:40960
  ds_read_b64_tr_b16 v[38:39], v222 offset:41984
  buffer_store_dwordx4 v[16:19], v1, s[16:19], s61 offen offset:2048 sc1
  v_mfma_f32_16x16x32_bf16 v[248:251], v[40:43], v[196:199], v[248:251]
  v_accvgpr_read_b32 v8, a184
  v_accvgpr_read_b32 v9, a185
  v_mov_b64 v[190:191], 0
  v_mfma_f32_16x16x32_bf16 v[64:67], v[44:47], v[200:203], v[64:67]
  buffer_load_dwordx4 v3, s[24:27], s47 offen offset:0 sc1 lds
  v_accvgpr_read_b32 v12, a188
  v_mov_b64 v[178:179], 0
  v_mfma_f32_16x16x32_bf16 v[72:75], v[44:47], v[204:207], v[72:75]
  s_waitcnt lgkmcnt(8)
  v_accvgpr_read_b32 v10, a186
  v_accvgpr_read_b32 v11, a187
  v_mfma_f32_16x16x32_bf16 v[68:71], v[48:51], v[200:203], v[68:71]
  buffer_load_dwordx4 v3, s[24:27], s47 offen offset:1024 sc1 lds
  v_cvt_pk_bf16_f32 v16, v8, v9
  v_mov_b64 v[192:193], 0
  v_mfma_f32_16x16x32_bf16 v[76:79], v[48:51], v[204:207], v[76:79]
  v_accvgpr_read_b32 v13, a189
  v_accvgpr_read_b32 v14, a190
  v_accvgpr_read_b32 v15, a191
  v_mfma_f32_16x16x32_bf16 v[80:83], v[52:55], v[200:203], v[80:83]
  v_cvt_pk_bf16_f32 v17, v10, v11
  v_cvt_pk_bf16_f32 v18, v12, v13
  v_cvt_pk_bf16_f32 v19, v14, v15
  v_mfma_f32_16x16x32_bf16 v[88:91], v[52:55], v[204:207], v[88:91]
  s_waitcnt lgkmcnt(4)
  buffer_store_dwordx4 v[16:19], v1, s[16:19], s61 offen offset:3072 sc1
  v_mov_b64 v[180:181], 0
  v_mfma_f32_16x16x32_bf16 v[84:87], v[56:59], v[200:203], v[84:87]
  buffer_load_dwordx4 v3, s[24:27], s47 offen offset:2048 sc1 lds
  v_mov_b64 v[162:163], 0
  v_mov_b64 v[194:195], 0
  v_mfma_f32_16x16x32_bf16 v[92:95], v[56:59], v[204:207], v[92:95]
  v_mov_b64 v[132:133], 0
  v_mov_b64 v[140:141], 0
  v_mov_b64 v[148:149], 0
  v_mfma_f32_16x16x32_bf16 v[224:227], v[60:63], v[200:203], v[224:227]
  buffer_load_dwordx4 v3, s[24:27], s47 offen offset:3072 sc1 lds
  v_mov_b64 v[154:155], 0
  v_mov_b64 v[182:183], 0
  v_mfma_f32_16x16x32_bf16 v[232:235], v[60:63], v[204:207], v[232:235]
  s_waitcnt lgkmcnt(0)
  v_mov_b64 v[138:139], 0
  v_mov_b64 v[146:147], 0
  v_mfma_f32_16x16x32_bf16 v[228:231], v[32:35], v[200:203], v[228:231]
  v_mov_b64 v[150:151], 0
  v_mov_b64 v[164:165], 0
  v_mov_b64 v[196:197], 0
  v_mfma_f32_16x16x32_bf16 v[236:239], v[32:35], v[204:207], v[236:239]
  v_mov_b64 v[128:129], 0
  v_mov_b64 v[134:135], 0
  v_mov_b64 v[142:143], 0
  v_mfma_f32_16x16x32_bf16 v[240:243], v[36:39], v[200:203], v[240:243]
  v_mov_b64 v[152:153], 0
  v_mov_b64 v[166:167], 0
  v_mov_b64 v[198:199], 0
  v_mfma_f32_16x16x32_bf16 v[248:251], v[36:39], v[204:207], v[248:251]
  v_mov_b64 v[130:131], 0
  v_mov_b64 v[136:137], 0
  v_mov_b64 v[144:145], 0
  s_cmp_eq_u32 s72, 1
  s_cbranch_scc0 M_LATE
M_LATE_RET:
  s_cmp_lt_u32 s33, 8
  s_cbranch_scc1 M_GETQ
M_GETQ_RET:
  v_mov_b32 v20, 0x41800000
  v_mov_b32 v21, 0x41800000
  v_pk_mul_f32 v[64:65], v[64:65], v[20:21]
  v_pk_mul_f32 v[66:67], v[66:67], v[20:21]
  v_pk_mul_f32 v[68:69], v[68:69], v[20:21]
  v_pk_mul_f32 v[70:71], v[70:71], v[20:21]
  v_pk_mul_f32 v[72:73], v[72:73], v[20:21]
  v_pk_mul_f32 v[74:75], v[74:75], v[20:21]
  v_pk_mul_f32 v[76:77], v[76:77], v[20:21]
  v_pk_mul_f32 v[78:79], v[78:79], v[20:21]
  v_pk_mul_f32 v[80:81], v[80:81], v[20:21]
  v_pk_mul_f32 v[82:83], v[82:83], v[20:21]
  v_pk_mul_f32 v[84:85], v[84:85], v[20:21]
  v_pk_mul_f32 v[86:87], v[86:87], v[20:21]
  v_pk_mul_f32 v[88:89], v[88:89], v[20:21]
  v_pk_mul_f32 v[90:91], v[90:91], v[20:21]
  v_pk_mul_f32 v[92:93], v[92:93], v[20:21]
  v_pk_mul_f32 v[94:95], v[94:95], v[20:21]
  v_pk_mul_f32 v[224:225], v[224:225], v[20:21]
  v_pk_mul_f32 v[226:227], v[226:227], v[20:21]
  v_pk_mul_f32 v[228:229], v[228:229], v[20:21]
  v_pk_mul_f32 v[230:231], v[230:231], v[20:21]
  v_pk_mul_f32 v[232:233], v[232:233], v[20:21]
  v_pk_mul_f32 v[234:235], v[234:235], v[20:21]
  v_pk_mul_f32 v[236:237], v[236:237], v[20:21]
  v_pk_mul_f32 v[238:239], v[238:239], v[20:21]
  v_pk_mul_f32 v[240:241], v[240:241], v[20:21]
  v_pk_mul_f32 v[242:243], v[242:243], v[20:21]
  v_pk_mul_f32 v[248:249], v[248:249], v[20:21]
  v_pk_mul_f32 v[250:251], v[250:251], v[20:21]
  s_waitcnt vmcnt(20)
  v_cvt_pk_bf16_f32 v100, v64, v65
  v_cvt_pk_bf16_f32 v101, v66, v67
  v_cvt_pk_bf16_f32 v102, v68, v69
  v_cvt_pk_bf16_f32 v103, v70, v71
  v_cvt_pk_bf16_f32 v104, v72, v73
  v_cvt_pk_bf16_f32 v105, v74, v75
  v_cvt_pk_bf16_f32 v106, v76, v77
  v_cvt_pk_bf16_f32 v107, v78, v79
  v_cvt_pk_bf16_f32 v108, v80, v81
  v_cvt_pk_bf16_f32 v109, v82, v83
  v_cvt_pk_bf16_f32 v110, v84, v85
  v_cvt_pk_bf16_f32 v111, v86, v87
  v_cvt_pk_bf16_f32 v112, v88, v89
  v_cvt_pk_bf16_f32 v113, v90, v91
  v_cvt_pk_bf16_f32 v114, v92, v93
  v_cvt_pk_bf16_f32 v115, v94, v95
  v_cvt_pk_bf16_f32 v116, v224, v225
  v_cvt_pk_bf16_f32 v117, v226, v227
  v_cvt_pk_bf16_f32 v118, v228, v229
  v_cvt_pk_bf16_f32 v119, v230, v231
  v_cvt_pk_bf16_f32 v120, v232, v233
  v_cvt_pk_bf16_f32 v121, v234, v235
  v_cvt_pk_bf16_f32 v122, v236, v237
  v_cvt_pk_bf16_f32 v123, v238, v239
  v_cvt_pk_bf16_f32 v124, v240, v241
  v_cvt_pk_bf16_f32 v125, v242, v243
  v_cvt_pk_bf16_f32 v126, v248, v249
  v_cvt_pk_bf16_f32 v127, v250, v251
  s_mov_b32 s24, s82
  s_mov_b32 s25, s83
  s_mov_b32 s26, 0x1c0000
  s_mov_b32 s27, 0x20000
  s_mul_i32 s5, s33, 14336
  s_mul_i32 s6, s3, 3584
  s_add_u32 s5, s5, s6
  s_mul_i32 s6, s32, 229376
  s_add_u32 s83, s5, s6
  v_lshrrev_b32 v18, 4, v0
  v_lshlrev_b32 v97, 7, v18
  s_mul_i32 s5, s33, 6272
  s_mul_i32 s6, s3, 1664
  s_add_u32 s5, s5, s6
  s_mul_i32 s6, s32, 100352
  s_add_u32 s84, s5, s6
  v_lshrrev_b32 v18, 5, v0
  v_lshlrev_b32 v98, 7, v18
  v_add_u32 v10, 0x10000, v1
  v_and_b32 v18, 15, v0
  v_lshrrev_b32 v19, 4, v0
  v_lshlrev_b32 v19, 2, v19
  v_sub_u32 v13, v18, v19
  v_mov_b32 v14, 0xf149f2ca
  v_cmp_le_i32 s[64:65], 0, v13
  v_cmp_le_i32 s[66:67], 1, v13
  v_cmp_le_i32 s[68:69], 2, v13
  v_cmp_le_i32 s[70:71], 3, v13
  s_mov_b32 s82, 0x3fb8aa3b
  s_cmp_eq_u32 s3, 0
  s_cselect_b32 s78, 2, 0
  s_mul_i32 s5, s3, 7168
  s_add_u32 s5, s5, 0x20000
  v_add_u32 v11, s5, v1
  s_getpc_b64 s[80:81]
M_PC_A:
  s_lshr_b32 s7, s2, 3
  s_lshl_b32 s7, s7, 2
  s_add_u32 s7, s7, s3
  s_mul_i32 s7, s7, 512
  v_min_u32 v99, 3, v0
  v_lshl_add_u32 v99, v99, 7, s7
  v_min_u32 v99, M_CODE_END-M_PC_A-8, v99
  v_mov_b64 v[200:201], 0
  v_mov_b64 v[202:203], 0
  v_mov_b64 v[204:205], 0
  v_mov_b64 v[206:207], 0
  v_mov_b64 v[208:209], 0
  v_mov_b64 v[210:211], 0
  v_mov_b64 v[212:213], 0
  v_mov_b64 v[214:215], 0
  v_mov_b64 v[216:217], 0
  v_mov_b64 v[218:219], 0
  v_mov_b64 v[220:221], 0
  v_mov_b64 v[222:223], 0
  v_mov_b64 v[224:225], 0
  v_mov_b64 v[226:227], 0
  v_mov_b64 v[228:229], 0
  v_mov_b64 v[230:231], 0
  v_mov_b64 v[232:233], 0
  v_mov_b64 v[234:235], 0
  v_mov_b64 v[236:237], 0
  v_mov_b64 v[238:239], 0
  v_mov_b64 v[240:241], 0
  v_mov_b64 v[242:243], 0
  v_mov_b64 v[244:245], 0
  v_mov_b64 v[246:247], 0
  v_mov_b64 v[248:249], 0
  v_mov_b64 v[250:251], 0
  v_mov_b64 v[252:253], 0
  v_mov_b64 v[254:255], 0
  v_mov_b64 v[80:81], 0
  v_mov_b64 v[82:83], 0
  v_mov_b64 v[84:85], 0
  v_mov_b64 v[86:87], 0
  v_mov_b64 v[8:9], 0
  s_cmp_lt_u32 s33, 8
  s_cbranch_scc1 M_WAITQ
M_WAITQ_RET:
  s_barrier
  ds_write_b128 v11, v[100:103] offset:0
  ds_write_b128 v11, v[104:107] offset:1024
  ds_write_b128 v11, v[108:111] offset:2048
  ds_write_b128 v11, v[112:115] offset:3072
  ds_write_b128 v11, v[116:119] offset:4096
  ds_write_b128 v11, v[120:123] offset:5120
  ds_write_b128 v11, v[124:127] offset:6144
  ds_read_b128 a[128:131], v1 offset:0
  ds_read_b128 a[132:135], v1 offset:1024
  ds_read_b128 a[136:139], v1 offset:2048
  ds_read_b128 a[140:143], v1 offset:3072
  ds_read_b128 a[144:147], v1 offset:4096
  ds_read_b128 a[148:151], v1 offset:5120
  ds_read_b128 a[152:155], v1 offset:6144
  ds_read_b128 a[156:159], v1 offset:7168
  ds_read_b128 a[160:163], v1 offset:8192
  ds_read_b128 a[164:167], v1 offset:9216
  ds_read_b128 a[168:171], v1 offset:10240
  ds_read_b128 a[172:175], v1 offset:11264
  ds_read_b128 a[176:179], v1 offset:12288
  ds_read_b128 a[180:183], v1 offset:13312
  s_waitcnt lgkmcnt(6)
  v_mfma_f32_16x16x32_bf16 v[32:35], a[128:131], a[0:3], v[80:83]
  ds_read_b128 a[184:187], v1 offset:14336
  v_mfma_f32_16x16x32_bf16 v[40:43], a[128:131], a[4:7], v[84:87]
  v_mfma_f32_16x16x32_bf16 v[36:39], a[132:135], a[0:3], v[80:83]
  ds_read_b128 a[188:191], v1 offset:15360
  v_mfma_f32_16x16x32_bf16 v[44:47], a[132:135], a[4:7], v[84:87]
  v_mfma_f32_16x16x32_bf16 v[32:35], a[136:139], a[8:11], v[32:35]
  s_waitcnt vmcnt(16)
  s_waitcnt lgkmcnt(0)
  v_mfma_f32_16x16x32_bf16 v[40:43], a[136:139], a[12:15], v[40:43]
  s_barrier
  ds_read_b128 a[128:131], v1 offset:16384
  v_mfma_f32_16x16x32_bf16 v[36:39], a[140:143], a[8:11], v[36:39]
  ds_read_b128 a[132:135], v1 offset:17408
  v_mfma_f32_16x16x32_bf16 v[44:47], a[140:143], a[12:15], v[44:47]
  v_mfma_f32_16x16x32_bf16 v[32:35], a[144:147], a[16:19], v[32:35]
  ds_read_b128 a[136:139], v1 offset:18432
  v_mfma_f32_16x16x32_bf16 v[40:43], a[144:147], a[20:23], v[40:43]
  v_mfma_f32_16x16x32_bf16 v[36:39], a[148:151], a[16:19], v[36:39]
  ds_read_b128 a[140:143], v1 offset:19456
  v_mfma_f32_16x16x32_bf16 v[44:47], a[148:151], a[20:23], v[44:47]
  v_mfma_f32_16x16x32_bf16 v[32:35], a[152:155], a[24:27], v[32:35]
  ds_read_b128 a[144:147], v1 offset:20480
  v_mfma_f32_16x16x32_bf16 v[40:43], a[152:155], a[28:31], v[40:43]
  v_mfma_f32_16x16x32_bf16 v[36:39], a[156:159], a[24:27], v[36:39]
  ds_read_b128 a[148:151], v1 offset:21504
  v_mfma_f32_16x16x32_bf16 v[44:47], a[156:159], a[28:31], v[44:47]
  v_mfma_f32_16x16x32_bf16 v[32:35], a[160:163], a[32:35], v[32:35]
  ds_read_b128 a[152:155], v1 offset:22528
  v_mfma_f32_16x16x32_bf16 v[40:43], a[160:163], a[36:39], v[40:43]
  v_mfma_f32_16x16x32_bf16 v[36:39], a[164:167], a[32:35], v[36:39]
  ds_read_b128 a[156:159], v1 offset:23552
  v_mfma_f32_16x16x32_bf16 v[44:47], a[164:167], a[36:39], v[44:47]
  v_mfma_f32_16x16x32_bf16 v[32:35], a[168:171], a[40:43], v[32:35]
  ds_read_b128 a[160:163], v1 offset:24576
  v_mfma_f32_16x16x32_bf16 v[40:43], a[168:171], a[44:47], v[40:43]
  v_mfma_f32_16x16x32_bf16 v[36:39], a[172:175], a[40:43], v[36:39]
  ds_read_b128 a[164:167], v1 offset:25600
  v_mfma_f32_16x16x32_bf16 v[44:47], a[172:175], a[44:47], v[44:47]
  v_mfma_f32_16x16x32_bf16 v[32:35], a[176:179], a[48:51], v[32:35]
  ds_read_b128 a[168:171], v1 offset:26624
  v_mfma_f32_16x16x32_bf16 v[40:43], a[176:179], a[52:55], v[40:43]
  v_mfma_f32_16x16x32_bf16 v[36:39], a[180:183], a[48:51], v[36:39]
  ds_read_b128 a[172:175], v1 offset:27648
  v_mfma_f32_16x16x32_bf16 v[44:47], a[180:183], a[52:55], v[44:47]
  v_mfma_f32_16x16x32_bf16 v[32:35], a[184:187], a[56:59], v[32:35]
  ds_read_b128 a[176:179], v1 offset:28672
  v_mfma_f32_16x16x32_bf16 v[40:43], a[184:187], a[60:63], v[40:43]
  v_mfma_f32_16x16x32_bf16 v[36:39], a[188:191], a[56:59], v[36:39]
  ds_read_b128 a[180:183], v1 offset:29696
  v_mfma_f32_16x16x32_bf16 v[44:47], a[188:191], a[60:63], v[44:47]
  s_mov_b32 s44, 819200
  s_cmp_gt_u32 s34, 4
  s_cselect_b32 s44, 1114112, s44
  s_add_u32 s44, s44, s42
  s_cmp_gt_u32 s34, 4
  s_cselect_b32 s38, 0x8000, s52
  s_add_u32 m0, s43, 0
  s_nop 0
  buffer_load_dwordx4 v3, s[16:19], s44 offen offset:0 sc1 lds
  buffer_load_dwordx4 v3, s[16:19], s44 offen offset:1024 sc1 lds
  buffer_load_dwordx4 v3, s[16:19], s44 offen offset:2048 sc1 lds
  buffer_load_dwordx4 v3, s[16:19], s44 offen offset:3072 sc1 lds
  s_mov_b32 s37, 0
  s_branch A_FIRST
A_Q0:
  s_waitcnt lgkmcnt(6)
  v_mfma_f32_16x16x32_bf16 v[48:51], a[128:131], a[0:3], v[80:83]
  s_add_u32 m0, s43, 98304
  ds_read_b128 a[184:187], v1 offset:30720
  ds_read_b128 v[120:123], v11
  v_mfma_f32_16x16x32_bf16 v[56:59], a[128:131], a[4:7], v[84:87]
  v_exp_f32 v32, v32
  v_mfma_f32_16x16x32_bf16 v[52:55], a[132:135], a[0:3], v[80:83]
  ds_read_b128 a[188:191], v1 offset:31744
  buffer_load_dwordx4 v4, s[16:19], s46 offen offset:0 sc1 lds
  v_mfma_f32_16x16x32_bf16 v[60:63], a[132:135], a[4:7], v[84:87]
  s_add_u32 s60, s60, s57
  v_exp_f32 v33, v33
  v_mfma_f32_16x16x32_bf16 v[48:51], a[136:139], a[8:11], v[48:51]
  v_exp_f32 v34, v34
  v_mfma_f32_16x16x32_bf16 v[56:59], a[136:139], a[12:15], v[56:59]
  s_add_u32 s61, s60, 0
  ds_read_b128 a[128:131], v10 offset:0
  v_accvgpr_read_b32 v100, a192
  v_mfma_f32_16x16x32_bf16 v[52:55], a[140:143], a[8:11], v[52:55]
  ds_read_b128 a[132:135], v10 offset:1024
  v_cvt_pk_bf16_f32 v64, v32, v33
  v_add_f32 v8, v8, v32
  v_mfma_f32_16x16x32_bf16 v[60:63], a[140:143], a[12:15], v[60:63]
  v_exp_f32 v35, v35
  v_mfma_f32_16x16x32_bf16 v[48:51], a[144:147], a[16:19], v[48:51]
  ds_read_b128 a[136:139], v10 offset:2048
  v_accvgpr_read_b32 v101, a193
  v_add_f32 v8, v8, v33
  v_mfma_f32_16x16x32_bf16 v[56:59], a[144:147], a[20:23], v[56:59]
  v_exp_f32 v36, v36
  v_mfma_f32_16x16x32_bf16 v[52:55], a[148:151], a[16:19], v[52:55]
  ds_read_b128 a[140:143], v10 offset:3072
  buffer_load_dwordx4 v4, s[16:19], s46 offen offset:1024 sc1 lds
  v_accvgpr_read_b32 v102, a194
  v_mfma_f32_16x16x32_bf16 v[60:63], a[148:151], a[20:23], v[60:63]
  v_exp_f32 v37, v37
  v_mfma_f32_16x16x32_bf16 v[48:51], a[152:155], a[24:27], v[48:51]
  v_exp_f32 v38, v38
  v_add_f32 v8, v8, v34
  v_mfma_f32_16x16x32_bf16 v[56:59], a[152:155], a[28:31], v[56:59]
  ds_read_b128 a[144:147], v10 offset:4096
  v_cvt_pk_bf16_f32 v65, v34, v35
  v_mfma_f32_16x16x32_bf16 v[52:55], a[156:159], a[24:27], v[52:55]
  s_waitcnt lgkmcnt(5)
  ds_read_b128 a[148:151], v10 offset:5120
  v_accvgpr_read_b32 v103, a195
  v_mfma_f32_16x16x32_bf16 v[60:63], a[156:159], a[28:31], v[60:63]
  v_exp_f32 v39, v39
  v_mfma_f32_16x16x32_bf16 v[48:51], a[160:163], a[32:35], v[48:51]
  v_exp_f32 v40, v40
  v_add_f32 v8, v8, v35
  v_mfma_f32_16x16x32_bf16 v[56:59], a[160:163], a[36:39], v[56:59]
  ds_read_b128 a[152:155], v10 offset:6144
  v_cvt_pk_bf16_f32 v66, v36, v37
  v_mfma_f32_16x16x32_bf16 v[52:55], a[164:167], a[32:35], v[52:55]
  ds_read_b128 a[156:159], v10 offset:7168
  buffer_load_dwordx4 v4, s[16:19], s46 offen offset:2048 sc1 lds
  v_add_f32 v8, v8, v36
  v_mfma_f32_16x16x32_bf16 v[60:63], a[164:167], a[36:39], v[60:63]
  v_exp_f32 v41, v41
  v_mfma_f32_16x16x32_bf16 v[48:51], a[168:171], a[40:43], v[48:51]
  v_exp_f32 v42, v42
  v_add_f32 v8, v8, v37
  v_mfma_f32_16x16x32_bf16 v[56:59], a[168:171], a[44:47], v[56:59]
  ds_read_b128 a[160:163], v10 offset:8192
  v_cvt_pk_bf16_f32 v67, v38, v39
  v_mfma_f32_16x16x32_bf16 v[52:55], a[172:175], a[40:43], v[52:55]
  ds_read_b128 a[164:167], v10 offset:9216
  v_accvgpr_read_b32 v104, a196
  v_accvgpr_read_b32 v105, a197
  v_mfma_f32_16x16x32_bf16 v[60:63], a[172:175], a[44:47], v[60:63]
  v_exp_f32 v43, v43
  v_mfma_f32_16x16x32_bf16 v[48:51], a[176:179], a[48:51], v[48:51]
  v_exp_f32 v44, v44
  v_add_f32 v8, v8, v38
  v_mfma_f32_16x16x32_bf16 v[56:59], a[176:179], a[52:55], v[56:59]
  ds_read_b128 a[168:171], v10 offset:10240
  v_cvt_pk_bf16_f32 v68, v40, v41
  v_mfma_f32_16x16x32_bf16 v[52:55], a[180:183], a[48:51], v[52:55]
  ds_read_b128 a[172:175], v10 offset:11264
  buffer_load_dwordx4 v4, s[16:19], s46 offen offset:3072 sc1 lds
  v_add_f32 v8, v8, v39
  v_mfma_f32_16x16x32_bf16 v[60:63], a[180:183], a[52:55], v[60:63]
  v_exp_f32 v45, v45
  v_mfma_f32_16x16x32_bf16 v[48:51], a[184:187], a[56:59], v[48:51]
  v_accvgpr_read_b32 v106, a198
  v_accvgpr_read_b32 v107, a199
  v_add_f32 v9, v9, v40
  v_mfma_f32_16x16x32_bf16 v[56:59], a[184:187], a[60:63], v[56:59]
  ds_read_b128 a[176:179], v10 offset:12288
  v_cvt_pk_bf16_f32 v69, v42, v43
  v_mfma_f32_16x16x32_bf16 v[52:55], a[188:191], a[56:59], v[52:55]
  ds_read_b128 a[180:183], v10 offset:13312
  v_exp_f32 v47, v47
  v_mfma_f32_16x16x32_bf16 v[60:63], a[188:191], a[60:63], v[60:63]
  s_waitcnt lgkmcnt(6)
  v_exp_f32 v46, v46
  v_mfma_f32_16x16x32_bf16 v[128:131], a[128:131], v[64:67], v[128:131]
  v_cvt_pk_bf16_f32 v71, v46, v47
  v_cvt_pk_bf16_f32 v100, v100, v101
  v_add_f32 v9, v9, v41
  v_mfma_f32_16x16x32_bf16 v[132:135], a[132:135], v[64:67], v[132:135]
  ds_read_b128 a[184:187], v10 offset:14336
  v_cvt_pk_bf16_f32 v70, v44, v45
  v_mfma_f32_16x16x32_bf16 v[144:147], a[136:139], v[64:67], v[144:147]
  s_add_u32 s45, s44, s38
  ds_read_b128 a[188:191], v10 offset:15360
  v_cvt_pk_bf16_f32 v101, v102, v103
  v_mfma_f32_16x16x32_bf16 v[148:151], a[140:143], v[64:67], v[148:151]
  v_lshlrev_b32 v124, 16, v120
  v_and_b32 v125, 0xffff0000, v120
  v_mfma_f32_16x16x32_bf16 v[136:139], a[128:131], v[68:71], v[136:139]
  s_waitcnt vmcnt(14)
  s_barrier
  v_cvt_pk_bf16_f32 v103, v106, v107
  v_mfma_f32_16x16x32_bf16 v[140:143], a[132:135], v[68:71], v[140:143]
  ds_read_b128 a[128:131], v1 offset:32768
  v_cvt_pk_bf16_f32 v102, v104, v105
  v_mfma_f32_16x16x32_bf16 v[152:155], a[136:139], v[68:71], v[152:155]
  s_add_u32 m0, s43, 16384
  ds_read_b128 a[132:135], v1 offset:33792
  v_max3_f32 v18, v48, v49, v50
  v_mfma_f32_16x16x32_bf16 v[156:159], a[140:143], v[68:71], v[156:159]
  buffer_store_dwordx4 v[100:103], v1, s[16:19], s61 offen offset:0 sc1
  s_nop 1
  v_accvgpr_read_b32 v100, a200
  v_mfma_f32_16x16x32_bf16 v[160:163], a[144:147], v[64:67], v[160:163]
  ds_read_b128 a[136:139], v1 offset:34816
  buffer_load_dwordx4 v3, s[16:19], s45 offen offset:0 sc1 lds
  v_add_f32 v9, v9, v42
  v_mfma_f32_16x16x32_bf16 v[168:171], a[144:147], v[68:71], v[168:171]
  v_lshlrev_b32 v126, 16, v121
  v_accvgpr_read_b32 v101, a201
  v_mfma_f32_16x16x32_bf16 v[164:167], a[148:151], v[64:67], v[164:167]
  v_and_b32 v127, 0xffff0000, v121
  v_accvgpr_read_b32 v102, a202
  v_add_f32 v9, v9, v43
  v_mfma_f32_16x16x32_bf16 v[172:175], a[148:151], v[68:71], v[172:175]
  ds_read_b128 a[140:143], v1 offset:35840
  v_max3_f32 v19, v51, v52, v53
  v_mfma_f32_16x16x32_bf16 v[176:179], a[152:155], v[64:67], v[176:179]
  v_accvgpr_read_b32 v103, a203
  v_accvgpr_read_b32 v104, a204
  v_add_f32 v9, v9, v44
  v_mfma_f32_16x16x32_bf16 v[184:187], a[152:155], v[68:71], v[184:187]
  ds_read_b128 a[144:147], v1 offset:36864
  v_max3_f32 v20, v54, v55, v56
  v_mfma_f32_16x16x32_bf16 v[180:183], a[156:159], v[64:67], v[180:183]
  s_waitcnt lgkmcnt(5)
  ds_read_b128 a[148:151], v1 offset:37888
  buffer_load_dwordx4 v3, s[16:19], s45 offen offset:1024 sc1 lds
  v_mfma_f32_16x16x32_bf16 v[188:191], a[156:159], v[68:71], v[188:191]
  v_exp_f32 v24, -v124
  v_mfma_f32_16x16x32_bf16 v[192:195], a[160:163], v[64:67], v[192:195]
  v_accvgpr_read_b32 v105, a205
  v_accvgpr_read_b32 v106, a206
  v_add_f32 v9, v9, v45
  v_mfma_f32_16x16x32_bf16 v[200:203], a[160:163], v[68:71], v[200:203]
  ds_read_b128 a[152:155], v1 offset:38912
  v_max3_f32 v21, v57, v58, v59
  v_mfma_f32_16x16x32_bf16 v[196:199], a[164:167], v[64:67], v[196:199]
  v_accvgpr_read_b32 v107, a207
  v_cvt_pk_bf16_f32 v100, v100, v101
  v_cvt_pk_bf16_f32 v101, v102, v103
  v_mfma_f32_16x16x32_bf16 v[204:207], a[164:167], v[68:71], v[204:207]
  ds_read_b128 a[156:159], v1 offset:39936
  v_max3_f32 v22, v60, v61, v62
  v_mfma_f32_16x16x32_bf16 v[208:211], a[168:171], v[64:67], v[208:211]
  ds_read_b128 a[160:163], v1 offset:40960
  buffer_load_dwordx4 v3, s[16:19], s45 offen offset:2048 sc1 lds
  v_add_f32 v9, v9, v46
  v_mfma_f32_16x16x32_bf16 v[216:219], a[168:171], v[68:71], v[216:219]
  v_exp_f32 v25, -v125
  v_mfma_f32_16x16x32_bf16 v[212:215], a[172:175], v[64:67], v[212:215]
  v_cvt_pk_bf16_f32 v102, v104, v105
  v_cvt_pk_bf16_f32 v103, v106, v107
  v_add_f32 v9, v9, v47
  v_mfma_f32_16x16x32_bf16 v[220:223], a[172:175], v[68:71], v[220:223]
  ds_read_b128 a[164:167], v1 offset:41984
  v_max3_f32 v18, v18, v19, v20
  v_mfma_f32_16x16x32_bf16 v[224:227], a[176:179], v[64:67], v[224:227]
  v_exp_f32 v26, -v126
  v_mfma_f32_16x16x32_bf16 v[232:235], a[176:179], v[68:71], v[232:235]
  ds_read_b128 a[168:171], v1 offset:43008
  v_max3_f32 v21, v21, v22, v63
  v_mfma_f32_16x16x32_bf16 v[228:231], a[180:183], v[64:67], v[228:231]
  ds_read_b128 a[172:175], v1 offset:44032
  buffer_load_dwordx4 v3, s[16:19], s45 offen offset:3072 sc1 lds
  buffer_store_dwordx4 v[100:103], v1, s[16:19], s61 offen offset:1024 sc1
  v_mfma_f32_16x16x32_bf16 v[236:239], a[180:183], v[68:71], v[236:239]
  s_nop 0
  v_accvgpr_read_b32 v100, a208
  v_accvgpr_read_b32 v101, a209
  v_mfma_f32_16x16x32_bf16 v[240:243], a[184:187], v[64:67], v[240:243]
  v_exp_f32 v27, -v127
  v_mfma_f32_16x16x32_bf16 v[248:251], a[184:187], v[68:71], v[248:251]
  ds_read_b128 a[176:179], v1 offset:45056
  v_max_f32 v15, v18, v21
  v_mfma_f32_16x16x32_bf16 v[244:247], a[188:191], v[64:67], v[244:247]
  v_accvgpr_read_b32 v102, a210
  v_accvgpr_read_b32 v103, a211
  v_mfma_f32_16x16x32_bf16 v[252:255], a[188:191], v[68:71], v[252:255]
  ds_read_b128 a[180:183], v1 offset:46080
  v_cmp_lt_f32 vcc, s36, v15
  s_cbranch_vccnz A_ST_Q0
A_RET_Q0:
  s_cmp_eq_u32 s35, s49
  s_cbranch_scc1 A_SW1
A_SW1_RET_Q1:
  s_waitcnt lgkmcnt(6)
  v_mfma_f32_16x16x32_bf16 v[32:35], a[128:131], a[0:3], v[80:83]
  s_add_u32 m0, s43, 114688
  ds_read_b128 a[184:187], v1 offset:47104
  v_accvgpr_read_b32 v104, a212
  v_mfma_f32_16x16x32_bf16 v[40:43], a[128:131], a[4:7], v[84:87]
  v_exp_f32 v48, v48
  v_mfma_f32_16x16x32_bf16 v[36:39], a[132:135], a[0:3], v[80:83]
  ds_read_b128 a[188:191], v1 offset:48128
  buffer_load_dwordx4 v4, s[16:19], s47 offen offset:0 sc1 lds
  v_accvgpr_read_b32 v105, a213
  v_mfma_f32_16x16x32_bf16 v[44:47], a[132:135], a[4:7], v[84:87]
  v_exp_f32 v49, v49
  v_mfma_f32_16x16x32_bf16 v[32:35], a[136:139], a[8:11], v[32:35]
  ds_read_b128 a[128:131], v10 offset:16384
  v_accvgpr_read_b32 v106, a214
  v_add_f32 v8, v8, v48
  v_mfma_f32_16x16x32_bf16 v[40:43], a[136:139], a[12:15], v[40:43]
  v_exp_f32 v50, v50
  v_mfma_f32_16x16x32_bf16 v[36:39], a[140:143], a[8:11], v[36:39]
  ds_read_b128 a[132:135], v10 offset:17408
  v_cvt_pk_bf16_f32 v72, v48, v49
  v_accvgpr_read_b32 v107, a215
  v_mfma_f32_16x16x32_bf16 v[44:47], a[140:143], a[12:15], v[44:47]
  v_exp_f32 v51, v51
  v_mfma_f32_16x16x32_bf16 v[32:35], a[144:147], a[16:19], v[32:35]
  ds_read_b128 a[136:139], v10 offset:18432
  v_exp_f32 v53, v53
  v_mfma_f32_16x16x32_bf16 v[40:43], a[144:147], a[20:23], v[40:43]
  v_exp_f32 v52, v52
  v_mfma_f32_16x16x32_bf16 v[36:39], a[148:151], a[16:19], v[36:39]
  ds_read_b128 a[140:143], v10 offset:19456
  buffer_load_dwordx4 v4, s[16:19], s47 offen offset:1024 sc1 lds
  v_add_f32 v8, v8, v49
  v_mfma_f32_16x16x32_bf16 v[44:47], a[148:151], a[20:23], v[44:47]
  v_cvt_pk_bf16_f32 v73, v50, v51
  v_fma_f32 v24, v24, s82, s82
  v_mfma_f32_16x16x32_bf16 v[32:35], a[152:155], a[24:27], v[32:35]
  ds_read_b128 a[144:147], v10 offset:20480
  v_cvt_pk_bf16_f32 v100, v100, v101
  v_cvt_pk_bf16_f32 v101, v102, v103
  v_mfma_f32_16x16x32_bf16 v[40:43], a[152:155], a[28:31], v[40:43]
  v_exp_f32 v54, v54
  v_mfma_f32_16x16x32_bf16 v[36:39], a[156:159], a[24:27], v[36:39]
  s_waitcnt lgkmcnt(5)
  ds_read_b128 a[148:151], v10 offset:21504
  v_cvt_pk_bf16_f32 v74, v52, v53
  v_mfma_f32_16x16x32_bf16 v[44:47], a[156:159], a[28:31], v[44:47]
  v_exp_f32 v55, v55
  v_mfma_f32_16x16x32_bf16 v[32:35], a[160:163], a[32:35], v[32:35]
  ds_read_b128 a[152:155], v10 offset:22528
  v_cvt_pk_bf16_f32 v102, v104, v105
  v_add_f32 v8, v8, v50
  v_mfma_f32_16x16x32_bf16 v[40:43], a[160:163], a[36:39], v[40:43]
  v_exp_f32 v56, v56
  v_mfma_f32_16x16x32_bf16 v[36:39], a[164:167], a[32:35], v[36:39]
  ds_read_b128 a[156:159], v10 offset:23552
  buffer_load_dwordx4 v4, s[16:19], s47 offen offset:2048 sc1 lds
  v_cvt_pk_bf16_f32 v75, v54, v55
  v_mfma_f32_16x16x32_bf16 v[44:47], a[164:167], a[36:39], v[44:47]
  v_exp_f32 v57, v57
  v_mfma_f32_16x16x32_bf16 v[32:35], a[168:171], a[40:43], v[32:35]
  v_exp_f32 v58, v58
  v_cvt_pk_bf16_f32 v103, v106, v107
  v_mfma_f32_16x16x32_bf16 v[40:43], a[168:171], a[44:47], v[40:43]
  ds_read_b128 a[160:163], v10 offset:24576
  buffer_store_dwordx4 v[100:103], v1, s[16:19], s61 offen offset:2048 sc1
  v_mfma_f32_16x16x32_bf16 v[36:39], a[172:175], a[40:43], v[36:39]
  ds_read_b128 a[164:167], v10 offset:25600
  v_cvt_pk_bf16_f32 v76, v56, v57
  v_add_f32 v8, v8, v51
  v_mfma_f32_16x16x32_bf16 v[44:47], a[172:175], a[44:47], v[44:47]
  v_exp_f32 v59, v59
  v_mfma_f32_16x16x32_bf16 v[32:35], a[176:179], a[48:51], v[32:35]
  ds_read_b128 a[168:171], v10 offset:26624
  v_fma_f32 v25, v25, s82, s82
  v_accvgpr_read_b32 v100, a216
  v_mfma_f32_16x16x32_bf16 v[40:43], a[176:179], a[52:55], v[40:43]
  v_exp_f32 v60, v60
  v_mfma_f32_16x16x32_bf16 v[36:39], a[180:183], a[48:51], v[36:39]
  ds_read_b128 a[172:175], v10 offset:27648
  buffer_load_dwordx4 v4, s[16:19], s47 offen offset:3072 sc1 lds
  v_add_f32 v8, v8, v52
  v_mfma_f32_16x16x32_bf16 v[44:47], a[180:183], a[52:55], v[44:47]
  v_exp_f32 v61, v61
  v_mfma_f32_16x16x32_bf16 v[32:35], a[184:187], a[56:59], v[32:35]
  v_exp_f32 v62, v62
  v_accvgpr_read_b32 v101, a217
  v_mfma_f32_16x16x32_bf16 v[40:43], a[184:187], a[60:63], v[40:43]
  ds_read_b128 a[176:179], v10 offset:28672
  v_cvt_pk_bf16_f32 v77, v58, v59
  v_mfma_f32_16x16x32_bf16 v[36:39], a[188:191], a[56:59], v[36:39]
  s_waitcnt lgkmcnt(5)
  ds_read_b128 a[180:183], v10 offset:29696
  buffer_load_dword v2, v97, s[8:11], s83 offen
  v_mfma_f32_16x16x32_bf16 v[44:47], a[188:191], a[60:63], v[44:47]
  v_exp_f32 v63, v63
  v_add_f32 v9, v9, v60
  v_mfma_f32_16x16x32_bf16 v[128:131], a[128:131], v[72:75], v[128:131]
  s_add_u32 s83, s83, 512
  ds_read_b128 a[184:187], v10 offset:30720
  v_add_f32 v9, v9, v61
  v_mfma_f32_16x16x32_bf16 v[132:135], a[132:135], v[72:75], v[132:135]
  v_cvt_pk_bf16_f32 v78, v60, v61
  v_cvt_pk_bf16_f32 v79, v62, v63
  v_accvgpr_read_b32 v102, a218
  v_mfma_f32_16x16x32_bf16 v[144:147], a[136:139], v[72:75], v[144:147]
  s_add_u32 s46, s45, s38
  ds_read_b128 a[188:191], v10 offset:31744
  s_cmp_eq_u32 s35, s39
  s_cselect_b32 s46, s40, s46
  s_cselect_b32 s38, s52, s38
  v_add_f32 v9, v9, v63
  v_mfma_f32_16x16x32_bf16 v[148:151], a[140:143], v[72:75], v[148:151]
  v_fma_f32 v26, v26, s82, s82
  v_accvgpr_read_b32 v103, a219
  v_accvgpr_read_b32 v104, a220
  v_mfma_f32_16x16x32_bf16 v[136:139], a[128:131], v[76:79], v[136:139]
  s_waitcnt vmcnt(12)
  s_barrier
  v_add_f32 v8, v8, v53
  v_mfma_f32_16x16x32_bf16 v[140:143], a[132:135], v[76:79], v[140:143]
  ds_read_b128 a[128:131], v1 offset:49152
  v_accvgpr_read_b32 v105, a221
  v_mfma_f32_16x16x32_bf16 v[152:155], a[136:139], v[76:79], v[152:155]
  s_add_u32 m0, s43, 32768
  ds_read_b128 a[132:135], v1 offset:50176
  s_cmp_eq_u32 s35, 6
  s_cselect_b32 s46, s41, s46
  s_cselect_b32 s38, 0x8000, s38
  v_accvgpr_read_b32 v107, a223
  v_mfma_f32_16x16x32_bf16 v[156:159], a[140:143], v[76:79], v[156:159]
  v_fma_f32 v27, v27, s82, s82
  v_accvgpr_read_b32 v106, a222
  v_mfma_f32_16x16x32_bf16 v[160:163], a[144:147], v[72:75], v[160:163]
  ds_read_b128 a[136:139], v1 offset:51200
  buffer_load_dwordx4 v3, s[16:19], s46 offen offset:0 sc1 lds
  v_add_f32 v8, v8, v54
  v_mfma_f32_16x16x32_bf16 v[168:171], a[144:147], v[76:79], v[168:171]
  v_rcp_f32 v24, v24
  v_mfma_f32_16x16x32_bf16 v[164:167], a[148:151], v[72:75], v[164:167]
  v_cvt_pk_bf16_f32 v100, v100, v101
  v_cvt_pk_bf16_f32 v101, v102, v103
  v_cvt_pk_bf16_f32 v102, v104, v105
  v_mfma_f32_16x16x32_bf16 v[172:175], a[148:151], v[76:79], v[172:175]
  ds_read_b128 a[140:143], v1 offset:52224
  v_max3_f32 v18, v32, v33, v34
  v_mfma_f32_16x16x32_bf16 v[176:179], a[152:155], v[72:75], v[176:179]
  v_rcp_f32 v25, v25
  v_add_f32 v8, v8, v55
  v_mfma_f32_16x16x32_bf16 v[184:187], a[152:155], v[76:79], v[184:187]
  ds_read_b128 a[144:147], v1 offset:53248
  v_max3_f32 v19, v35, v36, v37
  v_mfma_f32_16x16x32_bf16 v[180:183], a[156:159], v[72:75], v[180:183]
  s_waitcnt lgkmcnt(5)
  ds_read_b128 a[148:151], v1 offset:54272
  buffer_load_dwordx4 v3, s[16:19], s46 offen offset:1024 sc1 lds
  v_mfma_f32_16x16x32_bf16 v[188:191], a[156:159], v[76:79], v[188:191]
  v_rcp_f32 v26, v26
  v_add_f32 v9, v9, v62
  v_mfma_f32_16x16x32_bf16 v[192:195], a[160:163], v[72:75], v[192:195]
  ds_read_b128 a[152:155], v1 offset:55296
  v_max3_f32 v20, v38, v39, v40
  v_cvt_pk_bf16_f32 v103, v106, v107
  v_mfma_f32_16x16x32_bf16 v[200:203], a[160:163], v[76:79], v[200:203]
  buffer_store_dwordx4 v[100:103], v1, s[16:19], s61 offen offset:3072 sc1
  s_add_u32 s61, s60, 4096
  s_nop 0
  v_accvgpr_read_b32 v100, a224
  v_mfma_f32_16x16x32_bf16 v[196:199], a[164:167], v[72:75], v[196:199]
  v_max3_f32 v22, v44, v45, v46
  v_accvgpr_read_b32 v101, a225
  v_add_f32 v9, v9, v56
  v_mfma_f32_16x16x32_bf16 v[204:207], a[164:167], v[76:79], v[204:207]
  ds_read_b128 a[156:159], v1 offset:56320
  v_max3_f32 v21, v41, v42, v43
  v_mfma_f32_16x16x32_bf16 v[208:211], a[168:171], v[72:75], v[208:211]
  ds_read_b128 a[160:163], v1 offset:57344
  buffer_load_dwordx4 v3, s[16:19], s46 offen offset:2048 sc1 lds
  v_accvgpr_read_b32 v102, a226
  v_mfma_f32_16x16x32_bf16 v[216:219], a[168:171], v[76:79], v[216:219]
  v_rcp_f32 v27, v27
  v_mfma_f32_16x16x32_bf16 v[212:215], a[172:175], v[72:75], v[212:215]
  v_mul_f32 v24, v24, v124
  v_accvgpr_read_b32 v103, a227
  v_add_f32 v9, v9, v57
  v_mfma_f32_16x16x32_bf16 v[220:223], a[172:175], v[76:79], v[220:223]
  ds_read_b128 a[164:167], v1 offset:58368
  v_max3_f32 v18, v18, v19, v20
  v_mfma_f32_16x16x32_bf16 v[224:227], a[176:179], v[72:75], v[224:227]
  v_mul_f32 v25, v25, v125
  v_accvgpr_read_b32 v104, a228
  v_accvgpr_read_b32 v105, a229
  v_mfma_f32_16x16x32_bf16 v[232:235], a[176:179], v[76:79], v[232:235]
  ds_read_b128 a[168:171], v1 offset:59392
  v_max3_f32 v21, v21, v22, v47
  v_mfma_f32_16x16x32_bf16 v[228:231], a[180:183], v[72:75], v[228:231]
  ds_read_b128 a[172:175], v1 offset:60416
  buffer_load_dwordx4 v3, s[16:19], s46 offen offset:3072 sc1 lds
  v_add_f32 v9, v9, v58
  v_mfma_f32_16x16x32_bf16 v[236:239], a[180:183], v[76:79], v[236:239]
  v_mul_f32 v26, v26, v126
  v_mul_f32 v27, v27, v127
  v_mfma_f32_16x16x32_bf16 v[240:243], a[184:187], v[72:75], v[240:243]
  v_cvt_pk_bf16_f32 v28, v24, v25
  v_accvgpr_read_b32 v106, a230
  v_accvgpr_read_b32 v107, a231
  v_mfma_f32_16x16x32_bf16 v[248:251], a[184:187], v[76:79], v[248:251]
  ds_read_b128 a[176:179], v1 offset:61440
  v_max_f32 v15, v18, v21
  v_mfma_f32_16x16x32_bf16 v[244:247], a[188:191], v[72:75], v[244:247]
  v_cvt_pk_bf16_f32 v29, v26, v27
  v_cvt_pk_bf16_f32 v100, v100, v101
  v_add_f32 v9, v9, v59
  v_mfma_f32_16x16x32_bf16 v[252:255], a[188:191], v[76:79], v[252:255]
  ds_read_b128 a[180:183], v1 offset:62464
  v_cmp_lt_f32 vcc, s36, v15
  s_cmp_eq_u32 s35, s49
  s_cbranch_scc1 A_SW2
  s_cbranch_vccnz A_ST_Q1
A_RET_Q1:
  s_waitcnt lgkmcnt(6)
  v_mfma_f32_16x16x32_bf16 v[48:51], a[128:131], a[0:3], v[80:83]
  s_add_u32 m0, s43, 65536
  ds_read_b128 a[184:187], v1 offset:63488
  v_cvt_pk_bf16_f32 v101, v102, v103
  v_mfma_f32_16x16x32_bf16 v[56:59], a[128:131], a[4:7], v[84:87]
  v_exp_f32 v32, v32
  v_mfma_f32_16x16x32_bf16 v[52:55], a[132:135], a[0:3], v[80:83]
  ds_read_b128 a[188:191], v1 offset:64512
  buffer_load_dwordx4 v4, s[16:19], s44 offen offset:0 sc1 lds
  v_add_f32 v8, v8, v32
  v_mfma_f32_16x16x32_bf16 v[60:63], a[132:135], a[4:7], v[84:87]
  v_exp_f32 v33, v33
  v_mfma_f32_16x16x32_bf16 v[48:51], a[136:139], a[8:11], v[48:51]
  ds_read_b128 a[128:131], v10 offset:32768
  v_cvt_pk_bf16_f32 v102, v104, v105
  v_cvt_pk_bf16_f32 v103, v106, v107
  v_mfma_f32_16x16x32_bf16 v[56:59], a[136:139], a[12:15], v[56:59]
  v_exp_f32 v34, v34
  v_mfma_f32_16x16x32_bf16 v[52:55], a[140:143], a[8:11], v[52:55]
  ds_read_b128 a[132:135], v10 offset:33792
  v_cvt_pk_bf16_f32 v64, v32, v33
  v_add_f32 v8, v8, v33
  v_mfma_f32_16x16x32_bf16 v[60:63], a[140:143], a[12:15], v[60:63]
  v_exp_f32 v35, v35
  v_mfma_f32_16x16x32_bf16 v[48:51], a[144:147], a[16:19], v[48:51]
  ds_read_b128 a[136:139], v10 offset:34816
  v_exp_f32 v36, v36
  v_mfma_f32_16x16x32_bf16 v[56:59], a[144:147], a[20:23], v[56:59]
  buffer_store_dwordx4 v[100:103], v1, s[16:19], s61 offen offset:0 sc1
  v_add_f32 v8, v8, v34
  v_mfma_f32_16x16x32_bf16 v[52:55], a[148:151], a[16:19], v[52:55]
  ds_read_b128 a[140:143], v10 offset:35840
  buffer_load_dwordx4 v4, s[16:19], s44 offen offset:1024 sc1 lds
  v_cvt_pk_bf16_f32 v65, v34, v35
  v_mfma_f32_16x16x32_bf16 v[60:63], a[148:151], a[20:23], v[60:63]
  v_exp_f32 v37, v37
  v_mfma_f32_16x16x32_bf16 v[48:51], a[152:155], a[24:27], v[48:51]
  ds_read_b128 a[144:147], v10 offset:36864
  v_accvgpr_read_b32 v100, a232
  v_add_f32 v8, v8, v35
  v_mfma_f32_16x16x32_bf16 v[56:59], a[152:155], a[28:31], v[56:59]
  v_exp_f32 v38, v38
  v_mfma_f32_16x16x32_bf16 v[52:55], a[156:159], a[24:27], v[52:55]
  s_waitcnt lgkmcnt(5)
  ds_read_b128 a[148:151], v10 offset:37888
  v_cvt_pk_bf16_f32 v66, v36, v37
  v_mfma_f32_16x16x32_bf16 v[60:63], a[156:159], a[28:31], v[60:63]
  v_exp_f32 v39, v39
  v_mfma_f32_16x16x32_bf16 v[48:51], a[160:163], a[32:35], v[48:51]
  ds_read_b128 a[152:155], v10 offset:38912
  v_accvgpr_read_b32 v101, a233
  v_accvgpr_read_b32 v102, a234
  v_mfma_f32_16x16x32_bf16 v[56:59], a[160:163], a[36:39], v[56:59]
  v_exp_f32 v40, v40
  v_mfma_f32_16x16x32_bf16 v[52:55], a[164:167], a[32:35], v[52:55]
  ds_read_b128 a[156:159], v10 offset:39936
  buffer_load_dwordx4 v4, s[16:19], s44 offen offset:2048 sc1 lds
  v_add_f32 v8, v8, v36
  v_mfma_f32_16x16x32_bf16 v[60:63], a[164:167], a[36:39], v[60:63]
  v_exp_f32 v41, v41
  v_mfma_f32_16x16x32_bf16 v[48:51], a[168:171], a[40:43], v[48:51]
  v_exp_f32 v42, v42
  v_add_f32 v8, v8, v37
  v_mfma_f32_16x16x32_bf16 v[56:59], a[168:171], a[44:47], v[56:59]
  ds_read_b128 a[160:163], v10 offset:40960
  v_cvt_pk_bf16_f32 v67, v38, v39
  v_mfma_f32_16x16x32_bf16 v[52:55], a[172:175], a[40:43], v[52:55]
  ds_read_b128 a[164:167], v10 offset:41984
  v_accvgpr_read_b32 v103, a235
  v_add_f32 v8, v8, v38
  v_mfma_f32_16x16x32_bf16 v[60:63], a[172:175], a[44:47], v[60:63]
  v_exp_f32 v43, v43
  v_mfma_f32_16x16x32_bf16 v[48:51], a[176:179], a[48:51], v[48:51]
  v_exp_f32 v44, v44
  v_accvgpr_read_b32 v104, a236
  v_mfma_f32_16x16x32_bf16 v[56:59], a[176:179], a[52:55], v[56:59]
  ds_read_b128 a[168:171], v10 offset:43008
  v_cvt_pk_bf16_f32 v68, v40, v41
  v_mfma_f32_16x16x32_bf16 v[52:55], a[180:183], a[48:51], v[52:55]
  ds_read_b128 a[172:175], v10 offset:44032
  buffer_load_dwordx4 v4, s[16:19], s44 offen offset:3072 sc1 lds
  v_add_f32 v8, v8, v39
  v_mfma_f32_16x16x32_bf16 v[60:63], a[180:183], a[52:55], v[60:63]
  v_exp_f32 v45, v45
  v_mfma_f32_16x16x32_bf16 v[48:51], a[184:187], a[56:59], v[48:51]
  v_lshlrev_b32 v124, 16, v122
  v_accvgpr_read_b32 v105, a237
  v_add_f32 v9, v9, v40
  v_mfma_f32_16x16x32_bf16 v[56:59], a[184:187], a[60:63], v[56:59]
  ds_read_b128 a[176:179], v10 offset:45056
  v_cvt_pk_bf16_f32 v69, v42, v43
  v_mfma_f32_16x16x32_bf16 v[52:55], a[188:191], a[56:59], v[52:55]
  ds_read_b128 a[180:183], v10 offset:46080
  v_exp_f32 v47, v47
  v_mfma_f32_16x16x32_bf16 v[60:63], a[188:191], a[60:63], v[60:63]
  s_waitcnt lgkmcnt(6)
  v_exp_f32 v46, v46
  v_mfma_f32_16x16x32_bf16 v[128:131], a[128:131], v[64:67], v[128:131]
  v_cvt_pk_bf16_f32 v71, v46, v47
  v_accvgpr_read_b32 v106, a238
  v_add_f32 v9, v9, v41
  v_mfma_f32_16x16x32_bf16 v[132:135], a[132:135], v[64:67], v[132:135]
  ds_read_b128 a[184:187], v10 offset:47104
  v_cvt_pk_bf16_f32 v70, v44, v45
  v_mfma_f32_16x16x32_bf16 v[144:147], a[136:139], v[64:67], v[144:147]
  s_add_u32 s47, s46, s38
  ds_read_b128 a[188:191], v10 offset:48128
  v_cvt_pk_bf16_f32 v100, v100, v101
  v_mfma_f32_16x16x32_bf16 v[148:151], a[140:143], v[64:67], v[148:151]
  v_and_b32 v125, 0xffff0000, v122
  v_accvgpr_read_b32 v107, a239
  v_mfma_f32_16x16x32_bf16 v[136:139], a[128:131], v[68:71], v[136:139]
  s_waitcnt vmcnt(11)
  s_barrier
  v_cvt_pk_bf16_f32 v101, v102, v103
  v_mfma_f32_16x16x32_bf16 v[140:143], a[132:135], v[68:71], v[140:143]
  ds_read_b128 a[128:131], v1 offset:0
  v_cvt_pk_bf16_f32 v102, v104, v105
  v_mfma_f32_16x16x32_bf16 v[152:155], a[136:139], v[68:71], v[152:155]
  s_add_u32 m0, s43, 49152
  ds_read_b128 a[132:135], v1 offset:1024
  v_cvt_pk_bf16_f32 v103, v106, v107
  v_mfma_f32_16x16x32_bf16 v[156:159], a[140:143], v[68:71], v[156:159]
  v_max3_f32 v18, v48, v49, v50
  v_lshlrev_b32 v126, 16, v123
  v_mfma_f32_16x16x32_bf16 v[160:163], a[144:147], v[64:67], v[160:163]
  ds_read_b128 a[136:139], v1 offset:2048
  buffer_load_dwordx4 v3, s[16:19], s47 offen offset:0 sc1 lds
  v_and_b32 v127, 0xffff0000, v123
  v_mfma_f32_16x16x32_bf16 v[168:171], a[144:147], v[68:71], v[168:171]
  buffer_store_dwordx4 v[100:103], v1, s[16:19], s61 offen offset:1024 sc1
  v_add_f32 v9, v9, v42
  v_mfma_f32_16x16x32_bf16 v[164:167], a[148:151], v[64:67], v[164:167]
  ds_read_b128 a[140:143], v1 offset:3072
  s_cmp_lt_u32 s35, s78
  s_cbranch_scc1 A_KV2S
A_KV2S_RET_Q:
  v_mfma_f32_16x16x32_bf16 v[172:175], a[148:151], v[68:71], v[172:175]
  v_accvgpr_read_b32 v100, a240
  v_accvgpr_read_b32 v101, a241
  v_mfma_f32_16x16x32_bf16 v[176:179], a[152:155], v[64:67], v[176:179]
  v_exp_f32 v24, -v124
  v_add_f32 v9, v9, v43
  v_mfma_f32_16x16x32_bf16 v[184:187], a[152:155], v[68:71], v[184:187]
  ds_read_b128 a[144:147], v1 offset:4096
  v_max3_f32 v19, v51, v52, v53
  v_mfma_f32_16x16x32_bf16 v[180:183], a[156:159], v[64:67], v[180:183]
  s_waitcnt lgkmcnt(5)
  ds_read_b128 a[148:151], v1 offset:5120
  buffer_load_dwordx4 v3, s[16:19], s47 offen offset:1024 sc1 lds
  v_mfma_f32_16x16x32_bf16 v[188:191], a[156:159], v[68:71], v[188:191]
  v_accvgpr_read_b32 v102, a242
  v_accvgpr_read_b32 v103, a243
  v_mfma_f32_16x16x32_bf16 v[192:195], a[160:163], v[64:67], v[192:195]
  v_accvgpr_read_b32 v104, a244
  v_accvgpr_read_b32 v105, a245
  v_add_f32 v9, v9, v44
  v_mfma_f32_16x16x32_bf16 v[200:203], a[160:163], v[68:71], v[200:203]
  ds_read_b128 a[152:155], v1 offset:6144
  v_max3_f32 v20, v54, v55, v56
  v_mfma_f32_16x16x32_bf16 v[196:199], a[164:167], v[64:67], v[196:199]
  v_exp_f32 v25, -v125
  v_accvgpr_read_b32 v106, a246
  v_mfma_f32_16x16x32_bf16 v[204:207], a[164:167], v[68:71], v[204:207]
  ds_read_b128 a[156:159], v1 offset:7168
  v_max3_f32 v21, v57, v58, v59
  v_mfma_f32_16x16x32_bf16 v[208:211], a[168:171], v[64:67], v[208:211]
  ds_read_b128 a[160:163], v1 offset:8192
  buffer_load_dwordx4 v3, s[16:19], s47 offen offset:2048 sc1 lds
  v_add_f32 v9, v9, v45
  v_mfma_f32_16x16x32_bf16 v[216:219], a[168:171], v[68:71], v[216:219]
  v_accvgpr_read_b32 v107, a247
  v_cvt_pk_bf16_f32 v100, v100, v101
  v_mfma_f32_16x16x32_bf16 v[212:215], a[172:175], v[64:67], v[212:215]
  v_max3_f32 v18, v18, v19, v20
  v_cvt_pk_bf16_f32 v101, v102, v103
  v_add_f32 v9, v9, v46
  v_mfma_f32_16x16x32_bf16 v[220:223], a[172:175], v[68:71], v[220:223]
  ds_read_b128 a[164:167], v1 offset:9216
  v_max3_f32 v22, v60, v61, v62
  v_mfma_f32_16x16x32_bf16 v[224:227], a[176:179], v[64:67], v[224:227]
  v_exp_f32 v26, -v126
  v_add_f32 v9, v9, v47
  v_mfma_f32_16x16x32_bf16 v[232:235], a[176:179], v[68:71], v[232:235]
  ds_read_b128 a[168:171], v1 offset:10240
  v_max3_f32 v21, v21, v22, v63
  v_mfma_f32_16x16x32_bf16 v[228:231], a[180:183], v[64:67], v[228:231]
  ds_read_b128 a[172:175], v1 offset:11264
  buffer_load_dwordx4 v3, s[16:19], s47 offen offset:3072 sc1 lds
  v_cvt_pk_bf16_f32 v103, v106, v107
  v_mfma_f32_16x16x32_bf16 v[236:239], a[180:183], v[68:71], v[236:239]
  v_cvt_pk_bf16_f32 v102, v104, v105
  buffer_store_dwordx4 v[100:103], v1, s[16:19], s61 offen offset:2048 sc1
  v_mfma_f32_16x16x32_bf16 v[240:243], a[184:187], v[64:67], v[240:243]
  v_exp_f32 v27, -v127
  v_mfma_f32_16x16x32_bf16 v[248:251], a[184:187], v[68:71], v[248:251]
  ds_read_b128 a[176:179], v1 offset:12288
  v_max_f32 v15, v18, v21
  v_mfma_f32_16x16x32_bf16 v[244:247], a[188:191], v[64:67], v[244:247]
  v_accvgpr_read_b32 v100, a248
  v_accvgpr_read_b32 v101, a249
  v_mfma_f32_16x16x32_bf16 v[252:255], a[188:191], v[68:71], v[252:255]
  ds_read_b128 a[180:183], v1 offset:13312
  v_cmp_lt_f32 vcc, s36, v15
  s_cbranch_vccnz A_ST_Q2
A_RET_Q2:
  s_waitcnt lgkmcnt(6)
  v_mfma_f32_16x16x32_bf16 v[32:35], a[128:131], a[0:3], v[80:83]
  s_add_u32 m0, s43, 81920
  ds_read_b128 a[184:187], v1 offset:14336
  v_accvgpr_read_b32 v102, a250
  v_mfma_f32_16x16x32_bf16 v[40:43], a[128:131], a[4:7], v[84:87]
  v_exp_f32 v48, v48
  v_mfma_f32_16x16x32_bf16 v[36:39], a[132:135], a[0:3], v[80:83]
  ds_read_b128 a[188:191], v1 offset:15360
  buffer_load_dwordx4 v4, s[16:19], s45 offen offset:0 sc1 lds
  v_accvgpr_read_b32 v103, a251
  v_mfma_f32_16x16x32_bf16 v[44:47], a[132:135], a[4:7], v[84:87]
  v_exp_f32 v49, v49
  v_mfma_f32_16x16x32_bf16 v[32:35], a[136:139], a[8:11], v[32:35]
  ds_read_b128 a[128:131], v10 offset:49152
  v_accvgpr_read_b32 v104, a252
  v_accvgpr_read_b32 v105, a253
  v_mfma_f32_16x16x32_bf16 v[40:43], a[136:139], a[12:15], v[40:43]
  v_exp_f32 v50, v50
  v_mfma_f32_16x16x32_bf16 v[36:39], a[140:143], a[8:11], v[36:39]
  ds_read_b128 a[132:135], v10 offset:50176
  v_cvt_pk_bf16_f32 v72, v48, v49
  v_mfma_f32_16x16x32_bf16 v[44:47], a[140:143], a[12:15], v[44:47]
  v_exp_f32 v51, v51
  v_mfma_f32_16x16x32_bf16 v[32:35], a[144:147], a[16:19], v[32:35]
  ds_read_b128 a[136:139], v10 offset:51200
  v_exp_f32 v53, v53
  v_mfma_f32_16x16x32_bf16 v[40:43], a[144:147], a[20:23], v[40:43]
  v_exp_f32 v52, v52
  v_mfma_f32_16x16x32_bf16 v[36:39], a[148:151], a[16:19], v[36:39]
  ds_read_b128 a[140:143], v10 offset:52224
  buffer_load_dwordx4 v4, s[16:19], s45 offen offset:1024 sc1 lds
  v_accvgpr_read_b32 v107, a255
  v_mfma_f32_16x16x32_bf16 v[44:47], a[148:151], a[20:23], v[44:47]
  v_cvt_pk_bf16_f32 v73, v50, v51
  v_accvgpr_read_b32 v106, a254
  v_mfma_f32_16x16x32_bf16 v[32:35], a[152:155], a[24:27], v[32:35]
  ds_read_b128 a[144:147], v10 offset:53248
  v_fma_f32 v24, v24, s82, s82
  v_cvt_pk_bf16_f32 v100, v100, v101
  v_mfma_f32_16x16x32_bf16 v[40:43], a[152:155], a[28:31], v[40:43]
  v_exp_f32 v54, v54
  v_mfma_f32_16x16x32_bf16 v[36:39], a[156:159], a[24:27], v[36:39]
  s_waitcnt lgkmcnt(5)
  ds_read_b128 a[148:151], v10 offset:54272
  v_cvt_pk_bf16_f32 v74, v52, v53
  v_mfma_f32_16x16x32_bf16 v[44:47], a[156:159], a[28:31], v[44:47]
  v_exp_f32 v55, v55
  v_mfma_f32_16x16x32_bf16 v[32:35], a[160:163], a[32:35], v[32:35]
  ds_read_b128 a[152:155], v10 offset:55296
  v_cvt_pk_bf16_f32 v101, v102, v103
  v_cvt_pk_bf16_f32 v102, v104, v105
  v_mfma_f32_16x16x32_bf16 v[40:43], a[160:163], a[36:39], v[40:43]
  v_exp_f32 v56, v56
  v_mfma_f32_16x16x32_bf16 v[36:39], a[164:167], a[32:35], v[36:39]
  ds_read_b128 a[156:159], v10 offset:56320
  buffer_load_dwordx4 v4, s[16:19], s45 offen offset:2048 sc1 lds
  v_cvt_pk_bf16_f32 v75, v54, v55
  v_mfma_f32_16x16x32_bf16 v[44:47], a[164:167], a[36:39], v[44:47]
  v_exp_f32 v57, v57
  v_mfma_f32_16x16x32_bf16 v[32:35], a[168:171], a[40:43], v[32:35]
  ds_read_b128 a[160:163], v10 offset:57344
  v_cvt_pk_bf16_f32 v103, v106, v107
  v_mfma_f32_16x16x32_bf16 v[40:43], a[168:171], a[44:47], v[40:43]
  v_exp_f32 v58, v58
  v_mfma_f32_16x16x32_bf16 v[36:39], a[172:175], a[40:43], v[36:39]
  v_exp_f32 v59, v59
  v_cvt_pk_bf16_f32 v76, v56, v57
  v_mfma_f32_16x16x32_bf16 v[44:47], a[172:175], a[44:47], v[44:47]
  ds_read_b128 a[164:167], v10 offset:58368
  buffer_store_dwordx4 v[100:103], v1, s[16:19], s61 offen offset:3072 sc1
  v_mfma_f32_16x16x32_bf16 v[32:35], a[176:179], a[48:51], v[32:35]
  ds_read_b128 a[168:171], v10 offset:59392
  v_add_f32 v8, v8, v51
  v_mfma_f32_16x16x32_bf16 v[40:43], a[176:179], a[52:55], v[40:43]
  v_exp_f32 v60, v60
  v_mfma_f32_16x16x32_bf16 v[36:39], a[180:183], a[48:51], v[36:39]
  ds_read_b128 a[172:175], v10 offset:60416
  buffer_load_dwordx4 v4, s[16:19], s45 offen offset:3072 sc1 lds
  v_mfma_f32_16x16x32_bf16 v[44:47], a[180:183], a[52:55], v[44:47]
  v_exp_f32 v61, v61
  v_mfma_f32_16x16x32_bf16 v[32:35], a[184:187], a[56:59], v[32:35]
  v_exp_f32 v62, v62
  v_mfma_f32_16x16x32_bf16 v[40:43], a[184:187], a[60:63], v[40:43]
  ds_read_b128 a[176:179], v10 offset:61440
  v_cvt_pk_bf16_f32 v77, v58, v59
  v_mfma_f32_16x16x32_bf16 v[36:39], a[188:191], a[56:59], v[36:39]
  s_waitcnt lgkmcnt(5)
  ds_read_b128 a[180:183], v10 offset:62464
  buffer_load_dword v2, v98, s[12:15], s84 offen
  v_mfma_f32_16x16x32_bf16 v[44:47], a[188:191], a[60:63], v[44:47]
  v_exp_f32 v63, v63
  v_mfma_f32_16x16x32_bf16 v[128:131], a[128:131], v[72:75], v[128:131]
  s_add_u32 s84, s84, 256
  ds_read_b128 a[184:187], v10 offset:63488
  v_add_f32 v9, v9, v58
  v_mfma_f32_16x16x32_bf16 v[132:135], a[132:135], v[72:75], v[132:135]
  v_cvt_pk_bf16_f32 v78, v60, v61
  v_cvt_pk_bf16_f32 v79, v62, v63
  v_mfma_f32_16x16x32_bf16 v[144:147], a[136:139], v[72:75], v[144:147]
  s_add_u32 s44, s47, s38
  ds_read_b128 a[188:191], v10 offset:64512
  v_add_f32 v9, v9, v59
  v_mfma_f32_16x16x32_bf16 v[148:151], a[140:143], v[72:75], v[148:151]
  v_fma_f32 v25, v25, s82, s82
  v_fma_f32 v26, v26, s82, s82
  v_mfma_f32_16x16x32_bf16 v[136:139], a[128:131], v[76:79], v[136:139]
  s_waitcnt vmcnt(12)
  s_barrier
  v_add_f32 v9, v9, v62
  v_mfma_f32_16x16x32_bf16 v[140:143], a[132:135], v[76:79], v[140:143]
  ds_read_b128 a[128:131], v1 offset:16384
  v_fma_f32 v27, v27, s82, s82
  v_mfma_f32_16x16x32_bf16 v[152:155], a[136:139], v[76:79], v[152:155]
  s_add_u32 m0, s43, 0
  ds_read_b128 a[132:135], v1 offset:17408
  v_add_f32 v9, v9, v60
  v_mfma_f32_16x16x32_bf16 v[156:159], a[140:143], v[76:79], v[156:159]
  v_max3_f32 v18, v32, v33, v34
  v_add_f32 v8, v8, v49
  v_mfma_f32_16x16x32_bf16 v[160:163], a[144:147], v[72:75], v[160:163]
  ds_read_b128 a[136:139], v1 offset:18432
  buffer_load_dwordx4 v3, s[16:19], s44 offen offset:0 sc1 lds
  v_add_f32 v9, v9, v63
  v_mfma_f32_16x16x32_bf16 v[168:171], a[144:147], v[76:79], v[168:171]
  v_rcp_f32 v24, v24
  v_mfma_f32_16x16x32_bf16 v[164:167], a[148:151], v[72:75], v[164:167]
  ds_read_b128 a[140:143], v1 offset:19456
  s_cmp_eq_u32 s35, s50
  s_cbranch_scc1 A_SIG
A_SIG_RET_Q:
  v_mfma_f32_16x16x32_bf16 v[172:175], a[148:151], v[76:79], v[172:175]
  v_add_f32 v8, v8, v50
  v_add_f32 v9, v9, v61
  v_mfma_f32_16x16x32_bf16 v[176:179], a[152:155], v[72:75], v[176:179]
  v_rcp_f32 v25, v25
  v_mfma_f32_16x16x32_bf16 v[184:187], a[152:155], v[76:79], v[184:187]
  ds_read_b128 a[144:147], v1 offset:20480
  v_max3_f32 v19, v35, v36, v37
  v_mfma_f32_16x16x32_bf16 v[180:183], a[156:159], v[72:75], v[180:183]
  s_waitcnt lgkmcnt(5)
  ds_read_b128 a[148:151], v1 offset:21504
  buffer_load_dwordx4 v3, s[16:19], s44 offen offset:1024 sc1 lds
  v_mfma_f32_16x16x32_bf16 v[188:191], a[156:159], v[76:79], v[188:191]
  v_rcp_f32 v26, v26
  v_mfma_f32_16x16x32_bf16 v[192:195], a[160:163], v[72:75], v[192:195]
  v_add_f32 v8, v8, v48
  v_add_f32 v8, v8, v52
  v_mfma_f32_16x16x32_bf16 v[200:203], a[160:163], v[76:79], v[200:203]
  ds_read_b128 a[152:155], v1 offset:22528
  v_max3_f32 v20, v38, v39, v40
  v_mfma_f32_16x16x32_bf16 v[196:199], a[164:167], v[72:75], v[196:199]
  v_rcp_f32 v27, v27
  v_mfma_f32_16x16x32_bf16 v[204:207], a[164:167], v[76:79], v[204:207]
  ds_read_b128 a[156:159], v1 offset:23552
  v_max3_f32 v21, v41, v42, v43
  v_mfma_f32_16x16x32_bf16 v[208:211], a[168:171], v[72:75], v[208:211]
  ds_read_b128 a[160:163], v1 offset:24576
  buffer_load_dwordx4 v3, s[16:19], s44 offen offset:2048 sc1 lds
  v_mfma_f32_16x16x32_bf16 v[216:219], a[168:171], v[76:79], v[216:219]
  v_mul_f32 v24, v24, v124
  v_add_f32 v8, v8, v53
  v_mfma_f32_16x16x32_bf16 v[212:215], a[172:175], v[72:75], v[212:215]
  v_max3_f32 v18, v18, v19, v20
  v_add_f32 v8, v8, v54
  v_mfma_f32_16x16x32_bf16 v[220:223], a[172:175], v[76:79], v[220:223]
  ds_read_b128 a[164:167], v1 offset:25600
  v_max3_f32 v22, v44, v45, v46
  v_mfma_f32_16x16x32_bf16 v[224:227], a[176:179], v[72:75], v[224:227]
  v_mul_f32 v25, v25, v125
  v_add_f32 v8, v8, v55
  v_mfma_f32_16x16x32_bf16 v[232:235], a[176:179], v[76:79], v[232:235]
  ds_read_b128 a[168:171], v1 offset:26624
  v_max3_f32 v21, v21, v22, v47
  v_mfma_f32_16x16x32_bf16 v[228:231], a[180:183], v[72:75], v[228:231]
  ds_read_b128 a[172:175], v1 offset:27648
  buffer_load_dwordx4 v3, s[16:19], s44 offen offset:3072 sc1 lds
  v_mfma_f32_16x16x32_bf16 v[236:239], a[180:183], v[76:79], v[236:239]
  v_mul_f32 v26, v26, v126
  v_mul_f32 v27, v27, v127
  v_mfma_f32_16x16x32_bf16 v[240:243], a[184:187], v[72:75], v[240:243]
  v_cvt_pk_bf16_f32 v30, v24, v25
  v_add_f32 v9, v9, v56
  v_mfma_f32_16x16x32_bf16 v[248:251], a[184:187], v[76:79], v[248:251]
  ds_read_b128 a[176:179], v1 offset:28672
  v_max_f32 v15, v18, v21
  v_mfma_f32_16x16x32_bf16 v[244:247], a[188:191], v[72:75], v[244:247]
  v_cvt_pk_bf16_f32 v31, v26, v27
  v_add_f32 v9, v9, v57
  v_mfma_f32_16x16x32_bf16 v[252:255], a[188:191], v[76:79], v[252:255]
  ds_read_b128 a[180:183], v1 offset:29696
  v_cmp_lt_f32 vcc, s36, v15
  s_cbranch_vccnz A_ST_Q3
A_RET_Q3:
  s_mov_b32 s35, 1
A_LOOP:
  s_waitcnt lgkmcnt(6)
  v_mfma_f32_16x16x32_bf16 v[48:51], a[128:131], a[0:3], v[80:83]
  s_add_u32 m0, s43, 98304
  ds_read_b128 a[184:187], v1 offset:30720
  ds_write_b128 v11, v[28:31]
  v_mfma_f32_16x16x32_bf16 v[56:59], a[128:131], a[4:7], v[84:87]
  v_exp_f32 v32, v32
  v_mfma_f32_16x16x32_bf16 v[52:55], a[132:135], a[0:3], v[80:83]
  ds_read_b128 a[188:191], v1 offset:31744
  buffer_load_dwordx4 v4, s[16:19], s46 offen offset:0 sc1 lds
  v_mfma_f32_16x16x32_bf16 v[60:63], a[132:135], a[4:7], v[84:87]
  v_exp_f32 v33, v33
  v_mfma_f32_16x16x32_bf16 v[48:51], a[136:139], a[8:11], v[48:51]
  v_exp_f32 v34, v34
  v_mfma_f32_16x16x32_bf16 v[56:59], a[136:139], a[12:15], v[56:59]
  ds_read_b128 a[128:131], v10 offset:0
  ds_read_b128 v[120:123], v11 offset:1024
  v_mfma_f32_16x16x32_bf16 v[52:55], a[140:143], a[8:11], v[52:55]
  v_add_u32 v11, 0x400, v11
  v_add_f32 v8, v8, v32
  v_mfma_f32_16x16x32_bf16 v[60:63], a[140:143], a[12:15], v[60:63]
  ds_read_b128 a[132:135], v10 offset:1024
  v_mfma_f32_16x16x32_bf16 v[48:51], a[144:147], a[16:19], v[48:51]
  ds_read_b128 a[136:139], v10 offset:2048
  v_cvt_pk_bf16_f32 v64, v32, v33
  v_mfma_f32_16x16x32_bf16 v[56:59], a[144:147], a[20:23], v[56:59]
  v_exp_f32 v35, v35
  v_mfma_f32_16x16x32_bf16 v[52:55], a[148:151], a[16:19], v[52:55]
  ds_read_b128 a[140:143], v10 offset:3072
  buffer_load_dwordx4 v4, s[16:19], s46 offen offset:1024 sc1 lds
  v_mfma_f32_16x16x32_bf16 v[60:63], a[148:151], a[20:23], v[60:63]
  v_exp_f32 v36, v36
  v_mfma_f32_16x16x32_bf16 v[48:51], a[152:155], a[24:27], v[48:51]
  ds_read_b128 a[144:147], v10 offset:4096
  v_cvt_pk_bf16_f32 v65, v34, v35
  v_mfma_f32_16x16x32_bf16 v[56:59], a[152:155], a[28:31], v[56:59]
  v_exp_f32 v37, v37
  v_mfma_f32_16x16x32_bf16 v[52:55], a[156:159], a[24:27], v[52:55]
  v_exp_f32 v38, v38
  v_mfma_f32_16x16x32_bf16 v[60:63], a[156:159], a[28:31], v[60:63]
  s_waitcnt lgkmcnt(6)
  ds_read_b128 a[148:151], v10 offset:5120
  v_mfma_f32_16x16x32_bf16 v[48:51], a[160:163], a[32:35], v[48:51]
  ds_read_b128 a[152:155], v10 offset:6144
  v_cvt_pk_bf16_f32 v66, v36, v37
  v_mfma_f32_16x16x32_bf16 v[56:59], a[160:163], a[36:39], v[56:59]
  v_exp_f32 v39, v39
  v_mfma_f32_16x16x32_bf16 v[52:55], a[164:167], a[32:35], v[52:55]
  ds_read_b128 a[156:159], v10 offset:7168
  buffer_load_dwordx4 v4, s[16:19], s46 offen offset:2048 sc1 lds
  v_mfma_f32_16x16x32_bf16 v[60:63], a[164:167], a[36:39], v[60:63]
  v_exp_f32 v40, v40
  v_mfma_f32_16x16x32_bf16 v[48:51], a[168:171], a[40:43], v[48:51]
  ds_read_b128 a[160:163], v10 offset:8192
  v_cvt_pk_bf16_f32 v67, v38, v39
  v_mfma_f32_16x16x32_bf16 v[56:59], a[168:171], a[44:47], v[56:59]
  v_exp_f32 v41, v41
  v_mfma_f32_16x16x32_bf16 v[52:55], a[172:175], a[40:43], v[52:55]
  ds_read_b128 a[164:167], v10 offset:9216
  v_exp_f32 v43, v43
  v_mfma_f32_16x16x32_bf16 v[60:63], a[172:175], a[44:47], v[60:63]
  v_exp_f32 v42, v42
  v_mfma_f32_16x16x32_bf16 v[48:51], a[176:179], a[48:51], v[48:51]
  v_exp_f32 v44, v44
  v_mfma_f32_16x16x32_bf16 v[56:59], a[176:179], a[52:55], v[56:59]
  ds_read_b128 a[168:171], v10 offset:10240
  v_cvt_pk_bf16_f32 v68, v40, v41
  v_mfma_f32_16x16x32_bf16 v[52:55], a[180:183], a[48:51], v[52:55]
  ds_read_b128 a[172:175], v10 offset:11264
  buffer_load_dwordx4 v4, s[16:19], s46 offen offset:3072 sc1 lds
  v_mfma_f32_16x16x32_bf16 v[60:63], a[180:183], a[52:55], v[60:63]
  v_add_f32 v8, v8, v33
  v_add_f32 v9, v9, v41
  v_mfma_f32_16x16x32_bf16 v[48:51], a[184:187], a[56:59], v[48:51]
  ds_read_b128 a[176:179], v10 offset:12288
  v_cvt_pk_bf16_f32 v69, v42, v43
  v_mfma_f32_16x16x32_bf16 v[56:59], a[184:187], a[60:63], v[56:59]
  v_exp_f32 v45, v45
  v_mfma_f32_16x16x32_bf16 v[52:55], a[188:191], a[56:59], v[52:55]
  ds_read_b128 a[180:183], v10 offset:13312
  v_exp_f32 v47, v47
  v_mfma_f32_16x16x32_bf16 v[60:63], a[188:191], a[60:63], v[60:63]
  s_waitcnt lgkmcnt(6)
  v_exp_f32 v46, v46
  v_mfma_f32_16x16x32_bf16 v[128:131], a[128:131], v[64:67], v[128:131]
  v_cvt_pk_bf16_f32 v71, v46, v47
  v_add_f32 v9, v9, v42
  v_mfma_f32_16x16x32_bf16 v[132:135], a[132:135], v[64:67], v[132:135]
  ds_read_b128 a[184:187], v10 offset:14336
  v_cvt_pk_bf16_f32 v70, v44, v45
  v_mfma_f32_16x16x32_bf16 v[144:147], a[136:139], v[64:67], v[144:147]
  s_add_u32 s45, s44, s38
  ds_read_b128 a[188:191], v10 offset:15360
  v_mfma_f32_16x16x32_bf16 v[148:151], a[140:143], v[64:67], v[148:151]
  v_lshlrev_b32 v124, 16, v120
  v_and_b32 v125, 0xffff0000, v120
  v_mfma_f32_16x16x32_bf16 v[136:139], a[128:131], v[68:71], v[136:139]
  s_waitcnt vmcnt(9)
  s_barrier
  v_mfma_f32_16x16x32_bf16 v[140:143], a[132:135], v[68:71], v[140:143]
  ds_read_b128 a[128:131], v1 offset:32768
  v_add_f32 v9, v9, v43
  v_mfma_f32_16x16x32_bf16 v[152:155], a[136:139], v[68:71], v[152:155]
  s_add_u32 m0, s43, 16384
  ds_read_b128 a[132:135], v1 offset:33792
  v_mfma_f32_16x16x32_bf16 v[156:159], a[140:143], v[68:71], v[156:159]
  v_max3_f32 v18, v48, v49, v50
  v_add_f32 v9, v9, v40
  v_mfma_f32_16x16x32_bf16 v[160:163], a[144:147], v[64:67], v[160:163]
  ds_read_b128 a[136:139], v1 offset:34816
  buffer_load_dwordx4 v3, s[16:19], s45 offen offset:0 sc1 lds
  v_mfma_f32_16x16x32_bf16 v[168:171], a[144:147], v[68:71], v[168:171]
  v_lshlrev_b32 v126, 16, v121
  v_add_f32 v9, v9, v44
  v_mfma_f32_16x16x32_bf16 v[164:167], a[148:151], v[64:67], v[164:167]
  v_and_b32 v127, 0xffff0000, v121
  v_add_f32 v9, v9, v45
  v_mfma_f32_16x16x32_bf16 v[172:175], a[148:151], v[68:71], v[172:175]
  ds_read_b128 a[140:143], v1 offset:35840
  v_max3_f32 v19, v51, v52, v53
  v_mfma_f32_16x16x32_bf16 v[176:179], a[152:155], v[64:67], v[176:179]
  v_add_f32 v8, v8, v34
  v_add_f32 v9, v9, v46
  v_mfma_f32_16x16x32_bf16 v[184:187], a[152:155], v[68:71], v[184:187]
  ds_read_b128 a[144:147], v1 offset:36864
  v_max3_f32 v20, v54, v55, v56
  v_mfma_f32_16x16x32_bf16 v[180:183], a[156:159], v[64:67], v[180:183]
  s_waitcnt lgkmcnt(5)
  ds_read_b128 a[148:151], v1 offset:37888
  buffer_load_dwordx4 v3, s[16:19], s45 offen offset:1024 sc1 lds
  v_mfma_f32_16x16x32_bf16 v[188:191], a[156:159], v[68:71], v[188:191]
  v_exp_f32 v24, -v124
  v_mfma_f32_16x16x32_bf16 v[192:195], a[160:163], v[64:67], v[192:195]
  v_add_f32 v8, v8, v35
  v_add_f32 v9, v9, v47
  v_mfma_f32_16x16x32_bf16 v[200:203], a[160:163], v[68:71], v[200:203]
  ds_read_b128 a[152:155], v1 offset:38912
  v_max3_f32 v21, v57, v58, v59
  v_mfma_f32_16x16x32_bf16 v[196:199], a[164:167], v[64:67], v[196:199]
  v_max3_f32 v22, v60, v61, v62
  v_add_f32 v8, v8, v36
  v_mfma_f32_16x16x32_bf16 v[204:207], a[164:167], v[68:71], v[204:207]
  ds_read_b128 a[156:159], v1 offset:39936
  v_mfma_f32_16x16x32_bf16 v[208:211], a[168:171], v[64:67], v[208:211]
  ds_read_b128 a[160:163], v1 offset:40960
  buffer_load_dwordx4 v3, s[16:19], s45 offen offset:2048 sc1 lds
  v_mfma_f32_16x16x32_bf16 v[216:219], a[168:171], v[68:71], v[216:219]
  v_exp_f32 v25, -v125
  v_mfma_f32_16x16x32_bf16 v[212:215], a[172:175], v[64:67], v[212:215]
  v_max3_f32 v18, v18, v19, v20
  v_add_f32 v8, v8, v37
  v_mfma_f32_16x16x32_bf16 v[220:223], a[172:175], v[68:71], v[220:223]
  ds_read_b128 a[164:167], v1 offset:41984
  v_mfma_f32_16x16x32_bf16 v[224:227], a[176:179], v[64:67], v[224:227]
  v_exp_f32 v26, -v126
  v_mfma_f32_16x16x32_bf16 v[232:235], a[176:179], v[68:71], v[232:235]
  ds_read_b128 a[168:171], v1 offset:43008
  v_max3_f32 v21, v21, v22, v63
  v_mfma_f32_16x16x32_bf16 v[228:231], a[180:183], v[64:67], v[228:231]
  ds_read_b128 a[172:175], v1 offset:44032
  buffer_load_dwordx4 v3, s[16:19], s45 offen offset:3072 sc1 lds
  v_mfma_f32_16x16x32_bf16 v[236:239], a[180:183], v[68:71], v[236:239]
  v_add_f32 v8, v8, v38
  v_mfma_f32_16x16x32_bf16 v[240:243], a[184:187], v[64:67], v[240:243]
  v_exp_f32 v27, -v127
  v_mfma_f32_16x16x32_bf16 v[248:251], a[184:187], v[68:71], v[248:251]
  ds_read_b128 a[176:179], v1 offset:45056
  v_max_f32 v15, v18, v21
  v_mfma_f32_16x16x32_bf16 v[244:247], a[188:191], v[64:67], v[244:247]
  v_cmp_lt_f32 vcc, s36, v15
  v_add_f32 v8, v8, v39
  v_mfma_f32_16x16x32_bf16 v[252:255], a[188:191], v[68:71], v[252:255]
  ds_read_b128 a[180:183], v1 offset:46080
  s_cbranch_vccnz A_ST_L0
A_RET_L0:
  s_cmp_eq_u32 s35, s49
  s_cbranch_scc1 A_SW1
A_SW1_RET_L1:
  s_waitcnt lgkmcnt(6)
  v_mfma_f32_16x16x32_bf16 v[32:35], a[128:131], a[0:3], v[80:83]
  s_add_u32 m0, s43, 114688
  ds_read_b128 a[184:187], v1 offset:47104
  v_mfma_f32_16x16x32_bf16 v[40:43], a[128:131], a[4:7], v[84:87]
  v_exp_f32 v48, v48
  v_mfma_f32_16x16x32_bf16 v[36:39], a[132:135], a[0:3], v[80:83]
  ds_read_b128 a[188:191], v1 offset:48128
  buffer_load_dwordx4 v4, s[16:19], s47 offen offset:0 sc1 lds
  v_mfma_f32_16x16x32_bf16 v[44:47], a[132:135], a[4:7], v[84:87]
  v_exp_f32 v49, v49
  v_mfma_f32_16x16x32_bf16 v[32:35], a[136:139], a[8:11], v[32:35]
  v_exp_f32 v50, v50
  v_mfma_f32_16x16x32_bf16 v[40:43], a[136:139], a[12:15], v[40:43]
  ds_read_b128 a[128:131], v10 offset:16384
  v_mfma_f32_16x16x32_bf16 v[36:39], a[140:143], a[8:11], v[36:39]
  ds_read_b128 a[132:135], v10 offset:17408
  v_cvt_pk_bf16_f32 v72, v48, v49
  v_mfma_f32_16x16x32_bf16 v[44:47], a[140:143], a[12:15], v[44:47]
  v_exp_f32 v51, v51
  v_mfma_f32_16x16x32_bf16 v[32:35], a[144:147], a[16:19], v[32:35]
  ds_read_b128 a[136:139], v10 offset:18432
  v_exp_f32 v53, v53
  v_mfma_f32_16x16x32_bf16 v[40:43], a[144:147], a[20:23], v[40:43]
  v_exp_f32 v52, v52
  v_mfma_f32_16x16x32_bf16 v[36:39], a[148:151], a[16:19], v[36:39]
  ds_read_b128 a[140:143], v10 offset:19456
  buffer_load_dwordx4 v4, s[16:19], s47 offen offset:1024 sc1 lds
  v_mfma_f32_16x16x32_bf16 v[44:47], a[148:151], a[20:23], v[44:47]
  v_cvt_pk_bf16_f32 v73, v50, v51
  v_fma_f32 v24, v24, s82, s82
  v_mfma_f32_16x16x32_bf16 v[32:35], a[152:155], a[24:27], v[32:35]
  ds_read_b128 a[144:147], v10 offset:20480
  v_add_f32 v8, v8, v50
  v_mfma_f32_16x16x32_bf16 v[40:43], a[152:155], a[28:31], v[40:43]
  v_exp_f32 v54, v54
  v_mfma_f32_16x16x32_bf16 v[36:39], a[156:159], a[24:27], v[36:39]
  s_waitcnt lgkmcnt(5)
  ds_read_b128 a[148:151], v10 offset:21504
  v_cvt_pk_bf16_f32 v74, v52, v53
  v_mfma_f32_16x16x32_bf16 v[44:47], a[156:159], a[28:31], v[44:47]
  v_exp_f32 v55, v55
  v_mfma_f32_16x16x32_bf16 v[32:35], a[160:163], a[32:35], v[32:35]
  ds_read_b128 a[152:155], v10 offset:22528
  v_add_f32 v8, v8, v51
  v_mfma_f32_16x16x32_bf16 v[40:43], a[160:163], a[36:39], v[40:43]
  v_exp_f32 v56, v56
  v_mfma_f32_16x16x32_bf16 v[36:39], a[164:167], a[32:35], v[36:39]
  ds_read_b128 a[156:159], v10 offset:23552
  buffer_load_dwordx4 v4, s[16:19], s47 offen offset:2048 sc1 lds
  v_cvt_pk_bf16_f32 v75, v54, v55
  v_mfma_f32_16x16x32_bf16 v[44:47], a[164:167], a[36:39], v[44:47]
  v_exp_f32 v57, v57
  v_mfma_f32_16x16x32_bf16 v[32:35], a[168:171], a[40:43], v[32:35]
  ds_read_b128 a[160:163], v10 offset:24576
  v_add_f32 v8, v8, v52
  v_mfma_f32_16x16x32_bf16 v[40:43], a[168:171], a[44:47], v[40:43]
  v_exp_f32 v58, v58
  v_mfma_f32_16x16x32_bf16 v[36:39], a[172:175], a[40:43], v[36:39]
  ds_read_b128 a[164:167], v10 offset:25600
  v_cvt_pk_bf16_f32 v76, v56, v57
  v_mfma_f32_16x16x32_bf16 v[44:47], a[172:175], a[44:47], v[44:47]
  v_exp_f32 v59, v59
  v_mfma_f32_16x16x32_bf16 v[32:35], a[176:179], a[48:51], v[32:35]
  ds_read_b128 a[168:171], v10 offset:26624
  v_fma_f32 v25, v25, s82, s82
  v_mfma_f32_16x16x32_bf16 v[40:43], a[176:179], a[52:55], v[40:43]
  v_exp_f32 v60, v60
  v_mfma_f32_16x16x32_bf16 v[36:39], a[180:183], a[48:51], v[36:39]
  ds_read_b128 a[172:175], v10 offset:27648
  buffer_load_dwordx4 v4, s[16:19], s47 offen offset:3072 sc1 lds
  v_mfma_f32_16x16x32_bf16 v[44:47], a[180:183], a[52:55], v[44:47]
  v_exp_f32 v61, v61
  v_mfma_f32_16x16x32_bf16 v[32:35], a[184:187], a[56:59], v[32:35]
  v_exp_f32 v62, v62
  v_mfma_f32_16x16x32_bf16 v[40:43], a[184:187], a[60:63], v[40:43]
  ds_read_b128 a[176:179], v10 offset:28672
  v_cvt_pk_bf16_f32 v77, v58, v59
  v_mfma_f32_16x16x32_bf16 v[36:39], a[188:191], a[56:59], v[36:39]
  s_waitcnt lgkmcnt(5)
  ds_read_b128 a[180:183], v10 offset:29696
  buffer_load_dword v2, v97, s[8:11], s83 offen
  v_mfma_f32_16x16x32_bf16 v[44:47], a[188:191], a[60:63], v[44:47]
  v_exp_f32 v63, v63
  v_mfma_f32_16x16x32_bf16 v[128:131], a[128:131], v[72:75], v[128:131]
  s_add_u32 s83, s83, 512
  ds_read_b128 a[184:187], v10 offset:30720
  v_add_f32 v9, v9, v63
  v_mfma_f32_16x16x32_bf16 v[132:135], a[132:135], v[72:75], v[132:135]
  v_cvt_pk_bf16_f32 v78, v60, v61
  v_cvt_pk_bf16_f32 v79, v62, v63
  v_mfma_f32_16x16x32_bf16 v[144:147], a[136:139], v[72:75], v[144:147]
  s_add_u32 s46, s45, s38
  ds_read_b128 a[188:191], v10 offset:31744
  s_cmp_eq_u32 s35, s39
  s_cselect_b32 s46, s40, s46
  s_cselect_b32 s38, s52, s38
  v_mfma_f32_16x16x32_bf16 v[148:151], a[140:143], v[72:75], v[148:151]
  v_fma_f32 v26, v26, s82, s82
  v_add_f32 v8, v8, v53
  v_mfma_f32_16x16x32_bf16 v[136:139], a[128:131], v[76:79], v[136:139]
  s_waitcnt vmcnt(9)
  s_barrier
  v_mfma_f32_16x16x32_bf16 v[140:143], a[132:135], v[76:79], v[140:143]
  ds_read_b128 a[128:131], v1 offset:49152
  v_add_f32 v8, v8, v54
  v_mfma_f32_16x16x32_bf16 v[152:155], a[136:139], v[76:79], v[152:155]
  s_add_u32 m0, s43, 32768
  ds_read_b128 a[132:135], v1 offset:50176
  s_cmp_eq_u32 s35, 6
  s_cselect_b32 s46, s41, s46
  s_cselect_b32 s38, 0x8000, s38
  v_mfma_f32_16x16x32_bf16 v[156:159], a[140:143], v[76:79], v[156:159]
  v_fma_f32 v27, v27, s82, s82
  v_add_f32 v8, v8, v55
  v_mfma_f32_16x16x32_bf16 v[160:163], a[144:147], v[72:75], v[160:163]
  ds_read_b128 a[136:139], v1 offset:51200
  buffer_load_dwordx4 v3, s[16:19], s46 offen offset:0 sc1 lds
  v_mfma_f32_16x16x32_bf16 v[168:171], a[144:147], v[76:79], v[168:171]
  v_rcp_f32 v24, v24
  v_mfma_f32_16x16x32_bf16 v[164:167], a[148:151], v[72:75], v[164:167]
  v_add_f32 v8, v8, v48
  v_add_f32 v9, v9, v56
  v_mfma_f32_16x16x32_bf16 v[172:175], a[148:151], v[76:79], v[172:175]
  ds_read_b128 a[140:143], v1 offset:52224
  v_max3_f32 v18, v32, v33, v34
  v_mfma_f32_16x16x32_bf16 v[176:179], a[152:155], v[72:75], v[176:179]
  v_rcp_f32 v25, v25
  v_mfma_f32_16x16x32_bf16 v[184:187], a[152:155], v[76:79], v[184:187]
  ds_read_b128 a[144:147], v1 offset:53248
  v_max3_f32 v19, v35, v36, v37
  v_mfma_f32_16x16x32_bf16 v[180:183], a[156:159], v[72:75], v[180:183]
  s_waitcnt lgkmcnt(5)
  ds_read_b128 a[148:151], v1 offset:54272
  buffer_load_dwordx4 v3, s[16:19], s46 offen offset:1024 sc1 lds
  v_mfma_f32_16x16x32_bf16 v[188:191], a[156:159], v[76:79], v[188:191]
  v_rcp_f32 v26, v26
  v_mfma_f32_16x16x32_bf16 v[192:195], a[160:163], v[72:75], v[192:195]
  v_add_f32 v8, v8, v49
  v_add_f32 v9, v9, v57
  v_mfma_f32_16x16x32_bf16 v[200:203], a[160:163], v[76:79], v[200:203]
  ds_read_b128 a[152:155], v1 offset:55296
  v_max3_f32 v20, v38, v39, v40
  v_mfma_f32_16x16x32_bf16 v[196:199], a[164:167], v[72:75], v[196:199]
  v_max3_f32 v22, v44, v45, v46
  v_add_f32 v9, v9, v58
  v_mfma_f32_16x16x32_bf16 v[204:207], a[164:167], v[76:79], v[204:207]
  ds_read_b128 a[156:159], v1 offset:56320
  v_max3_f32 v21, v41, v42, v43
  v_mfma_f32_16x16x32_bf16 v[208:211], a[168:171], v[72:75], v[208:211]
  ds_read_b128 a[160:163], v1 offset:57344
  buffer_load_dwordx4 v3, s[16:19], s46 offen offset:2048 sc1 lds
  v_mfma_f32_16x16x32_bf16 v[216:219], a[168:171], v[76:79], v[216:219]
  v_rcp_f32 v27, v27
  v_mfma_f32_16x16x32_bf16 v[212:215], a[172:175], v[72:75], v[212:215]
  v_mul_f32 v24, v24, v124
  v_add_f32 v9, v9, v59
  v_mfma_f32_16x16x32_bf16 v[220:223], a[172:175], v[76:79], v[220:223]
  ds_read_b128 a[164:167], v1 offset:58368
  v_max3_f32 v18, v18, v19, v20
  v_mfma_f32_16x16x32_bf16 v[224:227], a[176:179], v[72:75], v[224:227]
  v_mul_f32 v25, v25, v125
  v_add_f32 v9, v9, v60
  v_mfma_f32_16x16x32_bf16 v[232:235], a[176:179], v[76:79], v[232:235]
  ds_read_b128 a[168:171], v1 offset:59392
  v_max3_f32 v21, v21, v22, v47
  v_mfma_f32_16x16x32_bf16 v[228:231], a[180:183], v[72:75], v[228:231]
  ds_read_b128 a[172:175], v1 offset:60416
  buffer_load_dwordx4 v3, s[16:19], s46 offen offset:3072 sc1 lds
  v_mfma_f32_16x16x32_bf16 v[236:239], a[180:183], v[76:79], v[236:239]
  v_mul_f32 v26, v26, v126
  v_mul_f32 v27, v27, v127
  v_mfma_f32_16x16x32_bf16 v[240:243], a[184:187], v[72:75], v[240:243]
  v_cvt_pk_bf16_f32 v28, v24, v25
  v_add_f32 v9, v9, v61
  v_mfma_f32_16x16x32_bf16 v[248:251], a[184:187], v[76:79], v[248:251]
  ds_read_b128 a[176:179], v1 offset:61440
  v_max_f32 v15, v18, v21
  v_mfma_f32_16x16x32_bf16 v[244:247], a[188:191], v[72:75], v[244:247]
  v_cvt_pk_bf16_f32 v29, v26, v27
  v_add_f32 v9, v9, v62
  v_mfma_f32_16x16x32_bf16 v[252:255], a[188:191], v[76:79], v[252:255]
  ds_read_b128 a[180:183], v1 offset:62464
  v_cmp_lt_f32 vcc, s36, v15
  s_cmp_eq_u32 s35, s49
  s_cbranch_scc1 A_SW2
  s_cbranch_vccnz A_ST_L1
A_RET_L1:
  s_waitcnt lgkmcnt(6)
  v_mfma_f32_16x16x32_bf16 v[48:51], a[128:131], a[0:3], v[80:83]
  s_add_u32 m0, s43, 65536
  ds_read_b128 a[184:187], v1 offset:63488
  v_mfma_f32_16x16x32_bf16 v[56:59], a[128:131], a[4:7], v[84:87]
  v_exp_f32 v32, v32
  v_mfma_f32_16x16x32_bf16 v[52:55], a[132:135], a[0:3], v[80:83]
  ds_read_b128 a[188:191], v1 offset:64512
  buffer_load_dwordx4 v4, s[16:19], s44 offen offset:0 sc1 lds
  v_mfma_f32_16x16x32_bf16 v[60:63], a[132:135], a[4:7], v[84:87]
  v_exp_f32 v33, v33
  v_mfma_f32_16x16x32_bf16 v[48:51], a[136:139], a[8:11], v[48:51]
  v_exp_f32 v34, v34
  v_mfma_f32_16x16x32_bf16 v[56:59], a[136:139], a[12:15], v[56:59]
  ds_read_b128 a[128:131], v10 offset:32768
  v_mfma_f32_16x16x32_bf16 v[52:55], a[140:143], a[8:11], v[52:55]
  ds_read_b128 a[132:135], v10 offset:33792
  v_cvt_pk_bf16_f32 v64, v32, v33
  v_mfma_f32_16x16x32_bf16 v[60:63], a[140:143], a[12:15], v[60:63]
  v_exp_f32 v35, v35
  v_mfma_f32_16x16x32_bf16 v[48:51], a[144:147], a[16:19], v[48:51]
  v_exp_f32 v36, v36
  v_mfma_f32_16x16x32_bf16 v[56:59], a[144:147], a[20:23], v[56:59]
  ds_read_b128 a[136:139], v10 offset:34816
  v_mfma_f32_16x16x32_bf16 v[52:55], a[148:151], a[16:19], v[52:55]
  ds_read_b128 a[140:143], v10 offset:35840
  buffer_load_dwordx4 v4, s[16:19], s44 offen offset:1024 sc1 lds
  v_cvt_pk_bf16_f32 v65, v34, v35
  v_mfma_f32_16x16x32_bf16 v[60:63], a[148:151], a[20:23], v[60:63]
  v_exp_f32 v37, v37
  v_mfma_f32_16x16x32_bf16 v[48:51], a[152:155], a[24:27], v[48:51]
  v_exp_f32 v38, v38
  v_mfma_f32_16x16x32_bf16 v[56:59], a[152:155], a[28:31], v[56:59]
  ds_read_b128 a[144:147], v10 offset:36864
  v_mfma_f32_16x16x32_bf16 v[52:55], a[156:159], a[24:27], v[52:55]
  s_waitcnt lgkmcnt(5)
  ds_read_b128 a[148:151], v10 offset:37888
  v_cvt_pk_bf16_f32 v66, v36, v37
  v_mfma_f32_16x16x32_bf16 v[60:63], a[156:159], a[28:31], v[60:63]
  v_exp_f32 v39, v39
  v_mfma_f32_16x16x32_bf16 v[48:51], a[160:163], a[32:35], v[48:51]
  ds_read_b128 a[152:155], v10 offset:38912
  v_add_f32 v8, v8, v38
  v_mfma_f32_16x16x32_bf16 v[56:59], a[160:163], a[36:39], v[56:59]
  v_exp_f32 v40, v40
  v_mfma_f32_16x16x32_bf16 v[52:55], a[164:167], a[32:35], v[52:55]
  ds_read_b128 a[156:159], v10 offset:39936
  buffer_load_dwordx4 v4, s[16:19], s44 offen offset:2048 sc1 lds
  v_mfma_f32_16x16x32_bf16 v[60:63], a[164:167], a[36:39], v[60:63]
  v_exp_f32 v41, v41
  v_mfma_f32_16x16x32_bf16 v[48:51], a[168:171], a[40:43], v[48:51]
  v_exp_f32 v42, v42
  v_mfma_f32_16x16x32_bf16 v[56:59], a[168:171], a[44:47], v[56:59]
  ds_read_b128 a[160:163], v10 offset:40960
  v_cvt_pk_bf16_f32 v67, v38, v39
  v_mfma_f32_16x16x32_bf16 v[52:55], a[172:175], a[40:43], v[52:55]
  ds_read_b128 a[164:167], v10 offset:41984
  v_add_f32 v8, v8, v39
  v_mfma_f32_16x16x32_bf16 v[60:63], a[172:175], a[44:47], v[60:63]
  v_exp_f32 v43, v43
  v_mfma_f32_16x16x32_bf16 v[48:51], a[176:179], a[48:51], v[48:51]
  v_exp_f32 v44, v44
  v_mfma_f32_16x16x32_bf16 v[56:59], a[176:179], a[52:55], v[56:59]
  ds_read_b128 a[168:171], v10 offset:43008
  v_cvt_pk_bf16_f32 v68, v40, v41
  v_mfma_f32_16x16x32_bf16 v[52:55], a[180:183], a[48:51], v[52:55]
  ds_read_b128 a[172:175], v10 offset:44032
  buffer_load_dwordx4 v4, s[16:19], s44 offen offset:3072 sc1 lds
  v_mfma_f32_16x16x32_bf16 v[60:63], a[180:183], a[52:55], v[60:63]
  v_exp_f32 v45, v45
  v_mfma_f32_16x16x32_bf16 v[48:51], a[184:187], a[56:59], v[48:51]
  v_lshlrev_b32 v124, 16, v122
  v_add_f32 v9, v9, v40
  v_mfma_f32_16x16x32_bf16 v[56:59], a[184:187], a[60:63], v[56:59]
  ds_read_b128 a[176:179], v10 offset:45056
  v_cvt_pk_bf16_f32 v69, v42, v43
  v_mfma_f32_16x16x32_bf16 v[52:55], a[188:191], a[56:59], v[52:55]
  ds_read_b128 a[180:183], v10 offset:46080
  v_exp_f32 v47, v47
  v_mfma_f32_16x16x32_bf16 v[60:63], a[188:191], a[60:63], v[60:63]
  s_waitcnt lgkmcnt(6)
  v_exp_f32 v46, v46
  v_mfma_f32_16x16x32_bf16 v[128:131], a[128:131], v[64:67], v[128:131]
  v_cvt_pk_bf16_f32 v71, v46, v47
  v_add_f32 v9, v9, v41
  v_mfma_f32_16x16x32_bf16 v[132:135], a[132:135], v[64:67], v[132:135]
  ds_read_b128 a[184:187], v10 offset:47104
  v_cvt_pk_bf16_f32 v70, v44, v45
  v_mfma_f32_16x16x32_bf16 v[144:147], a[136:139], v[64:67], v[144:147]
  ds_read_b128 a[188:191], v10 offset:48128
  v_mfma_f32_16x16x32_bf16 v[148:151], a[140:143], v[64:67], v[148:151]
  s_bitcmp1_b32 10, s35
  s_cbranch_scc1 A_KV2L
A_KV2L_RET:
  v_and_b32 v125, 0xffff0000, v122
  v_mfma_f32_16x16x32_bf16 v[136:139], a[128:131], v[68:71], v[136:139]
  s_cmp_eq_u32 s35, s49
  s_cbranch_scc1 A_ALTW
  s_waitcnt vmcnt(9)
A_ALTW_RET:
  s_barrier
  v_mfma_f32_16x16x32_bf16 v[140:143], a[132:135], v[68:71], v[140:143]
  ds_read_b128 a[128:131], v1 offset:0
  v_mfma_f32_16x16x32_bf16 v[152:155], a[136:139], v[68:71], v[152:155]
  s_add_u32 m0, s43, 49152
  ds_read_b128 a[132:135], v1 offset:1024
  s_add_u32 s47, s46, s38
  v_mfma_f32_16x16x32_bf16 v[156:159], a[140:143], v[68:71], v[156:159]
  v_max3_f32 v18, v48, v49, v50
  v_add_f32 v8, v8, v37
  v_mfma_f32_16x16x32_bf16 v[160:163], a[144:147], v[64:67], v[160:163]
  ds_read_b128 a[136:139], v1 offset:2048
  buffer_load_dwordx4 v3, s[16:19], s47 offen offset:0 sc1 lds
  v_mfma_f32_16x16x32_bf16 v[168:171], a[144:147], v[68:71], v[168:171]
  v_lshlrev_b32 v126, 16, v123
  v_add_f32 v9, v9, v42
  v_mfma_f32_16x16x32_bf16 v[164:167], a[148:151], v[64:67], v[164:167]
  ds_read_b128 a[140:143], v1 offset:3072
  v_mfma_f32_16x16x32_bf16 v[172:175], a[148:151], v[68:71], v[172:175]
  s_cmp_lt_u32 s35, s78
  s_cbranch_scc1 A_KV2S
A_KV2S_RET:
  v_and_b32 v127, 0xffff0000, v123
  v_mfma_f32_16x16x32_bf16 v[176:179], a[152:155], v[64:67], v[176:179]
  v_add_f32 v8, v8, v32
  v_add_f32 v9, v9, v43
  v_mfma_f32_16x16x32_bf16 v[184:187], a[152:155], v[68:71], v[184:187]
  ds_read_b128 a[144:147], v1 offset:4096
  v_max3_f32 v19, v51, v52, v53
  v_mfma_f32_16x16x32_bf16 v[180:183], a[156:159], v[64:67], v[180:183]
  s_waitcnt lgkmcnt(5)
  ds_read_b128 a[148:151], v1 offset:5120
  buffer_load_dwordx4 v3, s[16:19], s47 offen offset:1024 sc1 lds
  v_mfma_f32_16x16x32_bf16 v[188:191], a[156:159], v[68:71], v[188:191]
  v_exp_f32 v24, -v124
  v_mfma_f32_16x16x32_bf16 v[192:195], a[160:163], v[64:67], v[192:195]
  v_add_f32 v8, v8, v33
  v_add_f32 v9, v9, v44
  v_mfma_f32_16x16x32_bf16 v[200:203], a[160:163], v[68:71], v[200:203]
  ds_read_b128 a[152:155], v1 offset:6144
  v_max3_f32 v20, v54, v55, v56
  v_mfma_f32_16x16x32_bf16 v[196:199], a[164:167], v[64:67], v[196:199]
  v_exp_f32 v25, -v125
  v_mfma_f32_16x16x32_bf16 v[204:207], a[164:167], v[68:71], v[204:207]
  ds_read_b128 a[156:159], v1 offset:7168
  v_max3_f32 v21, v57, v58, v59
  v_mfma_f32_16x16x32_bf16 v[208:211], a[168:171], v[64:67], v[208:211]
  ds_read_b128 a[160:163], v1 offset:8192
  buffer_load_dwordx4 v3, s[16:19], s47 offen offset:2048 sc1 lds
  v_mfma_f32_16x16x32_bf16 v[216:219], a[168:171], v[68:71], v[216:219]
  v_add_f32 v8, v8, v34
  v_add_f32 v9, v9, v45
  v_mfma_f32_16x16x32_bf16 v[212:215], a[172:175], v[64:67], v[212:215]
  v_exp_f32 v26, -v126
  v_mfma_f32_16x16x32_bf16 v[220:223], a[172:175], v[68:71], v[220:223]
  ds_read_b128 a[164:167], v1 offset:9216
  v_max3_f32 v22, v60, v61, v62
  v_mfma_f32_16x16x32_bf16 v[224:227], a[176:179], v[64:67], v[224:227]
  v_max3_f32 v21, v21, v22, v63
  v_add_f32 v9, v9, v46
  v_mfma_f32_16x16x32_bf16 v[232:235], a[176:179], v[68:71], v[232:235]
  ds_read_b128 a[168:171], v1 offset:10240
  v_max3_f32 v18, v18, v19, v20
  v_mfma_f32_16x16x32_bf16 v[228:231], a[180:183], v[64:67], v[228:231]
  ds_read_b128 a[172:175], v1 offset:11264
  buffer_load_dwordx4 v3, s[16:19], s47 offen offset:3072 sc1 lds
  v_mfma_f32_16x16x32_bf16 v[236:239], a[180:183], v[68:71], v[236:239]
  v_add_f32 v8, v8, v35
  v_add_f32 v9, v9, v47
  v_mfma_f32_16x16x32_bf16 v[240:243], a[184:187], v[64:67], v[240:243]
  v_exp_f32 v27, -v127
  v_mfma_f32_16x16x32_bf16 v[248:251], a[184:187], v[68:71], v[248:251]
  ds_read_b128 a[176:179], v1 offset:12288
  v_max_f32 v15, v18, v21
  v_mfma_f32_16x16x32_bf16 v[244:247], a[188:191], v[64:67], v[244:247]
  v_cmp_lt_f32 vcc, s36, v15
  v_add_f32 v8, v8, v36
  v_mfma_f32_16x16x32_bf16 v[252:255], a[188:191], v[68:71], v[252:255]
  ds_read_b128 a[180:183], v1 offset:13312
  s_cbranch_vccnz A_ST_L2
A_RET_L2:
  s_waitcnt lgkmcnt(6)
  v_mfma_f32_16x16x32_bf16 v[32:35], a[128:131], a[0:3], v[80:83]
  s_add_u32 m0, s43, 81920
  ds_read_b128 a[184:187], v1 offset:14336
  v_mfma_f32_16x16x32_bf16 v[40:43], a[128:131], a[4:7], v[84:87]
  v_exp_f32 v48, v48
  v_mfma_f32_16x16x32_bf16 v[36:39], a[132:135], a[0:3], v[80:83]
  ds_read_b128 a[188:191], v1 offset:15360
  buffer_load_dwordx4 v4, s[16:19], s45 offen offset:0 sc1 lds
  v_mfma_f32_16x16x32_bf16 v[44:47], a[132:135], a[4:7], v[84:87]
  v_exp_f32 v49, v49
  v_mfma_f32_16x16x32_bf16 v[32:35], a[136:139], a[8:11], v[32:35]
  v_exp_f32 v50, v50
  v_mfma_f32_16x16x32_bf16 v[40:43], a[136:139], a[12:15], v[40:43]
  ds_read_b128 a[128:131], v10 offset:49152
  v_mfma_f32_16x16x32_bf16 v[36:39], a[140:143], a[8:11], v[36:39]
  ds_read_b128 a[132:135], v10 offset:50176
  v_cvt_pk_bf16_f32 v72, v48, v49
  v_mfma_f32_16x16x32_bf16 v[44:47], a[140:143], a[12:15], v[44:47]
  v_exp_f32 v51, v51
  v_mfma_f32_16x16x32_bf16 v[32:35], a[144:147], a[16:19], v[32:35]
  ds_read_b128 a[136:139], v10 offset:51200
  v_exp_f32 v53, v53
  v_mfma_f32_16x16x32_bf16 v[40:43], a[144:147], a[20:23], v[40:43]
  v_exp_f32 v52, v52
  v_mfma_f32_16x16x32_bf16 v[36:39], a[148:151], a[16:19], v[36:39]
  ds_read_b128 a[140:143], v10 offset:52224
  buffer_load_dwordx4 v4, s[16:19], s45 offen offset:1024 sc1 lds
  v_mfma_f32_16x16x32_bf16 v[44:47], a[148:151], a[20:23], v[44:47]
  v_cvt_pk_bf16_f32 v73, v50, v51
  v_add_f32 v8, v8, v51
  v_mfma_f32_16x16x32_bf16 v[32:35], a[152:155], a[24:27], v[32:35]
  ds_read_b128 a[144:147], v10 offset:53248
  v_fma_f32 v24, v24, s82, s82
  v_mfma_f32_16x16x32_bf16 v[40:43], a[152:155], a[28:31], v[40:43]
  v_exp_f32 v54, v54
  v_mfma_f32_16x16x32_bf16 v[36:39], a[156:159], a[24:27], v[36:39]
  s_waitcnt lgkmcnt(5)
  ds_read_b128 a[148:151], v10 offset:54272
  v_cvt_pk_bf16_f32 v74, v52, v53
  v_mfma_f32_16x16x32_bf16 v[44:47], a[156:159], a[28:31], v[44:47]
  v_exp_f32 v55, v55
  v_mfma_f32_16x16x32_bf16 v[32:35], a[160:163], a[32:35], v[32:35]
  ds_read_b128 a[152:155], v10 offset:55296
  v_add_f32 v8, v8, v52
  v_mfma_f32_16x16x32_bf16 v[40:43], a[160:163], a[36:39], v[40:43]
  v_exp_f32 v56, v56
  v_mfma_f32_16x16x32_bf16 v[36:39], a[164:167], a[32:35], v[36:39]
  ds_read_b128 a[156:159], v10 offset:56320
  buffer_load_dwordx4 v4, s[16:19], s45 offen offset:2048 sc1 lds
  v_cvt_pk_bf16_f32 v75, v54, v55
  v_mfma_f32_16x16x32_bf16 v[44:47], a[164:167], a[36:39], v[44:47]
  v_exp_f32 v57, v57
  v_mfma_f32_16x16x32_bf16 v[32:35], a[168:171], a[40:43], v[32:35]
  ds_read_b128 a[160:163], v10 offset:57344
  v_add_f32 v8, v8, v53
  v_mfma_f32_16x16x32_bf16 v[40:43], a[168:171], a[44:47], v[40:43]
  v_exp_f32 v58, v58
  v_mfma_f32_16x16x32_bf16 v[36:39], a[172:175], a[40:43], v[36:39]
  ds_read_b128 a[164:167], v10 offset:58368
  v_cvt_pk_bf16_f32 v76, v56, v57
  v_mfma_f32_16x16x32_bf16 v[44:47], a[172:175], a[44:47], v[44:47]
  v_exp_f32 v59, v59
  v_mfma_f32_16x16x32_bf16 v[32:35], a[176:179], a[48:51], v[32:35]
  ds_read_b128 a[168:171], v10 offset:59392
  v_add_f32 v8, v8, v54
  v_mfma_f32_16x16x32_bf16 v[40:43], a[176:179], a[52:55], v[40:43]
  v_exp_f32 v60, v60
  v_mfma_f32_16x16x32_bf16 v[36:39], a[180:183], a[48:51], v[36:39]
  ds_read_b128 a[172:175], v10 offset:60416
  buffer_load_dwordx4 v4, s[16:19], s45 offen offset:3072 sc1 lds
  v_mfma_f32_16x16x32_bf16 v[44:47], a[180:183], a[52:55], v[44:47]
  v_exp_f32 v61, v61
  v_mfma_f32_16x16x32_bf16 v[32:35], a[184:187], a[56:59], v[32:35]
  v_exp_f32 v62, v62
  v_mfma_f32_16x16x32_bf16 v[40:43], a[184:187], a[60:63], v[40:43]
  ds_read_b128 a[176:179], v10 offset:61440
  v_cvt_pk_bf16_f32 v77, v58, v59
  v_mfma_f32_16x16x32_bf16 v[36:39], a[188:191], a[56:59], v[36:39]
  s_waitcnt lgkmcnt(5)
  ds_read_b128 a[180:183], v10 offset:62464
  buffer_load_dword v2, v98, s[12:15], s84 offen
  v_mfma_f32_16x16x32_bf16 v[44:47], a[188:191], a[60:63], v[44:47]
  v_exp_f32 v63, v63
  v_mfma_f32_16x16x32_bf16 v[128:131], a[128:131], v[72:75], v[128:131]
  s_add_u32 s84, s84, 256
  ds_read_b128 a[184:187], v10 offset:63488
  v_add_f32 v9, v9, v61
  v_mfma_f32_16x16x32_bf16 v[132:135], a[132:135], v[72:75], v[132:135]
  v_cvt_pk_bf16_f32 v78, v60, v61
  v_cvt_pk_bf16_f32 v79, v62, v63
  v_mfma_f32_16x16x32_bf16 v[144:147], a[136:139], v[72:75], v[144:147]
  s_add_u32 s44, s47, s38
  ds_read_b128 a[188:191], v10 offset:64512
  v_add_f32 v9, v9, v62
  v_mfma_f32_16x16x32_bf16 v[148:151], a[140:143], v[72:75], v[148:151]
  v_fma_f32 v25, v25, s82, s82
  v_fma_f32 v26, v26, s82, s82
  v_mfma_f32_16x16x32_bf16 v[136:139], a[128:131], v[76:79], v[136:139]
  s_waitcnt vmcnt(9)
  s_barrier
  v_mfma_f32_16x16x32_bf16 v[140:143], a[132:135], v[76:79], v[140:143]
  ds_read_b128 a[128:131], v1 offset:16384
  v_fma_f32 v27, v27, s82, s82
  v_mfma_f32_16x16x32_bf16 v[152:155], a[136:139], v[76:79], v[152:155]
  s_add_u32 m0, s43, 0
  ds_read_b128 a[132:135], v1 offset:17408
  v_add_f32 v9, v9, v63
  v_mfma_f32_16x16x32_bf16 v[156:159], a[140:143], v[76:79], v[156:159]
  v_max3_f32 v18, v32, v33, v34
  v_add_f32 v8, v8, v49
  v_mfma_f32_16x16x32_bf16 v[160:163], a[144:147], v[72:75], v[160:163]
  ds_read_b128 a[136:139], v1 offset:18432
  buffer_load_dwordx4 v3, s[16:19], s44 offen offset:0 sc1 lds
  v_mfma_f32_16x16x32_bf16 v[168:171], a[144:147], v[76:79], v[168:171]
  v_rcp_f32 v24, v24
  v_mfma_f32_16x16x32_bf16 v[164:167], a[148:151], v[72:75], v[164:167]
  ds_read_b128 a[140:143], v1 offset:19456
  v_mfma_f32_16x16x32_bf16 v[172:175], a[148:151], v[76:79], v[172:175]
  s_cmp_eq_u32 s35, s50
  s_cbranch_scc1 A_SIG
A_SIG_RET:
  v_add_f32 v8, v8, v50
  v_mfma_f32_16x16x32_bf16 v[176:179], a[152:155], v[72:75], v[176:179]
  v_rcp_f32 v25, v25
  v_mfma_f32_16x16x32_bf16 v[184:187], a[152:155], v[76:79], v[184:187]
  ds_read_b128 a[144:147], v1 offset:20480
  v_max3_f32 v19, v35, v36, v37
  v_mfma_f32_16x16x32_bf16 v[180:183], a[156:159], v[72:75], v[180:183]
  s_waitcnt lgkmcnt(5)
  ds_read_b128 a[148:151], v1 offset:21504
  buffer_load_dwordx4 v3, s[16:19], s44 offen offset:1024 sc1 lds
  v_mfma_f32_16x16x32_bf16 v[188:191], a[156:159], v[76:79], v[188:191]
  v_rcp_f32 v26, v26
  v_mfma_f32_16x16x32_bf16 v[192:195], a[160:163], v[72:75], v[192:195]
  v_add_f32 v8, v8, v48
  v_add_f32 v8, v8, v55
  v_mfma_f32_16x16x32_bf16 v[200:203], a[160:163], v[76:79], v[200:203]
  ds_read_b128 a[152:155], v1 offset:22528
  v_max3_f32 v20, v38, v39, v40
  v_mfma_f32_16x16x32_bf16 v[196:199], a[164:167], v[72:75], v[196:199]
  v_rcp_f32 v27, v27
  v_mfma_f32_16x16x32_bf16 v[204:207], a[164:167], v[76:79], v[204:207]
  ds_read_b128 a[156:159], v1 offset:23552
  v_max3_f32 v21, v41, v42, v43
  v_mfma_f32_16x16x32_bf16 v[208:211], a[168:171], v[72:75], v[208:211]
  ds_read_b128 a[160:163], v1 offset:24576
  buffer_load_dwordx4 v3, s[16:19], s44 offen offset:2048 sc1 lds
  v_mfma_f32_16x16x32_bf16 v[216:219], a[168:171], v[76:79], v[216:219]
  v_mul_f32 v24, v24, v124
  v_add_f32 v9, v9, v56
  v_mfma_f32_16x16x32_bf16 v[212:215], a[172:175], v[72:75], v[212:215]
  v_max3_f32 v18, v18, v19, v20
  v_add_f32 v9, v9, v57
  v_mfma_f32_16x16x32_bf16 v[220:223], a[172:175], v[76:79], v[220:223]
  ds_read_b128 a[164:167], v1 offset:25600
  v_max3_f32 v22, v44, v45, v46
  v_mfma_f32_16x16x32_bf16 v[224:227], a[176:179], v[72:75], v[224:227]
  v_mul_f32 v25, v25, v125
  v_add_f32 v9, v9, v58
  v_mfma_f32_16x16x32_bf16 v[232:235], a[176:179], v[76:79], v[232:235]
  ds_read_b128 a[168:171], v1 offset:26624
  v_max3_f32 v21, v21, v22, v47
  v_mfma_f32_16x16x32_bf16 v[228:231], a[180:183], v[72:75], v[228:231]
  ds_read_b128 a[172:175], v1 offset:27648
  buffer_load_dwordx4 v3, s[16:19], s44 offen offset:3072 sc1 lds
  v_mfma_f32_16x16x32_bf16 v[236:239], a[180:183], v[76:79], v[236:239]
  v_mul_f32 v26, v26, v126
  v_mul_f32 v27, v27, v127
  v_mfma_f32_16x16x32_bf16 v[240:243], a[184:187], v[72:75], v[240:243]
  v_cvt_pk_bf16_f32 v30, v24, v25
  v_add_f32 v9, v9, v59
  v_mfma_f32_16x16x32_bf16 v[248:251], a[184:187], v[76:79], v[248:251]
  ds_read_b128 a[176:179], v1 offset:28672
  v_max_f32 v15, v18, v21
  v_mfma_f32_16x16x32_bf16 v[244:247], a[188:191], v[72:75], v[244:247]
  v_cvt_pk_bf16_f32 v31, v26, v27
  v_add_f32 v9, v9, v60
  v_mfma_f32_16x16x32_bf16 v[252:255], a[188:191], v[76:79], v[252:255]
  ds_read_b128 a[180:183], v1 offset:29696
  v_cmp_lt_f32 vcc, s36, v15
  s_cbranch_vccnz A_ST_L3
A_RET_L3:
  s_add_u32 s35, s35, 1
  s_bitcmp1_b32 20, s35
  s_cbranch_scc1 A_KV2C
  s_cmp_lt_u32 s35, 7
  s_cbranch_scc1 A_LOOP
  s_waitcnt lgkmcnt(6)
  ds_write_b128 v11, v[28:31]
  v_subrev_u32 v11, 0x1800, v11
  v_mfma_f32_16x16x32_bf16 v[48:51], a[128:131], a[0:3], v[80:83]
  s_add_u32 m0, s43, 98304
  ds_read_b128 a[184:187], v1 offset:30720
  ds_read_b128 a[192:195], v11 offset:0
  v_mfma_f32_16x16x32_bf16 v[56:59], a[128:131], a[4:7], v[84:87]
  v_exp_f32 v32, v32
  v_mfma_f32_16x16x32_bf16 v[52:55], a[132:135], a[0:3], v[80:83]
  ds_read_b128 a[188:191], v1 offset:31744
  buffer_load_dwordx4 v4, s[16:19], s46 offen offset:0 sc1 lds
  ds_read_b128 a[196:199], v11 offset:1024
  v_mfma_f32_16x16x32_bf16 v[60:63], a[132:135], a[4:7], v[84:87]
  v_exp_f32 v33, v33
  v_mfma_f32_16x16x32_bf16 v[48:51], a[136:139], a[8:11], v[48:51]
  v_exp_f32 v34, v34
  v_mfma_f32_16x16x32_bf16 v[56:59], a[136:139], a[12:15], v[56:59]
  ds_read_b128 a[128:131], v10 offset:0
  ds_read_b128 a[200:203], v11 offset:2048
  v_mfma_f32_16x16x32_bf16 v[52:55], a[140:143], a[8:11], v[52:55]
  v_exp_f32 v35, v35
  v_cvt_pk_bf16_f32 v64, v32, v33
  v_mfma_f32_16x16x32_bf16 v[60:63], a[140:143], a[12:15], v[60:63]
  ds_read_b128 a[132:135], v10 offset:1024
  ds_read_b128 a[204:207], v11 offset:3072
  v_mfma_f32_16x16x32_bf16 v[48:51], a[144:147], a[16:19], v[48:51]
  ds_read_b128 a[136:139], v10 offset:2048
  v_exp_f32 v37, v37
  v_mfma_f32_16x16x32_bf16 v[56:59], a[144:147], a[20:23], v[56:59]
  ds_read_b128 a[208:211], v11 offset:4096
  v_exp_f32 v36, v36
  v_mfma_f32_16x16x32_bf16 v[52:55], a[148:151], a[16:19], v[52:55]
  ds_read_b128 a[140:143], v10 offset:3072
  buffer_load_dwordx4 v4, s[16:19], s46 offen offset:1024 sc1 lds
  v_mfma_f32_16x16x32_bf16 v[60:63], a[148:151], a[20:23], v[60:63]
  ds_read_b128 a[212:215], v11 offset:5120
  v_cvt_pk_bf16_f32 v65, v34, v35
  v_mfma_f32_16x16x32_bf16 v[48:51], a[152:155], a[24:27], v[48:51]
  v_exp_f32 v38, v38
  v_mfma_f32_16x16x32_bf16 v[56:59], a[152:155], a[28:31], v[56:59]
  ds_read_b128 a[144:147], v10 offset:4096
  ds_read_b64 a[216:217], v11 offset:6144
  v_mfma_f32_16x16x32_bf16 v[52:55], a[156:159], a[24:27], v[52:55]
  v_exp_f32 v39, v39
  v_cvt_pk_bf16_f32 v66, v36, v37
  v_mfma_f32_16x16x32_bf16 v[60:63], a[156:159], a[28:31], v[60:63]
  s_waitcnt lgkmcnt(11)
  ds_read_b128 a[148:151], v10 offset:5120
  ds_read_b64 a[220:221], v11 offset:6152
  v_mfma_f32_16x16x32_bf16 v[48:51], a[160:163], a[32:35], v[48:51]
  ds_read_b128 a[152:155], v10 offset:6144
  v_exp_f32 v41, v41
  v_mfma_f32_16x16x32_bf16 v[56:59], a[160:163], a[36:39], v[56:59]
  v_exp_f32 v40, v40
  v_mfma_f32_16x16x32_bf16 v[52:55], a[164:167], a[32:35], v[52:55]
  ds_read_b128 a[156:159], v10 offset:7168
  buffer_load_dwordx4 v4, s[16:19], s46 offen offset:2048 sc1 lds
  v_mfma_f32_16x16x32_bf16 v[60:63], a[164:167], a[36:39], v[60:63]
  v_lshrrev_b32 v24, 3, v0
  v_cvt_pk_bf16_f32 v67, v38, v39
  v_mfma_f32_16x16x32_bf16 v[48:51], a[168:171], a[40:43], v[48:51]
  v_mul_u32_u24 v24, 896, v24
  v_exp_f32 v43, v43
  v_mfma_f32_16x16x32_bf16 v[56:59], a[168:171], a[44:47], v[56:59]
  ds_read_b128 a[160:163], v10 offset:8192
  v_exp_f32 v42, v42
  v_mfma_f32_16x16x32_bf16 v[52:55], a[172:175], a[40:43], v[52:55]
  v_and_b32 v25, 7, v0
  v_cvt_pk_bf16_f32 v68, v40, v41
  v_mfma_f32_16x16x32_bf16 v[60:63], a[172:175], a[44:47], v[60:63]
  ds_read_b128 a[164:167], v10 offset:9216
  v_lshrrev_b32 v26, 4, v0
  v_mfma_f32_16x16x32_bf16 v[48:51], a[176:179], a[48:51], v[48:51]
  v_exp_f32 v44, v44
  v_mfma_f32_16x16x32_bf16 v[56:59], a[176:179], a[52:55], v[56:59]
  ds_read_b128 a[168:171], v10 offset:10240
  v_lshlrev_b32 v27, 1, v26
  v_mfma_f32_16x16x32_bf16 v[52:55], a[180:183], a[48:51], v[52:55]
  ds_read_b128 a[172:175], v10 offset:11264
  buffer_load_dwordx4 v4, s[16:19], s46 offen offset:3072 sc1 lds
  v_xor_b32 v25, v25, v27
  v_mfma_f32_16x16x32_bf16 v[60:63], a[180:183], a[52:55], v[60:63]
  v_exp_f32 v45, v45
  v_mfma_f32_16x16x32_bf16 v[48:51], a[184:187], a[56:59], v[48:51]
  v_cvt_pk_bf16_f32 v69, v42, v43
  v_exp_f32 v46, v46
  v_mfma_f32_16x16x32_bf16 v[56:59], a[184:187], a[60:63], v[56:59]
  ds_read_b128 a[176:179], v10 offset:12288
  v_lshl_add_u32 v100, v25, 4, v24
  v_mfma_f32_16x16x32_bf16 v[52:55], a[188:191], a[56:59], v[52:55]
  v_add_u32 v102, 12288, v100
  v_exp_f32 v47, v47
  v_mfma_f32_16x16x32_bf16 v[60:63], a[188:191], a[60:63], v[60:63]
  s_waitcnt lgkmcnt(5)
  ds_read_b128 a[180:183], v10 offset:13312
  v_add_u32 v101, 6144, v100
  v_mfma_f32_16x16x32_bf16 v[128:131], a[128:131], v[64:67], v[128:131]
  v_cvt_pk_bf16_f32 v70, v44, v45
  v_cvt_pk_bf16_f32 v71, v46, v47
  v_add_f32 v9, v9, v44
  v_mfma_f32_16x16x32_bf16 v[132:135], a[132:135], v[64:67], v[132:135]
  ds_read_b128 a[184:187], v10 offset:14336
  v_add_u32 v103, 18432, v100
  v_mfma_f32_16x16x32_bf16 v[144:147], a[136:139], v[64:67], v[144:147]
  s_mul_i32 s56, s32, 229376
  ds_read_b128 a[188:191], v10 offset:15360
  s_mul_i32 s4, s3, 57344
  s_add_u32 s56, s56, s4
  s_mul_i32 s57, s32, 100352
  s_mul_i32 s4, s3, 28672
  s_add_u32 s57, s57, s4
  v_mfma_f32_16x16x32_bf16 v[148:151], a[140:143], v[64:67], v[148:151]
  s_add_u32 s45, s44, s38
  v_add_f32 v8, v8, v32
  v_add_f32 v9, v9, v43
  v_mfma_f32_16x16x32_bf16 v[136:139], a[128:131], v[68:71], v[136:139]
  s_waitcnt vmcnt(9)
  s_barrier
  v_add_f32 v9, v9, v45
  v_mfma_f32_16x16x32_bf16 v[140:143], a[132:135], v[68:71], v[140:143]
  ds_read_b128 a[128:131], v1 offset:32768
  v_add_f32 v8, v8, v33
  v_mfma_f32_16x16x32_bf16 v[152:155], a[136:139], v[68:71], v[152:155]
  s_add_u32 m0, s43, 16384
  ds_read_b128 a[132:135], v1 offset:33792
  s_lshl_b32 s60, s3, 13
  v_add_f32 v9, v9, v41
  v_mfma_f32_16x16x32_bf16 v[156:159], a[140:143], v[68:71], v[156:159]
  v_lshrrev_b32 v24, 2, v0
  v_max3_f32 v18, v48, v49, v50
  v_mfma_f32_16x16x32_bf16 v[160:163], a[144:147], v[64:67], v[160:163]
  ds_read_b128 a[136:139], v1 offset:34816
  buffer_load_dwordx4 v3, s[16:19], s45 offen offset:0 sc1 lds
  v_accvgpr_write_b32 a219, 0
  v_mfma_f32_16x16x32_bf16 v[168:171], a[144:147], v[68:71], v[168:171]
  v_bfe_u32 v25, v0, 3, 2
  v_accvgpr_write_b32 a218, 0
  v_mfma_f32_16x16x32_bf16 v[164:167], a[148:151], v[64:67], v[164:167]
  ds_read_b128 a[140:143], v1 offset:35840
  buffer_load_dwordx4 v3, s[16:19], s45 offen offset:1024 sc1 lds
  v_add_f32 v9, v9, v46
  v_mfma_f32_16x16x32_bf16 v[172:175], a[148:151], v[68:71], v[172:175]
  v_accvgpr_write_b32 a222, 0
  v_accvgpr_write_b32 a223, 0
  v_mfma_f32_16x16x32_bf16 v[176:179], a[152:155], v[64:67], v[176:179]
  v_lshlrev_b32 v24, 7, v24
  v_add_f32 v8, v8, v34
  v_add_f32 v9, v9, v47
  v_mfma_f32_16x16x32_bf16 v[184:187], a[152:155], v[68:71], v[184:187]
  ds_read_b128 a[144:147], v1 offset:36864
  v_lshl_add_u32 v24, v25, 5, v24
  v_mfma_f32_16x16x32_bf16 v[180:183], a[156:159], v[64:67], v[180:183]
  s_waitcnt lgkmcnt(5)
  ds_read_b128 a[148:151], v1 offset:37888
  buffer_load_dwordx4 v3, s[16:19], s45 offen offset:2048 sc1 lds
  v_mfma_f32_16x16x32_bf16 v[188:191], a[156:159], v[68:71], v[188:191]
  v_max3_f32 v19, v51, v52, v53
  v_add_f32 v8, v8, v39
  v_mfma_f32_16x16x32_bf16 v[192:195], a[160:163], v[64:67], v[192:195]
  ds_read_b128 a[152:155], v1 offset:38912
  buffer_load_dwordx4 v3, s[16:19], s45 offen offset:3072 sc1 lds
  v_mfma_f32_16x16x32_bf16 v[200:203], a[160:163], v[68:71], v[200:203]
  v_and_b32 v25, 3, v0
  v_max3_f32 v20, v54, v55, v56
  v_mfma_f32_16x16x32_bf16 v[196:199], a[164:167], v[64:67], v[196:199]
  s_add_u32 m0, s43, 131072
  ds_read_b128 a[156:159], v1 offset:39936
  v_add_f32 v9, v9, v40
  v_mfma_f32_16x16x32_bf16 v[204:207], a[164:167], v[68:71], v[204:207]
  v_lshl_add_u32 v104, v25, 3, v24
  v_max3_f32 v21, v57, v58, v59
  v_mfma_f32_16x16x32_bf16 v[208:211], a[168:171], v[64:67], v[208:211]
  ds_read_b128 a[160:163], v1 offset:40960
  buffer_load_dwordx4 v4, s[16:19], s44 offen offset:0 sc1 lds
  v_mfma_f32_16x16x32_bf16 v[216:219], a[168:171], v[68:71], v[216:219]
  v_max3_f32 v22, v60, v61, v62
  v_add_f32 v8, v8, v35
  v_mfma_f32_16x16x32_bf16 v[212:215], a[172:175], v[64:67], v[212:215]
  v_xor_b32 v106, 64, v104
  v_add_f32 v8, v8, v36
  v_mfma_f32_16x16x32_bf16 v[220:223], a[172:175], v[68:71], v[220:223]
  ds_read_b128 a[164:167], v1 offset:41984
  v_xor_b32 v105, 32, v104
  v_mfma_f32_16x16x32_bf16 v[224:227], a[176:179], v[64:67], v[224:227]
  ds_read_b128 a[168:171], v1 offset:43008
  buffer_load_dwordx4 v4, s[16:19], s44 offen offset:1024 sc1 lds
  v_mfma_f32_16x16x32_bf16 v[232:235], a[176:179], v[68:71], v[232:235]
  v_max3_f32 v18, v18, v19, v20
  v_max3_f32 v21, v21, v22, v63
  v_mfma_f32_16x16x32_bf16 v[228:231], a[180:183], v[64:67], v[228:231]
  ds_read_b128 a[172:175], v1 offset:44032
  buffer_load_dwordx4 v4, s[16:19], s44 offen offset:2048 sc1 lds
  v_mfma_f32_16x16x32_bf16 v[236:239], a[180:183], v[68:71], v[236:239]
  v_xor_b32 v107, 96, v104
  v_add_f32 v8, v8, v37
  v_mfma_f32_16x16x32_bf16 v[240:243], a[184:187], v[64:67], v[240:243]
  s_lshl_b32 s62, s32, 6
  ds_read_b128 a[176:179], v1 offset:45056
  s_lshl_b32 s4, s33, 2
  s_add_u32 s62, s62, s4
  s_add_u32 s62, s62, s3
  s_mul_i32 s62, s62, 28672
  v_mfma_f32_16x16x32_bf16 v[248:251], a[184:187], v[68:71], v[248:251]
  s_add_u32 s62, s62, 83886080
  v_max_f32 v15, v18, v21
  v_add_f32 v9, v9, v42
  v_mfma_f32_16x16x32_bf16 v[244:247], a[188:191], v[64:67], v[244:247]
  ds_read_b128 a[180:183], v1 offset:46080
  buffer_load_dwordx4 v4, s[16:19], s44 offen offset:3072 sc1 lds
  v_mfma_f32_16x16x32_bf16 v[252:255], a[188:191], v[68:71], v[252:255]
  v_cmp_lt_f32 vcc, s36, v15
  v_add_f32 v8, v8, v38
  s_cbranch_vccnz A_ST_P28
A_RET_P28:
  s_cmp_eq_u32 s35, s49
  s_cbranch_scc1 A_SW1
A_SW1_RET_P29:
  s_waitcnt lgkmcnt(6)
  v_mfma_f32_16x16x32_bf16 v[32:35], a[128:131], a[0:3], v[80:83]
  s_add_u32 m0, s43, 114688
  ds_read_b128 a[184:187], v1 offset:47104
  v_mfma_f32_16x16x32_bf16 v[40:43], a[128:131], a[4:7], v[84:87]
  v_exp_f32 v48, v48
  v_mfma_f32_16x16x32_bf16 v[36:39], a[132:135], a[0:3], v[80:83]
  ds_read_b128 a[188:191], v1 offset:48128
  buffer_load_dwordx4 v4, s[16:19], s47 offen offset:0 sc1 lds
  v_mfma_f32_16x16x32_bf16 v[44:47], a[132:135], a[4:7], v[84:87]
  v_exp_f32 v49, v49
  v_mfma_f32_16x16x32_bf16 v[32:35], a[136:139], a[8:11], v[32:35]
  v_exp_f32 v50, v50
  v_mfma_f32_16x16x32_bf16 v[40:43], a[136:139], a[12:15], v[40:43]
  ds_read_b128 a[128:131], v10 offset:16384
  v_mfma_f32_16x16x32_bf16 v[36:39], a[140:143], a[8:11], v[36:39]
  ds_read_b128 a[132:135], v10 offset:17408
  v_cvt_pk_bf16_f32 v72, v48, v49
  v_mfma_f32_16x16x32_bf16 v[44:47], a[140:143], a[12:15], v[44:47]
  v_exp_f32 v51, v51
  v_mfma_f32_16x16x32_bf16 v[32:35], a[144:147], a[16:19], v[32:35]
  v_exp_f32 v52, v52
  v_mfma_f32_16x16x32_bf16 v[40:43], a[144:147], a[20:23], v[40:43]
  ds_read_b128 a[136:139], v10 offset:18432
  v_mfma_f32_16x16x32_bf16 v[36:39], a[148:151], a[16:19], v[36:39]
  ds_read_b128 a[140:143], v10 offset:19456
  buffer_load_dwordx4 v4, s[16:19], s47 offen offset:1024 sc1 lds
  v_cvt_pk_bf16_f32 v73, v50, v51
  v_mfma_f32_16x16x32_bf16 v[44:47], a[148:151], a[20:23], v[44:47]
  v_exp_f32 v53, v53
  v_mfma_f32_16x16x32_bf16 v[32:35], a[152:155], a[24:27], v[32:35]
  v_exp_f32 v54, v54
  v_mfma_f32_16x16x32_bf16 v[40:43], a[152:155], a[28:31], v[40:43]
  ds_read_b128 a[144:147], v10 offset:20480
  v_mfma_f32_16x16x32_bf16 v[36:39], a[156:159], a[24:27], v[36:39]
  s_waitcnt lgkmcnt(5)
  ds_read_b128 a[148:151], v10 offset:21504
  v_cvt_pk_bf16_f32 v74, v52, v53
  v_mfma_f32_16x16x32_bf16 v[44:47], a[156:159], a[28:31], v[44:47]
  v_exp_f32 v55, v55
  v_mfma_f32_16x16x32_bf16 v[32:35], a[160:163], a[32:35], v[32:35]
  v_exp_f32 v56, v56
  v_mfma_f32_16x16x32_bf16 v[40:43], a[160:163], a[36:39], v[40:43]
  ds_read_b128 a[152:155], v10 offset:22528
  v_mfma_f32_16x16x32_bf16 v[36:39], a[164:167], a[32:35], v[36:39]
  ds_read_b128 a[156:159], v10 offset:23552
  buffer_load_dwordx4 v4, s[16:19], s47 offen offset:2048 sc1 lds
  v_mfma_f32_16x16x32_bf16 v[44:47], a[164:167], a[36:39], v[44:47]
  v_exp_f32 v57, v57
  v_mfma_f32_16x16x32_bf16 v[32:35], a[168:171], a[40:43], v[32:35]
  v_exp_f32 v58, v58
  v_mfma_f32_16x16x32_bf16 v[40:43], a[168:171], a[44:47], v[40:43]
  ds_read_b128 a[160:163], v10 offset:24576
  v_cvt_pk_bf16_f32 v75, v54, v55
  v_mfma_f32_16x16x32_bf16 v[36:39], a[172:175], a[40:43], v[36:39]
  v_exp_f32 v59, v59
  v_mfma_f32_16x16x32_bf16 v[44:47], a[172:175], a[44:47], v[44:47]
  ds_read_b128 a[164:167], v10 offset:25600
  v_mfma_f32_16x16x32_bf16 v[32:35], a[176:179], a[48:51], v[32:35]
  v_exp_f32 v60, v60
  v_mfma_f32_16x16x32_bf16 v[40:43], a[176:179], a[52:55], v[40:43]
  ds_read_b128 a[168:171], v10 offset:26624
  v_cvt_pk_bf16_f32 v76, v56, v57
  v_mfma_f32_16x16x32_bf16 v[36:39], a[180:183], a[48:51], v[36:39]
  ds_read_b128 a[172:175], v10 offset:27648
  buffer_load_dwordx4 v4, s[16:19], s47 offen offset:3072 sc1 lds
  v_mfma_f32_16x16x32_bf16 v[44:47], a[180:183], a[52:55], v[44:47]
  v_exp_f32 v61, v61
  v_mfma_f32_16x16x32_bf16 v[32:35], a[184:187], a[56:59], v[32:35]
  v_cvt_pk_bf16_f32 v77, v58, v59
  v_add_f32 v8, v8, v49
  v_mfma_f32_16x16x32_bf16 v[40:43], a[184:187], a[60:63], v[40:43]
  ds_read_b128 a[176:179], v10 offset:28672
  v_mfma_f32_16x16x32_bf16 v[36:39], a[188:191], a[56:59], v[36:39]
  ds_read_b128 a[180:183], v10 offset:29696
  v_exp_f32 v63, v63
  v_mfma_f32_16x16x32_bf16 v[44:47], a[188:191], a[60:63], v[44:47]
  s_waitcnt lgkmcnt(6)
  v_exp_f32 v62, v62
  v_mfma_f32_16x16x32_bf16 v[128:131], a[128:131], v[72:75], v[128:131]
  v_cvt_pk_bf16_f32 v79, v62, v63
  v_add_f32 v9, v9, v63
  v_mfma_f32_16x16x32_bf16 v[132:135], a[132:135], v[72:75], v[132:135]
  ds_read_b128 a[184:187], v10 offset:30720
  v_cvt_pk_bf16_f32 v78, v60, v61
  v_mfma_f32_16x16x32_bf16 v[144:147], a[136:139], v[72:75], v[144:147]
  v_add_f32 v8, v8, v48
  v_add_f32 v8, v8, v50
  v_mfma_f32_16x16x32_bf16 v[148:151], a[140:143], v[72:75], v[148:151]
  ds_read_b128 a[188:191], v10 offset:31744
  v_mfma_f32_16x16x32_bf16 v[136:139], a[128:131], v[76:79], v[136:139]
  s_waitcnt vmcnt(12)
  s_barrier
  v_mfma_f32_16x16x32_bf16 v[140:143], a[132:135], v[76:79], v[140:143]
  ds_read_b128 a[128:131], v1 offset:49152
  v_mfma_f32_16x16x32_bf16 v[152:155], a[136:139], v[76:79], v[152:155]
  s_add_u32 m0, s43, 147456
  ds_read_b128 a[132:135], v1 offset:50176
  v_mfma_f32_16x16x32_bf16 v[156:159], a[140:143], v[76:79], v[156:159]
  s_cmp_eq_u32 s3, 0
  s_cbranch_scc1 A_MASK29
A_MASK29_RET:
  v_add_f32 v9, v9, v62
  v_mfma_f32_16x16x32_bf16 v[160:163], a[144:147], v[72:75], v[160:163]
  ds_read_b128 a[136:139], v1 offset:51200
  buffer_load_dwordx4 v4, s[16:19], s45 offen offset:0 sc1 lds
  v_mfma_f32_16x16x32_bf16 v[168:171], a[144:147], v[76:79], v[168:171]
  v_add_f32 v8, v8, v51
  v_mfma_f32_16x16x32_bf16 v[164:167], a[148:151], v[72:75], v[164:167]
  v_max3_f32 v18, v32, v33, v34
  v_add_f32 v8, v8, v52
  v_mfma_f32_16x16x32_bf16 v[172:175], a[148:151], v[76:79], v[172:175]
  ds_read_b128 a[140:143], v1 offset:52224
  v_mfma_f32_16x16x32_bf16 v[176:179], a[152:155], v[72:75], v[176:179]
  v_max3_f32 v19, v35, v36, v37
  v_add_f32 v8, v8, v53
  v_mfma_f32_16x16x32_bf16 v[184:187], a[152:155], v[76:79], v[184:187]
  ds_read_b128 a[144:147], v1 offset:53248
  v_mfma_f32_16x16x32_bf16 v[180:183], a[156:159], v[72:75], v[180:183]
  s_waitcnt lgkmcnt(5)
  ds_read_b128 a[148:151], v1 offset:54272
  v_mfma_f32_16x16x32_bf16 v[188:191], a[156:159], v[76:79], v[188:191]
  buffer_load_dwordx4 v4, s[16:19], s45 offen offset:1024 sc1 lds
  v_add_f32 v9, v9, v61
  v_mfma_f32_16x16x32_bf16 v[192:195], a[160:163], v[72:75], v[192:195]
  v_max3_f32 v20, v38, v39, v40
  v_add_f32 v8, v8, v54
  v_mfma_f32_16x16x32_bf16 v[200:203], a[160:163], v[76:79], v[200:203]
  ds_read_b128 a[152:155], v1 offset:55296
  v_mfma_f32_16x16x32_bf16 v[196:199], a[164:167], v[72:75], v[196:199]
  v_max3_f32 v21, v41, v42, v43
  v_add_f32 v8, v8, v55
  v_mfma_f32_16x16x32_bf16 v[204:207], a[164:167], v[76:79], v[204:207]
  ds_read_b128 a[156:159], v1 offset:56320
  v_mfma_f32_16x16x32_bf16 v[208:211], a[168:171], v[72:75], v[208:211]
  ds_read_b128 a[160:163], v1 offset:57344
  buffer_load_dwordx4 v4, s[16:19], s45 offen offset:2048 sc1 lds
  v_mfma_f32_16x16x32_bf16 v[216:219], a[168:171], v[76:79], v[216:219]
  v_add_f32 v9, v9, v56
  v_mfma_f32_16x16x32_bf16 v[212:215], a[172:175], v[72:75], v[212:215]
  v_max3_f32 v22, v44, v45, v46
  v_max3_f32 v18, v18, v19, v20
  v_mfma_f32_16x16x32_bf16 v[220:223], a[172:175], v[76:79], v[220:223]
  ds_read_b128 a[164:167], v1 offset:58368
  v_mfma_f32_16x16x32_bf16 v[224:227], a[176:179], v[72:75], v[224:227]
  v_max3_f32 v21, v21, v22, v47
  v_add_f32 v9, v9, v57
  v_mfma_f32_16x16x32_bf16 v[232:235], a[176:179], v[76:79], v[232:235]
  ds_read_b128 a[168:171], v1 offset:59392
  v_mfma_f32_16x16x32_bf16 v[228:231], a[180:183], v[72:75], v[228:231]
  ds_read_b128 a[172:175], v1 offset:60416
  buffer_load_dwordx4 v4, s[16:19], s45 offen offset:3072 sc1 lds
  v_mfma_f32_16x16x32_bf16 v[236:239], a[180:183], v[76:79], v[236:239]
  v_add_f32 v9, v9, v58
  v_mfma_f32_16x16x32_bf16 v[240:243], a[184:187], v[72:75], v[240:243]
  v_max_f32 v15, v18, v21
  v_add_f32 v9, v9, v59
  v_mfma_f32_16x16x32_bf16 v[248:251], a[184:187], v[76:79], v[248:251]
  ds_read_b128 a[176:179], v1 offset:61440
  v_mfma_f32_16x16x32_bf16 v[244:247], a[188:191], v[72:75], v[244:247]
  v_cmp_lt_f32 vcc, s36, v15
  v_add_f32 v9, v9, v60
  v_mfma_f32_16x16x32_bf16 v[252:255], a[188:191], v[76:79], v[252:255]
  ds_read_b128 a[180:183], v1 offset:62464
  s_cmp_eq_u32 s35, s49
  s_cbranch_scc1 A_SW2
  s_cbranch_vccnz A_ST_P29
A_RET_P29:
  s_cmp_eq_u32 s3, 0
  s_cbranch_scc1 A_TAILW0
  s_waitcnt lgkmcnt(6)
  v_mfma_f32_16x16x32_bf16 v[48:51], a[128:131], a[0:3], v[80:83]
  v_exp_f32 v32, v32
  v_mfma_f32_16x16x32_bf16 v[56:59], a[128:131], a[4:7], v[84:87]
  ds_read_b128 a[184:187], v1 offset:63488
  v_mfma_f32_16x16x32_bf16 v[52:55], a[132:135], a[0:3], v[80:83]
  v_exp_f32 v33, v33
  v_mfma_f32_16x16x32_bf16 v[60:63], a[132:135], a[4:7], v[84:87]
  ds_read_b128 a[188:191], v1 offset:64512
  v_mfma_f32_16x16x32_bf16 v[48:51], a[136:139], a[8:11], v[48:51]
  ds_read_b128 a[128:131], v10 offset:32768
  v_exp_f32 v35, v35
  v_mfma_f32_16x16x32_bf16 v[56:59], a[136:139], a[12:15], v[56:59]
  v_exp_f32 v34, v34
  v_mfma_f32_16x16x32_bf16 v[52:55], a[140:143], a[8:11], v[52:55]
  v_cvt_pk_bf16_f32 v64, v32, v33
  v_add_f32 v8, v8, v34
  v_mfma_f32_16x16x32_bf16 v[60:63], a[140:143], a[12:15], v[60:63]
  ds_read_b128 a[132:135], v10 offset:33792
  v_mfma_f32_16x16x32_bf16 v[48:51], a[144:147], a[16:19], v[48:51]
  v_exp_f32 v36, v36
  v_mfma_f32_16x16x32_bf16 v[56:59], a[144:147], a[20:23], v[56:59]
  ds_read_b128 a[136:139], v10 offset:34816
  v_mfma_f32_16x16x32_bf16 v[52:55], a[148:151], a[16:19], v[52:55]
  ds_read_b128 a[140:143], v10 offset:35840
  v_cvt_pk_bf16_f32 v65, v34, v35
  v_mfma_f32_16x16x32_bf16 v[60:63], a[148:151], a[20:23], v[60:63]
  v_exp_f32 v37, v37
  v_mfma_f32_16x16x32_bf16 v[48:51], a[152:155], a[24:27], v[48:51]
  v_exp_f32 v38, v38
  v_mfma_f32_16x16x32_bf16 v[56:59], a[152:155], a[28:31], v[56:59]
  ds_read_b128 a[144:147], v10 offset:36864
  v_mfma_f32_16x16x32_bf16 v[52:55], a[156:159], a[24:27], v[52:55]
  s_waitcnt lgkmcnt(5)
  ds_read_b128 a[148:151], v10 offset:37888
  v_cvt_pk_bf16_f32 v66, v36, v37
  v_mfma_f32_16x16x32_bf16 v[60:63], a[156:159], a[28:31], v[60:63]
  v_exp_f32 v39, v39
  v_mfma_f32_16x16x32_bf16 v[48:51], a[160:163], a[32:35], v[48:51]
  v_exp_f32 v40, v40
  v_mfma_f32_16x16x32_bf16 v[56:59], a[160:163], a[36:39], v[56:59]
  ds_read_b128 a[152:155], v10 offset:38912
  v_mfma_f32_16x16x32_bf16 v[52:55], a[164:167], a[32:35], v[52:55]
  ds_read_b128 a[156:159], v10 offset:39936
  v_cvt_pk_bf16_f32 v67, v38, v39
  v_mfma_f32_16x16x32_bf16 v[60:63], a[164:167], a[36:39], v[60:63]
  v_exp_f32 v41, v41
  v_mfma_f32_16x16x32_bf16 v[48:51], a[168:171], a[40:43], v[48:51]
  v_exp_f32 v42, v42
  v_mfma_f32_16x16x32_bf16 v[56:59], a[168:171], a[44:47], v[56:59]
  ds_read_b128 a[160:163], v10 offset:40960
  v_mfma_f32_16x16x32_bf16 v[52:55], a[172:175], a[40:43], v[52:55]
  v_exp_f32 v43, v43
  v_mfma_f32_16x16x32_bf16 v[60:63], a[172:175], a[44:47], v[60:63]
  ds_read_b128 a[164:167], v10 offset:41984
  v_mfma_f32_16x16x32_bf16 v[48:51], a[176:179], a[48:51], v[48:51]
  v_exp_f32 v44, v44
  v_mfma_f32_16x16x32_bf16 v[56:59], a[176:179], a[52:55], v[56:59]
  ds_read_b128 a[168:171], v10 offset:43008
  v_cvt_pk_bf16_f32 v68, v40, v41
  v_mfma_f32_16x16x32_bf16 v[52:55], a[180:183], a[48:51], v[52:55]
  v_exp_f32 v45, v45
  v_mfma_f32_16x16x32_bf16 v[60:63], a[180:183], a[52:55], v[60:63]
  ds_read_b128 a[172:175], v10 offset:44032
  v_mfma_f32_16x16x32_bf16 v[48:51], a[184:187], a[56:59], v[48:51]
  v_exp_f32 v46, v46
  v_mfma_f32_16x16x32_bf16 v[56:59], a[184:187], a[60:63], v[56:59]
  ds_read_b128 a[176:179], v10 offset:45056
  v_cvt_pk_bf16_f32 v69, v42, v43
  v_mfma_f32_16x16x32_bf16 v[52:55], a[188:191], a[56:59], v[52:55]
  v_exp_f32 v47, v47
  v_mfma_f32_16x16x32_bf16 v[60:63], a[188:191], a[60:63], v[60:63]
  s_waitcnt lgkmcnt(5)
  ds_read_b128 a[180:183], v10 offset:46080
  v_mfma_f32_16x16x32_bf16 v[128:131], a[128:131], v[64:67], v[128:131]
  v_cvt_pk_bf16_f32 v71, v46, v47
  v_add_f32 v9, v9, v47
  v_mfma_f32_16x16x32_bf16 v[132:135], a[132:135], v[64:67], v[132:135]
  ds_read_b128 a[184:187], v10 offset:47104
  v_cvt_pk_bf16_f32 v70, v44, v45
  v_mfma_f32_16x16x32_bf16 v[144:147], a[136:139], v[64:67], v[144:147]
  v_add_f32 v8, v8, v32
  v_add_f32 v8, v8, v35
  v_mfma_f32_16x16x32_bf16 v[148:151], a[140:143], v[64:67], v[148:151]
  ds_read_b128 a[188:191], v10 offset:48128
  v_mfma_f32_16x16x32_bf16 v[136:139], a[128:131], v[68:71], v[136:139]
  s_waitcnt vmcnt(0)
  s_barrier
  v_mfma_f32_16x16x32_bf16 v[140:143], a[132:135], v[68:71], v[140:143]
  s_mov_b32 s58, 32768
  ds_read_b128 a[128:131], v1 offset:0
  s_mov_b32 s59, 65536
  v_mfma_f32_16x16x32_bf16 v[152:155], a[136:139], v[68:71], v[152:155]
  ds_read_b128 a[132:135], v1 offset:1024
  s_add_u32 s61, s58, s60
  s_add_u32 m0, s61, 0
  s_add_u32 s61, s56, 0
  v_mfma_f32_16x16x32_bf16 v[156:159], a[140:143], v[68:71], v[156:159]
  v_add_f32 v8, v8, v33
  v_add_f32 v9, v9, v46
  v_mfma_f32_16x16x32_bf16 v[160:163], a[144:147], v[64:67], v[160:163]
  ds_read_b128 a[136:139], v1 offset:2048
  v_mfma_f32_16x16x32_bf16 v[168:171], a[144:147], v[68:71], v[168:171]
  s_cmp_eq_u32 s3, 1
  s_cbranch_scc1 A_MASK30
A_MASK30_RET:
  v_add_f32 v9, v9, v44
  v_mfma_f32_16x16x32_bf16 v[164:167], a[148:151], v[64:67], v[164:167]
  ds_read_b128 a[140:143], v1 offset:3072
  buffer_load_dwordx4 v100, s[8:11], s61 offen offset:0 sc1 lds
  v_mfma_f32_16x16x32_bf16 v[172:175], a[148:151], v[68:71], v[172:175]
  v_max3_f32 v18, v48, v49, v50
  v_mfma_f32_16x16x32_bf16 v[176:179], a[152:155], v[64:67], v[176:179]
  v_max3_f32 v19, v51, v52, v53
  v_add_f32 v8, v8, v36
  v_mfma_f32_16x16x32_bf16 v[184:187], a[152:155], v[68:71], v[184:187]
  ds_read_b128 a[144:147], v1 offset:4096
  v_mfma_f32_16x16x32_bf16 v[180:183], a[156:159], v[64:67], v[180:183]
  v_max3_f32 v20, v54, v55, v56
  v_add_f32 v9, v9, v45
  v_mfma_f32_16x16x32_bf16 v[188:191], a[156:159], v[68:71], v[188:191]
  s_waitcnt lgkmcnt(5)
  ds_read_b128 a[148:151], v1 offset:5120
  v_mfma_f32_16x16x32_bf16 v[192:195], a[160:163], v[64:67], v[192:195]
  ds_read_b128 a[152:155], v1 offset:6144
  buffer_load_dwordx4 v101, s[8:11], s61 offen offset:1024 sc1 lds
  v_mfma_f32_16x16x32_bf16 v[200:203], a[160:163], v[68:71], v[200:203]
  v_add_f32 v8, v8, v37
  v_mfma_f32_16x16x32_bf16 v[196:199], a[164:167], v[64:67], v[196:199]
  v_max3_f32 v21, v57, v58, v59
  v_add_f32 v8, v8, v38
  v_mfma_f32_16x16x32_bf16 v[204:207], a[164:167], v[68:71], v[204:207]
  ds_read_b128 a[156:159], v1 offset:7168
  v_mfma_f32_16x16x32_bf16 v[208:211], a[168:171], v[64:67], v[208:211]
  ds_read_b128 a[160:163], v1 offset:8192
  buffer_load_dwordx4 v102, s[8:11], s61 offen offset:2048 sc1 lds
  v_mfma_f32_16x16x32_bf16 v[216:219], a[168:171], v[68:71], v[216:219]
  v_add_f32 v8, v8, v39
  v_mfma_f32_16x16x32_bf16 v[212:215], a[172:175], v[64:67], v[212:215]
  v_max3_f32 v22, v60, v61, v62
  v_add_f32 v9, v9, v40
  v_mfma_f32_16x16x32_bf16 v[220:223], a[172:175], v[68:71], v[220:223]
  ds_read_b128 a[164:167], v1 offset:9216
  v_mfma_f32_16x16x32_bf16 v[224:227], a[176:179], v[64:67], v[224:227]
  v_max3_f32 v18, v18, v19, v20
  v_add_f32 v9, v9, v41
  v_mfma_f32_16x16x32_bf16 v[232:235], a[176:179], v[68:71], v[232:235]
  ds_read_b128 a[168:171], v1 offset:10240
  v_mfma_f32_16x16x32_bf16 v[228:231], a[180:183], v[64:67], v[228:231]
  ds_read_b128 a[172:175], v1 offset:11264
  buffer_load_dwordx4 v103, s[8:11], s61 offen offset:3072 sc1 lds
  v_mfma_f32_16x16x32_bf16 v[236:239], a[180:183], v[68:71], v[236:239]
  v_max3_f32 v21, v21, v22, v63
  v_mfma_f32_16x16x32_bf16 v[240:243], a[184:187], v[64:67], v[240:243]
  v_max_f32 v15, v18, v21
  v_add_f32 v9, v9, v42
  v_mfma_f32_16x16x32_bf16 v[248:251], a[184:187], v[68:71], v[248:251]
  ds_read_b128 a[176:179], v1 offset:12288
  v_mfma_f32_16x16x32_bf16 v[244:247], a[188:191], v[64:67], v[244:247]
  v_cmp_lt_f32 vcc, s36, v15
  v_add_f32 v9, v9, v43
  v_mfma_f32_16x16x32_bf16 v[252:255], a[188:191], v[68:71], v[252:255]
  ds_read_b128 a[180:183], v1 offset:13312
  s_cbranch_vccnz A_ST_P30
A_RET_P30:
  s_cmp_eq_u32 s3, 1
  s_cbranch_scc1 A_TAILW1
  s_waitcnt lgkmcnt(6)
  v_mfma_f32_16x16x32_bf16 v[32:35], a[128:131], a[0:3], v[80:83]
  v_exp_f32 v48, v48
  v_mfma_f32_16x16x32_bf16 v[40:43], a[128:131], a[4:7], v[84:87]
  ds_read_b128 a[184:187], v1 offset:14336
  v_mfma_f32_16x16x32_bf16 v[36:39], a[132:135], a[0:3], v[80:83]
  ds_read_b128 a[188:191], v1 offset:15360
  v_exp_f32 v50, v50
  v_mfma_f32_16x16x32_bf16 v[44:47], a[132:135], a[4:7], v[84:87]
  v_exp_f32 v49, v49
  v_mfma_f32_16x16x32_bf16 v[32:35], a[136:139], a[8:11], v[32:35]
  ds_read_b128 a[128:131], v10 offset:49152
  s_lshl_b32 s55, s48, 9
  s_add_u32 s55, s55, 121659392
  v_mfma_f32_16x16x32_bf16 v[40:43], a[136:139], a[12:15], v[40:43]
  v_mov_b32 v108, 8
  v_mfma_f32_16x16x32_bf16 v[36:39], a[140:143], a[8:11], v[36:39]
  ds_read_b128 a[132:135], v10 offset:50176
  v_cvt_pk_bf16_f32 v72, v48, v49
  v_mfma_f32_16x16x32_bf16 v[44:47], a[140:143], a[12:15], v[44:47]
  v_exp_f32 v51, v51
  v_mfma_f32_16x16x32_bf16 v[32:35], a[144:147], a[16:19], v[32:35]
  ds_read_b128 a[136:139], v10 offset:51200
  buffer_load_dwordx2 v[110:111], v108, s[16:19], s55 offen sc1
  v_mfma_f32_16x16x32_bf16 v[40:43], a[144:147], a[20:23], v[40:43]
  v_exp_f32 v52, v52
  v_mfma_f32_16x16x32_bf16 v[36:39], a[148:151], a[16:19], v[36:39]
  ds_read_b128 a[140:143], v10 offset:52224
  v_cvt_pk_bf16_f32 v73, v50, v51
  v_mfma_f32_16x16x32_bf16 v[44:47], a[148:151], a[20:23], v[44:47]
  v_exp_f32 v53, v53
  v_mfma_f32_16x16x32_bf16 v[32:35], a[152:155], a[24:27], v[32:35]
  ds_read_b128 a[144:147], v10 offset:53248
  s_add_u32 s61, s58, s60
  s_add_u32 m0, s61, 4096
  s_add_u32 s61, s56, 28672
  v_mfma_f32_16x16x32_bf16 v[40:43], a[152:155], a[28:31], v[40:43]
  v_exp_f32 v54, v54
  v_mfma_f32_16x16x32_bf16 v[36:39], a[156:159], a[24:27], v[36:39]
  s_waitcnt lgkmcnt(5)
  ds_read_b128 a[148:151], v10 offset:54272
  v_cvt_pk_bf16_f32 v74, v52, v53
  v_mfma_f32_16x16x32_bf16 v[44:47], a[156:159], a[28:31], v[44:47]
  v_exp_f32 v55, v55
  v_mfma_f32_16x16x32_bf16 v[32:35], a[160:163], a[32:35], v[32:35]
  ds_read_b128 a[152:155], v10 offset:55296
  buffer_load_dwordx4 v100, s[8:11], s61 offen offset:0 sc1 lds
  v_mfma_f32_16x16x32_bf16 v[40:43], a[160:163], a[36:39], v[40:43]
  v_exp_f32 v56, v56
  v_mfma_f32_16x16x32_bf16 v[36:39], a[164:167], a[32:35], v[36:39]
  ds_read_b128 a[156:159], v10 offset:56320
  v_cvt_pk_bf16_f32 v75, v54, v55
  v_mfma_f32_16x16x32_bf16 v[44:47], a[164:167], a[36:39], v[44:47]
  v_exp_f32 v57, v57
  v_mfma_f32_16x16x32_bf16 v[32:35], a[168:171], a[40:43], v[32:35]
  ds_read_b128 a[160:163], v10 offset:57344
  buffer_load_dwordx4 v101, s[8:11], s61 offen offset:1024 sc1 lds
  v_mfma_f32_16x16x32_bf16 v[40:43], a[168:171], a[44:47], v[40:43]
  v_exp_f32 v58, v58
  v_mfma_f32_16x16x32_bf16 v[36:39], a[172:175], a[40:43], v[36:39]
  v_exp_f32 v59, v59
  v_mfma_f32_16x16x32_bf16 v[44:47], a[172:175], a[44:47], v[44:47]
  ds_read_b128 a[164:167], v10 offset:58368
  v_mfma_f32_16x16x32_bf16 v[32:35], a[176:179], a[48:51], v[32:35]
  ds_read_b128 a[168:171], v10 offset:59392
  buffer_load_dwordx4 v102, s[8:11], s61 offen offset:2048 sc1 lds
  v_cvt_pk_bf16_f32 v76, v56, v57
  v_mfma_f32_16x16x32_bf16 v[40:43], a[176:179], a[52:55], v[40:43]
  v_exp_f32 v60, v60
  v_mfma_f32_16x16x32_bf16 v[36:39], a[180:183], a[48:51], v[36:39]
  v_exp_f32 v61, v61
  v_mfma_f32_16x16x32_bf16 v[44:47], a[180:183], a[52:55], v[44:47]
  ds_read_b128 a[172:175], v10 offset:60416
  v_mfma_f32_16x16x32_bf16 v[32:35], a[184:187], a[56:59], v[32:35]
  ds_read_b128 a[176:179], v10 offset:61440
  buffer_load_dwordx4 v103, s[8:11], s61 offen offset:3072 sc1 lds
  v_cvt_pk_bf16_f32 v77, v58, v59
  v_mfma_f32_16x16x32_bf16 v[40:43], a[184:187], a[60:63], v[40:43]
  v_exp_f32 v62, v62
  v_mfma_f32_16x16x32_bf16 v[36:39], a[188:191], a[56:59], v[36:39]
  v_exp_f32 v63, v63
  v_mfma_f32_16x16x32_bf16 v[44:47], a[188:191], a[60:63], v[44:47]
  s_waitcnt lgkmcnt(5)
  ds_read_b128 a[180:183], v10 offset:62464
  v_mfma_f32_16x16x32_bf16 v[128:131], a[128:131], v[72:75], v[128:131]
  ds_read_b128 a[184:187], v10 offset:63488
  s_add_u32 m0, s59, s43
  s_add_u32 s56, s56, 128
  v_mfma_f32_16x16x32_bf16 v[132:135], a[132:135], v[72:75], v[132:135]
  v_cvt_pk_bf16_f32 v78, v60, v61
  v_cvt_pk_bf16_f32 v79, v62, v63
  v_mfma_f32_16x16x32_bf16 v[144:147], a[136:139], v[72:75], v[144:147]
  v_add_f32 v8, v8, v48
  v_add_f32 v8, v8, v49
  v_mfma_f32_16x16x32_bf16 v[148:151], a[140:143], v[72:75], v[148:151]
  ds_read_b128 a[188:191], v10 offset:64512
  v_mfma_f32_16x16x32_bf16 v[136:139], a[128:131], v[76:79], v[136:139]
  ds_read_b128 a[128:131], v1 offset:16384
  v_mfma_f32_16x16x32_bf16 v[140:143], a[132:135], v[76:79], v[140:143]
  s_cmp_eq_u32 s3, 2
  s_cbranch_scc1 A_MASK31
A_MASK31_RET:
  v_add_f32 v9, v9, v61
  v_mfma_f32_16x16x32_bf16 v[152:155], a[136:139], v[76:79], v[152:155]
  ds_read_b128 a[132:135], v1 offset:17408
  buffer_load_dwordx4 v100, s[12:15], s57 offen offset:0 sc1 lds
  v_mfma_f32_16x16x32_bf16 v[156:159], a[140:143], v[76:79], v[156:159]
  v_add_f32 v8, v8, v50
  v_mfma_f32_16x16x32_bf16 v[160:163], a[144:147], v[72:75], v[160:163]
  v_max3_f32 v18, v32, v33, v34
  v_add_f32 v8, v8, v51
  v_mfma_f32_16x16x32_bf16 v[168:171], a[144:147], v[76:79], v[168:171]
  ds_read_b128 a[136:139], v1 offset:18432
  v_mfma_f32_16x16x32_bf16 v[164:167], a[148:151], v[72:75], v[164:167]
  ds_read_b128 a[140:143], v1 offset:19456
  buffer_load_dwordx4 v101, s[12:15], s57 offen offset:1024 sc1 lds
  v_mfma_f32_16x16x32_bf16 v[172:175], a[148:151], v[76:79], v[172:175]
  v_add_f32 v8, v8, v52
  v_mfma_f32_16x16x32_bf16 v[176:179], a[152:155], v[72:75], v[176:179]
  v_max3_f32 v19, v35, v36, v37
  v_add_f32 v8, v8, v53
  v_mfma_f32_16x16x32_bf16 v[184:187], a[152:155], v[76:79], v[184:187]
  ds_read_b128 a[144:147], v1 offset:20480
  v_mfma_f32_16x16x32_bf16 v[180:183], a[156:159], v[72:75], v[180:183]
  s_waitcnt lgkmcnt(5)
  ds_read_b128 a[148:151], v1 offset:21504
  v_mfma_f32_16x16x32_bf16 v[188:191], a[156:159], v[76:79], v[188:191]
  buffer_load_dwordx4 v102, s[12:15], s57 offen offset:2048 sc1 lds
  v_add_f32 v9, v9, v62
  v_mfma_f32_16x16x32_bf16 v[192:195], a[160:163], v[72:75], v[192:195]
  v_max3_f32 v20, v38, v39, v40
  v_add_f32 v8, v8, v54
  v_mfma_f32_16x16x32_bf16 v[200:203], a[160:163], v[76:79], v[200:203]
  ds_read_b128 a[152:155], v1 offset:22528
  v_mfma_f32_16x16x32_bf16 v[196:199], a[164:167], v[72:75], v[196:199]
  ds_read_b128 a[156:159], v1 offset:23552
  buffer_load_dwordx4 v103, s[12:15], s57 offen offset:3072 sc1 lds
  v_mfma_f32_16x16x32_bf16 v[204:207], a[164:167], v[76:79], v[204:207]
  v_add_f32 v8, v8, v55
  v_mfma_f32_16x16x32_bf16 v[208:211], a[168:171], v[72:75], v[208:211]
  v_max3_f32 v21, v41, v42, v43
  v_add_f32 v9, v9, v56
  v_mfma_f32_16x16x32_bf16 v[216:219], a[168:171], v[76:79], v[216:219]
  ds_read_b128 a[160:163], v1 offset:24576
  v_mfma_f32_16x16x32_bf16 v[212:215], a[172:175], v[72:75], v[212:215]
  s_add_u32 s57, s57, 128
  ds_read_b128 a[164:167], v1 offset:25600
  v_mfma_f32_16x16x32_bf16 v[220:223], a[172:175], v[76:79], v[220:223]
  v_max3_f32 v22, v44, v45, v46
  v_add_f32 v9, v9, v63
  v_mfma_f32_16x16x32_bf16 v[224:227], a[176:179], v[72:75], v[224:227]
  v_max3_f32 v18, v18, v19, v20
  v_add_f32 v9, v9, v57
  v_mfma_f32_16x16x32_bf16 v[232:235], a[176:179], v[76:79], v[232:235]
  ds_read_b128 a[168:171], v1 offset:26624
  v_mfma_f32_16x16x32_bf16 v[228:231], a[180:183], v[72:75], v[228:231]
  v_max3_f32 v21, v21, v22, v47
  v_add_f32 v9, v9, v58
  v_mfma_f32_16x16x32_bf16 v[236:239], a[180:183], v[76:79], v[236:239]
  ds_read_b128 a[172:175], v1 offset:27648
  v_mfma_f32_16x16x32_bf16 v[240:243], a[184:187], v[72:75], v[240:243]
  v_max_f32 v15, v18, v21
  v_add_f32 v9, v9, v59
  v_mfma_f32_16x16x32_bf16 v[248:251], a[184:187], v[76:79], v[248:251]
  ds_read_b128 a[176:179], v1 offset:28672
  v_mfma_f32_16x16x32_bf16 v[244:247], a[188:191], v[72:75], v[244:247]
  v_cmp_lt_f32 vcc, s36, v15
  v_add_f32 v9, v9, v60
  v_mfma_f32_16x16x32_bf16 v[252:255], a[188:191], v[76:79], v[252:255]
  ds_read_b128 a[180:183], v1 offset:29696
  s_cbranch_vccnz A_ST_P31
A_RET_P31:
  s_cmp_eq_u32 s3, 2
  s_cbranch_scc1 A_TAILW2
  s_waitcnt vmcnt(8)
  v_cmp_eq_u32 vcc, s86, v110
  v_cmp_eq_u32 s[4:5], s87, v111
  s_nop 0
  s_and_b64 vcc, vcc, s[4:5]
  s_cmp_eq_u64 vcc, exec
  s_cselect_b32 s53, 2, 0
  s_cmp_ge_u32 s33, 8
  s_cselect_b32 s51, s53, 0
  s_mov_b32 s28, s16
  s_mov_b32 s29, s17
  s_mul_i32 s30, s51, 0x8000000
  s_mov_b32 s31, 0x20000
  s_waitcnt lgkmcnt(6)
  v_add_u32 v10, 0x10000, v10
  s_lshl_b32 s54, s48, 2
  s_add_u32 s54, s54, s3
  s_lshl_b32 s55, s54, 10
  s_add_u32 s55, s55, 75497472
  s_lshl_b32 s54, s54, 14
  s_add_u32 s54, s54, 58720256
  v_lshrrev_b32 v108, 1, v1
  v_mfma_f32_16x16x32_bf16 v[48:51], a[128:131], a[0:3], v[80:83]
  ds_read_b128 a[184:187], v1 offset:30720
  buffer_load_dwordx2 v[112:113], v108, s[28:31], s55 offen sc1
  v_mfma_f32_16x16x32_bf16 v[56:59], a[128:131], a[4:7], v[84:87]
  v_exp_f32 v32, v32
  v_mfma_f32_16x16x32_bf16 v[52:55], a[132:135], a[0:3], v[80:83]
  ds_read_b128 a[188:191], v1 offset:31744
  buffer_load_dwordx2 v[114:115], v108, s[28:31], s55 offen offset:512 sc1
  v_mfma_f32_16x16x32_bf16 v[60:63], a[132:135], a[4:7], v[84:87]
  v_exp_f32 v33, v33
  v_mfma_f32_16x16x32_bf16 v[48:51], a[136:139], a[8:11], v[48:51]
  ds_read_b128 a[128:131], v10 offset:0
  buffer_load_dwordx4 a[64:67], v1, s[28:31], s54 offen offset:0 sc1
  v_mfma_f32_16x16x32_bf16 v[56:59], a[136:139], a[12:15], v[56:59]
  v_exp_f32 v34, v34
  v_mfma_f32_16x16x32_bf16 v[52:55], a[140:143], a[8:11], v[52:55]
  ds_read_b128 a[132:135], v10 offset:1024
  buffer_load_dwordx4 a[68:71], v1, s[28:31], s54 offen offset:1024 sc1
  v_cvt_pk_bf16_f32 v64, v32, v33
  v_mfma_f32_16x16x32_bf16 v[60:63], a[140:143], a[12:15], v[60:63]
  v_exp_f32 v35, v35
  v_mfma_f32_16x16x32_bf16 v[48:51], a[144:147], a[16:19], v[48:51]
  ds_read_b128 a[136:139], v10 offset:2048
  buffer_load_dwordx4 a[72:75], v1, s[28:31], s54 offen offset:2048 sc1
  v_mfma_f32_16x16x32_bf16 v[56:59], a[144:147], a[20:23], v[56:59]
  v_exp_f32 v36, v36
  v_mfma_f32_16x16x32_bf16 v[52:55], a[148:151], a[16:19], v[52:55]
  ds_read_b128 a[140:143], v10 offset:3072
  buffer_load_dwordx4 a[76:79], v1, s[28:31], s54 offen offset:3072 sc1
  v_mfma_f32_16x16x32_bf16 v[60:63], a[148:151], a[20:23], v[60:63]
  v_exp_f32 v37, v37
  v_mfma_f32_16x16x32_bf16 v[48:51], a[152:155], a[24:27], v[48:51]
  s_add_u32 s54, s54, 4096
  ds_read_b128 a[144:147], v10 offset:4096
  v_cvt_pk_bf16_f32 v65, v34, v35
  v_mfma_f32_16x16x32_bf16 v[56:59], a[152:155], a[28:31], v[56:59]
  v_exp_f32 v38, v38
  v_mfma_f32_16x16x32_bf16 v[52:55], a[156:159], a[24:27], v[52:55]
  s_waitcnt lgkmcnt(5)
  ds_read_b128 a[148:151], v10 offset:5120
  v_cvt_pk_bf16_f32 v66, v36, v37
  v_mfma_f32_16x16x32_bf16 v[60:63], a[156:159], a[28:31], v[60:63]
  v_exp_f32 v39, v39
  v_mfma_f32_16x16x32_bf16 v[48:51], a[160:163], a[32:35], v[48:51]
  ds_read_b128 a[152:155], v10 offset:6144
  buffer_load_dwordx4 a[80:83], v1, s[28:31], s54 offen offset:0 sc1
  v_mfma_f32_16x16x32_bf16 v[56:59], a[160:163], a[36:39], v[56:59]
  v_exp_f32 v40, v40
  v_mfma_f32_16x16x32_bf16 v[52:55], a[164:167], a[32:35], v[52:55]
  ds_read_b128 a[156:159], v10 offset:7168
  buffer_load_dwordx4 a[84:87], v1, s[28:31], s54 offen offset:1024 sc1
  v_mfma_f32_16x16x32_bf16 v[60:63], a[164:167], a[36:39], v[60:63]
  v_exp_f32 v41, v41
  v_mfma_f32_16x16x32_bf16 v[48:51], a[168:171], a[40:43], v[48:51]
  ds_read_b128 a[160:163], v10 offset:8192
  buffer_load_dwordx4 a[88:91], v1, s[28:31], s54 offen offset:2048 sc1
  v_cvt_pk_bf16_f32 v67, v38, v39
  v_mfma_f32_16x16x32_bf16 v[56:59], a[168:171], a[44:47], v[56:59]
  v_exp_f32 v42, v42
  v_mfma_f32_16x16x32_bf16 v[52:55], a[172:175], a[40:43], v[52:55]
  ds_read_b128 a[164:167], v10 offset:9216
  buffer_load_dwordx4 a[92:95], v1, s[28:31], s54 offen offset:3072 sc1
  v_mfma_f32_16x16x32_bf16 v[60:63], a[172:175], a[44:47], v[60:63]
  v_exp_f32 v43, v43
  v_mfma_f32_16x16x32_bf16 v[48:51], a[176:179], a[48:51], v[48:51]
  s_add_u32 s54, s54, 4096
  ds_read_b128 a[168:171], v10 offset:10240
  v_cvt_pk_bf16_f32 v68, v40, v41
  v_mfma_f32_16x16x32_bf16 v[56:59], a[176:179], a[52:55], v[56:59]
  v_exp_f32 v44, v44
  v_mfma_f32_16x16x32_bf16 v[52:55], a[180:183], a[48:51], v[52:55]
  ds_read_b128 a[172:175], v10 offset:11264
  buffer_load_dwordx4 a[96:99], v1, s[28:31], s54 offen offset:0 sc1
  v_mfma_f32_16x16x32_bf16 v[60:63], a[180:183], a[52:55], v[60:63]
  v_exp_f32 v45, v45
  v_mfma_f32_16x16x32_bf16 v[48:51], a[184:187], a[56:59], v[48:51]
  ds_read_b128 a[176:179], v10 offset:12288
  buffer_load_dwordx4 a[100:103], v1, s[28:31], s54 offen offset:1024 sc1
  v_mfma_f32_16x16x32_bf16 v[56:59], a[184:187], a[60:63], v[56:59]
  v_cvt_pk_bf16_f32 v69, v42, v43
  v_mfma_f32_16x16x32_bf16 v[52:55], a[188:191], a[56:59], v[52:55]
  ds_read_b128 a[180:183], v10 offset:13312
  v_exp_f32 v47, v47
  v_mfma_f32_16x16x32_bf16 v[60:63], a[188:191], a[60:63], v[60:63]
  s_waitcnt lgkmcnt(6)
  v_exp_f32 v46, v46
  v_mfma_f32_16x16x32_bf16 v[128:131], a[128:131], v[64:67], v[128:131]
  ds_read_b128 a[184:187], v10 offset:14336
  buffer_load_dwordx4 a[104:107], v1, s[28:31], s54 offen offset:2048 sc1
  v_mfma_f32_16x16x32_bf16 v[132:135], a[132:135], v[64:67], v[132:135]
  v_cvt_pk_bf16_f32 v70, v44, v45
  v_cvt_pk_bf16_f32 v71, v46, v47
  v_mfma_f32_16x16x32_bf16 v[144:147], a[136:139], v[64:67], v[144:147]
  ds_read_b128 a[188:191], v10 offset:15360
  buffer_load_dwordx4 a[108:111], v1, s[28:31], s54 offen offset:3072 sc1
  v_mfma_f32_16x16x32_bf16 v[148:151], a[140:143], v[64:67], v[148:151]
  v_add_f32 v8, v8, v35
  v_mfma_f32_16x16x32_bf16 v[136:139], a[128:131], v[68:71], v[136:139]
  s_add_u32 s54, s54, 4096
  v_mov_b32 v53, v14
  v_mfma_f32_16x16x32_bf16 v[140:143], a[132:135], v[68:71], v[140:143]
  v_mov_b32 v52, v14
  v_mfma_f32_16x16x32_bf16 v[152:155], a[136:139], v[68:71], v[152:155]
  buffer_load_dwordx4 a[112:115], v1, s[28:31], s54 offen offset:0 sc1
  v_add_f32 v8, v8, v32
  v_mfma_f32_16x16x32_bf16 v[156:159], a[140:143], v[68:71], v[156:159]
  v_add_f32 v8, v8, v36
  v_mfma_f32_16x16x32_bf16 v[160:163], a[144:147], v[64:67], v[160:163]
  buffer_load_dwordx4 a[116:119], v1, s[28:31], s54 offen offset:1024 sc1
  v_add_f32 v8, v8, v37
  v_mfma_f32_16x16x32_bf16 v[168:171], a[144:147], v[68:71], v[168:171]
  v_mov_b32 v54, v14
  v_mfma_f32_16x16x32_bf16 v[164:167], a[148:151], v[64:67], v[164:167]
  buffer_load_dwordx4 a[120:123], v1, s[28:31], s54 offen offset:2048 sc1
  v_add_f32 v8, v8, v38
  v_mfma_f32_16x16x32_bf16 v[172:175], a[148:151], v[68:71], v[172:175]
  v_mov_b32 v55, v14
  v_mfma_f32_16x16x32_bf16 v[176:179], a[152:155], v[64:67], v[176:179]
  buffer_load_dwordx4 a[124:127], v1, s[28:31], s54 offen offset:3072 sc1
  v_add_f32 v8, v8, v39
  v_mfma_f32_16x16x32_bf16 v[184:187], a[152:155], v[68:71], v[184:187]
  v_cndmask_b32 v48, v14, v48, s[64:65]
  v_mfma_f32_16x16x32_bf16 v[180:183], a[156:159], v[64:67], v[180:183]
  s_waitcnt lgkmcnt(0)
  v_add_f32 v8, v8, v34
  v_mfma_f32_16x16x32_bf16 v[188:191], a[156:159], v[68:71], v[188:191]
  v_cndmask_b32 v49, v14, v49, s[66:67]
  v_mfma_f32_16x16x32_bf16 v[192:195], a[160:163], v[64:67], v[192:195]
  v_cndmask_b32 v51, v14, v51, s[70:71]
  v_add_f32 v9, v9, v40
  v_mfma_f32_16x16x32_bf16 v[200:203], a[160:163], v[68:71], v[200:203]
  v_cndmask_b32 v50, v14, v50, s[68:69]
  v_mfma_f32_16x16x32_bf16 v[196:199], a[164:167], v[64:67], v[196:199]
  v_cndmask_b32 v61, v14, v61, s[66:67]
  v_add_f32 v9, v9, v41
  v_mfma_f32_16x16x32_bf16 v[204:207], a[164:167], v[68:71], v[204:207]
  v_cndmask_b32 v60, v14, v60, s[64:65]
  v_mfma_f32_16x16x32_bf16 v[208:211], a[168:171], v[64:67], v[208:211]
  v_cndmask_b32 v63, v14, v63, s[70:71]
  v_add_f32 v9, v9, v42
  v_mfma_f32_16x16x32_bf16 v[216:219], a[168:171], v[68:71], v[216:219]
  v_cndmask_b32 v62, v14, v62, s[68:69]
  v_mfma_f32_16x16x32_bf16 v[212:215], a[172:175], v[64:67], v[212:215]
  v_max3_f32 v19, v51, v52, v53
  v_add_f32 v9, v9, v43
  v_mfma_f32_16x16x32_bf16 v[220:223], a[172:175], v[68:71], v[220:223]
  v_max3_f32 v18, v48, v49, v50
  v_mfma_f32_16x16x32_bf16 v[224:227], a[176:179], v[64:67], v[224:227]
  v_max3_f32 v21, v57, v58, v59
  v_add_f32 v9, v9, v44
  v_mfma_f32_16x16x32_bf16 v[232:235], a[176:179], v[68:71], v[232:235]
  v_max3_f32 v20, v54, v55, v56
  v_mfma_f32_16x16x32_bf16 v[228:231], a[180:183], v[64:67], v[228:231]
  v_add_f32 v8, v8, v33
  v_add_f32 v9, v9, v45
  v_mfma_f32_16x16x32_bf16 v[236:239], a[180:183], v[68:71], v[236:239]
  v_max3_f32 v22, v60, v61, v62
  v_mfma_f32_16x16x32_bf16 v[240:243], a[184:187], v[64:67], v[240:243]
  v_max3_f32 v21, v21, v22, v63
  v_add_f32 v9, v9, v46
  v_mfma_f32_16x16x32_bf16 v[248:251], a[184:187], v[68:71], v[248:251]
  v_max3_f32 v18, v18, v19, v20
  v_mfma_f32_16x16x32_bf16 v[244:247], a[188:191], v[64:67], v[244:247]
  v_max_f32 v15, v18, v21
  v_add_f32 v9, v9, v47
  v_mfma_f32_16x16x32_bf16 v[252:255], a[188:191], v[68:71], v[252:255]
  v_cmp_lt_f32 vcc, s36, v15
  s_cbranch_vccnz A_ST_P32
A_RET_P32:
  v_add_u32 v10, 0x4000, v10
A_TAIL1:
  s_waitcnt lgkmcnt(0)
  ds_read_b128 a[128:131], v10 offset:0
  ds_read_b128 a[132:135], v10 offset:1024
  ds_read_b128 a[136:139], v10 offset:2048
  ds_read_b128 a[140:143], v10 offset:3072
  ds_read_b128 a[144:147], v10 offset:4096
  ds_read_b128 a[148:151], v10 offset:5120
  ds_read_b128 a[152:155], v10 offset:6144
  ds_read_b128 a[156:159], v10 offset:7168
  ds_read_b128 a[160:163], v10 offset:8192
  ds_read_b128 a[164:167], v10 offset:9216
  ds_read_b128 a[168:171], v10 offset:10240
  ds_read_b128 a[172:175], v10 offset:11264
  ds_read_b128 a[176:179], v10 offset:12288
  ds_read_b128 a[180:183], v10 offset:13312
  v_exp_f32 v48, v48
  v_exp_f32 v49, v49
  v_exp_f32 v50, v50
  v_exp_f32 v51, v51
  v_cvt_pk_bf16_f32 v72, v48, v49
  v_exp_f32 v52, v52
  v_exp_f32 v53, v53
  v_cvt_pk_bf16_f32 v73, v50, v51
  v_exp_f32 v54, v54
  v_exp_f32 v55, v55
  v_cvt_pk_bf16_f32 v74, v52, v53
  v_exp_f32 v56, v56
  v_exp_f32 v57, v57
  v_cvt_pk_bf16_f32 v75, v54, v55
  v_exp_f32 v58, v58
  v_exp_f32 v59, v59
  v_cvt_pk_bf16_f32 v76, v56, v57
  v_exp_f32 v60, v60
  v_exp_f32 v61, v61
  v_cvt_pk_bf16_f32 v77, v58, v59
  s_waitcnt lgkmcnt(6)
  v_mfma_f32_16x16x32_bf16 v[128:131], a[128:131], v[72:75], v[128:131]
  ds_read_b128 a[184:187], v10 offset:14336
  v_exp_f32 v63, v63
  v_cvt_pk_bf16_f32 v78, v60, v61
  v_mfma_f32_16x16x32_bf16 v[132:135], a[132:135], v[72:75], v[132:135]
  v_exp_f32 v62, v62
  s_nop 0
  v_cvt_pk_bf16_f32 v79, v62, v63
  v_mfma_f32_16x16x32_bf16 v[144:147], a[136:139], v[72:75], v[144:147]
  ds_read_b128 a[188:191], v10 offset:15360
  v_mfma_f32_16x16x32_bf16 v[148:151], a[140:143], v[72:75], v[148:151]
  v_mfma_f32_16x16x32_bf16 v[136:139], a[128:131], v[76:79], v[136:139]
  v_add_f32 v8, v8, v48
  v_mfma_f32_16x16x32_bf16 v[140:143], a[132:135], v[76:79], v[140:143]
  v_add_f32 v8, v8, v49
  v_mfma_f32_16x16x32_bf16 v[152:155], a[136:139], v[76:79], v[152:155]
  v_add_f32 v8, v8, v50
  v_mfma_f32_16x16x32_bf16 v[156:159], a[140:143], v[76:79], v[156:159]
  v_mfma_f32_16x16x32_bf16 v[160:163], a[144:147], v[72:75], v[160:163]
  v_add_f32 v8, v8, v51
  v_mfma_f32_16x16x32_bf16 v[168:171], a[144:147], v[76:79], v[168:171]
  v_mfma_f32_16x16x32_bf16 v[164:167], a[148:151], v[72:75], v[164:167]
  v_add_f32 v8, v8, v52
  v_mfma_f32_16x16x32_bf16 v[172:175], a[148:151], v[76:79], v[172:175]
  v_add_f32 v8, v8, v53
  v_mfma_f32_16x16x32_bf16 v[176:179], a[152:155], v[72:75], v[176:179]
  v_add_f32 v8, v8, v54
  v_mfma_f32_16x16x32_bf16 v[184:187], a[152:155], v[76:79], v[184:187]
  v_mfma_f32_16x16x32_bf16 v[180:183], a[156:159], v[72:75], v[180:183]
  v_add_f32 v8, v8, v55
  v_mfma_f32_16x16x32_bf16 v[188:191], a[156:159], v[76:79], v[188:191]
  s_waitcnt lgkmcnt(0)
  v_mfma_f32_16x16x32_bf16 v[192:195], a[160:163], v[72:75], v[192:195]
  v_add_f32 v9, v9, v56
  v_mfma_f32_16x16x32_bf16 v[200:203], a[160:163], v[76:79], v[200:203]
  v_mfma_f32_16x16x32_bf16 v[196:199], a[164:167], v[72:75], v[196:199]
  v_add_f32 v9, v9, v57
  v_mfma_f32_16x16x32_bf16 v[204:207], a[164:167], v[76:79], v[204:207]
  v_add_f32 v9, v9, v58
  v_mfma_f32_16x16x32_bf16 v[208:211], a[168:171], v[72:75], v[208:211]
  v_add_f32 v9, v9, v59
  v_mfma_f32_16x16x32_bf16 v[216:219], a[168:171], v[76:79], v[216:219]
  v_mfma_f32_16x16x32_bf16 v[212:215], a[172:175], v[72:75], v[212:215]
  v_add_f32 v9, v9, v60
  v_mfma_f32_16x16x32_bf16 v[220:223], a[172:175], v[76:79], v[220:223]
  v_mfma_f32_16x16x32_bf16 v[224:227], a[176:179], v[72:75], v[224:227]
  v_add_f32 v9, v9, v61
  v_mfma_f32_16x16x32_bf16 v[232:235], a[176:179], v[76:79], v[232:235]
  v_add_f32 v9, v9, v62
  v_mfma_f32_16x16x32_bf16 v[228:231], a[180:183], v[72:75], v[228:231]
  v_add_f32 v9, v9, v63
  v_mfma_f32_16x16x32_bf16 v[236:239], a[180:183], v[76:79], v[236:239]
  v_mfma_f32_16x16x32_bf16 v[240:243], a[184:187], v[72:75], v[240:243]
  v_mfma_f32_16x16x32_bf16 v[248:251], a[184:187], v[76:79], v[248:251]
  v_mfma_f32_16x16x32_bf16 v[244:247], a[188:191], v[72:75], v[244:247]
  v_mfma_f32_16x16x32_bf16 v[252:255], a[188:191], v[76:79], v[252:255]
A_FIN:
  s_cmp_ge_u32 s33, 8
  s_cbranch_scc1 A_MERGE
  v_mov_b32 v18, v8
  v_mov_b32 v19, v9
  s_nop 1
  v_permlane16_swap_b32 v8, v18
  v_permlane16_swap_b32 v9, v19
  v_add_f32 v8, v8, v18
  v_add_f32 v9, v9, v19
  v_mov_b32 v18, v8
  v_mov_b32 v19, v9
  s_nop 1
  v_permlane32_swap_b32 v8, v18
  v_permlane32_swap_b32 v9, v19
  v_add_f32 v8, v8, v18
  v_add_f32 v9, v9, v19
  v_rcp_f32 v18, v8
  v_rcp_f32 v20, v9
  s_nop 0
  v_mov_b32 v19, v18
  v_mov_b32 v21, v20
  v_pk_mul_f32 v[128:129], v[128:129], v[18:19]
  v_pk_mul_f32 v[130:131], v[130:131], v[18:19]
  v_cvt_pk_bf16_f32 v32, v128, v129
  v_pk_mul_f32 v[132:133], v[132:133], v[18:19]
  v_cvt_pk_bf16_f32 v33, v130, v131
  v_pk_mul_f32 v[134:135], v[134:135], v[18:19]
  v_cvt_pk_bf16_f32 v34, v132, v133
  v_pk_mul_f32 v[136:137], v[136:137], v[20:21]
  v_cvt_pk_bf16_f32 v35, v134, v135
  v_pk_mul_f32 v[138:139], v[138:139], v[20:21]
  v_cvt_pk_bf16_f32 v36, v136, v137
  v_pk_mul_f32 v[140:141], v[140:141], v[20:21]
  v_cvt_pk_bf16_f32 v37, v138, v139
  v_pk_mul_f32 v[142:143], v[142:143], v[20:21]
  v_cvt_pk_bf16_f32 v38, v140, v141
  v_pk_mul_f32 v[144:145], v[144:145], v[18:19]
  v_cvt_pk_bf16_f32 v39, v142, v143
  v_pk_mul_f32 v[146:147], v[146:147], v[18:19]
  v_cvt_pk_bf16_f32 v40, v144, v145
  v_pk_mul_f32 v[148:149], v[148:149], v[18:19]
  v_cvt_pk_bf16_f32 v41, v146, v147
  v_pk_mul_f32 v[150:151], v[150:151], v[18:19]
  v_cvt_pk_bf16_f32 v42, v148, v149
  v_pk_mul_f32 v[152:153], v[152:153], v[20:21]
  v_cvt_pk_bf16_f32 v43, v150, v151
  v_pk_mul_f32 v[154:155], v[154:155], v[20:21]
  v_cvt_pk_bf16_f32 v44, v152, v153
  v_pk_mul_f32 v[156:157], v[156:157], v[20:21]
  v_cvt_pk_bf16_f32 v45, v154, v155
  v_pk_mul_f32 v[158:159], v[158:159], v[20:21]
  v_cvt_pk_bf16_f32 v46, v156, v157
  v_pk_mul_f32 v[160:161], v[160:161], v[18:19]
  v_cvt_pk_bf16_f32 v47, v158, v159
  v_pk_mul_f32 v[162:163], v[162:163], v[18:19]
  v_cvt_pk_bf16_f32 v48, v160, v161
  v_pk_mul_f32 v[164:165], v[164:165], v[18:19]
  v_cvt_pk_bf16_f32 v49, v162, v163
  v_pk_mul_f32 v[166:167], v[166:167], v[18:19]
  v_cvt_pk_bf16_f32 v50, v164, v165
  v_pk_mul_f32 v[168:169], v[168:169], v[20:21]
  v_cvt_pk_bf16_f32 v51, v166, v167
  v_pk_mul_f32 v[170:171], v[170:171], v[20:21]
  v_cvt_pk_bf16_f32 v52, v168, v169
  v_pk_mul_f32 v[172:173], v[172:173], v[20:21]
  v_cvt_pk_bf16_f32 v53, v170, v171
  v_pk_mul_f32 v[174:175], v[174:175], v[20:21]
  v_cvt_pk_bf16_f32 v54, v172, v173
  v_pk_mul_f32 v[176:177], v[176:177], v[18:19]
  v_cvt_pk_bf16_f32 v55, v174, v175
  v_pk_mul_f32 v[178:179], v[178:179], v[18:19]
  v_cvt_pk_bf16_f32 v56, v176, v177
  v_pk_mul_f32 v[180:181], v[180:181], v[18:19]
  v_cvt_pk_bf16_f32 v57, v178, v179
  v_pk_mul_f32 v[182:183], v[182:183], v[18:19]
  v_cvt_pk_bf16_f32 v58, v180, v181
  v_pk_mul_f32 v[184:185], v[184:185], v[20:21]
  v_cvt_pk_bf16_f32 v59, v182, v183
  v_pk_mul_f32 v[186:187], v[186:187], v[20:21]
  v_cvt_pk_bf16_f32 v60, v184, v185
  v_pk_mul_f32 v[188:189], v[188:189], v[20:21]
  v_cvt_pk_bf16_f32 v61, v186, v187
  v_pk_mul_f32 v[190:191], v[190:191], v[20:21]
  v_cvt_pk_bf16_f32 v62, v188, v189
  v_pk_mul_f32 v[192:193], v[192:193], v[18:19]
  v_cvt_pk_bf16_f32 v63, v190, v191
  v_pk_mul_f32 v[194:195], v[194:195], v[18:19]
  v_cvt_pk_bf16_f32 v64, v192, v193
  v_pk_mul_f32 v[196:197], v[196:197], v[18:19]
  v_cvt_pk_bf16_f32 v65, v194, v195
  v_pk_mul_f32 v[198:199], v[198:199], v[18:19]
  v_cvt_pk_bf16_f32 v66, v196, v197
  v_pk_mul_f32 v[200:201], v[200:201], v[20:21]
  v_cvt_pk_bf16_f32 v67, v198, v199
  v_pk_mul_f32 v[202:203], v[202:203], v[20:21]
  v_cvt_pk_bf16_f32 v68, v200, v201
  v_pk_mul_f32 v[204:205], v[204:205], v[20:21]
  v_cvt_pk_bf16_f32 v69, v202, v203
  v_pk_mul_f32 v[206:207], v[206:207], v[20:21]
  v_cvt_pk_bf16_f32 v70, v204, v205
  v_pk_mul_f32 v[208:209], v[208:209], v[18:19]
  v_cvt_pk_bf16_f32 v71, v206, v207
  v_pk_mul_f32 v[210:211], v[210:211], v[18:19]
  v_cvt_pk_bf16_f32 v72, v208, v209
  v_pk_mul_f32 v[212:213], v[212:213], v[18:19]
  v_cvt_pk_bf16_f32 v73, v210, v211
  v_pk_mul_f32 v[214:215], v[214:215], v[18:19]
  v_cvt_pk_bf16_f32 v74, v212, v213
  v_pk_mul_f32 v[216:217], v[216:217], v[20:21]
  v_cvt_pk_bf16_f32 v75, v214, v215
  v_pk_mul_f32 v[218:219], v[218:219], v[20:21]
  v_cvt_pk_bf16_f32 v76, v216, v217
  v_pk_mul_f32 v[220:221], v[220:221], v[20:21]
  v_cvt_pk_bf16_f32 v77, v218, v219
  v_pk_mul_f32 v[222:223], v[222:223], v[20:21]
  v_cvt_pk_bf16_f32 v78, v220, v221
  v_pk_mul_f32 v[224:225], v[224:225], v[18:19]
  v_cvt_pk_bf16_f32 v79, v222, v223
  v_pk_mul_f32 v[226:227], v[226:227], v[18:19]
  v_cvt_pk_bf16_f32 v80, v224, v225
  v_pk_mul_f32 v[228:229], v[228:229], v[18:19]
  v_cvt_pk_bf16_f32 v81, v226, v227
  v_pk_mul_f32 v[230:231], v[230:231], v[18:19]
  v_cvt_pk_bf16_f32 v82, v228, v229
  v_pk_mul_f32 v[232:233], v[232:233], v[20:21]
  v_cvt_pk_bf16_f32 v83, v230, v231
  v_pk_mul_f32 v[234:235], v[234:235], v[20:21]
  v_cvt_pk_bf16_f32 v84, v232, v233
  v_pk_mul_f32 v[236:237], v[236:237], v[20:21]
  v_cvt_pk_bf16_f32 v85, v234, v235
  v_pk_mul_f32 v[238:239], v[238:239], v[20:21]
  v_cvt_pk_bf16_f32 v86, v236, v237
  v_pk_mul_f32 v[240:241], v[240:241], v[18:19]
  v_cvt_pk_bf16_f32 v87, v238, v239
  v_pk_mul_f32 v[242:243], v[242:243], v[18:19]
  v_cvt_pk_bf16_f32 v88, v240, v241
  v_pk_mul_f32 v[244:245], v[244:245], v[18:19]
  v_cvt_pk_bf16_f32 v89, v242, v243
  v_pk_mul_f32 v[246:247], v[246:247], v[18:19]
  v_cvt_pk_bf16_f32 v90, v244, v245
  v_pk_mul_f32 v[248:249], v[248:249], v[20:21]
  v_cvt_pk_bf16_f32 v91, v246, v247
  v_pk_mul_f32 v[250:251], v[250:251], v[20:21]
  v_cvt_pk_bf16_f32 v92, v248, v249
  v_pk_mul_f32 v[252:253], v[252:253], v[20:21]
  v_cvt_pk_bf16_f32 v93, v250, v251
  v_pk_mul_f32 v[254:255], v[254:255], v[20:21]
  v_cvt_pk_bf16_f32 v94, v252, v253
  v_cvt_pk_bf16_f32 v95, v254, v255
  s_branch A_EPI
A_MERGE:
  s_cmp_eq_u32 s51, 2
  s_cbranch_scc1 A_HAVE
  s_lshl_b32 s55, s48, 9
  s_add_u32 s55, s55, 121659392
  v_mov_b32 v18, 8
  s_mov_b32 s53, 0
A_POLL:
  buffer_load_dwordx2 v[20:21], v18, s[16:19], s55 offen sc1
  s_waitcnt vmcnt(0)
  v_cmp_eq_u32 vcc, s86, v20
  v_cmp_eq_u32 s[4:5], s87, v21
  s_nop 0
  s_and_b64 vcc, vcc, s[4:5]
  s_cmp_eq_u64 vcc, exec
  s_cbranch_scc1 A_POLL_OK
  s_sleep 4
  s_add_u32 s53, s53, 1
  s_cmp_lt_u32 s53, 200000
  s_cbranch_scc1 A_POLL
A_POLL_OK:
  s_lshl_b32 s54, s48, 2
  s_add_u32 s54, s54, s3
  s_lshl_b32 s55, s54, 10
  s_add_u32 s55, s55, 75497472
  s_lshl_b32 s54, s54, 14
  s_add_u32 s54, s54, 58720256
  v_lshrrev_b32 v108, 1, v1
  buffer_load_dwordx2 v[112:113], v108, s[16:19], s55 offen sc1
  buffer_load_dwordx2 v[114:115], v108, s[16:19], s55 offen offset:512 sc1
  buffer_load_dwordx4 a[64:67], v1, s[16:19], s54 offen offset:0 sc1
  buffer_load_dwordx4 a[68:71], v1, s[16:19], s54 offen offset:1024 sc1
  buffer_load_dwordx4 a[72:75], v1, s[16:19], s54 offen offset:2048 sc1
  buffer_load_dwordx4 a[76:79], v1, s[16:19], s54 offen offset:3072 sc1
  s_add_u32 s54, s54, 4096
  buffer_load_dwordx4 a[80:83], v1, s[16:19], s54 offen offset:0 sc1
  buffer_load_dwordx4 a[84:87], v1, s[16:19], s54 offen offset:1024 sc1
  buffer_load_dwordx4 a[88:91], v1, s[16:19], s54 offen offset:2048 sc1
  buffer_load_dwordx4 a[92:95], v1, s[16:19], s54 offen offset:3072 sc1
  s_add_u32 s54, s54, 4096
  buffer_load_dwordx4 a[96:99], v1, s[16:19], s54 offen offset:0 sc1
  buffer_load_dwordx4 a[100:103], v1, s[16:19], s54 offen offset:1024 sc1
  buffer_load_dwordx4 a[104:107], v1, s[16:19], s54 offen offset:2048 sc1
  buffer_load_dwordx4 a[108:111], v1, s[16:19], s54 offen offset:3072 sc1
  s_add_u32 s54, s54, 4096
  buffer_load_dwordx4 a[112:115], v1, s[16:19], s54 offen offset:0 sc1
  buffer_load_dwordx4 a[116:119], v1, s[16:19], s54 offen offset:1024 sc1
  buffer_load_dwordx4 a[120:123], v1, s[16:19], s54 offen offset:2048 sc1
  buffer_load_dwordx4 a[124:127], v1, s[16:19], s54 offen offset:3072 sc1
A_HAVE:
  s_waitcnt vmcnt(17)
  v_min_f32 v116, v80, v112
  v_sub_f32 v18, v116, v80
  v_sub_f32 v22, v116, v112
  v_exp_f32 v18, v18
  v_exp_f32 v22, v22
  s_nop 0
  s_waitcnt vmcnt(16)
  v_mul_f32 v116, v22, v114
  v_fma_f32 v116, v8, v18, v116
  v_min_f32 v117, v84, v113
  v_sub_f32 v20, v117, v84
  v_sub_f32 v24, v117, v113
  v_exp_f32 v20, v20
  v_exp_f32 v24, v24
  s_nop 0
  v_mul_f32 v117, v24, v115
  v_fma_f32 v117, v9, v20, v117
  v_mov_b32 v118, v116
  v_mov_b32 v119, v117
  s_nop 1
  v_permlane16_swap_b32 v116, v118
  v_permlane16_swap_b32 v117, v119
  v_add_f32 v116, v116, v118
  v_add_f32 v117, v117, v119
  v_mov_b32 v118, v116
  v_mov_b32 v119, v117
  s_nop 1
  v_permlane32_swap_b32 v116, v118
  v_permlane32_swap_b32 v117, v119
  v_add_f32 v116, v116, v118
  v_add_f32 v117, v117, v119
  v_rcp_f32 v116, v116
  s_nop 0
  v_mul_f32 v18, v18, v116
  v_mul_f32 v22, v22, v116
  v_mov_b32 v19, v18
  v_mov_b32 v23, v22
  v_rcp_f32 v117, v117
  s_nop 0
  v_mul_f32 v20, v20, v117
  v_mul_f32 v24, v24, v117
  v_mov_b32 v21, v20
  v_mov_b32 v25, v24
  v_pk_mul_f32 v[128:129], v[128:129], v[18:19]
  v_pk_mul_f32 v[130:131], v[130:131], v[18:19]
  v_pk_mul_f32 v[132:133], v[132:133], v[18:19]
  v_pk_mul_f32 v[134:135], v[134:135], v[18:19]
  v_pk_mul_f32 v[136:137], v[136:137], v[20:21]
  v_pk_mul_f32 v[138:139], v[138:139], v[20:21]
  v_pk_mul_f32 v[140:141], v[140:141], v[20:21]
  v_pk_mul_f32 v[142:143], v[142:143], v[20:21]
  v_pk_mul_f32 v[144:145], v[144:145], v[18:19]
  v_pk_mul_f32 v[146:147], v[146:147], v[18:19]
  v_pk_mul_f32 v[148:149], v[148:149], v[18:19]
  v_pk_mul_f32 v[150:151], v[150:151], v[18:19]
  v_pk_mul_f32 v[152:153], v[152:153], v[20:21]
  v_pk_mul_f32 v[154:155], v[154:155], v[20:21]
  v_pk_mul_f32 v[156:157], v[156:157], v[20:21]
  v_pk_mul_f32 v[158:159], v[158:159], v[20:21]
  v_pk_mul_f32 v[160:161], v[160:161], v[18:19]
  v_pk_mul_f32 v[162:163], v[162:163], v[18:19]
  v_pk_mul_f32 v[164:165], v[164:165], v[18:19]
  v_pk_mul_f32 v[166:167], v[166:167], v[18:19]
  v_pk_mul_f32 v[168:169], v[168:169], v[20:21]
  v_pk_mul_f32 v[170:171], v[170:171], v[20:21]
  v_pk_mul_f32 v[172:173], v[172:173], v[20:21]
  v_pk_mul_f32 v[174:175], v[174:175], v[20:21]
  v_pk_mul_f32 v[176:177], v[176:177], v[18:19]
  v_pk_mul_f32 v[178:179], v[178:179], v[18:19]
  v_pk_mul_f32 v[180:181], v[180:181], v[18:19]
  v_pk_mul_f32 v[182:183], v[182:183], v[18:19]
  v_pk_mul_f32 v[184:185], v[184:185], v[20:21]
  v_pk_mul_f32 v[186:187], v[186:187], v[20:21]
  v_pk_mul_f32 v[188:189], v[188:189], v[20:21]
  v_pk_mul_f32 v[190:191], v[190:191], v[20:21]
  v_pk_mul_f32 v[192:193], v[192:193], v[18:19]
  v_pk_mul_f32 v[194:195], v[194:195], v[18:19]
  v_pk_mul_f32 v[196:197], v[196:197], v[18:19]
  v_pk_mul_f32 v[198:199], v[198:199], v[18:19]
  v_pk_mul_f32 v[200:201], v[200:201], v[20:21]
  v_pk_mul_f32 v[202:203], v[202:203], v[20:21]
  v_pk_mul_f32 v[204:205], v[204:205], v[20:21]
  v_pk_mul_f32 v[206:207], v[206:207], v[20:21]
  v_pk_mul_f32 v[208:209], v[208:209], v[18:19]
  v_pk_mul_f32 v[210:211], v[210:211], v[18:19]
  v_pk_mul_f32 v[212:213], v[212:213], v[18:19]
  v_pk_mul_f32 v[214:215], v[214:215], v[18:19]
  v_pk_mul_f32 v[216:217], v[216:217], v[20:21]
  v_pk_mul_f32 v[218:219], v[218:219], v[20:21]
  v_pk_mul_f32 v[220:221], v[220:221], v[20:21]
  v_pk_mul_f32 v[222:223], v[222:223], v[20:21]
  v_pk_mul_f32 v[224:225], v[224:225], v[18:19]
  v_pk_mul_f32 v[226:227], v[226:227], v[18:19]
  v_pk_mul_f32 v[228:229], v[228:229], v[18:19]
  v_pk_mul_f32 v[230:231], v[230:231], v[18:19]
  v_pk_mul_f32 v[232:233], v[232:233], v[20:21]
  v_pk_mul_f32 v[234:235], v[234:235], v[20:21]
  v_pk_mul_f32 v[236:237], v[236:237], v[20:21]
  v_pk_mul_f32 v[238:239], v[238:239], v[20:21]
  v_pk_mul_f32 v[240:241], v[240:241], v[18:19]
  v_pk_mul_f32 v[242:243], v[242:243], v[18:19]
  v_pk_mul_f32 v[244:245], v[244:245], v[18:19]
  v_pk_mul_f32 v[246:247], v[246:247], v[18:19]
  v_pk_mul_f32 v[248:249], v[248:249], v[20:21]
  v_pk_mul_f32 v[250:251], v[250:251], v[20:21]
  v_pk_mul_f32 v[252:253], v[252:253], v[20:21]
  v_pk_mul_f32 v[254:255], v[254:255], v[20:21]
  s_waitcnt vmcnt(15)
  v_accvgpr_read_b32 v27, a64
  v_lshlrev_b32 v26, 16, v27
  v_and_b32 v27, 0xffff0000, v27
  v_pk_fma_f32 v[128:129], v[26:27], v[22:23], v[128:129]
  v_accvgpr_read_b32 v29, a65
  v_cvt_pk_bf16_f32 v32, v128, v129
  v_lshlrev_b32 v28, 16, v29
  v_and_b32 v29, 0xffff0000, v29
  v_pk_fma_f32 v[130:131], v[28:29], v[22:23], v[130:131]
  v_accvgpr_read_b32 v27, a66
  v_cvt_pk_bf16_f32 v33, v130, v131
  v_lshlrev_b32 v26, 16, v27
  v_and_b32 v27, 0xffff0000, v27
  v_pk_fma_f32 v[132:133], v[26:27], v[22:23], v[132:133]
  v_accvgpr_read_b32 v29, a67
  v_cvt_pk_bf16_f32 v34, v132, v133
  v_lshlrev_b32 v28, 16, v29
  v_and_b32 v29, 0xffff0000, v29
  v_pk_fma_f32 v[134:135], v[28:29], v[22:23], v[134:135]
  s_waitcnt vmcnt(14)
  v_accvgpr_read_b32 v27, a68
  v_cvt_pk_bf16_f32 v35, v134, v135
  v_lshlrev_b32 v26, 16, v27
  v_and_b32 v27, 0xffff0000, v27
  v_pk_fma_f32 v[136:137], v[26:27], v[24:25], v[136:137]
  v_accvgpr_read_b32 v29, a69
  v_cvt_pk_bf16_f32 v36, v136, v137
  v_lshlrev_b32 v28, 16, v29
  v_and_b32 v29, 0xffff0000, v29
  v_pk_fma_f32 v[138:139], v[28:29], v[24:25], v[138:139]
  v_accvgpr_read_b32 v27, a70
  v_cvt_pk_bf16_f32 v37, v138, v139
  v_lshlrev_b32 v26, 16, v27
  v_and_b32 v27, 0xffff0000, v27
  v_pk_fma_f32 v[140:141], v[26:27], v[24:25], v[140:141]
  v_accvgpr_read_b32 v29, a71
  v_cvt_pk_bf16_f32 v38, v140, v141
  v_lshlrev_b32 v28, 16, v29
  v_and_b32 v29, 0xffff0000, v29
  v_pk_fma_f32 v[142:143], v[28:29], v[24:25], v[142:143]
  s_waitcnt vmcnt(13)
  v_accvgpr_read_b32 v27, a72
  v_cvt_pk_bf16_f32 v39, v142, v143
  v_lshlrev_b32 v26, 16, v27
  v_and_b32 v27, 0xffff0000, v27
  v_pk_fma_f32 v[144:145], v[26:27], v[22:23], v[144:145]
  v_accvgpr_read_b32 v29, a73
  v_cvt_pk_bf16_f32 v40, v144, v145
  v_lshlrev_b32 v28, 16, v29
  v_and_b32 v29, 0xffff0000, v29
  v_pk_fma_f32 v[146:147], v[28:29], v[22:23], v[146:147]
  v_accvgpr_read_b32 v27, a74
  v_cvt_pk_bf16_f32 v41, v146, v147
  v_lshlrev_b32 v26, 16, v27
  v_and_b32 v27, 0xffff0000, v27
  v_pk_fma_f32 v[148:149], v[26:27], v[22:23], v[148:149]
  v_accvgpr_read_b32 v29, a75
  v_cvt_pk_bf16_f32 v42, v148, v149
  v_lshlrev_b32 v28, 16, v29
  v_and_b32 v29, 0xffff0000, v29
  v_pk_fma_f32 v[150:151], v[28:29], v[22:23], v[150:151]
  s_waitcnt vmcnt(12)
  v_accvgpr_read_b32 v27, a76
  v_cvt_pk_bf16_f32 v43, v150, v151
  v_lshlrev_b32 v26, 16, v27
  v_and_b32 v27, 0xffff0000, v27
  v_pk_fma_f32 v[152:153], v[26:27], v[24:25], v[152:153]
  v_accvgpr_read_b32 v29, a77
  v_cvt_pk_bf16_f32 v44, v152, v153
  v_lshlrev_b32 v28, 16, v29
  v_and_b32 v29, 0xffff0000, v29
  v_pk_fma_f32 v[154:155], v[28:29], v[24:25], v[154:155]
  v_accvgpr_read_b32 v27, a78
  v_cvt_pk_bf16_f32 v45, v154, v155
  v_lshlrev_b32 v26, 16, v27
  v_and_b32 v27, 0xffff0000, v27
  v_pk_fma_f32 v[156:157], v[26:27], v[24:25], v[156:157]
  v_accvgpr_read_b32 v29, a79
  v_cvt_pk_bf16_f32 v46, v156, v157
  v_lshlrev_b32 v28, 16, v29
  v_and_b32 v29, 0xffff0000, v29
  v_pk_fma_f32 v[158:159], v[28:29], v[24:25], v[158:159]
  s_waitcnt vmcnt(11)
  v_accvgpr_read_b32 v27, a80
  v_cvt_pk_bf16_f32 v47, v158, v159
  v_lshlrev_b32 v26, 16, v27
  v_and_b32 v27, 0xffff0000, v27
  v_pk_fma_f32 v[160:161], v[26:27], v[22:23], v[160:161]
  v_accvgpr_read_b32 v29, a81
  v_cvt_pk_bf16_f32 v48, v160, v161
  v_lshlrev_b32 v28, 16, v29
  v_and_b32 v29, 0xffff0000, v29
  v_pk_fma_f32 v[162:163], v[28:29], v[22:23], v[162:163]
  v_accvgpr_read_b32 v27, a82
  v_cvt_pk_bf16_f32 v49, v162, v163
  v_lshlrev_b32 v26, 16, v27
  v_and_b32 v27, 0xffff0000, v27
  v_pk_fma_f32 v[164:165], v[26:27], v[22:23], v[164:165]
  v_accvgpr_read_b32 v29, a83
  v_cvt_pk_bf16_f32 v50, v164, v165
  v_lshlrev_b32 v28, 16, v29
  v_and_b32 v29, 0xffff0000, v29
  v_pk_fma_f32 v[166:167], v[28:29], v[22:23], v[166:167]
  s_waitcnt vmcnt(10)
  v_accvgpr_read_b32 v27, a84
  v_cvt_pk_bf16_f32 v51, v166, v167
  v_lshlrev_b32 v26, 16, v27
  v_and_b32 v27, 0xffff0000, v27
  v_pk_fma_f32 v[168:169], v[26:27], v[24:25], v[168:169]
  v_accvgpr_read_b32 v29, a85
  v_cvt_pk_bf16_f32 v52, v168, v169
  v_lshlrev_b32 v28, 16, v29
  v_and_b32 v29, 0xffff0000, v29
  v_pk_fma_f32 v[170:171], v[28:29], v[24:25], v[170:171]
  v_accvgpr_read_b32 v27, a86
  v_cvt_pk_bf16_f32 v53, v170, v171
  v_lshlrev_b32 v26, 16, v27
  v_and_b32 v27, 0xffff0000, v27
  v_pk_fma_f32 v[172:173], v[26:27], v[24:25], v[172:173]
  v_accvgpr_read_b32 v29, a87
  v_cvt_pk_bf16_f32 v54, v172, v173
  v_lshlrev_b32 v28, 16, v29
  v_and_b32 v29, 0xffff0000, v29
  v_pk_fma_f32 v[174:175], v[28:29], v[24:25], v[174:175]
  s_waitcnt vmcnt(9)
  v_accvgpr_read_b32 v27, a88
  v_cvt_pk_bf16_f32 v55, v174, v175
  v_lshlrev_b32 v26, 16, v27
  v_and_b32 v27, 0xffff0000, v27
  v_pk_fma_f32 v[176:177], v[26:27], v[22:23], v[176:177]
  v_accvgpr_read_b32 v29, a89
  v_cvt_pk_bf16_f32 v56, v176, v177
  v_lshlrev_b32 v28, 16, v29
  v_and_b32 v29, 0xffff0000, v29
  v_pk_fma_f32 v[178:179], v[28:29], v[22:23], v[178:179]
  v_accvgpr_read_b32 v27, a90
  v_cvt_pk_bf16_f32 v57, v178, v179
  v_lshlrev_b32 v26, 16, v27
  v_and_b32 v27, 0xffff0000, v27
  v_pk_fma_f32 v[180:181], v[26:27], v[22:23], v[180:181]
  v_accvgpr_read_b32 v29, a91
  v_cvt_pk_bf16_f32 v58, v180, v181
  v_lshlrev_b32 v28, 16, v29
  v_and_b32 v29, 0xffff0000, v29
  v_pk_fma_f32 v[182:183], v[28:29], v[22:23], v[182:183]
  s_waitcnt vmcnt(8)
  v_accvgpr_read_b32 v27, a92
  v_cvt_pk_bf16_f32 v59, v182, v183
  v_lshlrev_b32 v26, 16, v27
  v_and_b32 v27, 0xffff0000, v27
  v_pk_fma_f32 v[184:185], v[26:27], v[24:25], v[184:185]
  v_accvgpr_read_b32 v29, a93
  v_cvt_pk_bf16_f32 v60, v184, v185
  v_lshlrev_b32 v28, 16, v29
  v_and_b32 v29, 0xffff0000, v29
  v_pk_fma_f32 v[186:187], v[28:29], v[24:25], v[186:187]
  v_accvgpr_read_b32 v27, a94
  v_cvt_pk_bf16_f32 v61, v186, v187
  v_lshlrev_b32 v26, 16, v27
  v_and_b32 v27, 0xffff0000, v27
  v_pk_fma_f32 v[188:189], v[26:27], v[24:25], v[188:189]
  v_accvgpr_read_b32 v29, a95
  v_cvt_pk_bf16_f32 v62, v188, v189
  v_lshlrev_b32 v28, 16, v29
  v_and_b32 v29, 0xffff0000, v29
  v_pk_fma_f32 v[190:191], v[28:29], v[24:25], v[190:191]
  s_waitcnt vmcnt(7)
  v_accvgpr_read_b32 v27, a96
  v_cvt_pk_bf16_f32 v63, v190, v191
  v_lshlrev_b32 v26, 16, v27
  v_and_b32 v27, 0xffff0000, v27
  v_pk_fma_f32 v[192:193], v[26:27], v[22:23], v[192:193]
  v_accvgpr_read_b32 v29, a97
  v_cvt_pk_bf16_f32 v64, v192, v193
  v_lshlrev_b32 v28, 16, v29
  v_and_b32 v29, 0xffff0000, v29
  v_pk_fma_f32 v[194:195], v[28:29], v[22:23], v[194:195]
  v_accvgpr_read_b32 v27, a98
  v_cvt_pk_bf16_f32 v65, v194, v195
  v_lshlrev_b32 v26, 16, v27
  v_and_b32 v27, 0xffff0000, v27
  v_pk_fma_f32 v[196:197], v[26:27], v[22:23], v[196:197]
  v_accvgpr_read_b32 v29, a99
  v_cvt_pk_bf16_f32 v66, v196, v197
  v_lshlrev_b32 v28, 16, v29
  v_and_b32 v29, 0xffff0000, v29
  v_pk_fma_f32 v[198:199], v[28:29], v[22:23], v[198:199]
  s_waitcnt vmcnt(6)
  v_accvgpr_read_b32 v27, a100
  v_cvt_pk_bf16_f32 v67, v198, v199
  v_lshlrev_b32 v26, 16, v27
  v_and_b32 v27, 0xffff0000, v27
  v_pk_fma_f32 v[200:201], v[26:27], v[24:25], v[200:201]
  v_accvgpr_read_b32 v29, a101
  v_cvt_pk_bf16_f32 v68, v200, v201
  v_lshlrev_b32 v28, 16, v29
  v_and_b32 v29, 0xffff0000, v29
  v_pk_fma_f32 v[202:203], v[28:29], v[24:25], v[202:203]
  v_accvgpr_read_b32 v27, a102
  v_cvt_pk_bf16_f32 v69, v202, v203
  v_lshlrev_b32 v26, 16, v27
  v_and_b32 v27, 0xffff0000, v27
  v_pk_fma_f32 v[204:205], v[26:27], v[24:25], v[204:205]
  v_accvgpr_read_b32 v29, a103
  v_cvt_pk_bf16_f32 v70, v204, v205
  v_lshlrev_b32 v28, 16, v29
  v_and_b32 v29, 0xffff0000, v29
  v_pk_fma_f32 v[206:207], v[28:29], v[24:25], v[206:207]
  s_waitcnt vmcnt(5)
  v_accvgpr_read_b32 v27, a104
  v_cvt_pk_bf16_f32 v71, v206, v207
  v_lshlrev_b32 v26, 16, v27
  v_and_b32 v27, 0xffff0000, v27
  v_pk_fma_f32 v[208:209], v[26:27], v[22:23], v[208:209]
  v_accvgpr_read_b32 v29, a105
  v_cvt_pk_bf16_f32 v72, v208, v209
  v_lshlrev_b32 v28, 16, v29
  v_and_b32 v29, 0xffff0000, v29
  v_pk_fma_f32 v[210:211], v[28:29], v[22:23], v[210:211]
  v_accvgpr_read_b32 v27, a106
  v_cvt_pk_bf16_f32 v73, v210, v211
  v_lshlrev_b32 v26, 16, v27
  v_and_b32 v27, 0xffff0000, v27
  v_pk_fma_f32 v[212:213], v[26:27], v[22:23], v[212:213]
  v_accvgpr_read_b32 v29, a107
  v_cvt_pk_bf16_f32 v74, v212, v213
  v_lshlrev_b32 v28, 16, v29
  v_and_b32 v29, 0xffff0000, v29
  v_pk_fma_f32 v[214:215], v[28:29], v[22:23], v[214:215]
  s_waitcnt vmcnt(4)
  v_accvgpr_read_b32 v27, a108
  v_cvt_pk_bf16_f32 v75, v214, v215
  v_lshlrev_b32 v26, 16, v27
  v_and_b32 v27, 0xffff0000, v27
  v_pk_fma_f32 v[216:217], v[26:27], v[24:25], v[216:217]
  v_accvgpr_read_b32 v29, a109
  v_cvt_pk_bf16_f32 v76, v216, v217
  v_lshlrev_b32 v28, 16, v29
  v_and_b32 v29, 0xffff0000, v29
  v_pk_fma_f32 v[218:219], v[28:29], v[24:25], v[218:219]
  v_accvgpr_read_b32 v27, a110
  v_cvt_pk_bf16_f32 v77, v218, v219
  v_lshlrev_b32 v26, 16, v27
  v_and_b32 v27, 0xffff0000, v27
  v_pk_fma_f32 v[220:221], v[26:27], v[24:25], v[220:221]
  v_accvgpr_read_b32 v29, a111
  v_cvt_pk_bf16_f32 v78, v220, v221
  v_lshlrev_b32 v28, 16, v29
  v_and_b32 v29, 0xffff0000, v29
  v_pk_fma_f32 v[222:223], v[28:29], v[24:25], v[222:223]
  s_waitcnt vmcnt(3)
  v_accvgpr_read_b32 v27, a112
  v_cvt_pk_bf16_f32 v79, v222, v223
  v_lshlrev_b32 v26, 16, v27
  v_and_b32 v27, 0xffff0000, v27
  v_pk_fma_f32 v[224:225], v[26:27], v[22:23], v[224:225]
  v_accvgpr_read_b32 v29, a113
  v_cvt_pk_bf16_f32 v80, v224, v225
  v_lshlrev_b32 v28, 16, v29
  v_and_b32 v29, 0xffff0000, v29
  v_pk_fma_f32 v[226:227], v[28:29], v[22:23], v[226:227]
  v_accvgpr_read_b32 v27, a114
  v_cvt_pk_bf16_f32 v81, v226, v227
  v_lshlrev_b32 v26, 16, v27
  v_and_b32 v27, 0xffff0000, v27
  v_pk_fma_f32 v[228:229], v[26:27], v[22:23], v[228:229]
  v_accvgpr_read_b32 v29, a115
  v_cvt_pk_bf16_f32 v82, v228, v229
  v_lshlrev_b32 v28, 16, v29
  v_and_b32 v29, 0xffff0000, v29
  v_pk_fma_f32 v[230:231], v[28:29], v[22:23], v[230:231]
  s_waitcnt vmcnt(2)
  v_accvgpr_read_b32 v27, a116
  v_cvt_pk_bf16_f32 v83, v230, v231
  v_lshlrev_b32 v26, 16, v27
  v_and_b32 v27, 0xffff0000, v27
  v_pk_fma_f32 v[232:233], v[26:27], v[24:25], v[232:233]
  v_accvgpr_read_b32 v29, a117
  v_cvt_pk_bf16_f32 v84, v232, v233
  v_lshlrev_b32 v28, 16, v29
  v_and_b32 v29, 0xffff0000, v29
  v_pk_fma_f32 v[234:235], v[28:29], v[24:25], v[234:235]
  v_accvgpr_read_b32 v27, a118
  v_cvt_pk_bf16_f32 v85, v234, v235
  v_lshlrev_b32 v26, 16, v27
  v_and_b32 v27, 0xffff0000, v27
  v_pk_fma_f32 v[236:237], v[26:27], v[24:25], v[236:237]
  v_accvgpr_read_b32 v29, a119
  v_cvt_pk_bf16_f32 v86, v236, v237
  v_lshlrev_b32 v28, 16, v29
  v_and_b32 v29, 0xffff0000, v29
  v_pk_fma_f32 v[238:239], v[28:29], v[24:25], v[238:239]
  s_waitcnt vmcnt(1)
  v_accvgpr_read_b32 v27, a120
  v_cvt_pk_bf16_f32 v87, v238, v239
  v_lshlrev_b32 v26, 16, v27
  v_and_b32 v27, 0xffff0000, v27
  v_pk_fma_f32 v[240:241], v[26:27], v[22:23], v[240:241]
  v_accvgpr_read_b32 v29, a121
  v_cvt_pk_bf16_f32 v88, v240, v241
  v_lshlrev_b32 v28, 16, v29
  v_and_b32 v29, 0xffff0000, v29
  v_pk_fma_f32 v[242:243], v[28:29], v[22:23], v[242:243]
  v_accvgpr_read_b32 v27, a122
  v_cvt_pk_bf16_f32 v89, v242, v243
  v_lshlrev_b32 v26, 16, v27
  v_and_b32 v27, 0xffff0000, v27
  v_pk_fma_f32 v[244:245], v[26:27], v[22:23], v[244:245]
  v_accvgpr_read_b32 v29, a123
  v_cvt_pk_bf16_f32 v90, v244, v245
  v_lshlrev_b32 v28, 16, v29
  v_and_b32 v29, 0xffff0000, v29
  v_pk_fma_f32 v[246:247], v[28:29], v[22:23], v[246:247]
  s_waitcnt vmcnt(0)
  v_accvgpr_read_b32 v27, a124
  v_cvt_pk_bf16_f32 v91, v246, v247
  v_lshlrev_b32 v26, 16, v27
  v_and_b32 v27, 0xffff0000, v27
  v_pk_fma_f32 v[248:249], v[26:27], v[24:25], v[248:249]
  v_accvgpr_read_b32 v29, a125
  v_cvt_pk_bf16_f32 v92, v248, v249
  v_lshlrev_b32 v28, 16, v29
  v_and_b32 v29, 0xffff0000, v29
  v_pk_fma_f32 v[250:251], v[28:29], v[24:25], v[250:251]
  v_accvgpr_read_b32 v27, a126
  v_cvt_pk_bf16_f32 v93, v250, v251
  v_lshlrev_b32 v26, 16, v27
  v_and_b32 v27, 0xffff0000, v27
  v_pk_fma_f32 v[252:253], v[26:27], v[24:25], v[252:253]
  v_accvgpr_read_b32 v29, a127
  v_cvt_pk_bf16_f32 v94, v252, v253
  v_lshlrev_b32 v28, 16, v29
  v_and_b32 v29, 0xffff0000, v29
  v_pk_fma_f32 v[254:255], v[28:29], v[24:25], v[254:255]
  v_cvt_pk_bf16_f32 v95, v254, v255
A_EPI:
  v_add_u32 v176, 0x10000, v104
  v_add_u32 v180, 0x20000, v104
  v_add_u32 v177, 0x10000, v105
  v_add_u32 v181, 0x20000, v105
  v_add_u32 v178, 0x10000, v106
  v_add_u32 v182, 0x20000, v106
  v_add_u32 v179, 0x10000, v107
  v_add_u32 v183, 0x20000, v107
  s_waitcnt vmcnt(0)
  s_barrier
  ds_read_b64_tr_b16 a[128:129], v104 offset:32768
  ds_read_b64_tr_b16 a[130:131], v104 offset:34816
  ds_read_b64_tr_b16 a[132:133], v105 offset:32768
  ds_read_b64_tr_b16 a[134:135], v105 offset:34816
  ds_read_b64_tr_b16 a[136:137], v104 offset:36864
  ds_read_b64_tr_b16 a[138:139], v104 offset:38912
  ds_read_b64_tr_b16 a[140:141], v105 offset:36864
  ds_read_b64_tr_b16 a[142:143], v105 offset:38912
  ds_read_b64_tr_b16 a[144:145], v104 offset:40960
  ds_read_b64_tr_b16 a[146:147], v104 offset:43008
  ds_read_b64_tr_b16 a[148:149], v105 offset:40960
  ds_read_b64_tr_b16 a[150:151], v105 offset:43008
  ds_read_b64_tr_b16 a[152:153], v104 offset:45056
  ds_read_b64_tr_b16 a[154:155], v104 offset:47104
  s_waitcnt lgkmcnt(10)
  v_mfma_f32_16x16x32_bf16 v[128:131], a[128:131], v[32:35], 0
  ds_read_b64_tr_b16 a[156:157], v105 offset:45056
  ds_read_b64_tr_b16 a[158:159], v105 offset:47104
  v_mfma_f32_16x16x32_bf16 v[136:139], a[128:131], v[36:39], 0
  s_mov_b32 s58, 81920
  s_mov_b32 s59, 114688
  v_mfma_f32_16x16x32_bf16 v[132:135], a[132:135], v[32:35], 0
  s_waitcnt lgkmcnt(8)
  ds_read_b64_tr_b16 a[128:129], v104 offset:49152
  ds_read_b64_tr_b16 a[130:131], v104 offset:51200
  v_mfma_f32_16x16x32_bf16 v[140:143], a[132:135], v[36:39], 0
  s_add_u32 s61, s58, s60
  s_add_u32 m0, s61, 0
  s_add_u32 s61, s56, 0
  v_mfma_f32_16x16x32_bf16 v[128:131], a[136:139], v[40:43], v[128:131]
  ds_read_b64_tr_b16 a[132:133], v105 offset:49152
  ds_read_b64_tr_b16 a[134:135], v105 offset:51200
  v_mfma_f32_16x16x32_bf16 v[136:139], a[136:139], v[44:47], v[136:139]
  buffer_load_dwordx4 v100, s[8:11], s61 offen offset:0 sc1 lds
  v_mfma_f32_16x16x32_bf16 v[132:135], a[140:143], v[40:43], v[132:135]
  s_waitcnt lgkmcnt(8)
  ds_read_b64_tr_b16 a[136:137], v104 offset:53248
  v_mfma_f32_16x16x32_bf16 v[140:143], a[140:143], v[44:47], v[140:143]
  ds_read_b64_tr_b16 a[138:139], v104 offset:55296
  buffer_load_dwordx4 v101, s[8:11], s61 offen offset:1024 sc1 lds
  v_mfma_f32_16x16x32_bf16 v[128:131], a[144:147], v[48:51], v[128:131]
  ds_read_b64_tr_b16 a[140:141], v105 offset:53248
  ds_read_b64_tr_b16 a[142:143], v105 offset:55296
  v_mfma_f32_16x16x32_bf16 v[136:139], a[144:147], v[52:55], v[136:139]
  buffer_load_dwordx4 v102, s[8:11], s61 offen offset:2048 sc1 lds
  v_mfma_f32_16x16x32_bf16 v[132:135], a[148:151], v[48:51], v[132:135]
  s_waitcnt lgkmcnt(8)
  ds_read_b64_tr_b16 a[144:145], v104 offset:57344
  v_mfma_f32_16x16x32_bf16 v[140:143], a[148:151], v[52:55], v[140:143]
  ds_read_b64_tr_b16 a[146:147], v104 offset:59392
  buffer_load_dwordx4 v103, s[8:11], s61 offen offset:3072 sc1 lds
  v_mfma_f32_16x16x32_bf16 v[128:131], a[152:155], v[56:59], v[128:131]
  ds_read_b64_tr_b16 a[148:149], v105 offset:57344
  v_mfma_f32_16x16x32_bf16 v[136:139], a[152:155], v[60:63], v[136:139]
  ds_read_b64_tr_b16 a[150:151], v105 offset:59392
  v_mfma_f32_16x16x32_bf16 v[132:135], a[156:159], v[56:59], v[132:135]
  s_waitcnt lgkmcnt(8)
  ds_read_b64_tr_b16 a[152:153], v104 offset:61440
  ds_read_b64_tr_b16 a[154:155], v104 offset:63488
  v_mfma_f32_16x16x32_bf16 v[140:143], a[156:159], v[60:63], v[140:143]
  s_add_u32 s61, s58, s60
  s_add_u32 m0, s61, 4096
  s_add_u32 s61, s56, 28672
  v_mfma_f32_16x16x32_bf16 v[128:131], a[128:131], v[64:67], v[128:131]
  ds_read_b64_tr_b16 a[156:157], v105 offset:61440
  ds_read_b64_tr_b16 a[158:159], v105 offset:63488
  v_mfma_f32_16x16x32_bf16 v[136:139], a[128:131], v[68:71], v[136:139]
  buffer_load_dwordx4 v100, s[8:11], s61 offen offset:0 sc1 lds
  v_mfma_f32_16x16x32_bf16 v[132:135], a[132:135], v[64:67], v[132:135]
  s_waitcnt lgkmcnt(8)
  ds_read_b64_tr_b16 a[128:129], v176 offset:0
  v_mfma_f32_16x16x32_bf16 v[140:143], a[132:135], v[68:71], v[140:143]
  ds_read_b64_tr_b16 a[130:131], v176 offset:2048
  buffer_load_dwordx4 v101, s[8:11], s61 offen offset:1024 sc1 lds
  v_mfma_f32_16x16x32_bf16 v[128:131], a[136:139], v[72:75], v[128:131]
  ds_read_b64_tr_b16 a[132:133], v177 offset:0
  ds_read_b64_tr_b16 a[134:135], v177 offset:2048
  v_mfma_f32_16x16x32_bf16 v[136:139], a[136:139], v[76:79], v[136:139]
  buffer_load_dwordx4 v102, s[8:11], s61 offen offset:2048 sc1 lds
  v_mfma_f32_16x16x32_bf16 v[132:135], a[140:143], v[72:75], v[132:135]
  s_waitcnt lgkmcnt(8)
  ds_read_b64_tr_b16 a[136:137], v176 offset:4096
  v_mfma_f32_16x16x32_bf16 v[140:143], a[140:143], v[76:79], v[140:143]
  ds_read_b64_tr_b16 a[138:139], v176 offset:6144
  buffer_load_dwordx4 v103, s[8:11], s61 offen offset:3072 sc1 lds
  v_mfma_f32_16x16x32_bf16 v[128:131], a[144:147], v[80:83], v[128:131]
  ds_read_b64_tr_b16 a[140:141], v177 offset:4096
  ds_read_b64_tr_b16 a[142:143], v177 offset:6144
  v_mfma_f32_16x16x32_bf16 v[136:139], a[144:147], v[84:87], v[136:139]
  s_add_u32 m0, s59, s43
  s_add_u32 s56, s56, 128
  v_mfma_f32_16x16x32_bf16 v[132:135], a[148:151], v[80:83], v[132:135]
  s_waitcnt lgkmcnt(8)
  ds_read_b64_tr_b16 a[144:145], v176 offset:8192
  v_mfma_f32_16x16x32_bf16 v[140:143], a[148:151], v[84:87], v[140:143]
  ds_read_b64_tr_b16 a[146:147], v176 offset:10240
  v_mfma_f32_16x16x32_bf16 v[128:131], a[152:155], v[88:91], v[128:131]
  ds_read_b64_tr_b16 a[148:149], v177 offset:8192
  ds_read_b64_tr_b16 a[150:151], v177 offset:10240
  v_mfma_f32_16x16x32_bf16 v[136:139], a[152:155], v[92:95], v[136:139]
  buffer_load_dwordx4 v100, s[12:15], s57 offen offset:0 sc1 lds
  v_mfma_f32_16x16x32_bf16 v[132:135], a[156:159], v[88:91], v[132:135]
  s_waitcnt lgkmcnt(8)
  ds_read_b64_tr_b16 a[152:153], v176 offset:12288
  v_mfma_f32_16x16x32_bf16 v[140:143], a[156:159], v[92:95], v[140:143]
  buffer_load_dwordx4 v101, s[12:15], s57 offen offset:1024 sc1 lds
  v_mfma_f32_16x16x32_bf16 v[128:131], a[128:131], a[192:195], v[128:131]
  ds_read_b64_tr_b16 a[156:157], v177 offset:12288
  v_mfma_f32_16x16x32_bf16 v[136:139], a[128:131], a[196:199], v[136:139]
  buffer_load_dwordx4 v102, s[12:15], s57 offen offset:2048 sc1 lds
  v_mfma_f32_16x16x32_bf16 v[132:135], a[132:135], a[192:195], v[132:135]
  s_waitcnt lgkmcnt(6)
  ds_read_b64_tr_b16 a[128:129], v106 offset:32768
  v_mfma_f32_16x16x32_bf16 v[140:143], a[132:135], a[196:199], v[140:143]
  ds_read_b64_tr_b16 a[130:131], v106 offset:34816
  buffer_load_dwordx4 v103, s[12:15], s57 offen offset:3072 sc1 lds
  v_mfma_f32_16x16x32_bf16 v[128:131], a[136:139], a[200:203], v[128:131]
  ds_read_b64_tr_b16 a[132:133], v107 offset:32768
  v_mfma_f32_16x16x32_bf16 v[136:139], a[136:139], a[204:207], v[136:139]
  s_add_u32 s57, s57, 128
  ds_read_b64_tr_b16 a[134:135], v107 offset:34816
  v_mfma_f32_16x16x32_bf16 v[132:135], a[140:143], a[200:203], v[132:135]
  s_waitcnt lgkmcnt(6)
  ds_read_b64_tr_b16 a[136:137], v106 offset:36864
  v_mfma_f32_16x16x32_bf16 v[140:143], a[140:143], a[204:207], v[140:143]
  ds_read_b64_tr_b16 a[138:139], v106 offset:38912
  v_mfma_f32_16x16x32_bf16 v[128:131], a[144:147], a[208:211], v[128:131]
  ds_read_b64_tr_b16 a[140:141], v107 offset:36864
  ds_read_b64_tr_b16 a[142:143], v107 offset:38912
  v_mfma_f32_16x16x32_bf16 v[136:139], a[144:147], a[212:215], v[136:139]
  s_mov_b32 s58, 131072
  s_mov_b32 s59, 0
  v_mfma_f32_16x16x32_bf16 v[132:135], a[148:151], a[208:211], v[132:135]
  s_waitcnt lgkmcnt(8)
  ds_read_b64_tr_b16 a[144:145], v106 offset:40960
  ds_read_b64_tr_b16 a[146:147], v106 offset:43008
  v_mfma_f32_16x16x32_bf16 v[140:143], a[148:151], a[212:215], v[140:143]
  s_add_u32 s61, s58, s60
  s_add_u32 m0, s61, 0
  s_add_u32 s61, s56, 0
  v_mfma_f32_16x16x16_bf16 v[128:131], a[152:153], a[216:217], v[128:131]
  ds_read_b64_tr_b16 a[148:149], v107 offset:40960
  v_mfma_f32_16x16x16_bf16 v[136:139], a[152:153], a[220:221], v[136:139]
  ds_read_b64_tr_b16 a[150:151], v107 offset:43008
  v_mfma_f32_16x16x16_bf16 v[132:135], a[156:157], a[216:217], v[132:135]
  s_waitcnt lgkmcnt(8)
  ds_read_b64_tr_b16 a[152:153], v106 offset:45056
  v_mfma_f32_16x16x16_bf16 v[140:143], a[156:157], a[220:221], v[140:143]
  ds_read_b64_tr_b16 a[154:155], v106 offset:47104
  buffer_load_dwordx4 v100, s[8:11], s61 offen offset:0 sc1 lds
  v_mfma_f32_16x16x32_bf16 v[144:147], a[128:131], v[32:35], 0
  ds_read_b64_tr_b16 a[156:157], v107 offset:45056
  v_mfma_f32_16x16x32_bf16 v[152:155], a[128:131], v[36:39], 0
  ds_read_b64_tr_b16 a[158:159], v107 offset:47104
  v_mfma_f32_16x16x32_bf16 v[148:151], a[132:135], v[32:35], 0
  s_waitcnt lgkmcnt(8)
  ds_read_b64_tr_b16 a[128:129], v106 offset:49152
  v_mfma_f32_16x16x32_bf16 v[156:159], a[132:135], v[36:39], 0
  ds_read_b64_tr_b16 a[130:131], v106 offset:51200
  buffer_load_dwordx4 v101, s[8:11], s61 offen offset:1024 sc1 lds
  v_mfma_f32_16x16x32_bf16 v[144:147], a[136:139], v[40:43], v[144:147]
  ds_read_b64_tr_b16 a[132:133], v107 offset:49152
  v_mfma_f32_16x16x32_bf16 v[152:155], a[136:139], v[44:47], v[152:155]
  ds_read_b64_tr_b16 a[134:135], v107 offset:51200
  v_mfma_f32_16x16x32_bf16 v[148:151], a[140:143], v[40:43], v[148:151]
  s_waitcnt lgkmcnt(8)
  ds_read_b64_tr_b16 a[136:137], v106 offset:53248
  v_mfma_f32_16x16x32_bf16 v[156:159], a[140:143], v[44:47], v[156:159]
  ds_read_b64_tr_b16 a[138:139], v106 offset:55296
  buffer_load_dwordx4 v102, s[8:11], s61 offen offset:2048 sc1 lds
  v_mfma_f32_16x16x32_bf16 v[144:147], a[144:147], v[48:51], v[144:147]
  ds_read_b64_tr_b16 a[140:141], v107 offset:53248
  v_cvt_pk_bf16_f32 v160, v128, v129
  v_mfma_f32_16x16x32_bf16 v[152:155], a[144:147], v[52:55], v[152:155]
  ds_read_b64_tr_b16 a[142:143], v107 offset:55296
  v_mfma_f32_16x16x32_bf16 v[148:151], a[148:151], v[48:51], v[148:151]
  s_waitcnt lgkmcnt(8)
  ds_read_b64_tr_b16 a[144:145], v106 offset:57344
  v_mfma_f32_16x16x32_bf16 v[156:159], a[148:151], v[52:55], v[156:159]
  ds_read_b64_tr_b16 a[146:147], v106 offset:59392
  buffer_load_dwordx4 v103, s[8:11], s61 offen offset:3072 sc1 lds
  v_mfma_f32_16x16x32_bf16 v[144:147], a[152:155], v[56:59], v[144:147]
  ds_read_b64_tr_b16 a[148:149], v107 offset:57344
  v_cvt_pk_bf16_f32 v161, v130, v131
  v_mfma_f32_16x16x32_bf16 v[152:155], a[152:155], v[60:63], v[152:155]
  ds_read_b64_tr_b16 a[150:151], v107 offset:59392
  v_mfma_f32_16x16x32_bf16 v[148:151], a[156:159], v[56:59], v[148:151]
  s_waitcnt lgkmcnt(8)
  ds_read_b64_tr_b16 a[152:153], v106 offset:61440
  ds_read_b64_tr_b16 a[154:155], v106 offset:63488
  v_mfma_f32_16x16x32_bf16 v[156:159], a[156:159], v[60:63], v[156:159]
  s_add_u32 s61, s58, s60
  s_add_u32 m0, s61, 4096
  s_add_u32 s61, s56, 28672
  v_mfma_f32_16x16x32_bf16 v[144:147], a[128:131], v[64:67], v[144:147]
  ds_read_b64_tr_b16 a[156:157], v107 offset:61440
  v_cvt_pk_bf16_f32 v162, v132, v133
  v_mfma_f32_16x16x32_bf16 v[152:155], a[128:131], v[68:71], v[152:155]
  ds_read_b64_tr_b16 a[158:159], v107 offset:63488
  v_mfma_f32_16x16x32_bf16 v[148:151], a[132:135], v[64:67], v[148:151]
  s_waitcnt lgkmcnt(8)
  ds_read_b64_tr_b16 a[128:129], v178 offset:0
  v_mfma_f32_16x16x32_bf16 v[156:159], a[132:135], v[68:71], v[156:159]
  ds_read_b64_tr_b16 a[130:131], v178 offset:2048
  buffer_load_dwordx4 v100, s[8:11], s61 offen offset:0 sc1 lds
  v_mfma_f32_16x16x32_bf16 v[144:147], a[136:139], v[72:75], v[144:147]
  ds_read_b64_tr_b16 a[132:133], v179 offset:0
  v_cvt_pk_bf16_f32 v163, v134, v135
  v_mfma_f32_16x16x32_bf16 v[152:155], a[136:139], v[76:79], v[152:155]
  ds_read_b64_tr_b16 a[134:135], v179 offset:2048
  v_mfma_f32_16x16x32_bf16 v[148:151], a[140:143], v[72:75], v[148:151]
  s_waitcnt lgkmcnt(8)
  ds_read_b64_tr_b16 a[136:137], v178 offset:4096
  v_mfma_f32_16x16x32_bf16 v[156:159], a[140:143], v[76:79], v[156:159]
  ds_read_b64_tr_b16 a[138:139], v178 offset:6144
  buffer_load_dwordx4 v101, s[8:11], s61 offen offset:1024 sc1 lds
  v_mfma_f32_16x16x32_bf16 v[144:147], a[144:147], v[80:83], v[144:147]
  ds_read_b64_tr_b16 a[140:141], v179 offset:4096
  ds_read_b64_tr_b16 a[142:143], v179 offset:6144
  v_mfma_f32_16x16x32_bf16 v[152:155], a[144:147], v[84:87], v[152:155]
  buffer_load_dwordx4 v102, s[8:11], s61 offen offset:2048 sc1 lds
  v_mfma_f32_16x16x32_bf16 v[148:151], a[148:151], v[80:83], v[148:151]
  s_waitcnt lgkmcnt(8)
  v_cvt_pk_bf16_f32 v164, v136, v137
  v_mfma_f32_16x16x32_bf16 v[156:159], a[148:151], v[84:87], v[156:159]
  ds_read_b64_tr_b16 a[144:145], v178 offset:8192
  ds_read_b64_tr_b16 a[146:147], v178 offset:10240
  v_mfma_f32_16x16x32_bf16 v[144:147], a[152:155], v[88:91], v[144:147]
  ds_read_b64_tr_b16 a[148:149], v179 offset:8192
  ds_read_b64_tr_b16 a[150:151], v179 offset:10240
  v_mfma_f32_16x16x32_bf16 v[152:155], a[152:155], v[92:95], v[152:155]
  buffer_load_dwordx4 v103, s[8:11], s61 offen offset:3072 sc1 lds
  v_mfma_f32_16x16x32_bf16 v[148:151], a[156:159], v[88:91], v[148:151]
  v_cvt_pk_bf16_f32 v165, v138, v139
  v_cvt_pk_bf16_f32 v166, v140, v141
  v_mfma_f32_16x16x32_bf16 v[156:159], a[156:159], v[92:95], v[156:159]
  s_waitcnt lgkmcnt(8)
  ds_read_b64_tr_b16 a[152:153], v178 offset:12288
  v_mfma_f32_16x16x32_bf16 v[144:147], a[128:131], a[192:195], v[144:147]
  ds_read_b64_tr_b16 a[156:157], v179 offset:12288
  v_mfma_f32_16x16x32_bf16 v[152:155], a[128:131], a[196:199], v[152:155]
  s_add_u32 m0, s59, s43
  s_add_u32 s56, s56, 128
  v_cvt_pk_bf16_f32 v167, v142, v143
  v_mfma_f32_16x16x32_bf16 v[148:151], a[132:135], a[192:195], v[148:151]
  s_waitcnt vmcnt(8)
  s_waitcnt lgkmcnt(0)
  s_barrier
  v_mfma_f32_16x16x32_bf16 v[156:159], a[132:135], a[196:199], v[156:159]
  ds_read_b64_tr_b16 a[128:129], v176 offset:16384
  ds_read_b64_tr_b16 a[130:131], v176 offset:18432
  v_mfma_f32_16x16x32_bf16 v[144:147], a[136:139], a[200:203], v[144:147]
  ds_read_b64_tr_b16 a[132:133], v177 offset:16384
  ds_read_b64_tr_b16 a[134:135], v177 offset:18432
  v_mfma_f32_16x16x32_bf16 v[152:155], a[136:139], a[204:207], v[152:155]
  buffer_load_dwordx4 v100, s[12:15], s57 offen offset:0 sc1 lds
  v_mfma_f32_16x16x32_bf16 v[148:151], a[140:143], a[200:203], v[148:151]
  ds_read_b64_tr_b16 a[136:137], v176 offset:20480
  v_mfma_f32_16x16x32_bf16 v[156:159], a[140:143], a[204:207], v[156:159]
  ds_read_b64_tr_b16 a[138:139], v176 offset:22528
  buffer_store_dwordx4 v[160:163], v1, s[16:19], s62 offen offset:0 sc1
  v_mfma_f32_16x16x32_bf16 v[144:147], a[144:147], a[208:211], v[144:147]
  ds_read_b64_tr_b16 a[140:141], v177 offset:20480
  ds_read_b64_tr_b16 a[142:143], v177 offset:22528
  v_mfma_f32_16x16x32_bf16 v[152:155], a[144:147], a[212:215], v[152:155]
  buffer_load_dwordx4 v101, s[12:15], s57 offen offset:1024 sc1 lds
  v_mfma_f32_16x16x32_bf16 v[148:151], a[148:151], a[208:211], v[148:151]
  ds_read_b64_tr_b16 a[144:145], v176 offset:24576
  v_mfma_f32_16x16x32_bf16 v[156:159], a[148:151], a[212:215], v[156:159]
  ds_read_b64_tr_b16 a[146:147], v176 offset:26624
  buffer_store_dwordx4 v[164:167], v1, s[16:19], s62 offen offset:1024 sc1
  v_mfma_f32_16x16x16_bf16 v[144:147], a[152:153], a[216:217], v[144:147]
  ds_read_b64_tr_b16 a[148:149], v177 offset:24576
  ds_read_b64_tr_b16 a[150:151], v177 offset:26624
  v_mfma_f32_16x16x16_bf16 v[152:155], a[152:153], a[220:221], v[152:155]
  buffer_load_dwordx4 v102, s[12:15], s57 offen offset:2048 sc1 lds
  v_mfma_f32_16x16x16_bf16 v[148:151], a[156:157], a[216:217], v[148:151]
  s_waitcnt lgkmcnt(8)
  ds_read_b64_tr_b16 a[152:153], v176 offset:28672
  v_mfma_f32_16x16x16_bf16 v[156:159], a[156:157], a[220:221], v[156:159]
  ds_read_b64_tr_b16 a[154:155], v176 offset:30720
  v_mfma_f32_16x16x32_bf16 v[128:131], a[128:131], v[32:35], 0
  ds_read_b64_tr_b16 a[156:157], v177 offset:28672
  ds_read_b64_tr_b16 a[158:159], v177 offset:30720
  v_mfma_f32_16x16x32_bf16 v[136:139], a[128:131], v[36:39], 0
  buffer_load_dwordx4 v103, s[12:15], s57 offen offset:3072 sc1 lds
  v_mfma_f32_16x16x32_bf16 v[132:135], a[132:135], v[32:35], 0
  s_waitcnt lgkmcnt(8)
  ds_read_b64_tr_b16 a[128:129], v176 offset:32768
  v_mfma_f32_16x16x32_bf16 v[140:143], a[132:135], v[36:39], 0
  ds_read_b64_tr_b16 a[130:131], v176 offset:34816
  v_mfma_f32_16x16x32_bf16 v[128:131], a[136:139], v[40:43], v[128:131]
  ds_read_b64_tr_b16 a[132:133], v177 offset:32768
  v_mfma_f32_16x16x32_bf16 v[136:139], a[136:139], v[44:47], v[136:139]
  s_add_u32 s57, s57, 128
  ds_read_b64_tr_b16 a[134:135], v177 offset:34816
  v_mfma_f32_16x16x32_bf16 v[132:135], a[140:143], v[40:43], v[132:135]
  s_waitcnt lgkmcnt(8)
  ds_read_b64_tr_b16 a[136:137], v176 offset:36864
  v_mfma_f32_16x16x32_bf16 v[140:143], a[140:143], v[44:47], v[140:143]
  ds_read_b64_tr_b16 a[138:139], v176 offset:38912
  v_mfma_f32_16x16x32_bf16 v[128:131], a[144:147], v[48:51], v[128:131]
  ds_read_b64_tr_b16 a[140:141], v177 offset:36864
  ds_read_b64_tr_b16 a[142:143], v177 offset:38912
  v_mfma_f32_16x16x32_bf16 v[136:139], a[144:147], v[52:55], v[136:139]
  s_mov_b32 s58, 32768
  s_mov_b32 s59, 65536
  v_cvt_pk_bf16_f32 v168, v144, v145
  v_mfma_f32_16x16x32_bf16 v[132:135], a[148:151], v[48:51], v[132:135]
  s_waitcnt lgkmcnt(8)
  ds_read_b64_tr_b16 a[144:145], v176 offset:40960
  v_mfma_f32_16x16x32_bf16 v[140:143], a[148:151], v[52:55], v[140:143]
  ds_read_b64_tr_b16 a[146:147], v176 offset:43008
  v_mfma_f32_16x16x32_bf16 v[128:131], a[152:155], v[56:59], v[128:131]
  ds_read_b64_tr_b16 a[148:149], v177 offset:40960
  ds_read_b64_tr_b16 a[150:151], v177 offset:43008
  v_mfma_f32_16x16x32_bf16 v[136:139], a[152:155], v[60:63], v[136:139]
  s_add_u32 s61, s58, s60
  s_add_u32 m0, s61, 0
  s_add_u32 s61, s56, 0
  v_cvt_pk_bf16_f32 v169, v146, v147
  v_mfma_f32_16x16x32_bf16 v[132:135], a[156:159], v[56:59], v[132:135]
  s_waitcnt lgkmcnt(8)
  ds_read_b64_tr_b16 a[152:153], v176 offset:45056
  v_mfma_f32_16x16x32_bf16 v[140:143], a[156:159], v[60:63], v[140:143]
  ds_read_b64_tr_b16 a[154:155], v176 offset:47104
  v_mfma_f32_16x16x32_bf16 v[128:131], a[128:131], v[64:67], v[128:131]
  ds_read_b64_tr_b16 a[156:157], v177 offset:45056
  ds_read_b64_tr_b16 a[158:159], v177 offset:47104
  v_mfma_f32_16x16x32_bf16 v[136:139], a[128:131], v[68:71], v[136:139]
  buffer_load_dwordx4 v100, s[8:11], s61 offen offset:0 sc1 lds
  v_mfma_f32_16x16x32_bf16 v[132:135], a[132:135], v[64:67], v[132:135]
  s_waitcnt lgkmcnt(8)
  v_cvt_pk_bf16_f32 v170, v148, v149
  v_mfma_f32_16x16x32_bf16 v[140:143], a[132:135], v[68:71], v[140:143]
  ds_read_b64_tr_b16 a[128:129], v176 offset:49152
  ds_read_b64_tr_b16 a[130:131], v176 offset:51200
  v_mfma_f32_16x16x32_bf16 v[128:131], a[136:139], v[72:75], v[128:131]
  ds_read_b64_tr_b16 a[132:133], v177 offset:49152
  ds_read_b64_tr_b16 a[134:135], v177 offset:51200
  v_mfma_f32_16x16x32_bf16 v[136:139], a[136:139], v[76:79], v[136:139]
  buffer_load_dwordx4 v101, s[8:11], s61 offen offset:1024 sc1 lds
  v_mfma_f32_16x16x32_bf16 v[132:135], a[140:143], v[72:75], v[132:135]
  s_waitcnt lgkmcnt(8)
  v_cvt_pk_bf16_f32 v171, v150, v151
  v_mfma_f32_16x16x32_bf16 v[140:143], a[140:143], v[76:79], v[140:143]
  ds_read_b64_tr_b16 a[136:137], v176 offset:53248
  ds_read_b64_tr_b16 a[138:139], v176 offset:55296
  v_mfma_f32_16x16x32_bf16 v[128:131], a[144:147], v[80:83], v[128:131]
  ds_read_b64_tr_b16 a[140:141], v177 offset:53248
  ds_read_b64_tr_b16 a[142:143], v177 offset:55296
  v_mfma_f32_16x16x32_bf16 v[136:139], a[144:147], v[84:87], v[136:139]
  buffer_load_dwordx4 v102, s[8:11], s61 offen offset:2048 sc1 lds
  v_mfma_f32_16x16x32_bf16 v[132:135], a[148:151], v[80:83], v[132:135]
  s_waitcnt lgkmcnt(8)
  v_cvt_pk_bf16_f32 v172, v152, v153
  v_mfma_f32_16x16x32_bf16 v[140:143], a[148:151], v[84:87], v[140:143]
  ds_read_b64_tr_b16 a[144:145], v176 offset:57344
  ds_read_b64_tr_b16 a[146:147], v176 offset:59392
  v_mfma_f32_16x16x32_bf16 v[128:131], a[152:155], v[88:91], v[128:131]
  ds_read_b64_tr_b16 a[148:149], v177 offset:57344
  ds_read_b64_tr_b16 a[150:151], v177 offset:59392
  v_mfma_f32_16x16x32_bf16 v[136:139], a[152:155], v[92:95], v[136:139]
  buffer_load_dwordx4 v103, s[8:11], s61 offen offset:3072 sc1 lds
  v_mfma_f32_16x16x32_bf16 v[132:135], a[156:159], v[88:91], v[132:135]
  s_waitcnt lgkmcnt(8)
  v_cvt_pk_bf16_f32 v173, v154, v155
  v_mfma_f32_16x16x32_bf16 v[140:143], a[156:159], v[92:95], v[140:143]
  ds_read_b64_tr_b16 a[152:153], v176 offset:61440
  v_mfma_f32_16x16x32_bf16 v[128:131], a[128:131], a[192:195], v[128:131]
  v_cvt_pk_bf16_f32 v174, v156, v157
  v_cvt_pk_bf16_f32 v175, v158, v159
  v_mfma_f32_16x16x32_bf16 v[136:139], a[128:131], a[196:199], v[136:139]
  ds_read_b64_tr_b16 a[156:157], v177 offset:61440
  v_mfma_f32_16x16x32_bf16 v[132:135], a[132:135], a[192:195], v[132:135]
  s_waitcnt lgkmcnt(6)
  ds_read_b64_tr_b16 a[128:129], v178 offset:16384
  ds_read_b64_tr_b16 a[130:131], v178 offset:18432
  v_mfma_f32_16x16x32_bf16 v[140:143], a[132:135], a[196:199], v[140:143]
  s_add_u32 s61, s58, s60
  s_add_u32 m0, s61, 4096
  s_add_u32 s61, s56, 28672
  v_mfma_f32_16x16x32_bf16 v[128:131], a[136:139], a[200:203], v[128:131]
  ds_read_b64_tr_b16 a[132:133], v179 offset:16384
  ds_read_b64_tr_b16 a[134:135], v179 offset:18432
  v_mfma_f32_16x16x32_bf16 v[136:139], a[136:139], a[204:207], v[136:139]
  buffer_store_dwordx4 v[168:171], v1, s[16:19], s62 offen offset:2048 sc1
  v_mfma_f32_16x16x32_bf16 v[132:135], a[140:143], a[200:203], v[132:135]
  s_waitcnt lgkmcnt(6)
  ds_read_b64_tr_b16 a[136:137], v178 offset:20480
  v_mfma_f32_16x16x32_bf16 v[140:143], a[140:143], a[204:207], v[140:143]
  ds_read_b64_tr_b16 a[138:139], v178 offset:22528
  buffer_load_dwordx4 v100, s[8:11], s61 offen offset:0 sc1 lds
  v_mfma_f32_16x16x32_bf16 v[128:131], a[144:147], a[208:211], v[128:131]
  ds_read_b64_tr_b16 a[140:141], v179 offset:20480
  ds_read_b64_tr_b16 a[142:143], v179 offset:22528
  v_mfma_f32_16x16x32_bf16 v[136:139], a[144:147], a[212:215], v[136:139]
  buffer_store_dwordx4 v[172:175], v1, s[16:19], s62 offen offset:3072 sc1
  s_add_u32 s62, s62, 4096
  v_mfma_f32_16x16x32_bf16 v[132:135], a[148:151], a[208:211], v[132:135]
  s_waitcnt lgkmcnt(8)
  ds_read_b64_tr_b16 a[144:145], v178 offset:24576
  v_mfma_f32_16x16x32_bf16 v[140:143], a[148:151], a[212:215], v[140:143]
  ds_read_b64_tr_b16 a[146:147], v178 offset:26624
  buffer_load_dwordx4 v101, s[8:11], s61 offen offset:1024 sc1 lds
  v_mfma_f32_16x16x16_bf16 v[128:131], a[152:153], a[216:217], v[128:131]
  ds_read_b64_tr_b16 a[148:149], v179 offset:24576
  v_mfma_f32_16x16x16_bf16 v[136:139], a[152:153], a[220:221], v[136:139]
  ds_read_b64_tr_b16 a[150:151], v179 offset:26624
  v_mfma_f32_16x16x16_bf16 v[132:135], a[156:157], a[216:217], v[132:135]
  s_waitcnt lgkmcnt(8)
  ds_read_b64_tr_b16 a[152:153], v178 offset:28672
  v_mfma_f32_16x16x16_bf16 v[140:143], a[156:157], a[220:221], v[140:143]
  ds_read_b64_tr_b16 a[154:155], v178 offset:30720
  buffer_load_dwordx4 v102, s[8:11], s61 offen offset:2048 sc1 lds
  v_mfma_f32_16x16x32_bf16 v[144:147], a[128:131], v[32:35], 0
  ds_read_b64_tr_b16 a[156:157], v179 offset:28672
  v_mfma_f32_16x16x32_bf16 v[152:155], a[128:131], v[36:39], 0
  ds_read_b64_tr_b16 a[158:159], v179 offset:30720
  v_mfma_f32_16x16x32_bf16 v[148:151], a[132:135], v[32:35], 0
  s_waitcnt lgkmcnt(8)
  ds_read_b64_tr_b16 a[128:129], v178 offset:32768
  v_mfma_f32_16x16x32_bf16 v[156:159], a[132:135], v[36:39], 0
  ds_read_b64_tr_b16 a[130:131], v178 offset:34816
  buffer_load_dwordx4 v103, s[8:11], s61 offen offset:3072 sc1 lds
  v_mfma_f32_16x16x32_bf16 v[144:147], a[136:139], v[40:43], v[144:147]
  ds_read_b64_tr_b16 a[132:133], v179 offset:32768
  v_mfma_f32_16x16x32_bf16 v[152:155], a[136:139], v[44:47], v[152:155]
  ds_read_b64_tr_b16 a[134:135], v179 offset:34816
  v_mfma_f32_16x16x32_bf16 v[148:151], a[140:143], v[40:43], v[148:151]
  ds_read_b64_tr_b16 a[136:137], v178 offset:36864
  ds_read_b64_tr_b16 a[138:139], v178 offset:38912
  v_mfma_f32_16x16x32_bf16 v[156:159], a[140:143], v[44:47], v[156:159]
  s_waitcnt lgkmcnt(10)
  s_add_u32 m0, s59, s43
  s_add_u32 s56, s56, 128
  v_mfma_f32_16x16x32_bf16 v[144:147], a[144:147], v[48:51], v[144:147]
  ds_read_b64_tr_b16 a[140:141], v179 offset:36864
  v_cvt_pk_bf16_f32 v160, v128, v129
  v_mfma_f32_16x16x32_bf16 v[152:155], a[144:147], v[52:55], v[152:155]
  ds_read_b64_tr_b16 a[142:143], v179 offset:38912
  v_mfma_f32_16x16x32_bf16 v[148:151], a[148:151], v[48:51], v[148:151]
  s_waitcnt lgkmcnt(8)
  v_cvt_pk_bf16_f32 v161, v130, v131
  v_mfma_f32_16x16x32_bf16 v[156:159], a[148:151], v[52:55], v[156:159]
  ds_read_b64_tr_b16 a[144:145], v178 offset:40960
  ds_read_b64_tr_b16 a[146:147], v178 offset:43008
  v_mfma_f32_16x16x32_bf16 v[144:147], a[152:155], v[56:59], v[144:147]
  ds_read_b64_tr_b16 a[148:149], v179 offset:40960
  ds_read_b64_tr_b16 a[150:151], v179 offset:43008
  v_mfma_f32_16x16x32_bf16 v[152:155], a[152:155], v[60:63], v[152:155]
  buffer_load_dwordx4 v100, s[12:15], s57 offen offset:0 sc1 lds
  v_mfma_f32_16x16x32_bf16 v[148:151], a[156:159], v[56:59], v[148:151]
  s_waitcnt lgkmcnt(8)
  ds_read_b64_tr_b16 a[152:153], v178 offset:45056
  v_mfma_f32_16x16x32_bf16 v[156:159], a[156:159], v[60:63], v[156:159]
  ds_read_b64_tr_b16 a[154:155], v178 offset:47104
  v_mfma_f32_16x16x32_bf16 v[144:147], a[128:131], v[64:67], v[144:147]
  ds_read_b64_tr_b16 a[156:157], v179 offset:45056
  ds_read_b64_tr_b16 a[158:159], v179 offset:47104
  v_mfma_f32_16x16x32_bf16 v[152:155], a[128:131], v[68:71], v[152:155]
  buffer_load_dwordx4 v101, s[12:15], s57 offen offset:1024 sc1 lds
  v_mfma_f32_16x16x32_bf16 v[148:151], a[132:135], v[64:67], v[148:151]
  s_waitcnt lgkmcnt(8)
  v_cvt_pk_bf16_f32 v162, v132, v133
  v_mfma_f32_16x16x32_bf16 v[156:159], a[132:135], v[68:71], v[156:159]
  ds_read_b64_tr_b16 a[128:129], v178 offset:49152
  ds_read_b64_tr_b16 a[130:131], v178 offset:51200
  v_mfma_f32_16x16x32_bf16 v[144:147], a[136:139], v[72:75], v[144:147]
  ds_read_b64_tr_b16 a[132:133], v179 offset:49152
  ds_read_b64_tr_b16 a[134:135], v179 offset:51200
  v_mfma_f32_16x16x32_bf16 v[152:155], a[136:139], v[76:79], v[152:155]
  buffer_load_dwordx4 v102, s[12:15], s57 offen offset:2048 sc1 lds
  v_mfma_f32_16x16x32_bf16 v[148:151], a[140:143], v[72:75], v[148:151]
  s_waitcnt lgkmcnt(8)
  v_cvt_pk_bf16_f32 v163, v134, v135
  v_mfma_f32_16x16x32_bf16 v[156:159], a[140:143], v[76:79], v[156:159]
  ds_read_b64_tr_b16 a[136:137], v178 offset:53248
  ds_read_b64_tr_b16 a[138:139], v178 offset:55296
  v_mfma_f32_16x16x32_bf16 v[144:147], a[144:147], v[80:83], v[144:147]
  ds_read_b64_tr_b16 a[140:141], v179 offset:53248
  ds_read_b64_tr_b16 a[142:143], v179 offset:55296
  v_mfma_f32_16x16x32_bf16 v[152:155], a[144:147], v[84:87], v[152:155]
  buffer_load_dwordx4 v103, s[12:15], s57 offen offset:3072 sc1 lds
  v_mfma_f32_16x16x32_bf16 v[148:151], a[148:151], v[80:83], v[148:151]
  s_waitcnt lgkmcnt(8)
  ds_read_b64_tr_b16 a[144:145], v178 offset:57344
  v_mfma_f32_16x16x32_bf16 v[156:159], a[148:151], v[84:87], v[156:159]
  ds_read_b64_tr_b16 a[146:147], v178 offset:59392
  v_mfma_f32_16x16x32_bf16 v[144:147], a[152:155], v[88:91], v[144:147]
  ds_read_b64_tr_b16 a[148:149], v179 offset:57344
  ds_read_b64_tr_b16 a[150:151], v179 offset:59392
  v_mfma_f32_16x16x32_bf16 v[152:155], a[152:155], v[92:95], v[152:155]
  s_add_u32 s57, s57, 128
  v_cvt_pk_bf16_f32 v164, v136, v137
  v_mfma_f32_16x16x32_bf16 v[148:151], a[156:159], v[88:91], v[148:151]
  s_waitcnt lgkmcnt(8)
  v_cvt_pk_bf16_f32 v165, v138, v139
  v_mfma_f32_16x16x32_bf16 v[156:159], a[156:159], v[92:95], v[156:159]
  ds_read_b64_tr_b16 a[152:153], v178 offset:61440
  v_mfma_f32_16x16x32_bf16 v[144:147], a[128:131], a[192:195], v[144:147]
  v_cvt_pk_bf16_f32 v166, v140, v141
  v_cvt_pk_bf16_f32 v167, v142, v143
  v_mfma_f32_16x16x32_bf16 v[152:155], a[128:131], a[196:199], v[152:155]
  ds_read_b64_tr_b16 a[156:157], v179 offset:61440
  v_mfma_f32_16x16x32_bf16 v[148:151], a[132:135], a[192:195], v[148:151]
  s_waitcnt vmcnt(14)
  s_waitcnt lgkmcnt(0)
  s_barrier
  v_mfma_f32_16x16x32_bf16 v[156:159], a[132:135], a[196:199], v[156:159]
  ds_read_b64_tr_b16 a[128:129], v180 offset:0
  ds_read_b64_tr_b16 a[130:131], v180 offset:2048
  v_mfma_f32_16x16x32_bf16 v[144:147], a[136:139], a[200:203], v[144:147]
  ds_read_b64_tr_b16 a[132:133], v181 offset:0
  ds_read_b64_tr_b16 a[134:135], v181 offset:2048
  v_mfma_f32_16x16x32_bf16 v[152:155], a[136:139], a[204:207], v[152:155]
  s_mov_b32 s58, 81920
  s_mov_b32 s59, 114688
  buffer_store_dwordx4 v[160:163], v1, s[16:19], s62 offen offset:0 sc1
  v_mfma_f32_16x16x32_bf16 v[148:151], a[140:143], a[200:203], v[148:151]
  ds_read_b64_tr_b16 a[136:137], v180 offset:4096
  v_mfma_f32_16x16x32_bf16 v[156:159], a[140:143], a[204:207], v[156:159]
  ds_read_b64_tr_b16 a[138:139], v180 offset:6144
  v_mfma_f32_16x16x32_bf16 v[144:147], a[144:147], a[208:211], v[144:147]
  ds_read_b64_tr_b16 a[140:141], v181 offset:4096
  ds_read_b64_tr_b16 a[142:143], v181 offset:6144
  v_mfma_f32_16x16x32_bf16 v[152:155], a[144:147], a[212:215], v[152:155]
  s_add_u32 s61, s58, s60
  s_add_u32 m0, s61, 0
  s_add_u32 s61, s56, 0
  v_mfma_f32_16x16x32_bf16 v[148:151], a[148:151], a[208:211], v[148:151]
  ds_read_b64_tr_b16 a[144:145], v180 offset:8192
  v_mfma_f32_16x16x32_bf16 v[156:159], a[148:151], a[212:215], v[156:159]
  ds_read_b64_tr_b16 a[146:147], v180 offset:10240
  buffer_store_dwordx4 v[164:167], v1, s[16:19], s62 offen offset:1024 sc1
  v_mfma_f32_16x16x16_bf16 v[144:147], a[152:153], a[216:217], v[144:147]
  ds_read_b64_tr_b16 a[148:149], v181 offset:8192
  v_mfma_f32_16x16x16_bf16 v[152:155], a[152:153], a[220:221], v[152:155]
  ds_read_b64_tr_b16 a[150:151], v181 offset:10240
  v_mfma_f32_16x16x16_bf16 v[148:151], a[156:157], a[216:217], v[148:151]
  s_waitcnt lgkmcnt(8)
  ds_read_b64_tr_b16 a[152:153], v180 offset:12288
  v_mfma_f32_16x16x16_bf16 v[156:159], a[156:157], a[220:221], v[156:159]
  ds_read_b64_tr_b16 a[154:155], v180 offset:14336
  buffer_load_dwordx4 v100, s[8:11], s61 offen offset:0 sc1 lds
  v_mfma_f32_16x16x32_bf16 v[128:131], a[128:131], v[32:35], 0
  ds_read_b64_tr_b16 a[156:157], v181 offset:12288
  v_mfma_f32_16x16x32_bf16 v[136:139], a[128:131], v[36:39], 0
  ds_read_b64_tr_b16 a[158:159], v181 offset:14336
  v_mfma_f32_16x16x32_bf16 v[132:135], a[132:135], v[32:35], 0
  s_waitcnt lgkmcnt(8)
  ds_read_b64_tr_b16 a[128:129], v180 offset:16384
  v_mfma_f32_16x16x32_bf16 v[140:143], a[132:135], v[36:39], 0
  ds_read_b64_tr_b16 a[130:131], v180 offset:18432
  v_mfma_f32_16x16x32_bf16 v[128:131], a[136:139], v[40:43], v[128:131]
  ds_read_b64_tr_b16 a[132:133], v181 offset:16384
  ds_read_b64_tr_b16 a[134:135], v181 offset:18432
  v_mfma_f32_16x16x32_bf16 v[136:139], a[136:139], v[44:47], v[136:139]
  buffer_load_dwordx4 v101, s[8:11], s61 offen offset:1024 sc1 lds
  v_mfma_f32_16x16x32_bf16 v[132:135], a[140:143], v[40:43], v[132:135]
  s_waitcnt lgkmcnt(8)
  ds_read_b64_tr_b16 a[136:137], v180 offset:20480
  v_mfma_f32_16x16x32_bf16 v[140:143], a[140:143], v[44:47], v[140:143]
  ds_read_b64_tr_b16 a[138:139], v180 offset:22528
  v_mfma_f32_16x16x32_bf16 v[128:131], a[144:147], v[48:51], v[128:131]
  ds_read_b64_tr_b16 a[140:141], v181 offset:20480
  v_cvt_pk_bf16_f32 v168, v144, v145
  v_mfma_f32_16x16x32_bf16 v[136:139], a[144:147], v[52:55], v[136:139]
  ds_read_b64_tr_b16 a[142:143], v181 offset:22528
  v_mfma_f32_16x16x32_bf16 v[132:135], a[148:151], v[48:51], v[132:135]
  s_waitcnt lgkmcnt(8)
  ds_read_b64_tr_b16 a[144:145], v180 offset:24576
  v_mfma_f32_16x16x32_bf16 v[140:143], a[148:151], v[52:55], v[140:143]
  ds_read_b64_tr_b16 a[146:147], v180 offset:26624
  buffer_load_dwordx4 v102, s[8:11], s61 offen offset:2048 sc1 lds
  v_mfma_f32_16x16x32_bf16 v[128:131], a[152:155], v[56:59], v[128:131]
  ds_read_b64_tr_b16 a[148:149], v181 offset:24576
  v_cvt_pk_bf16_f32 v169, v146, v147
  v_mfma_f32_16x16x32_bf16 v[136:139], a[152:155], v[60:63], v[136:139]
  ds_read_b64_tr_b16 a[150:151], v181 offset:26624
  v_mfma_f32_16x16x32_bf16 v[132:135], a[156:159], v[56:59], v[132:135]
  s_waitcnt lgkmcnt(8)
  ds_read_b64_tr_b16 a[152:153], v180 offset:28672
  v_mfma_f32_16x16x32_bf16 v[140:143], a[156:159], v[60:63], v[140:143]
  ds_read_b64_tr_b16 a[154:155], v180 offset:30720
  buffer_load_dwordx4 v103, s[8:11], s61 offen offset:3072 sc1 lds
  v_mfma_f32_16x16x32_bf16 v[128:131], a[128:131], v[64:67], v[128:131]
  ds_read_b64_tr_b16 a[156:157], v181 offset:28672
  v_cvt_pk_bf16_f32 v170, v148, v149
  v_mfma_f32_16x16x32_bf16 v[136:139], a[128:131], v[68:71], v[136:139]
  ds_read_b64_tr_b16 a[158:159], v181 offset:30720
  v_mfma_f32_16x16x32_bf16 v[132:135], a[132:135], v[64:67], v[132:135]
  s_waitcnt lgkmcnt(8)
  ds_read_b64_tr_b16 a[128:129], v104 offset:0
  v_mfma_f32_16x16x32_bf16 v[140:143], a[132:135], v[68:71], v[140:143]
  ds_read_b64_tr_b16 a[130:131], v104 offset:2048
  v_mfma_f32_16x16x32_bf16 v[128:131], a[136:139], v[72:75], v[128:131]
  ds_read_b64_tr_b16 a[132:133], v105 offset:0
  ds_read_b64_tr_b16 a[134:135], v105 offset:2048
  v_mfma_f32_16x16x32_bf16 v[136:139], a[136:139], v[76:79], v[136:139]
  s_add_u32 s61, s58, s60
  s_add_u32 m0, s61, 4096
  s_add_u32 s61, s56, 28672
  v_mfma_f32_16x16x32_bf16 v[132:135], a[140:143], v[72:75], v[132:135]
  s_waitcnt lgkmcnt(8)
  v_cvt_pk_bf16_f32 v171, v150, v151
  v_mfma_f32_16x16x32_bf16 v[140:143], a[140:143], v[76:79], v[140:143]
  ds_read_b64_tr_b16 a[136:137], v104 offset:4096
  ds_read_b64_tr_b16 a[138:139], v104 offset:6144
  v_mfma_f32_16x16x32_bf16 v[128:131], a[144:147], v[80:83], v[128:131]
  ds_read_b64_tr_b16 a[140:141], v105 offset:4096
  v_cvt_pk_bf16_f32 v172, v152, v153
  v_mfma_f32_16x16x32_bf16 v[136:139], a[144:147], v[84:87], v[136:139]
  ds_read_b64_tr_b16 a[142:143], v105 offset:6144
  v_mfma_f32_16x16x32_bf16 v[132:135], a[148:151], v[80:83], v[132:135]
  s_waitcnt lgkmcnt(8)
  ds_read_b64_tr_b16 a[144:145], v104 offset:8192
  v_mfma_f32_16x16x32_bf16 v[140:143], a[148:151], v[84:87], v[140:143]
  ds_read_b64_tr_b16 a[146:147], v104 offset:10240
  buffer_load_dwordx4 v100, s[8:11], s61 offen offset:0 sc1 lds
  v_mfma_f32_16x16x32_bf16 v[128:131], a[152:155], v[88:91], v[128:131]
  ds_read_b64_tr_b16 a[148:149], v105 offset:8192
  v_cvt_pk_bf16_f32 v173, v154, v155
  v_mfma_f32_16x16x32_bf16 v[136:139], a[152:155], v[92:95], v[136:139]
  ds_read_b64_tr_b16 a[150:151], v105 offset:10240
  v_mfma_f32_16x16x32_bf16 v[132:135], a[156:159], v[88:91], v[132:135]
  s_waitcnt lgkmcnt(8)
  v_cvt_pk_bf16_f32 v174, v156, v157
  v_mfma_f32_16x16x32_bf16 v[140:143], a[156:159], v[92:95], v[140:143]
  ds_read_b64_tr_b16 a[152:153], v104 offset:12288
  v_mfma_f32_16x16x32_bf16 v[128:131], a[128:131], a[192:195], v[128:131]
  ds_read_b64_tr_b16 a[156:157], v105 offset:12288
  buffer_load_dwordx4 v101, s[8:11], s61 offen offset:1024 sc1 lds
  v_mfma_f32_16x16x32_bf16 v[136:139], a[128:131], a[196:199], v[136:139]
  v_cvt_pk_bf16_f32 v175, v158, v159
  v_mfma_f32_16x16x32_bf16 v[132:135], a[132:135], a[192:195], v[132:135]
  s_waitcnt lgkmcnt(6)
  ds_read_b64_tr_b16 a[128:129], v182 offset:0
  v_mfma_f32_16x16x32_bf16 v[140:143], a[132:135], a[196:199], v[140:143]
  ds_read_b64_tr_b16 a[130:131], v182 offset:2048
  buffer_store_dwordx4 v[168:171], v1, s[16:19], s62 offen offset:2048 sc1
  v_mfma_f32_16x16x32_bf16 v[128:131], a[136:139], a[200:203], v[128:131]
  ds_read_b64_tr_b16 a[132:133], v183 offset:0
  ds_read_b64_tr_b16 a[134:135], v183 offset:2048
  v_mfma_f32_16x16x32_bf16 v[136:139], a[136:139], a[204:207], v[136:139]
  buffer_load_dwordx4 v102, s[8:11], s61 offen offset:2048 sc1 lds
  v_mfma_f32_16x16x32_bf16 v[132:135], a[140:143], a[200:203], v[132:135]
  s_waitcnt lgkmcnt(6)
  ds_read_b64_tr_b16 a[136:137], v182 offset:4096
  v_mfma_f32_16x16x32_bf16 v[140:143], a[140:143], a[204:207], v[140:143]
  ds_read_b64_tr_b16 a[138:139], v182 offset:6144
  v_mfma_f32_16x16x32_bf16 v[128:131], a[144:147], a[208:211], v[128:131]
  ds_read_b64_tr_b16 a[140:141], v183 offset:4096
  ds_read_b64_tr_b16 a[142:143], v183 offset:6144
  v_mfma_f32_16x16x32_bf16 v[136:139], a[144:147], a[212:215], v[136:139]
  buffer_store_dwordx4 v[172:175], v1, s[16:19], s62 offen offset:3072 sc1
  s_add_u32 s62, s62, 4096
  v_mfma_f32_16x16x32_bf16 v[132:135], a[148:151], a[208:211], v[132:135]
  s_waitcnt lgkmcnt(8)
  ds_read_b64_tr_b16 a[144:145], v182 offset:8192
  v_mfma_f32_16x16x32_bf16 v[140:143], a[148:151], a[212:215], v[140:143]
  ds_read_b64_tr_b16 a[146:147], v182 offset:10240
  buffer_load_dwordx4 v103, s[8:11], s61 offen offset:3072 sc1 lds
  v_mfma_f32_16x16x16_bf16 v[128:131], a[152:153], a[216:217], v[128:131]
  ds_read_b64_tr_b16 a[148:149], v183 offset:8192
  v_mfma_f32_16x16x16_bf16 v[136:139], a[152:153], a[220:221], v[136:139]
  ds_read_b64_tr_b16 a[150:151], v183 offset:10240
  v_mfma_f32_16x16x16_bf16 v[132:135], a[156:157], a[216:217], v[132:135]
  s_waitcnt lgkmcnt(8)
  ds_read_b64_tr_b16 a[152:153], v182 offset:12288
  v_mfma_f32_16x16x16_bf16 v[140:143], a[156:157], a[220:221], v[140:143]
  ds_read_b64_tr_b16 a[154:155], v182 offset:14336
  v_mfma_f32_16x16x32_bf16 v[144:147], a[128:131], v[32:35], 0
  ds_read_b64_tr_b16 a[156:157], v183 offset:12288
  ds_read_b64_tr_b16 a[158:159], v183 offset:14336
  v_mfma_f32_16x16x32_bf16 v[152:155], a[128:131], v[36:39], 0
  s_add_u32 m0, s59, s43
  s_add_u32 s56, s56, 128
  v_mfma_f32_16x16x32_bf16 v[148:151], a[132:135], v[32:35], 0
  s_waitcnt lgkmcnt(8)
  ds_read_b64_tr_b16 a[128:129], v182 offset:16384
  v_mfma_f32_16x16x32_bf16 v[156:159], a[132:135], v[36:39], 0
  ds_read_b64_tr_b16 a[130:131], v182 offset:18432
  v_mfma_f32_16x16x32_bf16 v[144:147], a[136:139], v[40:43], v[144:147]
  ds_read_b64_tr_b16 a[132:133], v183 offset:16384
  v_mfma_f32_16x16x32_bf16 v[152:155], a[136:139], v[44:47], v[152:155]
  ds_read_b64_tr_b16 a[134:135], v183 offset:18432
  v_mfma_f32_16x16x32_bf16 v[148:151], a[140:143], v[40:43], v[148:151]
  s_waitcnt lgkmcnt(8)
  ds_read_b64_tr_b16 a[136:137], v182 offset:20480
  v_mfma_f32_16x16x32_bf16 v[156:159], a[140:143], v[44:47], v[156:159]
  ds_read_b64_tr_b16 a[138:139], v182 offset:22528
  buffer_load_dwordx4 v100, s[12:15], s57 offen offset:0 sc1 lds
  v_mfma_f32_16x16x32_bf16 v[144:147], a[144:147], v[48:51], v[144:147]
  ds_read_b64_tr_b16 a[140:141], v183 offset:20480
  v_cvt_pk_bf16_f32 v160, v128, v129
  v_mfma_f32_16x16x32_bf16 v[152:155], a[144:147], v[52:55], v[152:155]
  ds_read_b64_tr_b16 a[142:143], v183 offset:22528
  v_mfma_f32_16x16x32_bf16 v[148:151], a[148:151], v[48:51], v[148:151]
  s_waitcnt lgkmcnt(8)
  ds_read_b64_tr_b16 a[144:145], v182 offset:24576
  v_mfma_f32_16x16x32_bf16 v[156:159], a[148:151], v[52:55], v[156:159]
  ds_read_b64_tr_b16 a[146:147], v182 offset:26624
  buffer_load_dwordx4 v101, s[12:15], s57 offen offset:1024 sc1 lds
  v_mfma_f32_16x16x32_bf16 v[144:147], a[152:155], v[56:59], v[144:147]
  ds_read_b64_tr_b16 a[148:149], v183 offset:24576
  v_cvt_pk_bf16_f32 v161, v130, v131
  v_mfma_f32_16x16x32_bf16 v[152:155], a[152:155], v[60:63], v[152:155]
  ds_read_b64_tr_b16 a[150:151], v183 offset:26624
  v_mfma_f32_16x16x32_bf16 v[148:151], a[156:159], v[56:59], v[148:151]
  s_waitcnt lgkmcnt(8)
  ds_read_b64_tr_b16 a[152:153], v182 offset:28672
  v_mfma_f32_16x16x32_bf16 v[156:159], a[156:159], v[60:63], v[156:159]
  ds_read_b64_tr_b16 a[154:155], v182 offset:30720
  v_mfma_f32_16x16x32_bf16 v[144:147], a[128:131], v[64:67], v[144:147]
  ds_read_b64_tr_b16 a[156:157], v183 offset:28672
  ds_read_b64_tr_b16 a[158:159], v183 offset:30720
  v_mfma_f32_16x16x32_bf16 v[152:155], a[128:131], v[68:71], v[152:155]
  buffer_load_dwordx4 v102, s[12:15], s57 offen offset:2048 sc1 lds
  v_mfma_f32_16x16x32_bf16 v[148:151], a[132:135], v[64:67], v[148:151]
  s_waitcnt lgkmcnt(8)
  v_cvt_pk_bf16_f32 v162, v132, v133
  v_mfma_f32_16x16x32_bf16 v[156:159], a[132:135], v[68:71], v[156:159]
  ds_read_b64_tr_b16 a[128:129], v106 offset:0
  ds_read_b64_tr_b16 a[130:131], v106 offset:2048
  v_mfma_f32_16x16x32_bf16 v[144:147], a[136:139], v[72:75], v[144:147]
  ds_read_b64_tr_b16 a[132:133], v107 offset:0
  v_mfma_f32_16x16x32_bf16 v[152:155], a[136:139], v[76:79], v[152:155]
  ds_read_b64_tr_b16 a[134:135], v107 offset:2048
  v_mfma_f32_16x16x32_bf16 v[148:151], a[140:143], v[72:75], v[148:151]
  s_waitcnt lgkmcnt(8)
  ds_read_b64_tr_b16 a[136:137], v106 offset:4096
  v_mfma_f32_16x16x32_bf16 v[156:159], a[140:143], v[76:79], v[156:159]
  ds_read_b64_tr_b16 a[138:139], v106 offset:6144
  buffer_load_dwordx4 v103, s[12:15], s57 offen offset:3072 sc1 lds
  v_mfma_f32_16x16x32_bf16 v[144:147], a[144:147], v[80:83], v[144:147]
  ds_read_b64_tr_b16 a[140:141], v107 offset:4096
  v_cvt_pk_bf16_f32 v163, v134, v135
  v_mfma_f32_16x16x32_bf16 v[152:155], a[144:147], v[84:87], v[152:155]
  ds_read_b64_tr_b16 a[142:143], v107 offset:6144
  v_mfma_f32_16x16x32_bf16 v[148:151], a[148:151], v[80:83], v[148:151]
  s_waitcnt lgkmcnt(8)
  v_cvt_pk_bf16_f32 v164, v136, v137
  v_mfma_f32_16x16x32_bf16 v[156:159], a[148:151], v[84:87], v[156:159]
  ds_read_b64_tr_b16 a[144:145], v106 offset:8192
  ds_read_b64_tr_b16 a[146:147], v106 offset:10240
  v_mfma_f32_16x16x32_bf16 v[144:147], a[152:155], v[88:91], v[144:147]
  ds_read_b64_tr_b16 a[148:149], v107 offset:8192
  v_mfma_f32_16x16x32_bf16 v[152:155], a[152:155], v[92:95], v[152:155]
  s_add_u32 s57, s57, 128
  ds_read_b64_tr_b16 a[150:151], v107 offset:10240
  v_mfma_f32_16x16x32_bf16 v[148:151], a[156:159], v[88:91], v[148:151]
  v_cvt_pk_bf16_f32 v165, v138, v139
  v_cvt_pk_bf16_f32 v166, v140, v141
  v_mfma_f32_16x16x32_bf16 v[156:159], a[156:159], v[92:95], v[156:159]
  s_waitcnt lgkmcnt(8)
  ds_read_b64_tr_b16 a[152:153], v106 offset:12288
  v_mfma_f32_16x16x32_bf16 v[144:147], a[128:131], a[192:195], v[144:147]
  ds_read_b64_tr_b16 a[156:157], v107 offset:12288
  v_cvt_pk_bf16_f32 v167, v142, v143
  v_mfma_f32_16x16x32_bf16 v[152:155], a[128:131], a[196:199], v[152:155]
  buffer_store_dwordx4 v[160:163], v1, s[16:19], s62 offen offset:0 sc1
  v_mfma_f32_16x16x32_bf16 v[148:151], a[132:135], a[192:195], v[148:151]
  s_waitcnt vmcnt(17)
  s_waitcnt lgkmcnt(0)
  s_barrier
  v_mfma_f32_16x16x32_bf16 v[156:159], a[132:135], a[196:199], v[156:159]
  ds_read_b64_tr_b16 a[128:129], v104 offset:32768
  ds_read_b64_tr_b16 a[130:131], v104 offset:34816
  v_mfma_f32_16x16x32_bf16 v[144:147], a[136:139], a[200:203], v[144:147]
  ds_read_b64_tr_b16 a[132:133], v105 offset:32768
  ds_read_b64_tr_b16 a[134:135], v105 offset:34816
  v_mfma_f32_16x16x32_bf16 v[152:155], a[136:139], a[204:207], v[152:155]
  s_mov_b32 s58, 131072
  s_mov_b32 s59, 0
  v_mfma_f32_16x16x32_bf16 v[148:151], a[140:143], a[200:203], v[148:151]
  ds_read_b64_tr_b16 a[136:137], v104 offset:36864
  v_mfma_f32_16x16x32_bf16 v[156:159], a[140:143], a[204:207], v[156:159]
  ds_read_b64_tr_b16 a[138:139], v104 offset:38912
  v_mfma_f32_16x16x32_bf16 v[144:147], a[144:147], a[208:211], v[144:147]
  ds_read_b64_tr_b16 a[140:141], v105 offset:36864
  ds_read_b64_tr_b16 a[142:143], v105 offset:38912
  v_mfma_f32_16x16x32_bf16 v[152:155], a[144:147], a[212:215], v[152:155]
  s_add_u32 s61, s58, s60
  s_add_u32 m0, s61, 0
  s_add_u32 s61, s56, 0
  v_mfma_f32_16x16x32_bf16 v[148:151], a[148:151], a[208:211], v[148:151]
  ds_read_b64_tr_b16 a[144:145], v104 offset:40960
  v_mfma_f32_16x16x32_bf16 v[156:159], a[148:151], a[212:215], v[156:159]
  ds_read_b64_tr_b16 a[146:147], v104 offset:43008
  buffer_store_dwordx4 v[164:167], v1, s[16:19], s62 offen offset:1024 sc1
  v_mfma_f32_16x16x16_bf16 v[144:147], a[152:153], a[216:217], v[144:147]
  ds_read_b64_tr_b16 a[148:149], v105 offset:40960
  v_mfma_f32_16x16x16_bf16 v[152:155], a[152:153], a[220:221], v[152:155]
  ds_read_b64_tr_b16 a[150:151], v105 offset:43008
  v_mfma_f32_16x16x16_bf16 v[148:151], a[156:157], a[216:217], v[148:151]
  s_waitcnt lgkmcnt(8)
  ds_read_b64_tr_b16 a[152:153], v104 offset:45056
  v_mfma_f32_16x16x16_bf16 v[156:159], a[156:157], a[220:221], v[156:159]
  ds_read_b64_tr_b16 a[154:155], v104 offset:47104
  buffer_load_dwordx4 v100, s[8:11], s61 offen offset:0 sc1 lds
  v_mfma_f32_16x16x32_bf16 v[128:131], a[128:131], v[32:35], 0
  ds_read_b64_tr_b16 a[156:157], v105 offset:45056
  v_mfma_f32_16x16x32_bf16 v[136:139], a[128:131], v[36:39], 0
  ds_read_b64_tr_b16 a[158:159], v105 offset:47104
  v_mfma_f32_16x16x32_bf16 v[132:135], a[132:135], v[32:35], 0
  s_waitcnt lgkmcnt(8)
  ds_read_b64_tr_b16 a[128:129], v104 offset:49152
  v_mfma_f32_16x16x32_bf16 v[140:143], a[132:135], v[36:39], 0
  ds_read_b64_tr_b16 a[130:131], v104 offset:51200
  v_mfma_f32_16x16x32_bf16 v[128:131], a[136:139], v[40:43], v[128:131]
  ds_read_b64_tr_b16 a[132:133], v105 offset:49152
  ds_read_b64_tr_b16 a[134:135], v105 offset:51200
  v_mfma_f32_16x16x32_bf16 v[136:139], a[136:139], v[44:47], v[136:139]
  buffer_load_dwordx4 v101, s[8:11], s61 offen offset:1024 sc1 lds
  v_mfma_f32_16x16x32_bf16 v[132:135], a[140:143], v[40:43], v[132:135]
  s_waitcnt lgkmcnt(8)
  ds_read_b64_tr_b16 a[136:137], v104 offset:53248
  v_mfma_f32_16x16x32_bf16 v[140:143], a[140:143], v[44:47], v[140:143]
  ds_read_b64_tr_b16 a[138:139], v104 offset:55296
  v_mfma_f32_16x16x32_bf16 v[128:131], a[144:147], v[48:51], v[128:131]
  ds_read_b64_tr_b16 a[140:141], v105 offset:53248
  v_cvt_pk_bf16_f32 v168, v144, v145
  v_mfma_f32_16x16x32_bf16 v[136:139], a[144:147], v[52:55], v[136:139]
  ds_read_b64_tr_b16 a[142:143], v105 offset:55296
  v_mfma_f32_16x16x32_bf16 v[132:135], a[148:151], v[48:51], v[132:135]
  s_waitcnt lgkmcnt(8)
  ds_read_b64_tr_b16 a[144:145], v104 offset:57344
  v_mfma_f32_16x16x32_bf16 v[140:143], a[148:151], v[52:55], v[140:143]
  ds_read_b64_tr_b16 a[146:147], v104 offset:59392
  buffer_load_dwordx4 v102, s[8:11], s61 offen offset:2048 sc1 lds
  v_mfma_f32_16x16x32_bf16 v[128:131], a[152:155], v[56:59], v[128:131]
  ds_read_b64_tr_b16 a[148:149], v105 offset:57344
  v_cvt_pk_bf16_f32 v169, v146, v147
  v_mfma_f32_16x16x32_bf16 v[136:139], a[152:155], v[60:63], v[136:139]
  ds_read_b64_tr_b16 a[150:151], v105 offset:59392
  v_mfma_f32_16x16x32_bf16 v[132:135], a[156:159], v[56:59], v[132:135]
  s_waitcnt lgkmcnt(8)
  ds_read_b64_tr_b16 a[152:153], v104 offset:61440
  v_mfma_f32_16x16x32_bf16 v[140:143], a[156:159], v[60:63], v[140:143]
  ds_read_b64_tr_b16 a[154:155], v104 offset:63488
  buffer_load_dwordx4 v103, s[8:11], s61 offen offset:3072 sc1 lds
  v_mfma_f32_16x16x32_bf16 v[128:131], a[128:131], v[64:67], v[128:131]
  ds_read_b64_tr_b16 a[156:157], v105 offset:61440
  v_cvt_pk_bf16_f32 v170, v148, v149
  v_mfma_f32_16x16x32_bf16 v[136:139], a[128:131], v[68:71], v[136:139]
  ds_read_b64_tr_b16 a[158:159], v105 offset:63488
  v_mfma_f32_16x16x32_bf16 v[132:135], a[132:135], v[64:67], v[132:135]
  s_waitcnt lgkmcnt(8)
  ds_read_b64_tr_b16 a[128:129], v176 offset:0
  v_mfma_f32_16x16x32_bf16 v[140:143], a[132:135], v[68:71], v[140:143]
  ds_read_b64_tr_b16 a[130:131], v176 offset:2048
  v_mfma_f32_16x16x32_bf16 v[128:131], a[136:139], v[72:75], v[128:131]
  ds_read_b64_tr_b16 a[132:133], v177 offset:0
  ds_read_b64_tr_b16 a[134:135], v177 offset:2048
  v_mfma_f32_16x16x32_bf16 v[136:139], a[136:139], v[76:79], v[136:139]
  s_add_u32 s61, s58, s60
  s_add_u32 m0, s61, 4096
  s_add_u32 s61, s56, 28672
  v_mfma_f32_16x16x32_bf16 v[132:135], a[140:143], v[72:75], v[132:135]
  s_waitcnt lgkmcnt(8)
  v_cvt_pk_bf16_f32 v171, v150, v151
  v_mfma_f32_16x16x32_bf16 v[140:143], a[140:143], v[76:79], v[140:143]
  ds_read_b64_tr_b16 a[136:137], v176 offset:4096
  ds_read_b64_tr_b16 a[138:139], v176 offset:6144
  v_mfma_f32_16x16x32_bf16 v[128:131], a[144:147], v[80:83], v[128:131]
  ds_read_b64_tr_b16 a[140:141], v177 offset:4096
  v_cvt_pk_bf16_f32 v172, v152, v153
  v_mfma_f32_16x16x32_bf16 v[136:139], a[144:147], v[84:87], v[136:139]
  ds_read_b64_tr_b16 a[142:143], v177 offset:6144
  v_mfma_f32_16x16x32_bf16 v[132:135], a[148:151], v[80:83], v[132:135]
  s_waitcnt lgkmcnt(8)
  ds_read_b64_tr_b16 a[144:145], v176 offset:8192
  v_mfma_f32_16x16x32_bf16 v[140:143], a[148:151], v[84:87], v[140:143]
  ds_read_b64_tr_b16 a[146:147], v176 offset:10240
  buffer_load_dwordx4 v100, s[8:11], s61 offen offset:0 sc1 lds
  v_mfma_f32_16x16x32_bf16 v[128:131], a[152:155], v[88:91], v[128:131]
  ds_read_b64_tr_b16 a[148:149], v177 offset:8192
  v_cvt_pk_bf16_f32 v173, v154, v155
  v_mfma_f32_16x16x32_bf16 v[136:139], a[152:155], v[92:95], v[136:139]
  ds_read_b64_tr_b16 a[150:151], v177 offset:10240
  v_mfma_f32_16x16x32_bf16 v[132:135], a[156:159], v[88:91], v[132:135]
  s_waitcnt lgkmcnt(8)
  v_cvt_pk_bf16_f32 v174, v156, v157
  v_mfma_f32_16x16x32_bf16 v[140:143], a[156:159], v[92:95], v[140:143]
  ds_read_b64_tr_b16 a[152:153], v176 offset:12288
  v_mfma_f32_16x16x32_bf16 v[128:131], a[128:131], a[192:195], v[128:131]
  ds_read_b64_tr_b16 a[156:157], v177 offset:12288
  buffer_load_dwordx4 v101, s[8:11], s61 offen offset:1024 sc1 lds
  v_mfma_f32_16x16x32_bf16 v[136:139], a[128:131], a[196:199], v[136:139]
  v_cvt_pk_bf16_f32 v175, v158, v159
  v_mfma_f32_16x16x32_bf16 v[132:135], a[132:135], a[192:195], v[132:135]
  s_waitcnt lgkmcnt(6)
  ds_read_b64_tr_b16 a[128:129], v106 offset:32768
  v_mfma_f32_16x16x32_bf16 v[140:143], a[132:135], a[196:199], v[140:143]
  ds_read_b64_tr_b16 a[130:131], v106 offset:34816
  buffer_store_dwordx4 v[168:171], v1, s[16:19], s62 offen offset:2048 sc1
  v_mfma_f32_16x16x32_bf16 v[128:131], a[136:139], a[200:203], v[128:131]
  ds_read_b64_tr_b16 a[132:133], v107 offset:32768
  ds_read_b64_tr_b16 a[134:135], v107 offset:34816
  v_mfma_f32_16x16x32_bf16 v[136:139], a[136:139], a[204:207], v[136:139]
  buffer_load_dwordx4 v102, s[8:11], s61 offen offset:2048 sc1 lds
  v_mfma_f32_16x16x32_bf16 v[132:135], a[140:143], a[200:203], v[132:135]
  s_waitcnt lgkmcnt(6)
  ds_read_b64_tr_b16 a[136:137], v106 offset:36864
  v_mfma_f32_16x16x32_bf16 v[140:143], a[140:143], a[204:207], v[140:143]
  ds_read_b64_tr_b16 a[138:139], v106 offset:38912
  v_mfma_f32_16x16x32_bf16 v[128:131], a[144:147], a[208:211], v[128:131]
  ds_read_b64_tr_b16 a[140:141], v107 offset:36864
  ds_read_b64_tr_b16 a[142:143], v107 offset:38912
  v_mfma_f32_16x16x32_bf16 v[136:139], a[144:147], a[212:215], v[136:139]
  buffer_store_dwordx4 v[172:175], v1, s[16:19], s62 offen offset:3072 sc1
  s_add_u32 s62, s62, 4096
  v_mfma_f32_16x16x32_bf16 v[132:135], a[148:151], a[208:211], v[132:135]
  s_waitcnt lgkmcnt(8)
  ds_read_b64_tr_b16 a[144:145], v106 offset:40960
  v_mfma_f32_16x16x32_bf16 v[140:143], a[148:151], a[212:215], v[140:143]
  ds_read_b64_tr_b16 a[146:147], v106 offset:43008
  buffer_load_dwordx4 v103, s[8:11], s61 offen offset:3072 sc1 lds
  v_mfma_f32_16x16x16_bf16 v[128:131], a[152:153], a[216:217], v[128:131]
  ds_read_b64_tr_b16 a[148:149], v107 offset:40960
  v_mfma_f32_16x16x16_bf16 v[136:139], a[152:153], a[220:221], v[136:139]
  ds_read_b64_tr_b16 a[150:151], v107 offset:43008
  v_mfma_f32_16x16x16_bf16 v[132:135], a[156:157], a[216:217], v[132:135]
  s_waitcnt lgkmcnt(8)
  ds_read_b64_tr_b16 a[152:153], v106 offset:45056
  v_mfma_f32_16x16x16_bf16 v[140:143], a[156:157], a[220:221], v[140:143]
  ds_read_b64_tr_b16 a[154:155], v106 offset:47104
  v_mfma_f32_16x16x32_bf16 v[144:147], a[128:131], v[32:35], 0
  ds_read_b64_tr_b16 a[156:157], v107 offset:45056
  ds_read_b64_tr_b16 a[158:159], v107 offset:47104
  v_mfma_f32_16x16x32_bf16 v[152:155], a[128:131], v[36:39], 0
  s_add_u32 m0, s59, s43
  s_add_u32 s56, s56, 128
  v_mfma_f32_16x16x32_bf16 v[148:151], a[132:135], v[32:35], 0
  s_waitcnt lgkmcnt(8)
  ds_read_b64_tr_b16 a[128:129], v106 offset:49152
  v_mfma_f32_16x16x32_bf16 v[156:159], a[132:135], v[36:39], 0
  ds_read_b64_tr_b16 a[130:131], v106 offset:51200
  v_mfma_f32_16x16x32_bf16 v[144:147], a[136:139], v[40:43], v[144:147]
  ds_read_b64_tr_b16 a[132:133], v107 offset:49152
  v_mfma_f32_16x16x32_bf16 v[152:155], a[136:139], v[44:47], v[152:155]
  ds_read_b64_tr_b16 a[134:135], v107 offset:51200
  v_mfma_f32_16x16x32_bf16 v[148:151], a[140:143], v[40:43], v[148:151]
  s_waitcnt lgkmcnt(8)
  ds_read_b64_tr_b16 a[136:137], v106 offset:53248
  v_mfma_f32_16x16x32_bf16 v[156:159], a[140:143], v[44:47], v[156:159]
  ds_read_b64_tr_b16 a[138:139], v106 offset:55296
  buffer_load_dwordx4 v100, s[12:15], s57 offen offset:0 sc1 lds
  v_mfma_f32_16x16x32_bf16 v[144:147], a[144:147], v[48:51], v[144:147]
  ds_read_b64_tr_b16 a[140:141], v107 offset:53248
  v_cvt_pk_bf16_f32 v160, v128, v129
  v_mfma_f32_16x16x32_bf16 v[152:155], a[144:147], v[52:55], v[152:155]
  ds_read_b64_tr_b16 a[142:143], v107 offset:55296
  v_mfma_f32_16x16x32_bf16 v[148:151], a[148:151], v[48:51], v[148:151]
  s_waitcnt lgkmcnt(8)
  ds_read_b64_tr_b16 a[144:145], v106 offset:57344
  v_mfma_f32_16x16x32_bf16 v[156:159], a[148:151], v[52:55], v[156:159]
  ds_read_b64_tr_b16 a[146:147], v106 offset:59392
  buffer_load_dwordx4 v101, s[12:15], s57 offen offset:1024 sc1 lds
  v_mfma_f32_16x16x32_bf16 v[144:147], a[152:155], v[56:59], v[144:147]
  ds_read_b64_tr_b16 a[148:149], v107 offset:57344
  v_cvt_pk_bf16_f32 v161, v130, v131
  v_mfma_f32_16x16x32_bf16 v[152:155], a[152:155], v[60:63], v[152:155]
  ds_read_b64_tr_b16 a[150:151], v107 offset:59392
  v_mfma_f32_16x16x32_bf16 v[148:151], a[156:159], v[56:59], v[148:151]
  s_waitcnt lgkmcnt(8)
  ds_read_b64_tr_b16 a[152:153], v106 offset:61440
  v_mfma_f32_16x16x32_bf16 v[156:159], a[156:159], v[60:63], v[156:159]
  ds_read_b64_tr_b16 a[154:155], v106 offset:63488
  v_mfma_f32_16x16x32_bf16 v[144:147], a[128:131], v[64:67], v[144:147]
  ds_read_b64_tr_b16 a[156:157], v107 offset:61440
  ds_read_b64_tr_b16 a[158:159], v107 offset:63488
  v_mfma_f32_16x16x32_bf16 v[152:155], a[128:131], v[68:71], v[152:155]
  buffer_load_dwordx4 v102, s[12:15], s57 offen offset:2048 sc1 lds
  v_mfma_f32_16x16x32_bf16 v[148:151], a[132:135], v[64:67], v[148:151]
  s_waitcnt lgkmcnt(8)
  v_cvt_pk_bf16_f32 v162, v132, v133
  v_mfma_f32_16x16x32_bf16 v[156:159], a[132:135], v[68:71], v[156:159]
  ds_read_b64_tr_b16 a[128:129], v178 offset:0
  ds_read_b64_tr_b16 a[130:131], v178 offset:2048
  v_mfma_f32_16x16x32_bf16 v[144:147], a[136:139], v[72:75], v[144:147]
  ds_read_b64_tr_b16 a[132:133], v179 offset:0
  v_mfma_f32_16x16x32_bf16 v[152:155], a[136:139], v[76:79], v[152:155]
  ds_read_b64_tr_b16 a[134:135], v179 offset:2048
  v_mfma_f32_16x16x32_bf16 v[148:151], a[140:143], v[72:75], v[148:151]
  s_waitcnt lgkmcnt(8)
  ds_read_b64_tr_b16 a[136:137], v178 offset:4096
  v_mfma_f32_16x16x32_bf16 v[156:159], a[140:143], v[76:79], v[156:159]
  ds_read_b64_tr_b16 a[138:139], v178 offset:6144
  buffer_load_dwordx4 v103, s[12:15], s57 offen offset:3072 sc1 lds
  v_mfma_f32_16x16x32_bf16 v[144:147], a[144:147], v[80:83], v[144:147]
  ds_read_b64_tr_b16 a[140:141], v179 offset:4096
  v_cvt_pk_bf16_f32 v163, v134, v135
  v_mfma_f32_16x16x32_bf16 v[152:155], a[144:147], v[84:87], v[152:155]
  ds_read_b64_tr_b16 a[142:143], v179 offset:6144
  v_mfma_f32_16x16x32_bf16 v[148:151], a[148:151], v[80:83], v[148:151]
  s_waitcnt lgkmcnt(8)
  v_cvt_pk_bf16_f32 v164, v136, v137
  v_mfma_f32_16x16x32_bf16 v[156:159], a[148:151], v[84:87], v[156:159]
  ds_read_b64_tr_b16 a[144:145], v178 offset:8192
  ds_read_b64_tr_b16 a[146:147], v178 offset:10240
  v_mfma_f32_16x16x32_bf16 v[144:147], a[152:155], v[88:91], v[144:147]
  ds_read_b64_tr_b16 a[148:149], v179 offset:8192
  v_mfma_f32_16x16x32_bf16 v[152:155], a[152:155], v[92:95], v[152:155]
  s_add_u32 s57, s57, 128
  ds_read_b64_tr_b16 a[150:151], v179 offset:10240
  v_mfma_f32_16x16x32_bf16 v[148:151], a[156:159], v[88:91], v[148:151]
  v_cvt_pk_bf16_f32 v165, v138, v139
  v_cvt_pk_bf16_f32 v166, v140, v141
  v_mfma_f32_16x16x32_bf16 v[156:159], a[156:159], v[92:95], v[156:159]
  s_waitcnt lgkmcnt(8)
  ds_read_b64_tr_b16 a[152:153], v178 offset:12288
  v_mfma_f32_16x16x32_bf16 v[144:147], a[128:131], a[192:195], v[144:147]
  ds_read_b64_tr_b16 a[156:157], v179 offset:12288
  v_cvt_pk_bf16_f32 v167, v142, v143
  v_mfma_f32_16x16x32_bf16 v[152:155], a[128:131], a[196:199], v[152:155]
  buffer_store_dwordx4 v[160:163], v1, s[16:19], s62 offen offset:0 sc1
  v_mfma_f32_16x16x32_bf16 v[148:151], a[132:135], a[192:195], v[148:151]
  s_waitcnt vmcnt(17)
  s_waitcnt lgkmcnt(0)
  s_barrier
  v_mfma_f32_16x16x32_bf16 v[156:159], a[132:135], a[196:199], v[156:159]
  ds_read_b64_tr_b16 a[128:129], v176 offset:16384
  ds_read_b64_tr_b16 a[130:131], v176 offset:18432
  v_mfma_f32_16x16x32_bf16 v[144:147], a[136:139], a[200:203], v[144:147]
  ds_read_b64_tr_b16 a[132:133], v177 offset:16384
  ds_read_b64_tr_b16 a[134:135], v177 offset:18432
  v_mfma_f32_16x16x32_bf16 v[152:155], a[136:139], a[204:207], v[152:155]
  s_mov_b32 s58, 32768
  s_mov_b32 s59, 65536
  v_mfma_f32_16x16x32_bf16 v[148:151], a[140:143], a[200:203], v[148:151]
  ds_read_b64_tr_b16 a[136:137], v176 offset:20480
  v_mfma_f32_16x16x32_bf16 v[156:159], a[140:143], a[204:207], v[156:159]
  ds_read_b64_tr_b16 a[138:139], v176 offset:22528
  v_mfma_f32_16x16x32_bf16 v[144:147], a[144:147], a[208:211], v[144:147]
  ds_read_b64_tr_b16 a[140:141], v177 offset:20480
  ds_read_b64_tr_b16 a[142:143], v177 offset:22528
  v_mfma_f32_16x16x32_bf16 v[152:155], a[144:147], a[212:215], v[152:155]
  s_add_u32 s61, s58, s60
  s_add_u32 m0, s61, 0
  s_add_u32 s61, s56, 0
  v_mfma_f32_16x16x32_bf16 v[148:151], a[148:151], a[208:211], v[148:151]
  ds_read_b64_tr_b16 a[144:145], v176 offset:24576
  v_mfma_f32_16x16x32_bf16 v[156:159], a[148:151], a[212:215], v[156:159]
  ds_read_b64_tr_b16 a[146:147], v176 offset:26624
  buffer_store_dwordx4 v[164:167], v1, s[16:19], s62 offen offset:1024 sc1
  v_mfma_f32_16x16x16_bf16 v[144:147], a[152:153], a[216:217], v[144:147]
  ds_read_b64_tr_b16 a[148:149], v177 offset:24576
  v_mfma_f32_16x16x16_bf16 v[152:155], a[152:153], a[220:221], v[152:155]
  ds_read_b64_tr_b16 a[150:151], v177 offset:26624
  v_mfma_f32_16x16x16_bf16 v[148:151], a[156:157], a[216:217], v[148:151]
  s_waitcnt lgkmcnt(8)
  ds_read_b64_tr_b16 a[152:153], v176 offset:28672
  v_mfma_f32_16x16x16_bf16 v[156:159], a[156:157], a[220:221], v[156:159]
  ds_read_b64_tr_b16 a[154:155], v176 offset:30720
  buffer_load_dwordx4 v100, s[8:11], s61 offen offset:0 sc1 lds
  v_mfma_f32_16x16x32_bf16 v[128:131], a[128:131], v[32:35], 0
  ds_read_b64_tr_b16 a[156:157], v177 offset:28672
  v_mfma_f32_16x16x32_bf16 v[136:139], a[128:131], v[36:39], 0
  ds_read_b64_tr_b16 a[158:159], v177 offset:30720
  v_mfma_f32_16x16x32_bf16 v[132:135], a[132:135], v[32:35], 0
  s_waitcnt lgkmcnt(8)
  ds_read_b64_tr_b16 a[128:129], v176 offset:32768
  v_mfma_f32_16x16x32_bf16 v[140:143], a[132:135], v[36:39], 0
  ds_read_b64_tr_b16 a[130:131], v176 offset:34816
  v_mfma_f32_16x16x32_bf16 v[128:131], a[136:139], v[40:43], v[128:131]
  ds_read_b64_tr_b16 a[132:133], v177 offset:32768
  ds_read_b64_tr_b16 a[134:135], v177 offset:34816
  v_mfma_f32_16x16x32_bf16 v[136:139], a[136:139], v[44:47], v[136:139]
  buffer_load_dwordx4 v101, s[8:11], s61 offen offset:1024 sc1 lds
  v_mfma_f32_16x16x32_bf16 v[132:135], a[140:143], v[40:43], v[132:135]
  s_waitcnt lgkmcnt(8)
  ds_read_b64_tr_b16 a[136:137], v176 offset:36864
  v_mfma_f32_16x16x32_bf16 v[140:143], a[140:143], v[44:47], v[140:143]
  ds_read_b64_tr_b16 a[138:139], v176 offset:38912
  v_mfma_f32_16x16x32_bf16 v[128:131], a[144:147], v[48:51], v[128:131]
  ds_read_b64_tr_b16 a[140:141], v177 offset:36864
  v_cvt_pk_bf16_f32 v168, v144, v145
  v_mfma_f32_16x16x32_bf16 v[136:139], a[144:147], v[52:55], v[136:139]
  ds_read_b64_tr_b16 a[142:143], v177 offset:38912
  v_mfma_f32_16x16x32_bf16 v[132:135], a[148:151], v[48:51], v[132:135]
  s_waitcnt lgkmcnt(8)
  ds_read_b64_tr_b16 a[144:145], v176 offset:40960
  v_mfma_f32_16x16x32_bf16 v[140:143], a[148:151], v[52:55], v[140:143]
  ds_read_b64_tr_b16 a[146:147], v176 offset:43008
  buffer_load_dwordx4 v102, s[8:11], s61 offen offset:2048 sc1 lds
  v_mfma_f32_16x16x32_bf16 v[128:131], a[152:155], v[56:59], v[128:131]
  ds_read_b64_tr_b16 a[148:149], v177 offset:40960
  v_cvt_pk_bf16_f32 v169, v146, v147
  v_mfma_f32_16x16x32_bf16 v[136:139], a[152:155], v[60:63], v[136:139]
  ds_read_b64_tr_b16 a[150:151], v177 offset:43008
  v_mfma_f32_16x16x32_bf16 v[132:135], a[156:159], v[56:59], v[132:135]
  s_waitcnt lgkmcnt(8)
  ds_read_b64_tr_b16 a[152:153], v176 offset:45056
  v_mfma_f32_16x16x32_bf16 v[140:143], a[156:159], v[60:63], v[140:143]
  ds_read_b64_tr_b16 a[154:155], v176 offset:47104
  buffer_load_dwordx4 v103, s[8:11], s61 offen offset:3072 sc1 lds
  v_mfma_f32_16x16x32_bf16 v[128:131], a[128:131], v[64:67], v[128:131]
  ds_read_b64_tr_b16 a[156:157], v177 offset:45056
  v_cvt_pk_bf16_f32 v170, v148, v149
  v_mfma_f32_16x16x32_bf16 v[136:139], a[128:131], v[68:71], v[136:139]
  ds_read_b64_tr_b16 a[158:159], v177 offset:47104
  v_mfma_f32_16x16x32_bf16 v[132:135], a[132:135], v[64:67], v[132:135]
  s_waitcnt lgkmcnt(8)
  ds_read_b64_tr_b16 a[128:129], v176 offset:49152
  v_mfma_f32_16x16x32_bf16 v[140:143], a[132:135], v[68:71], v[140:143]
  ds_read_b64_tr_b16 a[130:131], v176 offset:51200
  v_mfma_f32_16x16x32_bf16 v[128:131], a[136:139], v[72:75], v[128:131]
  ds_read_b64_tr_b16 a[132:133], v177 offset:49152
  ds_read_b64_tr_b16 a[134:135], v177 offset:51200
  v_mfma_f32_16x16x32_bf16 v[136:139], a[136:139], v[76:79], v[136:139]
  s_add_u32 s61, s58, s60
  s_add_u32 m0, s61, 4096
  s_add_u32 s61, s56, 28672
  v_mfma_f32_16x16x32_bf16 v[132:135], a[140:143], v[72:75], v[132:135]
  s_waitcnt lgkmcnt(8)
  v_cvt_pk_bf16_f32 v171, v150, v151
  v_mfma_f32_16x16x32_bf16 v[140:143], a[140:143], v[76:79], v[140:143]
  ds_read_b64_tr_b16 a[136:137], v176 offset:53248
  ds_read_b64_tr_b16 a[138:139], v176 offset:55296
  v_mfma_f32_16x16x32_bf16 v[128:131], a[144:147], v[80:83], v[128:131]
  ds_read_b64_tr_b16 a[140:141], v177 offset:53248
  v_cvt_pk_bf16_f32 v172, v152, v153
  v_mfma_f32_16x16x32_bf16 v[136:139], a[144:147], v[84:87], v[136:139]
  ds_read_b64_tr_b16 a[142:143], v177 offset:55296
  v_mfma_f32_16x16x32_bf16 v[132:135], a[148:151], v[80:83], v[132:135]
  s_waitcnt lgkmcnt(8)
  ds_read_b64_tr_b16 a[144:145], v176 offset:57344
  v_mfma_f32_16x16x32_bf16 v[140:143], a[148:151], v[84:87], v[140:143]
  ds_read_b64_tr_b16 a[146:147], v176 offset:59392
  buffer_load_dwordx4 v100, s[8:11], s61 offen offset:0 sc1 lds
  v_mfma_f32_16x16x32_bf16 v[128:131], a[152:155], v[88:91], v[128:131]
  ds_read_b64_tr_b16 a[148:149], v177 offset:57344
  v_cvt_pk_bf16_f32 v173, v154, v155
  v_mfma_f32_16x16x32_bf16 v[136:139], a[152:155], v[92:95], v[136:139]
  ds_read_b64_tr_b16 a[150:151], v177 offset:59392
  v_mfma_f32_16x16x32_bf16 v[132:135], a[156:159], v[88:91], v[132:135]
  s_waitcnt lgkmcnt(8)
  v_cvt_pk_bf16_f32 v174, v156, v157
  v_mfma_f32_16x16x32_bf16 v[140:143], a[156:159], v[92:95], v[140:143]
  ds_read_b64_tr_b16 a[152:153], v176 offset:61440
  v_mfma_f32_16x16x32_bf16 v[128:131], a[128:131], a[192:195], v[128:131]
  ds_read_b64_tr_b16 a[156:157], v177 offset:61440
  buffer_load_dwordx4 v101, s[8:11], s61 offen offset:1024 sc1 lds
  v_mfma_f32_16x16x32_bf16 v[136:139], a[128:131], a[196:199], v[136:139]
  v_cvt_pk_bf16_f32 v175, v158, v159
  v_mfma_f32_16x16x32_bf16 v[132:135], a[132:135], a[192:195], v[132:135]
  s_waitcnt lgkmcnt(6)
  ds_read_b64_tr_b16 a[128:129], v178 offset:16384
  v_mfma_f32_16x16x32_bf16 v[140:143], a[132:135], a[196:199], v[140:143]
  ds_read_b64_tr_b16 a[130:131], v178 offset:18432
  buffer_store_dwordx4 v[168:171], v1, s[16:19], s62 offen offset:2048 sc1
  v_mfma_f32_16x16x32_bf16 v[128:131], a[136:139], a[200:203], v[128:131]
  ds_read_b64_tr_b16 a[132:133], v179 offset:16384
  ds_read_b64_tr_b16 a[134:135], v179 offset:18432
  v_mfma_f32_16x16x32_bf16 v[136:139], a[136:139], a[204:207], v[136:139]
  buffer_load_dwordx4 v102, s[8:11], s61 offen offset:2048 sc1 lds
  v_mfma_f32_16x16x32_bf16 v[132:135], a[140:143], a[200:203], v[132:135]
  s_waitcnt lgkmcnt(6)
  ds_read_b64_tr_b16 a[136:137], v178 offset:20480
  v_mfma_f32_16x16x32_bf16 v[140:143], a[140:143], a[204:207], v[140:143]
  ds_read_b64_tr_b16 a[138:139], v178 offset:22528
  v_mfma_f32_16x16x32_bf16 v[128:131], a[144:147], a[208:211], v[128:131]
  ds_read_b64_tr_b16 a[140:141], v179 offset:20480
  ds_read_b64_tr_b16 a[142:143], v179 offset:22528
  v_mfma_f32_16x16x32_bf16 v[136:139], a[144:147], a[212:215], v[136:139]
  buffer_store_dwordx4 v[172:175], v1, s[16:19], s62 offen offset:3072 sc1
  s_add_u32 s62, s62, 4096
  v_mfma_f32_16x16x32_bf16 v[132:135], a[148:151], a[208:211], v[132:135]
  s_waitcnt lgkmcnt(8)
  ds_read_b64_tr_b16 a[144:145], v178 offset:24576
  v_mfma_f32_16x16x32_bf16 v[140:143], a[148:151], a[212:215], v[140:143]
  ds_read_b64_tr_b16 a[146:147], v178 offset:26624
  buffer_load_dwordx4 v103, s[8:11], s61 offen offset:3072 sc1 lds
  v_mfma_f32_16x16x16_bf16 v[128:131], a[152:153], a[216:217], v[128:131]
  ds_read_b64_tr_b16 a[148:149], v179 offset:24576
  v_mfma_f32_16x16x16_bf16 v[136:139], a[152:153], a[220:221], v[136:139]
  ds_read_b64_tr_b16 a[150:151], v179 offset:26624
  v_mfma_f32_16x16x16_bf16 v[132:135], a[156:157], a[216:217], v[132:135]
  s_waitcnt lgkmcnt(8)
  ds_read_b64_tr_b16 a[152:153], v178 offset:28672
  v_mfma_f32_16x16x16_bf16 v[140:143], a[156:157], a[220:221], v[140:143]
  ds_read_b64_tr_b16 a[154:155], v178 offset:30720
  v_mfma_f32_16x16x32_bf16 v[144:147], a[128:131], v[32:35], 0
  ds_read_b64_tr_b16 a[156:157], v179 offset:28672
  ds_read_b64_tr_b16 a[158:159], v179 offset:30720
  v_mfma_f32_16x16x32_bf16 v[152:155], a[128:131], v[36:39], 0
  s_add_u32 m0, s59, s43
  s_add_u32 s56, s56, 128
  v_mfma_f32_16x16x32_bf16 v[148:151], a[132:135], v[32:35], 0
  s_waitcnt lgkmcnt(8)
  ds_read_b64_tr_b16 a[128:129], v178 offset:32768
  v_mfma_f32_16x16x32_bf16 v[156:159], a[132:135], v[36:39], 0
  ds_read_b64_tr_b16 a[130:131], v178 offset:34816
  v_mfma_f32_16x16x32_bf16 v[144:147], a[136:139], v[40:43], v[144:147]
  ds_read_b64_tr_b16 a[132:133], v179 offset:32768
  v_mfma_f32_16x16x32_bf16 v[152:155], a[136:139], v[44:47], v[152:155]
  ds_read_b64_tr_b16 a[134:135], v179 offset:34816
  v_mfma_f32_16x16x32_bf16 v[148:151], a[140:143], v[40:43], v[148:151]
  s_waitcnt lgkmcnt(8)
  ds_read_b64_tr_b16 a[136:137], v178 offset:36864
  v_mfma_f32_16x16x32_bf16 v[156:159], a[140:143], v[44:47], v[156:159]
  ds_read_b64_tr_b16 a[138:139], v178 offset:38912
  buffer_load_dwordx4 v100, s[12:15], s57 offen offset:0 sc1 lds
  v_mfma_f32_16x16x32_bf16 v[144:147], a[144:147], v[48:51], v[144:147]
  ds_read_b64_tr_b16 a[140:141], v179 offset:36864
  v_cvt_pk_bf16_f32 v160, v128, v129
  v_mfma_f32_16x16x32_bf16 v[152:155], a[144:147], v[52:55], v[152:155]
  ds_read_b64_tr_b16 a[142:143], v179 offset:38912
  v_mfma_f32_16x16x32_bf16 v[148:151], a[148:151], v[48:51], v[148:151]
  s_waitcnt lgkmcnt(8)
  ds_read_b64_tr_b16 a[144:145], v178 offset:40960
  v_mfma_f32_16x16x32_bf16 v[156:159], a[148:151], v[52:55], v[156:159]
  ds_read_b64_tr_b16 a[146:147], v178 offset:43008
  buffer_load_dwordx4 v101, s[12:15], s57 offen offset:1024 sc1 lds
  v_mfma_f32_16x16x32_bf16 v[144:147], a[152:155], v[56:59], v[144:147]
  ds_read_b64_tr_b16 a[148:149], v179 offset:40960
  v_mfma_f32_16x16x32_bf16 v[152:155], a[152:155], v[60:63], v[152:155]
  ds_read_b64_tr_b16 a[150:151], v179 offset:43008
  v_mfma_f32_16x16x32_bf16 v[148:151], a[156:159], v[56:59], v[148:151]
  s_waitcnt lgkmcnt(8)
  v_cvt_pk_bf16_f32 v161, v130, v131
  v_mfma_f32_16x16x32_bf16 v[156:159], a[156:159], v[60:63], v[156:159]
  ds_read_b64_tr_b16 a[152:153], v178 offset:45056
  ds_read_b64_tr_b16 a[154:155], v178 offset:47104
  v_mfma_f32_16x16x32_bf16 v[144:147], a[128:131], v[64:67], v[144:147]
  ds_read_b64_tr_b16 a[156:157], v179 offset:45056
  ds_read_b64_tr_b16 a[158:159], v179 offset:47104
  v_mfma_f32_16x16x32_bf16 v[152:155], a[128:131], v[68:71], v[152:155]
  buffer_load_dwordx4 v102, s[12:15], s57 offen offset:2048 sc1 lds
  v_mfma_f32_16x16x32_bf16 v[148:151], a[132:135], v[64:67], v[148:151]
  s_waitcnt lgkmcnt(8)
  ds_read_b64_tr_b16 a[128:129], v178 offset:49152
  v_mfma_f32_16x16x32_bf16 v[156:159], a[132:135], v[68:71], v[156:159]
  ds_read_b64_tr_b16 a[130:131], v178 offset:51200
  v_mfma_f32_16x16x32_bf16 v[144:147], a[136:139], v[72:75], v[144:147]
  ds_read_b64_tr_b16 a[132:133], v179 offset:49152
  v_cvt_pk_bf16_f32 v162, v132, v133
  v_mfma_f32_16x16x32_bf16 v[152:155], a[136:139], v[76:79], v[152:155]
  ds_read_b64_tr_b16 a[134:135], v179 offset:51200
  v_mfma_f32_16x16x32_bf16 v[148:151], a[140:143], v[72:75], v[148:151]
  s_waitcnt lgkmcnt(8)
  ds_read_b64_tr_b16 a[136:137], v178 offset:53248
  v_mfma_f32_16x16x32_bf16 v[156:159], a[140:143], v[76:79], v[156:159]
  ds_read_b64_tr_b16 a[138:139], v178 offset:55296
  buffer_load_dwordx4 v103, s[12:15], s57 offen offset:3072 sc1 lds
  v_mfma_f32_16x16x32_bf16 v[144:147], a[144:147], v[80:83], v[144:147]
  ds_read_b64_tr_b16 a[140:141], v179 offset:53248
  v_cvt_pk_bf16_f32 v163, v134, v135
  v_mfma_f32_16x16x32_bf16 v[152:155], a[144:147], v[84:87], v[152:155]
  ds_read_b64_tr_b16 a[142:143], v179 offset:55296
  v_mfma_f32_16x16x32_bf16 v[148:151], a[148:151], v[80:83], v[148:151]
  s_waitcnt lgkmcnt(8)
  ds_read_b64_tr_b16 a[144:145], v178 offset:57344
  v_mfma_f32_16x16x32_bf16 v[156:159], a[148:151], v[84:87], v[156:159]
  ds_read_b64_tr_b16 a[146:147], v178 offset:59392
  v_mfma_f32_16x16x32_bf16 v[144:147], a[152:155], v[88:91], v[144:147]
  ds_read_b64_tr_b16 a[148:149], v179 offset:57344
  ds_read_b64_tr_b16 a[150:151], v179 offset:59392
  v_mfma_f32_16x16x32_bf16 v[152:155], a[152:155], v[92:95], v[152:155]
  s_add_u32 s57, s57, 128
  v_cvt_pk_bf16_f32 v164, v136, v137
  v_mfma_f32_16x16x32_bf16 v[148:151], a[156:159], v[88:91], v[148:151]
  s_waitcnt lgkmcnt(8)
  v_cvt_pk_bf16_f32 v165, v138, v139
  v_mfma_f32_16x16x32_bf16 v[156:159], a[156:159], v[92:95], v[156:159]
  ds_read_b64_tr_b16 a[152:153], v178 offset:61440
  v_mfma_f32_16x16x32_bf16 v[144:147], a[128:131], a[192:195], v[144:147]
  v_cvt_pk_bf16_f32 v166, v140, v141
  v_cvt_pk_bf16_f32 v167, v142, v143
  v_mfma_f32_16x16x32_bf16 v[152:155], a[128:131], a[196:199], v[152:155]
  ds_read_b64_tr_b16 a[156:157], v179 offset:61440
  v_mfma_f32_16x16x32_bf16 v[148:151], a[132:135], a[192:195], v[148:151]
  s_waitcnt vmcnt(16)
  s_barrier
  s_waitcnt lgkmcnt(6)
  v_mfma_f32_16x16x32_bf16 v[156:159], a[132:135], a[196:199], v[156:159]
  ds_read_b64_tr_b16 a[128:129], v180 offset:0
  ds_read_b64_tr_b16 a[130:131], v180 offset:2048
  v_mfma_f32_16x16x32_bf16 v[144:147], a[136:139], a[200:203], v[144:147]
  ds_read_b64_tr_b16 a[132:133], v181 offset:0
  v_mfma_f32_16x16x32_bf16 v[152:155], a[136:139], a[204:207], v[152:155]
  ds_read_b64_tr_b16 a[134:135], v181 offset:2048
  v_mfma_f32_16x16x32_bf16 v[148:151], a[140:143], a[200:203], v[148:151]
  s_waitcnt lgkmcnt(6)
  ds_read_b64_tr_b16 a[136:137], v180 offset:4096
  v_mfma_f32_16x16x32_bf16 v[156:159], a[140:143], a[204:207], v[156:159]
  ds_read_b64_tr_b16 a[138:139], v180 offset:6144
  buffer_store_dwordx4 v[160:163], v1, s[16:19], s62 offen offset:0 sc1
  v_mfma_f32_16x16x32_bf16 v[144:147], a[144:147], a[208:211], v[144:147]
  ds_read_b64_tr_b16 a[140:141], v181 offset:4096
  ds_read_b64_tr_b16 a[142:143], v181 offset:6144
  v_mfma_f32_16x16x32_bf16 v[152:155], a[144:147], a[212:215], v[152:155]
  buffer_store_dwordx4 v[164:167], v1, s[16:19], s62 offen offset:1024 sc1
  v_mfma_f32_16x16x32_bf16 v[148:151], a[148:151], a[208:211], v[148:151]
  s_waitcnt lgkmcnt(8)
  ds_read_b64_tr_b16 a[144:145], v180 offset:8192
  v_mfma_f32_16x16x32_bf16 v[156:159], a[148:151], a[212:215], v[156:159]
  ds_read_b64_tr_b16 a[146:147], v180 offset:10240
  v_mfma_f32_16x16x16_bf16 v[144:147], a[152:153], a[216:217], v[144:147]
  ds_read_b64_tr_b16 a[148:149], v181 offset:8192
  v_mfma_f32_16x16x16_bf16 v[152:155], a[152:153], a[220:221], v[152:155]
  ds_read_b64_tr_b16 a[150:151], v181 offset:10240
  v_mfma_f32_16x16x16_bf16 v[148:151], a[156:157], a[216:217], v[148:151]
  s_waitcnt lgkmcnt(8)
  ds_read_b64_tr_b16 a[152:153], v180 offset:12288
  v_mfma_f32_16x16x16_bf16 v[156:159], a[156:157], a[220:221], v[156:159]
  ds_read_b64_tr_b16 a[154:155], v180 offset:14336
  v_mfma_f32_16x16x32_bf16 v[128:131], a[128:131], v[32:35], 0
  ds_read_b64_tr_b16 a[156:157], v181 offset:12288
  v_mfma_f32_16x16x32_bf16 v[136:139], a[128:131], v[36:39], 0
  ds_read_b64_tr_b16 a[158:159], v181 offset:14336
  v_mfma_f32_16x16x32_bf16 v[132:135], a[132:135], v[32:35], 0
  s_waitcnt lgkmcnt(8)
  ds_read_b64_tr_b16 a[128:129], v180 offset:16384
  v_mfma_f32_16x16x32_bf16 v[140:143], a[132:135], v[36:39], 0
  ds_read_b64_tr_b16 a[130:131], v180 offset:18432
  v_mfma_f32_16x16x32_bf16 v[128:131], a[136:139], v[40:43], v[128:131]
  ds_read_b64_tr_b16 a[132:133], v181 offset:16384
  v_mfma_f32_16x16x32_bf16 v[136:139], a[136:139], v[44:47], v[136:139]
  s_lshl_b32 s7, s33, 2
  ds_read_b64_tr_b16 a[134:135], v181 offset:18432
  s_lshr_b32 s4, s32, 2
  v_mfma_f32_16x16x32_bf16 v[132:135], a[140:143], v[40:43], v[132:135]
  s_waitcnt lgkmcnt(8)
  ds_read_b64_tr_b16 a[136:137], v180 offset:20480
  v_mfma_f32_16x16x32_bf16 v[140:143], a[140:143], v[44:47], v[140:143]
  s_add_u32 s4, s4, s7
  ds_read_b64_tr_b16 a[138:139], v180 offset:22528
  s_and_b32 s5, s32, 3
  v_mfma_f32_16x16x32_bf16 v[128:131], a[144:147], v[48:51], v[128:131]
  ds_read_b64_tr_b16 a[140:141], v181 offset:20480
  ds_read_b64_tr_b16 a[142:143], v181 offset:22528
  v_mfma_f32_16x16x32_bf16 v[136:139], a[144:147], v[52:55], v[136:139]
  s_lshl_b32 s6, s3, 2
  s_add_u32 s5, s5, s6
  v_cvt_pk_bf16_f32 v168, v144, v145
  v_mfma_f32_16x16x32_bf16 v[132:135], a[148:151], v[48:51], v[132:135]
  s_waitcnt lgkmcnt(8)
  ds_read_b64_tr_b16 a[144:145], v180 offset:24576
  v_mfma_f32_16x16x32_bf16 v[140:143], a[148:151], v[52:55], v[140:143]
  s_mul_i32 s6, s4, 28
  ds_read_b64_tr_b16 a[146:147], v180 offset:26624
  v_mfma_f32_16x16x32_bf16 v[128:131], a[152:155], v[56:59], v[128:131]
  ds_read_b64_tr_b16 a[148:149], v181 offset:24576
  ds_read_b64_tr_b16 a[150:151], v181 offset:26624
  v_mfma_f32_16x16x32_bf16 v[136:139], a[152:155], v[60:63], v[136:139]
  s_add_u32 s6, s6, s5
  s_lshl_b32 s6, s6, 10
  v_cvt_pk_bf16_f32 v169, v146, v147
  v_mfma_f32_16x16x32_bf16 v[132:135], a[156:159], v[56:59], v[132:135]
  s_waitcnt lgkmcnt(8)
  ds_read_b64_tr_b16 a[152:153], v180 offset:28672
  v_mfma_f32_16x16x32_bf16 v[140:143], a[156:159], v[60:63], v[140:143]
  s_add_u32 s53, s6, 83886080
  ds_read_b64_tr_b16 a[154:155], v180 offset:30720
  s_add_u32 s54, s53, 16384
  v_mfma_f32_16x16x32_bf16 v[128:131], a[128:131], v[64:67], v[128:131]
  ds_read_b64_tr_b16 a[156:157], v181 offset:28672
  v_cvt_pk_bf16_f32 v170, v148, v149
  v_mfma_f32_16x16x32_bf16 v[136:139], a[128:131], v[68:71], v[136:139]
  ds_read_b64_tr_b16 a[158:159], v181 offset:30720
  v_mfma_f32_16x16x32_bf16 v[132:135], a[132:135], v[64:67], v[132:135]
  s_waitcnt lgkmcnt(8)
  v_and_b32 v2, 15, v0
  v_mfma_f32_16x16x32_bf16 v[140:143], a[132:135], v[68:71], v[140:143]
  ds_read_b64_tr_b16 a[128:129], v104 offset:0
  ds_read_b64_tr_b16 a[130:131], v104 offset:2048
  v_mfma_f32_16x16x32_bf16 v[128:131], a[136:139], v[72:75], v[128:131]
  v_cvt_pk_bf16_f32 v171, v150, v151
  v_cvt_pk_bf16_f32 v172, v152, v153
  v_mfma_f32_16x16x32_bf16 v[136:139], a[136:139], v[76:79], v[136:139]
  ds_read_b64_tr_b16 a[132:133], v105 offset:0
  ds_read_b64_tr_b16 a[134:135], v105 offset:2048
  v_mfma_f32_16x16x32_bf16 v[132:135], a[140:143], v[72:75], v[132:135]
  s_waitcnt lgkmcnt(8)
  v_lshrrev_b32 v3, 4, v0
  v_mfma_f32_16x16x32_bf16 v[140:143], a[140:143], v[76:79], v[140:143]
  ds_read_b64_tr_b16 a[136:137], v104 offset:4096
  ds_read_b64_tr_b16 a[138:139], v104 offset:6144
  v_mfma_f32_16x16x32_bf16 v[128:131], a[144:147], v[80:83], v[128:131]
  ds_read_b64_tr_b16 a[140:141], v105 offset:4096
  v_mfma_f32_16x16x32_bf16 v[136:139], a[144:147], v[84:87], v[136:139]
  s_lshl_b32 s4, s4, 1
  ds_read_b64_tr_b16 a[142:143], v105 offset:6144
  v_mfma_f32_16x16x32_bf16 v[132:135], a[148:151], v[80:83], v[132:135]
  ds_read_b64_tr_b16 a[144:145], v104 offset:8192
  ds_read_b64_tr_b16 a[146:147], v104 offset:10240
  v_mfma_f32_16x16x32_bf16 v[140:143], a[148:151], v[84:87], v[140:143]
  s_waitcnt lgkmcnt(10)
  s_and_b32 s6, s32, 1
  v_cvt_pk_bf16_f32 v173, v154, v155
  v_mfma_f32_16x16x32_bf16 v[128:131], a[152:155], v[88:91], v[128:131]
  ds_read_b64_tr_b16 a[148:149], v105 offset:8192
  ds_read_b64_tr_b16 a[150:151], v105 offset:10240
  v_mfma_f32_16x16x32_bf16 v[136:139], a[152:155], v[92:95], v[136:139]
  s_add_u32 s4, s4, s6
  s_lshl_b32 s4, s4, 4
  v_cvt_pk_bf16_f32 v174, v156, v157
  v_mfma_f32_16x16x32_bf16 v[132:135], a[156:159], v[88:91], v[132:135]
  v_add_u32 v2, s4, v2
  v_cvt_pk_bf16_f32 v175, v158, v159
  v_mfma_f32_16x16x32_bf16 v[140:143], a[156:159], v[92:95], v[140:143]
  s_waitcnt lgkmcnt(8)
  ds_read_b64_tr_b16 a[152:153], v104 offset:12288
  v_mfma_f32_16x16x32_bf16 v[128:131], a[128:131], a[192:195], v[128:131]
  v_mul_u32_u24 v2, 896, v2
  v_lshl_add_u32 v2, v3, 3, v2
  v_mfma_f32_16x16x32_bf16 v[136:139], a[128:131], a[196:199], v[136:139]
  ds_read_b64_tr_b16 a[156:157], v105 offset:12288
  v_mfma_f32_16x16x32_bf16 v[132:135], a[132:135], a[192:195], v[132:135]
  s_waitcnt lgkmcnt(6)
  ds_read_b64_tr_b16 a[128:129], v182 offset:0
  v_mfma_f32_16x16x32_bf16 v[140:143], a[132:135], a[196:199], v[140:143]
  s_lshr_b32 s5, s5, 1
  ds_read_b64_tr_b16 a[130:131], v182 offset:2048
  s_lshl_b32 s5, s5, 6
  v_mfma_f32_16x16x32_bf16 v[128:131], a[136:139], a[200:203], v[128:131]
  ds_read_b64_tr_b16 a[132:133], v183 offset:0
  ds_read_b64_tr_b16 a[134:135], v183 offset:2048
  v_mfma_f32_16x16x32_bf16 v[136:139], a[136:139], a[204:207], v[136:139]
  buffer_store_dwordx4 v[168:171], v1, s[16:19], s62 offen offset:2048 sc1
  v_mfma_f32_16x16x32_bf16 v[132:135], a[140:143], a[200:203], v[132:135]
  s_waitcnt lgkmcnt(6)
  v_add_u32 v2, s5, v2
  v_mfma_f32_16x16x32_bf16 v[140:143], a[140:143], a[204:207], v[140:143]
  ds_read_b64_tr_b16 a[136:137], v182 offset:4096
  ds_read_b64_tr_b16 a[138:139], v182 offset:6144
  v_mfma_f32_16x16x32_bf16 v[128:131], a[144:147], a[208:211], v[128:131]
  ds_read_b64_tr_b16 a[140:141], v183 offset:4096
  ds_read_b64_tr_b16 a[142:143], v183 offset:6144
  v_mfma_f32_16x16x32_bf16 v[136:139], a[144:147], a[212:215], v[136:139]
  buffer_store_dwordx4 v[172:175], v1, s[16:19], s62 offen offset:3072 sc1
  s_add_u32 s62, s62, 4096
  v_mfma_f32_16x16x32_bf16 v[132:135], a[148:151], a[208:211], v[132:135]
  s_waitcnt lgkmcnt(8)
  ds_read_b64_tr_b16 a[144:145], v182 offset:8192
  v_mfma_f32_16x16x32_bf16 v[140:143], a[148:151], a[212:215], v[140:143]
  ds_read_b64_tr_b16 a[146:147], v182 offset:10240
  buffer_load_dwordx2 v[12:13], v2, s[20:23], 0 offen offset:0
  v_mfma_f32_16x16x16_bf16 v[128:131], a[152:153], a[216:217], v[128:131]
  ds_read_b64_tr_b16 a[148:149], v183 offset:8192
  v_mfma_f32_16x16x16_bf16 v[136:139], a[152:153], a[220:221], v[136:139]
  ds_read_b64_tr_b16 a[150:151], v183 offset:10240
  v_mfma_f32_16x16x16_bf16 v[132:135], a[156:157], a[216:217], v[132:135]
  s_waitcnt lgkmcnt(8)
  ds_read_b64_tr_b16 a[152:153], v182 offset:12288
  v_mfma_f32_16x16x16_bf16 v[140:143], a[156:157], a[220:221], v[140:143]
  ds_read_b64_tr_b16 a[154:155], v182 offset:14336
  buffer_load_dwordx2 v[14:15], v2, s[20:23], 0 offen offset:32
  v_mfma_f32_16x16x32_bf16 v[144:147], a[128:131], v[32:35], 0
  ds_read_b64_tr_b16 a[156:157], v183 offset:12288
  v_mfma_f32_16x16x32_bf16 v[152:155], a[128:131], v[36:39], 0
  ds_read_b64_tr_b16 a[158:159], v183 offset:14336
  v_mfma_f32_16x16x32_bf16 v[148:151], a[132:135], v[32:35], 0
  s_waitcnt lgkmcnt(8)
  ds_read_b64_tr_b16 a[128:129], v182 offset:16384
  v_mfma_f32_16x16x32_bf16 v[156:159], a[132:135], v[36:39], 0
  ds_read_b64_tr_b16 a[130:131], v182 offset:18432
  v_mfma_f32_16x16x32_bf16 v[144:147], a[136:139], v[40:43], v[144:147]
  ds_read_b64_tr_b16 a[132:133], v183 offset:16384
  ds_read_b64_tr_b16 a[134:135], v183 offset:18432
  v_mfma_f32_16x16x32_bf16 v[152:155], a[136:139], v[44:47], v[152:155]
  buffer_load_dwordx2 v[16:17], v2, s[20:23], 0 offen offset:512
  v_mfma_f32_16x16x32_bf16 v[148:151], a[140:143], v[40:43], v[148:151]
  s_waitcnt lgkmcnt(8)
  ds_read_b64_tr_b16 a[136:137], v182 offset:20480
  v_mfma_f32_16x16x32_bf16 v[156:159], a[140:143], v[44:47], v[156:159]
  ds_read_b64_tr_b16 a[138:139], v182 offset:22528
  v_mfma_f32_16x16x32_bf16 v[144:147], a[144:147], v[48:51], v[144:147]
  ds_read_b64_tr_b16 a[140:141], v183 offset:20480
  ds_read_b64_tr_b16 a[142:143], v183 offset:22528
  v_mfma_f32_16x16x32_bf16 v[152:155], a[144:147], v[52:55], v[152:155]
  buffer_load_dwordx2 v[18:19], v2, s[20:23], 0 offen offset:544
  v_mfma_f32_16x16x32_bf16 v[148:151], a[148:151], v[48:51], v[148:151]
  s_waitcnt lgkmcnt(8)
  v_cvt_pk_bf16_f32 v160, v128, v129
  v_mfma_f32_16x16x32_bf16 v[156:159], a[148:151], v[52:55], v[156:159]
  ds_read_b64_tr_b16 a[144:145], v182 offset:24576
  ds_read_b64_tr_b16 a[146:147], v182 offset:26624
  v_mfma_f32_16x16x32_bf16 v[144:147], a[152:155], v[56:59], v[144:147]
  ds_read_b64_tr_b16 a[148:149], v183 offset:24576
  ds_read_b64_tr_b16 a[150:151], v183 offset:26624
  v_mfma_f32_16x16x32_bf16 v[152:155], a[152:155], v[60:63], v[152:155]
  s_lshl_b32 s55, s33, 9
  s_add_u32 s55, s55, 121651200
  v_mfma_f32_16x16x32_bf16 v[148:151], a[156:159], v[56:59], v[148:151]
  s_waitcnt lgkmcnt(8)
  ds_read_b64_tr_b16 a[152:153], v182 offset:28672
  v_mfma_f32_16x16x32_bf16 v[156:159], a[156:159], v[60:63], v[156:159]
  ds_read_b64_tr_b16 a[154:155], v182 offset:30720
  v_mfma_f32_16x16x32_bf16 v[144:147], a[128:131], v[64:67], v[144:147]
  ds_read_b64_tr_b16 a[156:157], v183 offset:28672
  ds_read_b64_tr_b16 a[158:159], v183 offset:30720
  v_mfma_f32_16x16x32_bf16 v[152:155], a[128:131], v[68:71], v[152:155]
  s_lshl_b32 s63, s33, 9
  s_add_u32 s63, s63, 121724928
  v_mfma_f32_16x16x32_bf16 v[148:151], a[132:135], v[64:67], v[148:151]
  s_waitcnt lgkmcnt(8)
  v_cvt_pk_bf16_f32 v161, v130, v131
  v_mfma_f32_16x16x32_bf16 v[156:159], a[132:135], v[68:71], v[156:159]
  ds_read_b64_tr_b16 a[128:129], v106 offset:0
  ds_read_b64_tr_b16 a[130:131], v106 offset:2048
  v_mfma_f32_16x16x32_bf16 v[144:147], a[136:139], v[72:75], v[144:147]
  ds_read_b64_tr_b16 a[132:133], v107 offset:0
  v_mfma_f32_16x16x32_bf16 v[152:155], a[136:139], v[76:79], v[152:155]
  ds_read_b64_tr_b16 a[134:135], v107 offset:2048
  v_mfma_f32_16x16x32_bf16 v[148:151], a[140:143], v[72:75], v[148:151]
  s_waitcnt lgkmcnt(8)
  v_cvt_pk_bf16_f32 v162, v132, v133
  v_mfma_f32_16x16x32_bf16 v[156:159], a[140:143], v[76:79], v[156:159]
  ds_read_b64_tr_b16 a[136:137], v106 offset:4096
  ds_read_b64_tr_b16 a[138:139], v106 offset:6144
  v_mfma_f32_16x16x32_bf16 v[144:147], a[144:147], v[80:83], v[144:147]
  ds_read_b64_tr_b16 a[140:141], v107 offset:4096
  v_cvt_pk_bf16_f32 v163, v134, v135
  v_mfma_f32_16x16x32_bf16 v[152:155], a[144:147], v[84:87], v[152:155]
  ds_read_b64_tr_b16 a[142:143], v107 offset:6144
  v_mfma_f32_16x16x32_bf16 v[148:151], a[148:151], v[80:83], v[148:151]
  s_waitcnt lgkmcnt(8)
  ds_read_b64_tr_b16 a[144:145], v106 offset:8192
  v_mfma_f32_16x16x32_bf16 v[156:159], a[148:151], v[84:87], v[156:159]
  ds_read_b64_tr_b16 a[146:147], v106 offset:10240
  v_mfma_f32_16x16x32_bf16 v[144:147], a[152:155], v[88:91], v[144:147]
  ds_read_b64_tr_b16 a[148:149], v107 offset:8192
  v_cvt_pk_bf16_f32 v164, v136, v137
  v_mfma_f32_16x16x32_bf16 v[152:155], a[152:155], v[92:95], v[152:155]
  ds_read_b64_tr_b16 a[150:151], v107 offset:10240
  v_mfma_f32_16x16x32_bf16 v[148:151], a[156:159], v[88:91], v[148:151]
  s_waitcnt lgkmcnt(8)
  v_cvt_pk_bf16_f32 v165, v138, v139
  v_mfma_f32_16x16x32_bf16 v[156:159], a[156:159], v[92:95], v[156:159]
  ds_read_b64_tr_b16 a[152:153], v106 offset:12288
  v_mfma_f32_16x16x32_bf16 v[144:147], a[128:131], a[192:195], v[144:147]
  v_cvt_pk_bf16_f32 v166, v140, v141
  v_cvt_pk_bf16_f32 v167, v142, v143
  v_mfma_f32_16x16x32_bf16 v[152:155], a[128:131], a[196:199], v[152:155]
  ds_read_b64_tr_b16 a[156:157], v107 offset:12288
  v_mfma_f32_16x16x32_bf16 v[148:151], a[132:135], a[192:195], v[148:151]
  s_waitcnt vmcnt(8)
  s_barrier
  v_mfma_f32_16x16x32_bf16 v[156:159], a[132:135], a[196:199], v[156:159]
  s_waitcnt lgkmcnt(6)
  ds_read_b64_tr_b16 a[128:129], v104 offset:32768
  ds_read_b64_tr_b16 a[130:131], v104 offset:34816
  s_cmp_eq_u32 s3, 0
  s_cbranch_scc1 M_SYA
M_SYA_RET:
  v_mfma_f32_16x16x32_bf16 v[144:147], a[136:139], a[200:203], v[144:147]
  ds_read_b64_tr_b16 a[132:133], v105 offset:32768
  v_mfma_f32_16x16x32_bf16 v[152:155], a[136:139], a[204:207], v[152:155]
  ds_read_b64_tr_b16 a[134:135], v105 offset:34816
  v_mfma_f32_16x16x32_bf16 v[148:151], a[140:143], a[200:203], v[148:151]
  s_waitcnt lgkmcnt(6)
  ds_read_b64_tr_b16 a[136:137], v104 offset:36864
  v_mfma_f32_16x16x32_bf16 v[156:159], a[140:143], a[204:207], v[156:159]
  ds_read_b64_tr_b16 a[138:139], v104 offset:38912
  buffer_store_dwordx4 v[160:163], v1, s[16:19], s62 offen offset:0 sc1
  v_mfma_f32_16x16x32_bf16 v[144:147], a[144:147], a[208:211], v[144:147]
  ds_read_b64_tr_b16 a[140:141], v105 offset:36864
  ds_read_b64_tr_b16 a[142:143], v105 offset:38912
  v_mfma_f32_16x16x32_bf16 v[152:155], a[144:147], a[212:215], v[152:155]
  buffer_store_dwordx4 v[164:167], v1, s[16:19], s62 offen offset:1024 sc1
  v_mfma_f32_16x16x32_bf16 v[148:151], a[148:151], a[208:211], v[148:151]
  s_waitcnt lgkmcnt(8)
  ds_read_b64_tr_b16 a[144:145], v104 offset:40960
  v_mfma_f32_16x16x32_bf16 v[156:159], a[148:151], a[212:215], v[156:159]
  ds_read_b64_tr_b16 a[146:147], v104 offset:43008
  v_mfma_f32_16x16x16_bf16 v[144:147], a[152:153], a[216:217], v[144:147]
  ds_read_b64_tr_b16 a[148:149], v105 offset:40960
  v_mfma_f32_16x16x16_bf16 v[152:155], a[152:153], a[220:221], v[152:155]
  ds_read_b64_tr_b16 a[150:151], v105 offset:43008
  v_mfma_f32_16x16x16_bf16 v[148:151], a[156:157], a[216:217], v[148:151]
  s_waitcnt lgkmcnt(8)
  ds_read_b64_tr_b16 a[152:153], v104 offset:45056
  v_mfma_f32_16x16x16_bf16 v[156:159], a[156:157], a[220:221], v[156:159]
  ds_read_b64_tr_b16 a[154:155], v104 offset:47104
  v_mfma_f32_16x16x32_bf16 v[128:131], a[128:131], v[32:35], 0
  ds_read_b64_tr_b16 a[156:157], v105 offset:45056
  v_mfma_f32_16x16x32_bf16 v[136:139], a[128:131], v[36:39], 0
  ds_read_b64_tr_b16 a[158:159], v105 offset:47104
  v_mfma_f32_16x16x32_bf16 v[132:135], a[132:135], v[32:35], 0
  s_waitcnt lgkmcnt(8)
  ds_read_b64_tr_b16 a[128:129], v104 offset:49152
  v_mfma_f32_16x16x32_bf16 v[140:143], a[132:135], v[36:39], 0
  ds_read_b64_tr_b16 a[130:131], v104 offset:51200
  v_mfma_f32_16x16x32_bf16 v[128:131], a[136:139], v[40:43], v[128:131]
  ds_read_b64_tr_b16 a[132:133], v105 offset:49152
  v_mfma_f32_16x16x32_bf16 v[136:139], a[136:139], v[44:47], v[136:139]
  ds_read_b64_tr_b16 a[134:135], v105 offset:51200
  v_mfma_f32_16x16x32_bf16 v[132:135], a[140:143], v[40:43], v[132:135]
  s_waitcnt lgkmcnt(8)
  ds_read_b64_tr_b16 a[136:137], v104 offset:53248
  v_mfma_f32_16x16x32_bf16 v[140:143], a[140:143], v[44:47], v[140:143]
  ds_read_b64_tr_b16 a[138:139], v104 offset:55296
  v_mfma_f32_16x16x32_bf16 v[128:131], a[144:147], v[48:51], v[128:131]
  ds_read_b64_tr_b16 a[140:141], v105 offset:53248
  v_mfma_f32_16x16x32_bf16 v[136:139], a[144:147], v[52:55], v[136:139]
  ds_read_b64_tr_b16 a[142:143], v105 offset:55296
  v_mfma_f32_16x16x32_bf16 v[132:135], a[148:151], v[48:51], v[132:135]
  s_waitcnt lgkmcnt(8)
  v_cvt_pk_bf16_f32 v168, v144, v145
  v_mfma_f32_16x16x32_bf16 v[140:143], a[148:151], v[52:55], v[140:143]
  ds_read_b64_tr_b16 a[144:145], v104 offset:57344
  ds_read_b64_tr_b16 a[146:147], v104 offset:59392
  v_mfma_f32_16x16x32_bf16 v[128:131], a[152:155], v[56:59], v[128:131]
  ds_read_b64_tr_b16 a[148:149], v105 offset:57344
  v_mfma_f32_16x16x32_bf16 v[136:139], a[152:155], v[60:63], v[136:139]
  ds_read_b64_tr_b16 a[150:151], v105 offset:59392
  v_mfma_f32_16x16x32_bf16 v[132:135], a[156:159], v[56:59], v[132:135]
  s_waitcnt lgkmcnt(8)
  ds_read_b64_tr_b16 a[152:153], v104 offset:61440
  v_mfma_f32_16x16x32_bf16 v[140:143], a[156:159], v[60:63], v[140:143]
  ds_read_b64_tr_b16 a[154:155], v104 offset:63488
  v_mfma_f32_16x16x32_bf16 v[128:131], a[128:131], v[64:67], v[128:131]
  ds_read_b64_tr_b16 a[156:157], v105 offset:61440
  v_cvt_pk_bf16_f32 v169, v146, v147
  v_mfma_f32_16x16x32_bf16 v[136:139], a[128:131], v[68:71], v[136:139]
  ds_read_b64_tr_b16 a[158:159], v105 offset:63488
  v_mfma_f32_16x16x32_bf16 v[132:135], a[132:135], v[64:67], v[132:135]
  s_waitcnt lgkmcnt(8)
  ds_read_b64_tr_b16 a[128:129], v176 offset:0
  v_mfma_f32_16x16x32_bf16 v[140:143], a[132:135], v[68:71], v[140:143]
  ds_read_b64_tr_b16 a[130:131], v176 offset:2048
  v_mfma_f32_16x16x32_bf16 v[128:131], a[136:139], v[72:75], v[128:131]
  ds_read_b64_tr_b16 a[132:133], v177 offset:0
  v_cvt_pk_bf16_f32 v170, v148, v149
  v_mfma_f32_16x16x32_bf16 v[136:139], a[136:139], v[76:79], v[136:139]
  ds_read_b64_tr_b16 a[134:135], v177 offset:2048
  v_mfma_f32_16x16x32_bf16 v[132:135], a[140:143], v[72:75], v[132:135]
  s_waitcnt lgkmcnt(8)
  ds_read_b64_tr_b16 a[136:137], v176 offset:4096
  v_mfma_f32_16x16x32_bf16 v[140:143], a[140:143], v[76:79], v[140:143]
  ds_read_b64_tr_b16 a[138:139], v176 offset:6144
  v_mfma_f32_16x16x32_bf16 v[128:131], a[144:147], v[80:83], v[128:131]
  ds_read_b64_tr_b16 a[140:141], v177 offset:4096
  v_mfma_f32_16x16x32_bf16 v[136:139], a[144:147], v[84:87], v[136:139]
  ds_read_b64_tr_b16 a[142:143], v177 offset:6144
  v_mfma_f32_16x16x32_bf16 v[132:135], a[148:151], v[80:83], v[132:135]
  s_waitcnt lgkmcnt(8)
  ds_read_b64_tr_b16 a[144:145], v176 offset:8192
  v_mfma_f32_16x16x32_bf16 v[140:143], a[148:151], v[84:87], v[140:143]
  ds_read_b64_tr_b16 a[146:147], v176 offset:10240
  v_mfma_f32_16x16x32_bf16 v[128:131], a[152:155], v[88:91], v[128:131]
  ds_read_b64_tr_b16 a[148:149], v177 offset:8192
  v_cvt_pk_bf16_f32 v171, v150, v151
  v_mfma_f32_16x16x32_bf16 v[136:139], a[152:155], v[92:95], v[136:139]
  ds_read_b64_tr_b16 a[150:151], v177 offset:10240
  v_mfma_f32_16x16x32_bf16 v[132:135], a[156:159], v[88:91], v[132:135]
  s_waitcnt lgkmcnt(8)
  v_cvt_pk_bf16_f32 v172, v152, v153
  v_mfma_f32_16x16x32_bf16 v[140:143], a[156:159], v[92:95], v[140:143]
  ds_read_b64_tr_b16 a[152:153], v176 offset:12288
  v_mfma_f32_16x16x32_bf16 v[128:131], a[128:131], a[192:195], v[128:131]
  v_cvt_pk_bf16_f32 v173, v154, v155
  v_cvt_pk_bf16_f32 v174, v156, v157
  v_mfma_f32_16x16x32_bf16 v[136:139], a[128:131], a[196:199], v[136:139]
  ds_read_b64_tr_b16 a[156:157], v177 offset:12288
  v_mfma_f32_16x16x32_bf16 v[132:135], a[132:135], a[192:195], v[132:135]
  s_waitcnt lgkmcnt(6)
  ds_read_b64_tr_b16 a[128:129], v106 offset:32768
  v_mfma_f32_16x16x32_bf16 v[140:143], a[132:135], a[196:199], v[140:143]
  ds_read_b64_tr_b16 a[130:131], v106 offset:34816
  v_mfma_f32_16x16x32_bf16 v[128:131], a[136:139], a[200:203], v[128:131]
  ds_read_b64_tr_b16 a[132:133], v107 offset:32768
  v_mfma_f32_16x16x32_bf16 v[136:139], a[136:139], a[204:207], v[136:139]
  ds_read_b64_tr_b16 a[134:135], v107 offset:34816
  v_mfma_f32_16x16x32_bf16 v[132:135], a[140:143], a[200:203], v[132:135]
  s_waitcnt lgkmcnt(6)
  v_cvt_pk_bf16_f32 v175, v158, v159
  v_mfma_f32_16x16x32_bf16 v[140:143], a[140:143], a[204:207], v[140:143]
  ds_read_b64_tr_b16 a[136:137], v106 offset:36864
  ds_read_b64_tr_b16 a[138:139], v106 offset:38912
  v_mfma_f32_16x16x32_bf16 v[128:131], a[144:147], a[208:211], v[128:131]
  ds_read_b64_tr_b16 a[140:141], v107 offset:36864
  v_mfma_f32_16x16x32_bf16 v[136:139], a[144:147], a[212:215], v[136:139]
  ds_read_b64_tr_b16 a[142:143], v107 offset:38912
  v_mfma_f32_16x16x32_bf16 v[132:135], a[148:151], a[208:211], v[132:135]
  s_waitcnt lgkmcnt(8)
  ds_read_b64_tr_b16 a[144:145], v106 offset:40960
  v_mfma_f32_16x16x32_bf16 v[140:143], a[148:151], a[212:215], v[140:143]
  ds_read_b64_tr_b16 a[146:147], v106 offset:43008
  v_mfma_f32_16x16x16_bf16 v[128:131], a[152:153], a[216:217], v[128:131]
  ds_read_b64_tr_b16 a[148:149], v107 offset:40960
  ds_read_b64_tr_b16 a[150:151], v107 offset:43008
  v_mfma_f32_16x16x16_bf16 v[136:139], a[152:153], a[220:221], v[136:139]
  buffer_load_dwordx2 v[10:11], v5, s[16:19], s63 offen sc1
  v_mfma_f32_16x16x16_bf16 v[132:135], a[156:157], a[216:217], v[132:135]
  s_waitcnt lgkmcnt(8)
  ds_read_b64_tr_b16 a[152:153], v106 offset:45056
  v_mfma_f32_16x16x16_bf16 v[140:143], a[156:157], a[220:221], v[140:143]
  ds_read_b64_tr_b16 a[154:155], v106 offset:47104
  v_mfma_f32_16x16x32_bf16 v[144:147], a[128:131], v[32:35], 0
  ds_read_b64_tr_b16 a[156:157], v107 offset:45056
  v_mfma_f32_16x16x32_bf16 v[152:155], a[128:131], v[36:39], 0
  ds_read_b64_tr_b16 a[158:159], v107 offset:47104
  v_mfma_f32_16x16x32_bf16 v[148:151], a[132:135], v[32:35], 0
  s_waitcnt lgkmcnt(8)
  ds_read_b64_tr_b16 a[128:129], v106 offset:49152
  v_mfma_f32_16x16x32_bf16 v[156:159], a[132:135], v[36:39], 0
  ds_read_b64_tr_b16 a[130:131], v106 offset:51200
  buffer_store_dwordx4 v[168:171], v1, s[16:19], s62 offen offset:2048 sc1
  v_mfma_f32_16x16x32_bf16 v[144:147], a[136:139], v[40:43], v[144:147]
  ds_read_b64_tr_b16 a[132:133], v107 offset:49152
  ds_read_b64_tr_b16 a[134:135], v107 offset:51200
  v_mfma_f32_16x16x32_bf16 v[152:155], a[136:139], v[44:47], v[152:155]
  buffer_store_dwordx4 v[172:175], v1, s[16:19], s62 offen offset:3072 sc1
  s_add_u32 s62, s62, 4096
  v_mfma_f32_16x16x32_bf16 v[148:151], a[140:143], v[40:43], v[148:151]
  s_waitcnt lgkmcnt(8)
  ds_read_b64_tr_b16 a[136:137], v106 offset:53248
  v_mfma_f32_16x16x32_bf16 v[156:159], a[140:143], v[44:47], v[156:159]
  ds_read_b64_tr_b16 a[138:139], v106 offset:55296
  v_mfma_f32_16x16x32_bf16 v[144:147], a[144:147], v[48:51], v[144:147]
  ds_read_b64_tr_b16 a[140:141], v107 offset:53248
  v_mfma_f32_16x16x32_bf16 v[152:155], a[144:147], v[52:55], v[152:155]
  ds_read_b64_tr_b16 a[142:143], v107 offset:55296
  v_mfma_f32_16x16x32_bf16 v[148:151], a[148:151], v[48:51], v[148:151]
  s_waitcnt lgkmcnt(8)
  ds_read_b64_tr_b16 a[144:145], v106 offset:57344
  v_mfma_f32_16x16x32_bf16 v[156:159], a[148:151], v[52:55], v[156:159]
  ds_read_b64_tr_b16 a[146:147], v106 offset:59392
  v_mfma_f32_16x16x32_bf16 v[144:147], a[152:155], v[56:59], v[144:147]
  ds_read_b64_tr_b16 a[148:149], v107 offset:57344
  v_mfma_f32_16x16x32_bf16 v[152:155], a[152:155], v[60:63], v[152:155]
  ds_read_b64_tr_b16 a[150:151], v107 offset:59392
  v_mfma_f32_16x16x32_bf16 v[148:151], a[156:159], v[56:59], v[148:151]
  s_waitcnt lgkmcnt(8)
  ds_read_b64_tr_b16 a[152:153], v106 offset:61440
  v_mfma_f32_16x16x32_bf16 v[156:159], a[156:159], v[60:63], v[156:159]
  ds_read_b64_tr_b16 a[154:155], v106 offset:63488
  v_mfma_f32_16x16x32_bf16 v[144:147], a[128:131], v[64:67], v[144:147]
  ds_read_b64_tr_b16 a[156:157], v107 offset:61440
  v_mfma_f32_16x16x32_bf16 v[152:155], a[128:131], v[68:71], v[152:155]
  ds_read_b64_tr_b16 a[158:159], v107 offset:63488
  v_mfma_f32_16x16x32_bf16 v[148:151], a[132:135], v[64:67], v[148:151]
  s_waitcnt lgkmcnt(8)
  ds_read_b64_tr_b16 a[128:129], v178 offset:0
  v_mfma_f32_16x16x32_bf16 v[156:159], a[132:135], v[68:71], v[156:159]
  ds_read_b64_tr_b16 a[130:131], v178 offset:2048
  v_mfma_f32_16x16x32_bf16 v[144:147], a[136:139], v[72:75], v[144:147]
  ds_read_b64_tr_b16 a[132:133], v179 offset:0
  v_mfma_f32_16x16x32_bf16 v[152:155], a[136:139], v[76:79], v[152:155]
  ds_read_b64_tr_b16 a[134:135], v179 offset:2048
  v_mfma_f32_16x16x32_bf16 v[148:151], a[140:143], v[72:75], v[148:151]
  s_waitcnt lgkmcnt(8)
  ds_read_b64_tr_b16 a[136:137], v178 offset:4096
  v_mfma_f32_16x16x32_bf16 v[156:159], a[140:143], v[76:79], v[156:159]
  ds_read_b64_tr_b16 a[138:139], v178 offset:6144
  v_mfma_f32_16x16x32_bf16 v[144:147], a[144:147], v[80:83], v[144:147]
  ds_read_b64_tr_b16 a[140:141], v179 offset:4096
  v_mfma_f32_16x16x32_bf16 v[152:155], a[144:147], v[84:87], v[152:155]
  ds_read_b64_tr_b16 a[142:143], v179 offset:6144
  v_mfma_f32_16x16x32_bf16 v[148:151], a[148:151], v[80:83], v[148:151]
  s_waitcnt lgkmcnt(8)
  ds_read_b64_tr_b16 a[144:145], v178 offset:8192
  v_mfma_f32_16x16x32_bf16 v[156:159], a[148:151], v[84:87], v[156:159]
  ds_read_b64_tr_b16 a[146:147], v178 offset:10240
  v_mfma_f32_16x16x32_bf16 v[144:147], a[152:155], v[88:91], v[144:147]
  ds_read_b64_tr_b16 a[148:149], v179 offset:8192
  v_mfma_f32_16x16x32_bf16 v[152:155], a[152:155], v[92:95], v[152:155]
  ds_read_b64_tr_b16 a[150:151], v179 offset:10240
  v_mfma_f32_16x16x32_bf16 v[148:151], a[156:159], v[88:91], v[148:151]
  s_waitcnt lgkmcnt(8)
  v_cvt_pk_bf16_f32 v160, v128, v129
  v_mfma_f32_16x16x32_bf16 v[156:159], a[156:159], v[92:95], v[156:159]
  ds_read_b64_tr_b16 a[152:153], v178 offset:12288
  v_mfma_f32_16x16x32_bf16 v[144:147], a[128:131], a[192:195], v[144:147]
  ds_read_b64_tr_b16 a[156:157], v179 offset:12288
  v_mfma_f32_16x16x32_bf16 v[152:155], a[128:131], a[196:199], v[152:155]
  v_mfma_f32_16x16x32_bf16 v[148:151], a[132:135], a[192:195], v[148:151]
  s_waitcnt lgkmcnt(6)
  v_cvt_pk_bf16_f32 v162, v132, v133
  v_mfma_f32_16x16x32_bf16 v[156:159], a[132:135], a[196:199], v[156:159]
  v_cvt_pk_bf16_f32 v161, v130, v131
  v_mfma_f32_16x16x32_bf16 v[144:147], a[136:139], a[200:203], v[144:147]
  v_cvt_pk_bf16_f32 v164, v136, v137
  v_mfma_f32_16x16x32_bf16 v[152:155], a[136:139], a[204:207], v[152:155]
  v_cvt_pk_bf16_f32 v163, v134, v135
  v_mfma_f32_16x16x32_bf16 v[148:151], a[140:143], a[200:203], v[148:151]
  s_waitcnt lgkmcnt(2)
  v_cvt_pk_bf16_f32 v166, v140, v141
  v_mfma_f32_16x16x32_bf16 v[156:159], a[140:143], a[204:207], v[156:159]
  v_cvt_pk_bf16_f32 v165, v138, v139
  v_mfma_f32_16x16x32_bf16 v[144:147], a[144:147], a[208:211], v[144:147]
  v_cvt_pk_bf16_f32 v167, v142, v143
  v_mfma_f32_16x16x32_bf16 v[152:155], a[144:147], a[212:215], v[152:155]
  v_mfma_f32_16x16x32_bf16 v[148:151], a[148:151], a[208:211], v[148:151]
  s_waitcnt lgkmcnt(0)
  buffer_store_dwordx4 v[160:163], v1, s[16:19], s62 offen offset:0 sc1
  v_mfma_f32_16x16x32_bf16 v[156:159], a[148:151], a[212:215], v[156:159]
  buffer_store_dwordx4 v[164:167], v1, s[16:19], s62 offen offset:1024 sc1
  v_mfma_f32_16x16x16_bf16 v[144:147], a[152:153], a[216:217], v[144:147]
  v_mfma_f32_16x16x16_bf16 v[152:155], a[152:153], a[220:221], v[152:155]
  v_mfma_f32_16x16x16_bf16 v[148:151], a[156:157], a[216:217], v[148:151]
  s_nop 1
  v_mfma_f32_16x16x16_bf16 v[156:159], a[156:157], a[220:221], v[156:159]
  s_nop 7
  v_cvt_pk_bf16_f32 v168, v144, v145
  v_cvt_pk_bf16_f32 v169, v146, v147
  v_cvt_pk_bf16_f32 v170, v148, v149
  v_cvt_pk_bf16_f32 v171, v150, v151
  v_cvt_pk_bf16_f32 v172, v152, v153
  v_cvt_pk_bf16_f32 v173, v154, v155
  v_cvt_pk_bf16_f32 v174, v156, v157
  v_cvt_pk_bf16_f32 v175, v158, v159
  buffer_store_dwordx4 v[168:171], v1, s[16:19], s62 offen offset:2048 sc1
  buffer_store_dwordx4 v[172:175], v1, s[16:19], s62 offen offset:3072 sc1
  s_waitcnt vmcnt(6)
  v_cmp_eq_u32 vcc, s86, v10
  v_cmp_eq_u32 s[4:5], s87, v11
  s_nop 0
  s_and_b64 vcc, vcc, s[4:5]
  s_cmp_eq_u64 vcc, exec
  s_cselect_b32 s60, 1, 0
  s_cbranch_scc0 M_NOA
  buffer_load_dwordx4 v[184:187], v1, s[16:19], s53 offen sc1
  s_add_u32 s53, s53, 1835008
  buffer_load_dwordx4 v[188:191], v1, s[16:19], s53 offen sc1
  s_add_u32 s53, s53, 1835008
  buffer_load_dwordx4 v[192:195], v1, s[16:19], s53 offen sc1
  s_add_u32 s53, s53, 1835008
  buffer_load_dwordx4 v[196:199], v1, s[16:19], s53 offen sc1
  s_add_u32 s53, s53, 1835008
  buffer_load_dwordx4 v[200:203], v1, s[16:19], s53 offen sc1
  s_add_u32 s53, s53, 1835008
  buffer_load_dwordx4 v[204:207], v1, s[16:19], s53 offen sc1
  s_add_u32 s53, s53, 1835008
  buffer_load_dwordx4 v[208:211], v1, s[16:19], s53 offen sc1
  s_add_u32 s53, s53, 1835008
  buffer_load_dwordx4 v[212:215], v1, s[16:19], s53 offen sc1
  s_add_u32 s53, s53, 1835008
  buffer_load_dwordx4 v[216:219], v1, s[16:19], s53 offen sc1
  s_add_u32 s53, s53, 1835008
  buffer_load_dwordx4 v[220:223], v1, s[16:19], s53 offen sc1
  s_add_u32 s53, s53, 1835008
  buffer_load_dwordx4 v[224:227], v1, s[16:19], s53 offen sc1
  s_add_u32 s53, s53, 1835008
  buffer_load_dwordx4 v[228:231], v1, s[16:19], s53 offen sc1
  s_add_u32 s53, s53, 1835008
  buffer_load_dwordx4 v[232:235], v1, s[16:19], s53 offen sc1
  s_add_u32 s53, s53, 1835008
  buffer_load_dwordx4 v[236:239], v1, s[16:19], s53 offen sc1
  s_add_u32 s53, s53, 1835008
  buffer_load_dwordx4 v[240:243], v1, s[16:19], s53 offen sc1
  s_add_u32 s53, s53, 1835008
  buffer_load_dwordx4 v[244:247], v1, s[16:19], s53 offen sc1
  s_waitcnt vmcnt(16)
  s_branch M_A1
M_NOA:
  s_waitcnt vmcnt(0)
M_A1:
  s_barrier
  s_cmp_lg_u32 s3, 3
  s_cbranch_scc1 M_PA_OK
  s_lshl_b32 s6, s32, 3
  v_mov_b32 v20, s86
  v_mov_b32 v21, s87
  v_mov_b32 v22, s6
  s_mov_b64 exec, 1
  buffer_store_dwordx2 v[20:21], v22, s[16:19], s55 offen sc1
  s_mov_b64 exec, -1
  s_cmp_eq_u32 s60, 1
  s_cbranch_scc1 M_PA_OK
  s_mov_b32 s6, 0
M_PA:
  buffer_load_dwordx2 v[10:11], v5, s[16:19], s63 offen sc1
  s_waitcnt vmcnt(0)
  v_cmp_eq_u32 vcc, s86, v10
  v_cmp_eq_u32 s[4:5], s87, v11
  s_nop 0
  s_and_b64 vcc, vcc, s[4:5]
  s_cmp_eq_u64 vcc, exec
  s_cbranch_scc1 M_PA_OK
  s_sleep 2
  s_add_u32 s6, s6, 1
  s_cmp_lt_u32 s6, 200000
  s_cbranch_scc1 M_PA
  s_waitcnt vmcnt(0)
M_PA_OK:
  s_barrier
  s_cmp_eq_u32 s60, 1
  s_cbranch_scc1 M_A2
  buffer_load_dwordx4 v[184:187], v1, s[16:19], s53 offen sc1
  s_add_u32 s53, s53, 1835008
  buffer_load_dwordx4 v[188:191], v1, s[16:19], s53 offen sc1
  s_add_u32 s53, s53, 1835008
  buffer_load_dwordx4 v[192:195], v1, s[16:19], s53 offen sc1
  s_add_u32 s53, s53, 1835008
  buffer_load_dwordx4 v[196:199], v1, s[16:19], s53 offen sc1
  s_add_u32 s53, s53, 1835008
  buffer_load_dwordx4 v[200:203], v1, s[16:19], s53 offen sc1
  s_add_u32 s53, s53, 1835008
  buffer_load_dwordx4 v[204:207], v1, s[16:19], s53 offen sc1
  s_add_u32 s53, s53, 1835008
  buffer_load_dwordx4 v[208:211], v1, s[16:19], s53 offen sc1
  s_add_u32 s53, s53, 1835008
  buffer_load_dwordx4 v[212:215], v1, s[16:19], s53 offen sc1
  s_add_u32 s53, s53, 1835008
  buffer_load_dwordx4 v[216:219], v1, s[16:19], s53 offen sc1
  s_add_u32 s53, s53, 1835008
  buffer_load_dwordx4 v[220:223], v1, s[16:19], s53 offen sc1
  s_add_u32 s53, s53, 1835008
  buffer_load_dwordx4 v[224:227], v1, s[16:19], s53 offen sc1
  s_add_u32 s53, s53, 1835008
  buffer_load_dwordx4 v[228:231], v1, s[16:19], s53 offen sc1
  s_add_u32 s53, s53, 1835008
  buffer_load_dwordx4 v[232:235], v1, s[16:19], s53 offen sc1
  s_add_u32 s53, s53, 1835008
  buffer_load_dwordx4 v[236:239], v1, s[16:19], s53 offen sc1
  s_add_u32 s53, s53, 1835008
  buffer_load_dwordx4 v[240:243], v1, s[16:19], s53 offen sc1
  s_add_u32 s53, s53, 1835008
  buffer_load_dwordx4 v[244:247], v1, s[16:19], s53 offen sc1
M_A2:
  s_cmp_eq_u32 s3, 3
  s_cbranch_scc1 M_W3
  s_waitcnt vmcnt(0)
  v_lshlrev_b32 v20, 16, v12
  v_and_b32 v21, 0xffff0000, v12
  v_lshlrev_b32 v22, 16, v13
  v_and_b32 v23, 0xffff0000, v13
  v_lshlrev_b32 v24, 16, v14
  v_and_b32 v25, 0xffff0000, v14
  v_lshlrev_b32 v26, 16, v15
  v_and_b32 v27, 0xffff0000, v15
  v_lshlrev_b32 v28, 16, v184
  v_and_b32 v29, 0xffff0000, v184
  v_pk_add_f32 v[20:21], v[20:21], v[28:29]
  v_lshlrev_b32 v30, 16, v185
  v_and_b32 v31, 0xffff0000, v185
  v_pk_add_f32 v[22:23], v[22:23], v[30:31]
  v_lshlrev_b32 v28, 16, v186
  v_and_b32 v29, 0xffff0000, v186
  v_pk_add_f32 v[24:25], v[24:25], v[28:29]
  v_lshlrev_b32 v30, 16, v187
  v_and_b32 v31, 0xffff0000, v187
  v_pk_add_f32 v[26:27], v[26:27], v[30:31]
  v_lshlrev_b32 v28, 16, v188
  v_and_b32 v29, 0xffff0000, v188
  v_pk_add_f32 v[20:21], v[20:21], v[28:29]
  v_lshlrev_b32 v30, 16, v189
  v_and_b32 v31, 0xffff0000, v189
  v_pk_add_f32 v[22:23], v[22:23], v[30:31]
  v_lshlrev_b32 v28, 16, v190
  v_and_b32 v29, 0xffff0000, v190
  v_pk_add_f32 v[24:25], v[24:25], v[28:29]
  v_lshlrev_b32 v30, 16, v191
  v_and_b32 v31, 0xffff0000, v191
  v_pk_add_f32 v[26:27], v[26:27], v[30:31]
  v_lshlrev_b32 v28, 16, v192
  v_and_b32 v29, 0xffff0000, v192
  v_pk_add_f32 v[20:21], v[20:21], v[28:29]
  v_lshlrev_b32 v30, 16, v193
  v_and_b32 v31, 0xffff0000, v193
  v_pk_add_f32 v[22:23], v[22:23], v[30:31]
  v_lshlrev_b32 v28, 16, v194
  v_and_b32 v29, 0xffff0000, v194
  v_pk_add_f32 v[24:25], v[24:25], v[28:29]
  v_lshlrev_b32 v30, 16, v195
  v_and_b32 v31, 0xffff0000, v195
  v_pk_add_f32 v[26:27], v[26:27], v[30:31]
  v_lshlrev_b32 v28, 16, v196
  v_and_b32 v29, 0xffff0000, v196
  v_pk_add_f32 v[20:21], v[20:21], v[28:29]
  v_lshlrev_b32 v30, 16, v197
  v_and_b32 v31, 0xffff0000, v197
  v_pk_add_f32 v[22:23], v[22:23], v[30:31]
  v_lshlrev_b32 v28, 16, v198
  v_and_b32 v29, 0xffff0000, v198
  v_pk_add_f32 v[24:25], v[24:25], v[28:29]
  v_lshlrev_b32 v30, 16, v199
  v_and_b32 v31, 0xffff0000, v199
  v_pk_add_f32 v[26:27], v[26:27], v[30:31]
  v_lshlrev_b32 v28, 16, v200
  v_and_b32 v29, 0xffff0000, v200
  v_pk_add_f32 v[20:21], v[20:21], v[28:29]
  v_lshlrev_b32 v30, 16, v201
  v_and_b32 v31, 0xffff0000, v201
  v_pk_add_f32 v[22:23], v[22:23], v[30:31]
  v_lshlrev_b32 v28, 16, v202
  v_and_b32 v29, 0xffff0000, v202
  v_pk_add_f32 v[24:25], v[24:25], v[28:29]
  v_lshlrev_b32 v30, 16, v203
  v_and_b32 v31, 0xffff0000, v203
  v_pk_add_f32 v[26:27], v[26:27], v[30:31]
  v_lshlrev_b32 v28, 16, v204
  v_and_b32 v29, 0xffff0000, v204
  v_pk_add_f32 v[20:21], v[20:21], v[28:29]
  v_lshlrev_b32 v30, 16, v205
  v_and_b32 v31, 0xffff0000, v205
  v_pk_add_f32 v[22:23], v[22:23], v[30:31]
  v_lshlrev_b32 v28, 16, v206
  v_and_b32 v29, 0xffff0000, v206
  v_pk_add_f32 v[24:25], v[24:25], v[28:29]
  v_lshlrev_b32 v30, 16, v207
  v_and_b32 v31, 0xffff0000, v207
  v_pk_add_f32 v[26:27], v[26:27], v[30:31]
  v_lshlrev_b32 v28, 16, v208
  v_and_b32 v29, 0xffff0000, v208
  v_pk_add_f32 v[20:21], v[20:21], v[28:29]
  v_lshlrev_b32 v30, 16, v209
  v_and_b32 v31, 0xffff0000, v209
  v_pk_add_f32 v[22:23], v[22:23], v[30:31]
  v_lshlrev_b32 v28, 16, v210
  v_and_b32 v29, 0xffff0000, v210
  v_pk_add_f32 v[24:25], v[24:25], v[28:29]
  v_lshlrev_b32 v30, 16, v211
  v_and_b32 v31, 0xffff0000, v211
  v_pk_add_f32 v[26:27], v[26:27], v[30:31]
  v_lshlrev_b32 v28, 16, v212
  v_and_b32 v29, 0xffff0000, v212
  v_pk_add_f32 v[20:21], v[20:21], v[28:29]
  v_lshlrev_b32 v30, 16, v213
  v_and_b32 v31, 0xffff0000, v213
  v_pk_add_f32 v[22:23], v[22:23], v[30:31]
  v_lshlrev_b32 v28, 16, v214
  v_and_b32 v29, 0xffff0000, v214
  v_pk_add_f32 v[24:25], v[24:25], v[28:29]
  v_lshlrev_b32 v30, 16, v215
  v_and_b32 v31, 0xffff0000, v215
  v_pk_add_f32 v[26:27], v[26:27], v[30:31]
  v_lshlrev_b32 v28, 16, v216
  v_and_b32 v29, 0xffff0000, v216
  v_pk_add_f32 v[20:21], v[20:21], v[28:29]
  v_lshlrev_b32 v30, 16, v217
  v_and_b32 v31, 0xffff0000, v217
  v_pk_add_f32 v[22:23], v[22:23], v[30:31]
  v_lshlrev_b32 v28, 16, v218
  v_and_b32 v29, 0xffff0000, v218
  v_pk_add_f32 v[24:25], v[24:25], v[28:29]
  v_lshlrev_b32 v30, 16, v219
  v_and_b32 v31, 0xffff0000, v219
  v_pk_add_f32 v[26:27], v[26:27], v[30:31]
  v_lshlrev_b32 v28, 16, v220
  v_and_b32 v29, 0xffff0000, v220
  v_pk_add_f32 v[20:21], v[20:21], v[28:29]
  v_lshlrev_b32 v30, 16, v221
  v_and_b32 v31, 0xffff0000, v221
  v_pk_add_f32 v[22:23], v[22:23], v[30:31]
  v_lshlrev_b32 v28, 16, v222
  v_and_b32 v29, 0xffff0000, v222
  v_pk_add_f32 v[24:25], v[24:25], v[28:29]
  v_lshlrev_b32 v30, 16, v223
  v_and_b32 v31, 0xffff0000, v223
  v_pk_add_f32 v[26:27], v[26:27], v[30:31]
  v_lshlrev_b32 v28, 16, v224
  v_and_b32 v29, 0xffff0000, v224
  v_pk_add_f32 v[20:21], v[20:21], v[28:29]
  v_lshlrev_b32 v30, 16, v225
  v_and_b32 v31, 0xffff0000, v225
  v_pk_add_f32 v[22:23], v[22:23], v[30:31]
  v_lshlrev_b32 v28, 16, v226
  v_and_b32 v29, 0xffff0000, v226
  v_pk_add_f32 v[24:25], v[24:25], v[28:29]
  v_lshlrev_b32 v30, 16, v227
  v_and_b32 v31, 0xffff0000, v227
  v_pk_add_f32 v[26:27], v[26:27], v[30:31]
  v_lshlrev_b32 v28, 16, v228
  v_and_b32 v29, 0xffff0000, v228
  v_pk_add_f32 v[20:21], v[20:21], v[28:29]
  v_lshlrev_b32 v30, 16, v229
  v_and_b32 v31, 0xffff0000, v229
  v_pk_add_f32 v[22:23], v[22:23], v[30:31]
  v_lshlrev_b32 v28, 16, v230
  v_and_b32 v29, 0xffff0000, v230
  v_pk_add_f32 v[24:25], v[24:25], v[28:29]
  v_lshlrev_b32 v30, 16, v231
  v_and_b32 v31, 0xffff0000, v231
  v_pk_add_f32 v[26:27], v[26:27], v[30:31]
  v_lshlrev_b32 v28, 16, v232
  v_and_b32 v29, 0xffff0000, v232
  v_pk_add_f32 v[20:21], v[20:21], v[28:29]
  v_lshlrev_b32 v30, 16, v233
  v_and_b32 v31, 0xffff0000, v233
  v_pk_add_f32 v[22:23], v[22:23], v[30:31]
  v_lshlrev_b32 v28, 16, v234
  v_and_b32 v29, 0xffff0000, v234
  v_pk_add_f32 v[24:25], v[24:25], v[28:29]
  v_lshlrev_b32 v30, 16, v235
  v_and_b32 v31, 0xffff0000, v235
  v_pk_add_f32 v[26:27], v[26:27], v[30:31]
  v_lshlrev_b32 v28, 16, v236
  v_and_b32 v29, 0xffff0000, v236
  v_pk_add_f32 v[20:21], v[20:21], v[28:29]
  v_lshlrev_b32 v30, 16, v237
  v_and_b32 v31, 0xffff0000, v237
  v_pk_add_f32 v[22:23], v[22:23], v[30:31]
  v_lshlrev_b32 v28, 16, v238
  v_and_b32 v29, 0xffff0000, v238
  v_pk_add_f32 v[24:25], v[24:25], v[28:29]
  v_lshlrev_b32 v30, 16, v239
  v_and_b32 v31, 0xffff0000, v239
  v_pk_add_f32 v[26:27], v[26:27], v[30:31]
  v_lshlrev_b32 v28, 16, v240
  v_and_b32 v29, 0xffff0000, v240
  v_pk_add_f32 v[20:21], v[20:21], v[28:29]
  v_lshlrev_b32 v30, 16, v241
  v_and_b32 v31, 0xffff0000, v241
  v_pk_add_f32 v[22:23], v[22:23], v[30:31]
  v_lshlrev_b32 v28, 16, v242
  v_and_b32 v29, 0xffff0000, v242
  v_pk_add_f32 v[24:25], v[24:25], v[28:29]
  v_lshlrev_b32 v30, 16, v243
  v_and_b32 v31, 0xffff0000, v243
  v_pk_add_f32 v[26:27], v[26:27], v[30:31]
  v_lshlrev_b32 v28, 16, v244
  v_and_b32 v29, 0xffff0000, v244
  v_pk_add_f32 v[20:21], v[20:21], v[28:29]
  v_lshlrev_b32 v30, 16, v245
  v_and_b32 v31, 0xffff0000, v245
  v_pk_add_f32 v[22:23], v[22:23], v[30:31]
  v_lshlrev_b32 v28, 16, v246
  v_and_b32 v29, 0xffff0000, v246
  v_pk_add_f32 v[24:25], v[24:25], v[28:29]
  v_lshlrev_b32 v30, 16, v247
  v_and_b32 v31, 0xffff0000, v247
  v_pk_add_f32 v[26:27], v[26:27], v[30:31]
  v_cvt_pk_bf16_f32 v12, v20, v21
  v_cvt_pk_bf16_f32 v13, v22, v23
  v_cvt_pk_bf16_f32 v14, v24, v25
  v_cvt_pk_bf16_f32 v15, v26, v27
  buffer_store_dwordx2 v[12:13], v2, s[24:27], 0 offen offset:0
  buffer_store_dwordx2 v[14:15], v2, s[24:27], 0 offen offset:32
  s_barrier
  buffer_load_dwordx4 v[32:35], v1, s[16:19], s54 offen sc1
  s_add_u32 s54, s54, 1835008
  buffer_load_dwordx4 v[36:39], v1, s[16:19], s54 offen sc1
  s_add_u32 s54, s54, 1835008
  buffer_load_dwordx4 v[40:43], v1, s[16:19], s54 offen sc1
  s_add_u32 s54, s54, 1835008
  buffer_load_dwordx4 v[44:47], v1, s[16:19], s54 offen sc1
  s_add_u32 s54, s54, 1835008
  buffer_load_dwordx4 v[48:51], v1, s[16:19], s54 offen sc1
  s_add_u32 s54, s54, 1835008
  buffer_load_dwordx4 v[52:55], v1, s[16:19], s54 offen sc1
  s_add_u32 s54, s54, 1835008
  buffer_load_dwordx4 v[56:59], v1, s[16:19], s54 offen sc1
  s_add_u32 s54, s54, 1835008
  buffer_load_dwordx4 v[60:63], v1, s[16:19], s54 offen sc1
  s_add_u32 s54, s54, 1835008
  buffer_load_dwordx4 v[64:67], v1, s[16:19], s54 offen sc1
  s_add_u32 s54, s54, 1835008
  buffer_load_dwordx4 v[68:71], v1, s[16:19], s54 offen sc1
  s_add_u32 s54, s54, 1835008
  buffer_load_dwordx4 v[72:75], v1, s[16:19], s54 offen sc1
  s_add_u32 s54, s54, 1835008
  buffer_load_dwordx4 v[76:79], v1, s[16:19], s54 offen sc1
  s_add_u32 s54, s54, 1835008
  buffer_load_dwordx4 v[80:83], v1, s[16:19], s54 offen sc1
  s_add_u32 s54, s54, 1835008
  buffer_load_dwordx4 v[84:87], v1, s[16:19], s54 offen sc1
  s_add_u32 s54, s54, 1835008
  buffer_load_dwordx4 v[88:91], v1, s[16:19], s54 offen sc1
  s_add_u32 s54, s54, 1835008
  buffer_load_dwordx4 v[92:95], v1, s[16:19], s54 offen sc1
  v_lshlrev_b32 v20, 16, v16
  v_and_b32 v21, 0xffff0000, v16
  v_lshlrev_b32 v22, 16, v17
  v_and_b32 v23, 0xffff0000, v17
  v_lshlrev_b32 v24, 16, v18
  v_and_b32 v25, 0xffff0000, v18
  v_lshlrev_b32 v26, 16, v19
  v_and_b32 v27, 0xffff0000, v19
  s_waitcnt vmcnt(15)
  v_lshlrev_b32 v28, 16, v32
  v_and_b32 v29, 0xffff0000, v32
  v_pk_add_f32 v[20:21], v[20:21], v[28:29]
  v_lshlrev_b32 v30, 16, v33
  v_and_b32 v31, 0xffff0000, v33
  v_pk_add_f32 v[22:23], v[22:23], v[30:31]
  v_lshlrev_b32 v28, 16, v34
  v_and_b32 v29, 0xffff0000, v34
  v_pk_add_f32 v[24:25], v[24:25], v[28:29]
  v_lshlrev_b32 v30, 16, v35
  v_and_b32 v31, 0xffff0000, v35
  v_pk_add_f32 v[26:27], v[26:27], v[30:31]
  s_waitcnt vmcnt(14)
  v_lshlrev_b32 v28, 16, v36
  v_and_b32 v29, 0xffff0000, v36
  v_pk_add_f32 v[20:21], v[20:21], v[28:29]
  v_lshlrev_b32 v30, 16, v37
  v_and_b32 v31, 0xffff0000, v37
  v_pk_add_f32 v[22:23], v[22:23], v[30:31]
  v_lshlrev_b32 v28, 16, v38
  v_and_b32 v29, 0xffff0000, v38
  v_pk_add_f32 v[24:25], v[24:25], v[28:29]
  v_lshlrev_b32 v30, 16, v39
  v_and_b32 v31, 0xffff0000, v39
  v_pk_add_f32 v[26:27], v[26:27], v[30:31]
  s_waitcnt vmcnt(13)
  v_lshlrev_b32 v28, 16, v40
  v_and_b32 v29, 0xffff0000, v40
  v_pk_add_f32 v[20:21], v[20:21], v[28:29]
  v_lshlrev_b32 v30, 16, v41
  v_and_b32 v31, 0xffff0000, v41
  v_pk_add_f32 v[22:23], v[22:23], v[30:31]
  v_lshlrev_b32 v28, 16, v42
  v_and_b32 v29, 0xffff0000, v42
  v_pk_add_f32 v[24:25], v[24:25], v[28:29]
  v_lshlrev_b32 v30, 16, v43
  v_and_b32 v31, 0xffff0000, v43
  v_pk_add_f32 v[26:27], v[26:27], v[30:31]
  s_waitcnt vmcnt(12)
  v_lshlrev_b32 v28, 16, v44
  v_and_b32 v29, 0xffff0000, v44
  v_pk_add_f32 v[20:21], v[20:21], v[28:29]
  v_lshlrev_b32 v30, 16, v45
  v_and_b32 v31, 0xffff0000, v45
  v_pk_add_f32 v[22:23], v[22:23], v[30:31]
  v_lshlrev_b32 v28, 16, v46
  v_and_b32 v29, 0xffff0000, v46
  v_pk_add_f32 v[24:25], v[24:25], v[28:29]
  v_lshlrev_b32 v30, 16, v47
  v_and_b32 v31, 0xffff0000, v47
  v_pk_add_f32 v[26:27], v[26:27], v[30:31]
  s_waitcnt vmcnt(11)
  v_lshlrev_b32 v28, 16, v48
  v_and_b32 v29, 0xffff0000, v48
  v_pk_add_f32 v[20:21], v[20:21], v[28:29]
  v_lshlrev_b32 v30, 16, v49
  v_and_b32 v31, 0xffff0000, v49
  v_pk_add_f32 v[22:23], v[22:23], v[30:31]
  v_lshlrev_b32 v28, 16, v50
  v_and_b32 v29, 0xffff0000, v50
  v_pk_add_f32 v[24:25], v[24:25], v[28:29]
  v_lshlrev_b32 v30, 16, v51
  v_and_b32 v31, 0xffff0000, v51
  v_pk_add_f32 v[26:27], v[26:27], v[30:31]
  s_waitcnt vmcnt(10)
  v_lshlrev_b32 v28, 16, v52
  v_and_b32 v29, 0xffff0000, v52
  v_pk_add_f32 v[20:21], v[20:21], v[28:29]
  v_lshlrev_b32 v30, 16, v53
  v_and_b32 v31, 0xffff0000, v53
  v_pk_add_f32 v[22:23], v[22:23], v[30:31]
  v_lshlrev_b32 v28, 16, v54
  v_and_b32 v29, 0xffff0000, v54
  v_pk_add_f32 v[24:25], v[24:25], v[28:29]
  v_lshlrev_b32 v30, 16, v55
  v_and_b32 v31, 0xffff0000, v55
  v_pk_add_f32 v[26:27], v[26:27], v[30:31]
  s_waitcnt vmcnt(9)
  v_lshlrev_b32 v28, 16, v56
  v_and_b32 v29, 0xffff0000, v56
  v_pk_add_f32 v[20:21], v[20:21], v[28:29]
  v_lshlrev_b32 v30, 16, v57
  v_and_b32 v31, 0xffff0000, v57
  v_pk_add_f32 v[22:23], v[22:23], v[30:31]
  v_lshlrev_b32 v28, 16, v58
  v_and_b32 v29, 0xffff0000, v58
  v_pk_add_f32 v[24:25], v[24:25], v[28:29]
  v_lshlrev_b32 v30, 16, v59
  v_and_b32 v31, 0xffff0000, v59
  v_pk_add_f32 v[26:27], v[26:27], v[30:31]
  s_waitcnt vmcnt(8)
  v_lshlrev_b32 v28, 16, v60
  v_and_b32 v29, 0xffff0000, v60
  v_pk_add_f32 v[20:21], v[20:21], v[28:29]
  v_lshlrev_b32 v30, 16, v61
  v_and_b32 v31, 0xffff0000, v61
  v_pk_add_f32 v[22:23], v[22:23], v[30:31]
  v_lshlrev_b32 v28, 16, v62
  v_and_b32 v29, 0xffff0000, v62
  v_pk_add_f32 v[24:25], v[24:25], v[28:29]
  v_lshlrev_b32 v30, 16, v63
  v_and_b32 v31, 0xffff0000, v63
  v_pk_add_f32 v[26:27], v[26:27], v[30:31]
  s_waitcnt vmcnt(7)
  v_lshlrev_b32 v28, 16, v64
  v_and_b32 v29, 0xffff0000, v64
  v_pk_add_f32 v[20:21], v[20:21], v[28:29]
  v_lshlrev_b32 v30, 16, v65
  v_and_b32 v31, 0xffff0000, v65
  v_pk_add_f32 v[22:23], v[22:23], v[30:31]
  v_lshlrev_b32 v28, 16, v66
  v_and_b32 v29, 0xffff0000, v66
  v_pk_add_f32 v[24:25], v[24:25], v[28:29]
  v_lshlrev_b32 v30, 16, v67
  v_and_b32 v31, 0xffff0000, v67
  v_pk_add_f32 v[26:27], v[26:27], v[30:31]
  s_waitcnt vmcnt(6)
  v_lshlrev_b32 v28, 16, v68
  v_and_b32 v29, 0xffff0000, v68
  v_pk_add_f32 v[20:21], v[20:21], v[28:29]
  v_lshlrev_b32 v30, 16, v69
  v_and_b32 v31, 0xffff0000, v69
  v_pk_add_f32 v[22:23], v[22:23], v[30:31]
  v_lshlrev_b32 v28, 16, v70
  v_and_b32 v29, 0xffff0000, v70
  v_pk_add_f32 v[24:25], v[24:25], v[28:29]
  v_lshlrev_b32 v30, 16, v71
  v_and_b32 v31, 0xffff0000, v71
  v_pk_add_f32 v[26:27], v[26:27], v[30:31]
  s_waitcnt vmcnt(5)
  v_lshlrev_b32 v28, 16, v72
  v_and_b32 v29, 0xffff0000, v72
  v_pk_add_f32 v[20:21], v[20:21], v[28:29]
  v_lshlrev_b32 v30, 16, v73
  v_and_b32 v31, 0xffff0000, v73
  v_pk_add_f32 v[22:23], v[22:23], v[30:31]
  v_lshlrev_b32 v28, 16, v74
  v_and_b32 v29, 0xffff0000, v74
  v_pk_add_f32 v[24:25], v[24:25], v[28:29]
  v_lshlrev_b32 v30, 16, v75
  v_and_b32 v31, 0xffff0000, v75
  v_pk_add_f32 v[26:27], v[26:27], v[30:31]
  s_waitcnt vmcnt(4)
  v_lshlrev_b32 v28, 16, v76
  v_and_b32 v29, 0xffff0000, v76
  v_pk_add_f32 v[20:21], v[20:21], v[28:29]
  v_lshlrev_b32 v30, 16, v77
  v_and_b32 v31, 0xffff0000, v77
  v_pk_add_f32 v[22:23], v[22:23], v[30:31]
  v_lshlrev_b32 v28, 16, v78
  v_and_b32 v29, 0xffff0000, v78
  v_pk_add_f32 v[24:25], v[24:25], v[28:29]
  v_lshlrev_b32 v30, 16, v79
  v_and_b32 v31, 0xffff0000, v79
  v_pk_add_f32 v[26:27], v[26:27], v[30:31]
  s_waitcnt vmcnt(3)
  v_lshlrev_b32 v28, 16, v80
  v_and_b32 v29, 0xffff0000, v80
  v_pk_add_f32 v[20:21], v[20:21], v[28:29]
  v_lshlrev_b32 v30, 16, v81
  v_and_b32 v31, 0xffff0000, v81
  v_pk_add_f32 v[22:23], v[22:23], v[30:31]
  v_lshlrev_b32 v28, 16, v82
  v_and_b32 v29, 0xffff0000, v82
  v_pk_add_f32 v[24:25], v[24:25], v[28:29]
  v_lshlrev_b32 v30, 16, v83
  v_and_b32 v31, 0xffff0000, v83
  v_pk_add_f32 v[26:27], v[26:27], v[30:31]
  s_waitcnt vmcnt(2)
  v_lshlrev_b32 v28, 16, v84
  v_and_b32 v29, 0xffff0000, v84
  v_pk_add_f32 v[20:21], v[20:21], v[28:29]
  v_lshlrev_b32 v30, 16, v85
  v_and_b32 v31, 0xffff0000, v85
  v_pk_add_f32 v[22:23], v[22:23], v[30:31]
  v_lshlrev_b32 v28, 16, v86
  v_and_b32 v29, 0xffff0000, v86
  v_pk_add_f32 v[24:25], v[24:25], v[28:29]
  v_lshlrev_b32 v30, 16, v87
  v_and_b32 v31, 0xffff0000, v87
  v_pk_add_f32 v[26:27], v[26:27], v[30:31]
  s_waitcnt vmcnt(1)
  v_lshlrev_b32 v28, 16, v88
  v_and_b32 v29, 0xffff0000, v88
  v_pk_add_f32 v[20:21], v[20:21], v[28:29]
  v_lshlrev_b32 v30, 16, v89
  v_and_b32 v31, 0xffff0000, v89
  v_pk_add_f32 v[22:23], v[22:23], v[30:31]
  v_lshlrev_b32 v28, 16, v90
  v_and_b32 v29, 0xffff0000, v90
  v_pk_add_f32 v[24:25], v[24:25], v[28:29]
  v_lshlrev_b32 v30, 16, v91
  v_and_b32 v31, 0xffff0000, v91
  v_pk_add_f32 v[26:27], v[26:27], v[30:31]
  s_waitcnt vmcnt(0)
  v_lshlrev_b32 v28, 16, v92
  v_and_b32 v29, 0xffff0000, v92
  v_pk_add_f32 v[20:21], v[20:21], v[28:29]
  v_lshlrev_b32 v30, 16, v93
  v_and_b32 v31, 0xffff0000, v93
  v_pk_add_f32 v[22:23], v[22:23], v[30:31]
  v_lshlrev_b32 v28, 16, v94
  v_and_b32 v29, 0xffff0000, v94
  v_pk_add_f32 v[24:25], v[24:25], v[28:29]
  v_lshlrev_b32 v30, 16, v95
  v_and_b32 v31, 0xffff0000, v95
  v_pk_add_f32 v[26:27], v[26:27], v[30:31]
  v_cvt_pk_bf16_f32 v16, v20, v21
  v_cvt_pk_bf16_f32 v17, v22, v23
  v_cvt_pk_bf16_f32 v18, v24, v25
  v_cvt_pk_bf16_f32 v19, v26, v27
  buffer_store_dwordx2 v[16:17], v2, s[24:27], 0 offen offset:512
  buffer_store_dwordx2 v[18:19], v2, s[24:27], 0 offen offset:544
  s_branch M_DONE
M_W3:
  s_mov_b32 s6, 0
M_PB:
  buffer_load_dwordx2 v[10:11], v5, s[16:19], s55 offen sc1
  s_waitcnt vmcnt(0)
  v_cmp_eq_u32 vcc, s86, v10
  v_cmp_eq_u32 s[4:5], s87, v11
  s_nop 0
  s_and_b64 vcc, vcc, s[4:5]
  s_cmp_eq_u64 vcc, exec
  s_cbranch_scc1 M_PB_OK
  s_sleep 2
  s_add_u32 s6, s6, 1
  s_cmp_lt_u32 s6, 200000
  s_cbranch_scc1 M_PB
  s_waitcnt vmcnt(0)
M_PB_OK:
  s_barrier
  v_lshlrev_b32 v20, 16, v12
  v_and_b32 v21, 0xffff0000, v12
  v_lshlrev_b32 v22, 16, v13
  v_and_b32 v23, 0xffff0000, v13
  v_lshlrev_b32 v24, 16, v14
  v_and_b32 v25, 0xffff0000, v14
  v_lshlrev_b32 v26, 16, v15
  v_and_b32 v27, 0xffff0000, v15
  v_lshlrev_b32 v28, 16, v184
  v_and_b32 v29, 0xffff0000, v184
  v_pk_add_f32 v[20:21], v[20:21], v[28:29]
  v_lshlrev_b32 v30, 16, v185
  v_and_b32 v31, 0xffff0000, v185
  v_pk_add_f32 v[22:23], v[22:23], v[30:31]
  v_lshlrev_b32 v28, 16, v186
  v_and_b32 v29, 0xffff0000, v186
  v_pk_add_f32 v[24:25], v[24:25], v[28:29]
  v_lshlrev_b32 v30, 16, v187
  v_and_b32 v31, 0xffff0000, v187
  v_pk_add_f32 v[26:27], v[26:27], v[30:31]
  v_lshlrev_b32 v28, 16, v188
  v_and_b32 v29, 0xffff0000, v188
  v_pk_add_f32 v[20:21], v[20:21], v[28:29]
  v_lshlrev_b32 v30, 16, v189
  v_and_b32 v31, 0xffff0000, v189
  v_pk_add_f32 v[22:23], v[22:23], v[30:31]
  v_lshlrev_b32 v28, 16, v190
  v_and_b32 v29, 0xffff0000, v190
  v_pk_add_f32 v[24:25], v[24:25], v[28:29]
  v_lshlrev_b32 v30, 16, v191
  v_and_b32 v31, 0xffff0000, v191
  v_pk_add_f32 v[26:27], v[26:27], v[30:31]
  v_lshlrev_b32 v28, 16, v192
  v_and_b32 v29, 0xffff0000, v192
  v_pk_add_f32 v[20:21], v[20:21], v[28:29]
  v_lshlrev_b32 v30, 16, v193
  v_and_b32 v31, 0xffff0000, v193
  v_pk_add_f32 v[22:23], v[22:23], v[30:31]
  v_lshlrev_b32 v28, 16, v194
  v_and_b32 v29, 0xffff0000, v194
  v_pk_add_f32 v[24:25], v[24:25], v[28:29]
  v_lshlrev_b32 v30, 16, v195
  v_and_b32 v31, 0xffff0000, v195
  v_pk_add_f32 v[26:27], v[26:27], v[30:31]
  v_lshlrev_b32 v28, 16, v196
  v_and_b32 v29, 0xffff0000, v196
  v_pk_add_f32 v[20:21], v[20:21], v[28:29]
  v_lshlrev_b32 v30, 16, v197
  v_and_b32 v31, 0xffff0000, v197
  v_pk_add_f32 v[22:23], v[22:23], v[30:31]
  v_lshlrev_b32 v28, 16, v198
  v_and_b32 v29, 0xffff0000, v198
  v_pk_add_f32 v[24:25], v[24:25], v[28:29]
  v_lshlrev_b32 v30, 16, v199
  v_and_b32 v31, 0xffff0000, v199
  v_pk_add_f32 v[26:27], v[26:27], v[30:31]
  v_lshlrev_b32 v28, 16, v200
  v_and_b32 v29, 0xffff0000, v200
  v_pk_add_f32 v[20:21], v[20:21], v[28:29]
  v_lshlrev_b32 v30, 16, v201
  v_and_b32 v31, 0xffff0000, v201
  v_pk_add_f32 v[22:23], v[22:23], v[30:31]
  v_lshlrev_b32 v28, 16, v202
  v_and_b32 v29, 0xffff0000, v202
  v_pk_add_f32 v[24:25], v[24:25], v[28:29]
  v_lshlrev_b32 v30, 16, v203
  v_and_b32 v31, 0xffff0000, v203
  v_pk_add_f32 v[26:27], v[26:27], v[30:31]
  v_lshlrev_b32 v28, 16, v204
  v_and_b32 v29, 0xffff0000, v204
  v_pk_add_f32 v[20:21], v[20:21], v[28:29]
  v_lshlrev_b32 v30, 16, v205
  v_and_b32 v31, 0xffff0000, v205
  v_pk_add_f32 v[22:23], v[22:23], v[30:31]
  v_lshlrev_b32 v28, 16, v206
  v_and_b32 v29, 0xffff0000, v206
  v_pk_add_f32 v[24:25], v[24:25], v[28:29]
  v_lshlrev_b32 v30, 16, v207
  v_and_b32 v31, 0xffff0000, v207
  v_pk_add_f32 v[26:27], v[26:27], v[30:31]
  v_lshlrev_b32 v28, 16, v208
  v_and_b32 v29, 0xffff0000, v208
  v_pk_add_f32 v[20:21], v[20:21], v[28:29]
  v_lshlrev_b32 v30, 16, v209
  v_and_b32 v31, 0xffff0000, v209
  v_pk_add_f32 v[22:23], v[22:23], v[30:31]
  v_lshlrev_b32 v28, 16, v210
  v_and_b32 v29, 0xffff0000, v210
  v_pk_add_f32 v[24:25], v[24:25], v[28:29]
  v_lshlrev_b32 v30, 16, v211
  v_and_b32 v31, 0xffff0000, v211
  v_pk_add_f32 v[26:27], v[26:27], v[30:31]
  v_lshlrev_b32 v28, 16, v212
  v_and_b32 v29, 0xffff0000, v212
  v_pk_add_f32 v[20:21], v[20:21], v[28:29]
  v_lshlrev_b32 v30, 16, v213
  v_and_b32 v31, 0xffff0000, v213
  v_pk_add_f32 v[22:23], v[22:23], v[30:31]
  v_lshlrev_b32 v28, 16, v214
  v_and_b32 v29, 0xffff0000, v214
  v_pk_add_f32 v[24:25], v[24:25], v[28:29]
  v_lshlrev_b32 v30, 16, v215
  v_and_b32 v31, 0xffff0000, v215
  v_pk_add_f32 v[26:27], v[26:27], v[30:31]
  v_lshlrev_b32 v28, 16, v216
  v_and_b32 v29, 0xffff0000, v216
  v_pk_add_f32 v[20:21], v[20:21], v[28:29]
  v_lshlrev_b32 v30, 16, v217
  v_and_b32 v31, 0xffff0000, v217
  v_pk_add_f32 v[22:23], v[22:23], v[30:31]
  v_lshlrev_b32 v28, 16, v218
  v_and_b32 v29, 0xffff0000, v218
  v_pk_add_f32 v[24:25], v[24:25], v[28:29]
  v_lshlrev_b32 v30, 16, v219
  v_and_b32 v31, 0xffff0000, v219
  v_pk_add_f32 v[26:27], v[26:27], v[30:31]
  v_lshlrev_b32 v28, 16, v220
  v_and_b32 v29, 0xffff0000, v220
  v_pk_add_f32 v[20:21], v[20:21], v[28:29]
  v_lshlrev_b32 v30, 16, v221
  v_and_b32 v31, 0xffff0000, v221
  v_pk_add_f32 v[22:23], v[22:23], v[30:31]
  v_lshlrev_b32 v28, 16, v222
  v_and_b32 v29, 0xffff0000, v222
  v_pk_add_f32 v[24:25], v[24:25], v[28:29]
  v_lshlrev_b32 v30, 16, v223
  v_and_b32 v31, 0xffff0000, v223
  v_pk_add_f32 v[26:27], v[26:27], v[30:31]
  v_lshlrev_b32 v28, 16, v224
  v_and_b32 v29, 0xffff0000, v224
  v_pk_add_f32 v[20:21], v[20:21], v[28:29]
  v_lshlrev_b32 v30, 16, v225
  v_and_b32 v31, 0xffff0000, v225
  v_pk_add_f32 v[22:23], v[22:23], v[30:31]
  v_lshlrev_b32 v28, 16, v226
  v_and_b32 v29, 0xffff0000, v226
  v_pk_add_f32 v[24:25], v[24:25], v[28:29]
  v_lshlrev_b32 v30, 16, v227
  v_and_b32 v31, 0xffff0000, v227
  v_pk_add_f32 v[26:27], v[26:27], v[30:31]
  v_lshlrev_b32 v28, 16, v228
  v_and_b32 v29, 0xffff0000, v228
  v_pk_add_f32 v[20:21], v[20:21], v[28:29]
  v_lshlrev_b32 v30, 16, v229
  v_and_b32 v31, 0xffff0000, v229
  v_pk_add_f32 v[22:23], v[22:23], v[30:31]
  v_lshlrev_b32 v28, 16, v230
  v_and_b32 v29, 0xffff0000, v230
  v_pk_add_f32 v[24:25], v[24:25], v[28:29]
  v_lshlrev_b32 v30, 16, v231
  v_and_b32 v31, 0xffff0000, v231
  v_pk_add_f32 v[26:27], v[26:27], v[30:31]
  v_lshlrev_b32 v28, 16, v232
  v_and_b32 v29, 0xffff0000, v232
  v_pk_add_f32 v[20:21], v[20:21], v[28:29]
  v_lshlrev_b32 v30, 16, v233
  v_and_b32 v31, 0xffff0000, v233
  v_pk_add_f32 v[22:23], v[22:23], v[30:31]
  v_lshlrev_b32 v28, 16, v234
  v_and_b32 v29, 0xffff0000, v234
  v_pk_add_f32 v[24:25], v[24:25], v[28:29]
  v_lshlrev_b32 v30, 16, v235
  v_and_b32 v31, 0xffff0000, v235
  v_pk_add_f32 v[26:27], v[26:27], v[30:31]
  v_lshlrev_b32 v28, 16, v236
  v_and_b32 v29, 0xffff0000, v236
  v_pk_add_f32 v[20:21], v[20:21], v[28:29]
  v_lshlrev_b32 v30, 16, v237
  v_and_b32 v31, 0xffff0000, v237
  v_pk_add_f32 v[22:23], v[22:23], v[30:31]
  v_lshlrev_b32 v28, 16, v238
  v_and_b32 v29, 0xffff0000, v238
  v_pk_add_f32 v[24:25], v[24:25], v[28:29]
  v_lshlrev_b32 v30, 16, v239
  v_and_b32 v31, 0xffff0000, v239
  v_pk_add_f32 v[26:27], v[26:27], v[30:31]
  v_lshlrev_b32 v28, 16, v240
  v_and_b32 v29, 0xffff0000, v240
  v_pk_add_f32 v[20:21], v[20:21], v[28:29]
  v_lshlrev_b32 v30, 16, v241
  v_and_b32 v31, 0xffff0000, v241
  v_pk_add_f32 v[22:23], v[22:23], v[30:31]
  v_lshlrev_b32 v28, 16, v242
  v_and_b32 v29, 0xffff0000, v242
  v_pk_add_f32 v[24:25], v[24:25], v[28:29]
  v_lshlrev_b32 v30, 16, v243
  v_and_b32 v31, 0xffff0000, v243
  v_pk_add_f32 v[26:27], v[26:27], v[30:31]
  v_lshlrev_b32 v28, 16, v244
  v_and_b32 v29, 0xffff0000, v244
  v_pk_add_f32 v[20:21], v[20:21], v[28:29]
  v_lshlrev_b32 v30, 16, v245
  v_and_b32 v31, 0xffff0000, v245
  v_pk_add_f32 v[22:23], v[22:23], v[30:31]
  v_lshlrev_b32 v28, 16, v246
  v_and_b32 v29, 0xffff0000, v246
  v_pk_add_f32 v[24:25], v[24:25], v[28:29]
  v_lshlrev_b32 v30, 16, v247
  v_and_b32 v31, 0xffff0000, v247
  v_pk_add_f32 v[26:27], v[26:27], v[30:31]
  v_cvt_pk_bf16_f32 v12, v20, v21
  v_cvt_pk_bf16_f32 v13, v22, v23
  v_cvt_pk_bf16_f32 v14, v24, v25
  v_cvt_pk_bf16_f32 v15, v26, v27
  buffer_store_dwordx2 v[12:13], v2, s[24:27], 0 offen offset:0
  buffer_store_dwordx2 v[14:15], v2, s[24:27], 0 offen offset:32
M_DONE:
M_END:
  s_endpgm
A_TAILW0:
  v_add_u32 v10, 0x8000, v10
  s_branch A_TAIL0
A_TAILW1:
  v_add_u32 v10, 0xc000, v10
  s_add_u32 s61, s58, s60
  s_add_u32 m0, s61, 4096
  s_add_u32 s61, s56, 28672
  buffer_load_dwordx4 v100, s[8:11], s61 offen offset:0 sc1 lds
  buffer_load_dwordx4 v101, s[8:11], s61 offen offset:1024 sc1 lds
  buffer_load_dwordx4 v102, s[8:11], s61 offen offset:2048 sc1 lds
  buffer_load_dwordx4 v103, s[8:11], s61 offen offset:3072 sc1 lds
  s_add_u32 m0, s59, s43
  s_add_u32 s56, s56, 128
  buffer_load_dwordx4 v100, s[12:15], s57 offen offset:0 sc1 lds
  buffer_load_dwordx4 v101, s[12:15], s57 offen offset:1024 sc1 lds
  buffer_load_dwordx4 v102, s[12:15], s57 offen offset:2048 sc1 lds
  buffer_load_dwordx4 v103, s[12:15], s57 offen offset:3072 sc1 lds
  s_add_u32 s57, s57, 128
  s_branch A_TAIL1
A_TAILW2:
  v_add_u32 v10, 0x10000, v10
A_TAIL0:
  s_waitcnt lgkmcnt(0)
  ds_read_b128 a[128:131], v10 offset:0
  ds_read_b128 a[132:135], v10 offset:1024
  ds_read_b128 a[136:139], v10 offset:2048
  ds_read_b128 a[140:143], v10 offset:3072
  ds_read_b128 a[144:147], v10 offset:4096
  ds_read_b128 a[148:151], v10 offset:5120
  ds_read_b128 a[152:155], v10 offset:6144
  ds_read_b128 a[156:159], v10 offset:7168
  ds_read_b128 a[160:163], v10 offset:8192
  ds_read_b128 a[164:167], v10 offset:9216
  ds_read_b128 a[168:171], v10 offset:10240
  ds_read_b128 a[172:175], v10 offset:11264
  ds_read_b128 a[176:179], v10 offset:12288
  ds_read_b128 a[180:183], v10 offset:13312
  v_exp_f32 v32, v32
  v_exp_f32 v33, v33
  v_exp_f32 v34, v34
  v_exp_f32 v35, v35
  v_cvt_pk_bf16_f32 v64, v32, v33
  v_exp_f32 v36, v36
  v_exp_f32 v37, v37
  v_cvt_pk_bf16_f32 v65, v34, v35
  v_exp_f32 v38, v38
  v_exp_f32 v39, v39
  v_cvt_pk_bf16_f32 v66, v36, v37
  v_exp_f32 v40, v40
  v_exp_f32 v41, v41
  v_cvt_pk_bf16_f32 v67, v38, v39
  v_exp_f32 v42, v42
  v_exp_f32 v43, v43
  v_cvt_pk_bf16_f32 v68, v40, v41
  v_exp_f32 v44, v44
  v_exp_f32 v45, v45
  v_cvt_pk_bf16_f32 v69, v42, v43
  s_waitcnt lgkmcnt(6)
  v_mfma_f32_16x16x32_bf16 v[128:131], a[128:131], v[64:67], v[128:131]
  ds_read_b128 a[184:187], v10 offset:14336
  v_exp_f32 v47, v47
  v_cvt_pk_bf16_f32 v70, v44, v45
  v_mfma_f32_16x16x32_bf16 v[132:135], a[132:135], v[64:67], v[132:135]
  v_exp_f32 v46, v46
  s_nop 0
  v_cvt_pk_bf16_f32 v71, v46, v47
  v_mfma_f32_16x16x32_bf16 v[144:147], a[136:139], v[64:67], v[144:147]
  ds_read_b128 a[188:191], v10 offset:15360
  v_mfma_f32_16x16x32_bf16 v[148:151], a[140:143], v[64:67], v[148:151]
  v_mfma_f32_16x16x32_bf16 v[136:139], a[128:131], v[68:71], v[136:139]
  v_add_f32 v8, v8, v32
  v_mfma_f32_16x16x32_bf16 v[140:143], a[132:135], v[68:71], v[140:143]
  v_add_f32 v8, v8, v33
  v_mfma_f32_16x16x32_bf16 v[152:155], a[136:139], v[68:71], v[152:155]
  v_add_f32 v8, v8, v34
  v_mfma_f32_16x16x32_bf16 v[156:159], a[140:143], v[68:71], v[156:159]
  v_mfma_f32_16x16x32_bf16 v[160:163], a[144:147], v[64:67], v[160:163]
  v_add_f32 v8, v8, v35
  v_mfma_f32_16x16x32_bf16 v[168:171], a[144:147], v[68:71], v[168:171]
  v_mfma_f32_16x16x32_bf16 v[164:167], a[148:151], v[64:67], v[164:167]
  v_add_f32 v8, v8, v36
  v_mfma_f32_16x16x32_bf16 v[172:175], a[148:151], v[68:71], v[172:175]
  v_add_f32 v8, v8, v37
  v_mfma_f32_16x16x32_bf16 v[176:179], a[152:155], v[64:67], v[176:179]
  v_add_f32 v8, v8, v38
  v_mfma_f32_16x16x32_bf16 v[184:187], a[152:155], v[68:71], v[184:187]
  v_mfma_f32_16x16x32_bf16 v[180:183], a[156:159], v[64:67], v[180:183]
  v_add_f32 v8, v8, v39
  v_mfma_f32_16x16x32_bf16 v[188:191], a[156:159], v[68:71], v[188:191]
  s_waitcnt lgkmcnt(0)
  v_mfma_f32_16x16x32_bf16 v[192:195], a[160:163], v[64:67], v[192:195]
  v_add_f32 v9, v9, v40
  v_mfma_f32_16x16x32_bf16 v[200:203], a[160:163], v[68:71], v[200:203]
  v_mfma_f32_16x16x32_bf16 v[196:199], a[164:167], v[64:67], v[196:199]
  v_add_f32 v9, v9, v41
  v_mfma_f32_16x16x32_bf16 v[204:207], a[164:167], v[68:71], v[204:207]
  v_add_f32 v9, v9, v42
  v_mfma_f32_16x16x32_bf16 v[208:211], a[168:171], v[64:67], v[208:211]
  v_add_f32 v9, v9, v43
  v_mfma_f32_16x16x32_bf16 v[216:219], a[168:171], v[68:71], v[216:219]
  v_mfma_f32_16x16x32_bf16 v[212:215], a[172:175], v[64:67], v[212:215]
  v_add_f32 v9, v9, v44
  v_mfma_f32_16x16x32_bf16 v[220:223], a[172:175], v[68:71], v[220:223]
  v_mfma_f32_16x16x32_bf16 v[224:227], a[176:179], v[64:67], v[224:227]
  v_add_f32 v9, v9, v45
  v_mfma_f32_16x16x32_bf16 v[232:235], a[176:179], v[68:71], v[232:235]
  v_add_f32 v9, v9, v46
  v_mfma_f32_16x16x32_bf16 v[228:231], a[180:183], v[64:67], v[228:231]
  v_add_f32 v9, v9, v47
  v_mfma_f32_16x16x32_bf16 v[236:239], a[180:183], v[68:71], v[236:239]
  v_mfma_f32_16x16x32_bf16 v[240:243], a[184:187], v[64:67], v[240:243]
  v_mfma_f32_16x16x32_bf16 v[248:251], a[184:187], v[68:71], v[248:251]
  v_mfma_f32_16x16x32_bf16 v[244:247], a[188:191], v[64:67], v[244:247]
  v_mfma_f32_16x16x32_bf16 v[252:255], a[188:191], v[68:71], v[252:255]
  s_cmp_lg_u32 s3, 0
  s_cbranch_scc1 A_FIN
  s_waitcnt vmcnt(0)
  s_barrier
  s_mov_b32 s58, 32768
  s_mov_b32 s59, 65536
  s_add_u32 s61, s58, s60
  s_add_u32 m0, s61, 0
  s_add_u32 s61, s56, 0
  buffer_load_dwordx4 v100, s[8:11], s61 offen offset:0 sc1 lds
  buffer_load_dwordx4 v101, s[8:11], s61 offen offset:1024 sc1 lds
  buffer_load_dwordx4 v102, s[8:11], s61 offen offset:2048 sc1 lds
  buffer_load_dwordx4 v103, s[8:11], s61 offen offset:3072 sc1 lds
  s_add_u32 s61, s58, s60
  s_add_u32 m0, s61, 4096
  s_add_u32 s61, s56, 28672
  buffer_load_dwordx4 v100, s[8:11], s61 offen offset:0 sc1 lds
  buffer_load_dwordx4 v101, s[8:11], s61 offen offset:1024 sc1 lds
  buffer_load_dwordx4 v102, s[8:11], s61 offen offset:2048 sc1 lds
  buffer_load_dwordx4 v103, s[8:11], s61 offen offset:3072 sc1 lds
  s_add_u32 m0, s59, s43
  s_add_u32 s56, s56, 128
  buffer_load_dwordx4 v100, s[12:15], s57 offen offset:0 sc1 lds
  buffer_load_dwordx4 v101, s[12:15], s57 offen offset:1024 sc1 lds
  buffer_load_dwordx4 v102, s[12:15], s57 offen offset:2048 sc1 lds
  buffer_load_dwordx4 v103, s[12:15], s57 offen offset:3072 sc1 lds
  s_add_u32 s57, s57, 128
  s_cmp_eq_u32 s51, 0
  s_cbranch_scc1 A_FIN
  s_lshl_b32 s55, s48, 9
  s_add_u32 s55, s55, 121659392
  v_mov_b32 v108, s86
  v_mov_b32 v109, s87
  v_mov_b32 v110, 8
  s_mov_b64 exec, 1
  buffer_store_dwordx2 v[108:109], v110, s[16:19], s55 offen sc1
  s_mov_b64 exec, -1
  s_mov_b32 s51, 0
  s_branch A_FIN
A_ST_Q0:
  s_mov_b32 s37, 0
  s_branch A_RARE0
A_ST_Q1:
  s_mov_b32 s37, 0
  s_branch A_RARE1
A_ST_Q2:
  s_mov_b32 s37, 1
  s_branch A_RARE0
A_ST_Q3:
  s_mov_b32 s37, 1
  s_branch A_RARE1
A_ST_L0:
  s_mov_b32 s37, 2
  s_branch A_RARE0
A_ST_L1:
  s_mov_b32 s37, 2
  s_branch A_RARE1
A_ST_L2:
  s_mov_b32 s37, 3
  s_branch A_RARE0
A_ST_L3:
  s_mov_b32 s37, 3
  s_branch A_RARE1
A_ST_P28:
  s_mov_b32 s37, 4
  s_branch A_RARE0
A_MASK29:
  s_nop 7
  v_mov_b32 v36, v14
  v_mov_b32 v37, v14
  v_mov_b32 v38, v14
  v_mov_b32 v39, v14
  v_cndmask_b32 v32, v14, v32, s[64:65]
  v_cndmask_b32 v33, v14, v33, s[66:67]
  v_cndmask_b32 v34, v14, v34, s[68:69]
  v_cndmask_b32 v35, v14, v35, s[70:71]
  v_cndmask_b32 v44, v14, v44, s[64:65]
  v_cndmask_b32 v45, v14, v45, s[66:67]
  v_cndmask_b32 v46, v14, v46, s[68:69]
  v_cndmask_b32 v47, v14, v47, s[70:71]
  s_branch A_MASK29_RET
A_ST_P29:
  s_mov_b32 s37, 4
  s_branch A_RARE1
A_MASK30:
  s_nop 7
  v_mov_b32 v52, v14
  v_mov_b32 v53, v14
  v_mov_b32 v54, v14
  v_mov_b32 v55, v14
  v_cndmask_b32 v48, v14, v48, s[64:65]
  v_cndmask_b32 v49, v14, v49, s[66:67]
  v_cndmask_b32 v50, v14, v50, s[68:69]
  v_cndmask_b32 v51, v14, v51, s[70:71]
  v_cndmask_b32 v60, v14, v60, s[64:65]
  v_cndmask_b32 v61, v14, v61, s[66:67]
  v_cndmask_b32 v62, v14, v62, s[68:69]
  v_cndmask_b32 v63, v14, v63, s[70:71]
  s_branch A_MASK30_RET
A_ST_P30:
  s_mov_b32 s37, 5
  s_branch A_RARE0
A_MASK31:
  s_nop 7
  v_mov_b32 v36, v14
  v_mov_b32 v37, v14
  v_mov_b32 v38, v14
  v_mov_b32 v39, v14
  v_cndmask_b32 v32, v14, v32, s[64:65]
  v_cndmask_b32 v33, v14, v33, s[66:67]
  v_cndmask_b32 v34, v14, v34, s[68:69]
  v_cndmask_b32 v35, v14, v35, s[70:71]
  v_cndmask_b32 v44, v14, v44, s[64:65]
  v_cndmask_b32 v45, v14, v45, s[66:67]
  v_cndmask_b32 v46, v14, v46, s[68:69]
  v_cndmask_b32 v47, v14, v47, s[70:71]
  s_branch A_MASK31_RET
A_ST_P31:
  s_mov_b32 s37, 5
  s_branch A_RARE1
A_ST_P32:
  s_mov_b32 s37, 6
  s_branch A_RARE0
A_RARE0:
  v_max3_f32 v18, v48, v49, v50
  v_max3_f32 v20, v51, v52, v53
  v_max3_f32 v18, v18, v54, v55
  v_max_f32 v18, v18, v20
  v_max3_f32 v19, v56, v57, v58
  v_max3_f32 v21, v59, v60, v61
  v_max3_f32 v19, v19, v62, v63
  v_max_f32 v19, v19, v21
  v_mov_b32 v20, v18
  v_mov_b32 v21, v19
  s_nop 1
  v_permlane16_swap_b32 v18, v20
  v_permlane16_swap_b32 v19, v21
  v_max_f32 v18, v18, v20
  v_max_f32 v19, v19, v21
  v_mov_b32 v20, v18
  v_mov_b32 v21, v19
  s_nop 1
  v_permlane32_swap_b32 v18, v20
  v_permlane32_swap_b32 v19, v21
  v_max_f32 v18, v18, v20
  v_max_f32 v19, v19, v21
  v_max_f32 v18, 0, v18
  v_exp_f32 v22, -v18
  v_max_f32 v19, 0, v19
  v_exp_f32 v23, -v19
  v_sub_f32 v48, v48, v18
  v_sub_f32 v49, v49, v18
  v_sub_f32 v50, v50, v18
  v_sub_f32 v51, v51, v18
  v_sub_f32 v52, v52, v18
  v_sub_f32 v53, v53, v18
  v_sub_f32 v54, v54, v18
  v_sub_f32 v55, v55, v18
  v_sub_f32 v56, v56, v19
  v_sub_f32 v57, v57, v19
  v_sub_f32 v58, v58, v19
  v_sub_f32 v59, v59, v19
  v_sub_f32 v60, v60, v19
  v_sub_f32 v61, v61, v19
  v_sub_f32 v62, v62, v19
  v_sub_f32 v63, v63, v19
  v_sub_f32 v80, v80, v18
  v_sub_f32 v81, v81, v18
  v_sub_f32 v82, v82, v18
  v_sub_f32 v83, v83, v18
  v_sub_f32 v84, v84, v19
  v_sub_f32 v85, v85, v19
  v_sub_f32 v86, v86, v19
  v_sub_f32 v87, v87, v19
  v_mul_f32 v8, v8, v22
  v_mul_f32 v9, v9, v23
  v_mul_f32 v128, v128, v22
  v_mul_f32 v129, v129, v22
  v_mul_f32 v130, v130, v22
  v_mul_f32 v131, v131, v22
  v_mul_f32 v132, v132, v22
  v_mul_f32 v133, v133, v22
  v_mul_f32 v134, v134, v22
  v_mul_f32 v135, v135, v22
  v_mul_f32 v136, v136, v23
  v_mul_f32 v137, v137, v23
  v_mul_f32 v138, v138, v23
  v_mul_f32 v139, v139, v23
  v_mul_f32 v140, v140, v23
  v_mul_f32 v141, v141, v23
  v_mul_f32 v142, v142, v23
  v_mul_f32 v143, v143, v23
  v_mul_f32 v144, v144, v22
  v_mul_f32 v145, v145, v22
  v_mul_f32 v146, v146, v22
  v_mul_f32 v147, v147, v22
  v_mul_f32 v148, v148, v22
  v_mul_f32 v149, v149, v22
  v_mul_f32 v150, v150, v22
  v_mul_f32 v151, v151, v22
  v_mul_f32 v152, v152, v23
  v_mul_f32 v153, v153, v23
  v_mul_f32 v154, v154, v23
  v_mul_f32 v155, v155, v23
  v_mul_f32 v156, v156, v23
  v_mul_f32 v157, v157, v23
  v_mul_f32 v158, v158, v23
  v_mul_f32 v159, v159, v23
  v_mul_f32 v160, v160, v22
  v_mul_f32 v161, v161, v22
  v_mul_f32 v162, v162, v22
  v_mul_f32 v163, v163, v22
  v_mul_f32 v164, v164, v22
  v_mul_f32 v165, v165, v22
  v_mul_f32 v166, v166, v22
  v_mul_f32 v167, v167, v22
  v_mul_f32 v168, v168, v23
  v_mul_f32 v169, v169, v23
  v_mul_f32 v170, v170, v23
  v_mul_f32 v171, v171, v23
  v_mul_f32 v172, v172, v23
  v_mul_f32 v173, v173, v23
  v_mul_f32 v174, v174, v23
  v_mul_f32 v175, v175, v23
  v_mul_f32 v176, v176, v22
  v_mul_f32 v177, v177, v22
  v_mul_f32 v178, v178, v22
  v_mul_f32 v179, v179, v22
  v_mul_f32 v180, v180, v22
  v_mul_f32 v181, v181, v22
  v_mul_f32 v182, v182, v22
  v_mul_f32 v183, v183, v22
  v_mul_f32 v184, v184, v23
  v_mul_f32 v185, v185, v23
  v_mul_f32 v186, v186, v23
  v_mul_f32 v187, v187, v23
  v_mul_f32 v188, v188, v23
  v_mul_f32 v189, v189, v23
  v_mul_f32 v190, v190, v23
  v_mul_f32 v191, v191, v23
  v_mul_f32 v192, v192, v22
  v_mul_f32 v193, v193, v22
  v_mul_f32 v194, v194, v22
  v_mul_f32 v195, v195, v22
  v_mul_f32 v196, v196, v22
  v_mul_f32 v197, v197, v22
  v_mul_f32 v198, v198, v22
  v_mul_f32 v199, v199, v22
  v_mul_f32 v200, v200, v23
  v_mul_f32 v201, v201, v23
  v_mul_f32 v202, v202, v23
  v_mul_f32 v203, v203, v23
  v_mul_f32 v204, v204, v23
  v_mul_f32 v205, v205, v23
  v_mul_f32 v206, v206, v23
  v_mul_f32 v207, v207, v23
  v_mul_f32 v208, v208, v22
  v_mul_f32 v209, v209, v22
  v_mul_f32 v210, v210, v22
  v_mul_f32 v211, v211, v22
  v_mul_f32 v212, v212, v22
  v_mul_f32 v213, v213, v22
  v_mul_f32 v214, v214, v22
  v_mul_f32 v215, v215, v22
  v_mul_f32 v216, v216, v23
  v_mul_f32 v217, v217, v23
  v_mul_f32 v218, v218, v23
  v_mul_f32 v219, v219, v23
  v_mul_f32 v220, v220, v23
  v_mul_f32 v221, v221, v23
  v_mul_f32 v222, v222, v23
  v_mul_f32 v223, v223, v23
  v_mul_f32 v224, v224, v22
  v_mul_f32 v225, v225, v22
  v_mul_f32 v226, v226, v22
  v_mul_f32 v227, v227, v22
  v_mul_f32 v228, v228, v22
  v_mul_f32 v229, v229, v22
  v_mul_f32 v230, v230, v22
  v_mul_f32 v231, v231, v22
  v_mul_f32 v232, v232, v23
  v_mul_f32 v233, v233, v23
  v_mul_f32 v234, v234, v23
  v_mul_f32 v235, v235, v23
  v_mul_f32 v236, v236, v23
  v_mul_f32 v237, v237, v23
  v_mul_f32 v238, v238, v23
  v_mul_f32 v239, v239, v23
  v_mul_f32 v240, v240, v22
  v_mul_f32 v241, v241, v22
  v_mul_f32 v242, v242, v22
  v_mul_f32 v243, v243, v22
  v_mul_f32 v244, v244, v22
  v_mul_f32 v245, v245, v22
  v_mul_f32 v246, v246, v22
  v_mul_f32 v247, v247, v22
  v_mul_f32 v248, v248, v23
  v_mul_f32 v249, v249, v23
  v_mul_f32 v250, v250, v23
  v_mul_f32 v251, v251, v23
  v_mul_f32 v252, v252, v23
  v_mul_f32 v253, v253, v23
  v_mul_f32 v254, v254, v23
  v_mul_f32 v255, v255, v23
  s_cmp_eq_u32 s37, 0
  s_cbranch_scc1 A_RET_Q0
  s_cmp_eq_u32 s37, 1
  s_cbranch_scc1 A_RET_Q2
  s_cmp_eq_u32 s37, 2
  s_cbranch_scc1 A_RET_L0
  s_cmp_eq_u32 s37, 3
  s_cbranch_scc1 A_RET_L2
  s_cmp_eq_u32 s37, 4
  s_cbranch_scc1 A_RET_P28
  s_cmp_eq_u32 s37, 5
  s_cbranch_scc1 A_RET_P30
  s_branch A_RET_P32
A_RARE1:
  v_max3_f32 v18, v32, v33, v34
  v_max3_f32 v20, v35, v36, v37
  v_max3_f32 v18, v18, v38, v39
  v_max_f32 v18, v18, v20
  v_max3_f32 v19, v40, v41, v42
  v_max3_f32 v21, v43, v44, v45
  v_max3_f32 v19, v19, v46, v47
  v_max_f32 v19, v19, v21
  v_mov_b32 v20, v18
  v_mov_b32 v21, v19
  s_nop 1
  v_permlane16_swap_b32 v18, v20
  v_permlane16_swap_b32 v19, v21
  v_max_f32 v18, v18, v20
  v_max_f32 v19, v19, v21
  v_mov_b32 v20, v18
  v_mov_b32 v21, v19
  s_nop 1
  v_permlane32_swap_b32 v18, v20
  v_permlane32_swap_b32 v19, v21
  v_max_f32 v18, v18, v20
  v_max_f32 v19, v19, v21
  v_max_f32 v18, 0, v18
  v_exp_f32 v22, -v18
  v_max_f32 v19, 0, v19
  v_exp_f32 v23, -v19
  v_sub_f32 v32, v32, v18
  v_sub_f32 v33, v33, v18
  v_sub_f32 v34, v34, v18
  v_sub_f32 v35, v35, v18
  v_sub_f32 v36, v36, v18
  v_sub_f32 v37, v37, v18
  v_sub_f32 v38, v38, v18
  v_sub_f32 v39, v39, v18
  v_sub_f32 v40, v40, v19
  v_sub_f32 v41, v41, v19
  v_sub_f32 v42, v42, v19
  v_sub_f32 v43, v43, v19
  v_sub_f32 v44, v44, v19
  v_sub_f32 v45, v45, v19
  v_sub_f32 v46, v46, v19
  v_sub_f32 v47, v47, v19
  v_sub_f32 v80, v80, v18
  v_sub_f32 v81, v81, v18
  v_sub_f32 v82, v82, v18
  v_sub_f32 v83, v83, v18
  v_sub_f32 v84, v84, v19
  v_sub_f32 v85, v85, v19
  v_sub_f32 v86, v86, v19
  v_sub_f32 v87, v87, v19
  v_mul_f32 v8, v8, v22
  v_mul_f32 v9, v9, v23
  v_mul_f32 v128, v128, v22
  v_mul_f32 v129, v129, v22
  v_mul_f32 v130, v130, v22
  v_mul_f32 v131, v131, v22
  v_mul_f32 v132, v132, v22
  v_mul_f32 v133, v133, v22
  v_mul_f32 v134, v134, v22
  v_mul_f32 v135, v135, v22
  v_mul_f32 v136, v136, v23
  v_mul_f32 v137, v137, v23
  v_mul_f32 v138, v138, v23
  v_mul_f32 v139, v139, v23
  v_mul_f32 v140, v140, v23
  v_mul_f32 v141, v141, v23
  v_mul_f32 v142, v142, v23
  v_mul_f32 v143, v143, v23
  v_mul_f32 v144, v144, v22
  v_mul_f32 v145, v145, v22
  v_mul_f32 v146, v146, v22
  v_mul_f32 v147, v147, v22
  v_mul_f32 v148, v148, v22
  v_mul_f32 v149, v149, v22
  v_mul_f32 v150, v150, v22
  v_mul_f32 v151, v151, v22
  v_mul_f32 v152, v152, v23
  v_mul_f32 v153, v153, v23
  v_mul_f32 v154, v154, v23
  v_mul_f32 v155, v155, v23
  v_mul_f32 v156, v156, v23
  v_mul_f32 v157, v157, v23
  v_mul_f32 v158, v158, v23
  v_mul_f32 v159, v159, v23
  v_mul_f32 v160, v160, v22
  v_mul_f32 v161, v161, v22
  v_mul_f32 v162, v162, v22
  v_mul_f32 v163, v163, v22
  v_mul_f32 v164, v164, v22
  v_mul_f32 v165, v165, v22
  v_mul_f32 v166, v166, v22
  v_mul_f32 v167, v167, v22
  v_mul_f32 v168, v168, v23
  v_mul_f32 v169, v169, v23
  v_mul_f32 v170, v170, v23
  v_mul_f32 v171, v171, v23
  v_mul_f32 v172, v172, v23
  v_mul_f32 v173, v173, v23
  v_mul_f32 v174, v174, v23
  v_mul_f32 v175, v175, v23
  v_mul_f32 v176, v176, v22
  v_mul_f32 v177, v177, v22
  v_mul_f32 v178, v178, v22
  v_mul_f32 v179, v179, v22
  v_mul_f32 v180, v180, v22
  v_mul_f32 v181, v181, v22
  v_mul_f32 v182, v182, v22
  v_mul_f32 v183, v183, v22
  v_mul_f32 v184, v184, v23
  v_mul_f32 v185, v185, v23
  v_mul_f32 v186, v186, v23
  v_mul_f32 v187, v187, v23
  v_mul_f32 v188, v188, v23
  v_mul_f32 v189, v189, v23
  v_mul_f32 v190, v190, v23
  v_mul_f32 v191, v191, v23
  v_mul_f32 v192, v192, v22
  v_mul_f32 v193, v193, v22
  v_mul_f32 v194, v194, v22
  v_mul_f32 v195, v195, v22
  v_mul_f32 v196, v196, v22
  v_mul_f32 v197, v197, v22
  v_mul_f32 v198, v198, v22
  v_mul_f32 v199, v199, v22
  v_mul_f32 v200, v200, v23
  v_mul_f32 v201, v201, v23
  v_mul_f32 v202, v202, v23
  v_mul_f32 v203, v203, v23
  v_mul_f32 v204, v204, v23
  v_mul_f32 v205, v205, v23
  v_mul_f32 v206, v206, v23
  v_mul_f32 v207, v207, v23
  v_mul_f32 v208, v208, v22
  v_mul_f32 v209, v209, v22
  v_mul_f32 v210, v210, v22
  v_mul_f32 v211, v211, v22
  v_mul_f32 v212, v212, v22
  v_mul_f32 v213, v213, v22
  v_mul_f32 v214, v214, v22
  v_mul_f32 v215, v215, v22
  v_mul_f32 v216, v216, v23
  v_mul_f32 v217, v217, v23
  v_mul_f32 v218, v218, v23
  v_mul_f32 v219, v219, v23
  v_mul_f32 v220, v220, v23
  v_mul_f32 v221, v221, v23
  v_mul_f32 v222, v222, v23
  v_mul_f32 v223, v223, v23
  v_mul_f32 v224, v224, v22
  v_mul_f32 v225, v225, v22
  v_mul_f32 v226, v226, v22
  v_mul_f32 v227, v227, v22
  v_mul_f32 v228, v228, v22
  v_mul_f32 v229, v229, v22
  v_mul_f32 v230, v230, v22
  v_mul_f32 v231, v231, v22
  v_mul_f32 v232, v232, v23
  v_mul_f32 v233, v233, v23
  v_mul_f32 v234, v234, v23
  v_mul_f32 v235, v235, v23
  v_mul_f32 v236, v236, v23
  v_mul_f32 v237, v237, v23
  v_mul_f32 v238, v238, v23
  v_mul_f32 v239, v239, v23
  v_mul_f32 v240, v240, v22
  v_mul_f32 v241, v241, v22
  v_mul_f32 v242, v242, v22
  v_mul_f32 v243, v243, v22
  v_mul_f32 v244, v244, v22
  v_mul_f32 v245, v245, v22
  v_mul_f32 v246, v246, v22
  v_mul_f32 v247, v247, v22
  v_mul_f32 v248, v248, v23
  v_mul_f32 v249, v249, v23
  v_mul_f32 v250, v250, v23
  v_mul_f32 v251, v251, v23
  v_mul_f32 v252, v252, v23
  v_mul_f32 v253, v253, v23
  v_mul_f32 v254, v254, v23
  v_mul_f32 v255, v255, v23
  s_cmp_eq_u32 s37, 0
  s_cbranch_scc1 A_RET_Q1
  s_cmp_eq_u32 s37, 1
  s_cbranch_scc1 A_RET_Q3
  s_cmp_eq_u32 s37, 2
  s_cbranch_scc1 A_RET_L1
  s_cmp_eq_u32 s37, 3
  s_cbranch_scc1 A_RET_L3
  s_cmp_eq_u32 s37, 4
  s_cbranch_scc1 A_RET_P29
  s_branch A_RET_P31
A_FIRST:
  v_max3_f32 v18, v32, v33, v34
  v_max3_f32 v20, v35, v36, v37
  v_max3_f32 v18, v18, v38, v39
  v_max_f32 v18, v18, v20
  v_max3_f32 v19, v40, v41, v42
  v_max3_f32 v21, v43, v44, v45
  v_max3_f32 v19, v19, v46, v47
  v_max_f32 v19, v19, v21
  v_mov_b32 v20, v18
  v_mov_b32 v21, v19
  s_nop 1
  v_permlane16_swap_b32 v18, v20
  v_permlane16_swap_b32 v19, v21
  v_max_f32 v18, v18, v20
  v_max_f32 v19, v19, v21
  v_mov_b32 v20, v18
  v_mov_b32 v21, v19
  s_nop 1
  v_permlane32_swap_b32 v18, v20
  v_permlane32_swap_b32 v19, v21
  v_max_f32 v18, v18, v20
  v_max_f32 v19, v19, v21
  v_sub_f32 v32, v32, v18
  v_sub_f32 v33, v33, v18
  v_sub_f32 v34, v34, v18
  v_sub_f32 v35, v35, v18
  v_sub_f32 v36, v36, v18
  v_sub_f32 v37, v37, v18
  v_sub_f32 v38, v38, v18
  v_sub_f32 v39, v39, v18
  v_sub_f32 v40, v40, v19
  v_sub_f32 v41, v41, v19
  v_sub_f32 v42, v42, v19
  v_sub_f32 v43, v43, v19
  v_sub_f32 v44, v44, v19
  v_sub_f32 v45, v45, v19
  v_sub_f32 v46, v46, v19
  v_sub_f32 v47, v47, v19
  v_sub_f32 v80, 0, v18
  v_sub_f32 v81, 0, v18
  v_sub_f32 v82, 0, v18
  v_sub_f32 v83, 0, v18
  v_sub_f32 v84, 0, v19
  v_sub_f32 v85, 0, v19
  v_sub_f32 v86, 0, v19
  v_sub_f32 v87, 0, v19
  s_cmp_eq_u32 s37, 0
  s_cbranch_scc1 A_Q0
  s_cmp_eq_u32 s35, 7
  s_cbranch_scc1 A_RET_P29
  s_cmp_eq_u32 s35, 0
  s_cbranch_scc1 A_RET_Q1
  s_branch A_RET_L1
A_SW1:
  v_accvgpr_mov_b32 a0, a64
  v_accvgpr_mov_b32 a1, a65
  v_accvgpr_mov_b32 a2, a66
  v_accvgpr_mov_b32 a3, a67
  v_accvgpr_mov_b32 a4, a68
  v_accvgpr_mov_b32 a5, a69
  v_accvgpr_mov_b32 a6, a70
  v_accvgpr_mov_b32 a7, a71
  v_accvgpr_mov_b32 a8, a72
  v_accvgpr_mov_b32 a9, a73
  v_accvgpr_mov_b32 a10, a74
  v_accvgpr_mov_b32 a11, a75
  v_accvgpr_mov_b32 a12, a76
  v_accvgpr_mov_b32 a13, a77
  v_accvgpr_mov_b32 a14, a78
  v_accvgpr_mov_b32 a15, a79
  v_accvgpr_mov_b32 a16, a80
  v_accvgpr_mov_b32 a17, a81
  v_accvgpr_mov_b32 a18, a82
  v_accvgpr_mov_b32 a19, a83
  v_accvgpr_mov_b32 a20, a84
  v_accvgpr_mov_b32 a21, a85
  v_accvgpr_mov_b32 a22, a86
  v_accvgpr_mov_b32 a23, a87
  v_accvgpr_mov_b32 a24, a88
  v_accvgpr_mov_b32 a25, a89
  v_accvgpr_mov_b32 a26, a90
  v_accvgpr_mov_b32 a27, a91
  v_accvgpr_mov_b32 a28, a92
  v_accvgpr_mov_b32 a29, a93
  v_accvgpr_mov_b32 a30, a94
  v_accvgpr_mov_b32 a31, a95
  v_accvgpr_mov_b32 a32, a96
  v_accvgpr_mov_b32 a33, a97
  v_accvgpr_mov_b32 a34, a98
  v_accvgpr_mov_b32 a35, a99
  v_accvgpr_mov_b32 a36, a100
  v_accvgpr_mov_b32 a37, a101
  v_accvgpr_mov_b32 a38, a102
  v_accvgpr_mov_b32 a39, a103
  v_accvgpr_mov_b32 a40, a104
  v_accvgpr_mov_b32 a41, a105
  v_accvgpr_mov_b32 a42, a106
  v_accvgpr_mov_b32 a43, a107
  v_accvgpr_mov_b32 a44, a108
  v_accvgpr_mov_b32 a45, a109
  v_accvgpr_mov_b32 a46, a110
  v_accvgpr_mov_b32 a47, a111
  v_accvgpr_mov_b32 a48, a112
  v_accvgpr_mov_b32 a49, a113
  v_accvgpr_mov_b32 a50, a114
  v_accvgpr_mov_b32 a51, a115
  v_accvgpr_mov_b32 a52, a116
  v_accvgpr_mov_b32 a53, a117
  v_accvgpr_mov_b32 a54, a118
  v_accvgpr_mov_b32 a55, a119
  v_accvgpr_mov_b32 a56, a120
  v_accvgpr_mov_b32 a57, a121
  v_accvgpr_mov_b32 a58, a122
  v_accvgpr_mov_b32 a59, a123
  v_accvgpr_mov_b32 a60, a124
  v_accvgpr_mov_b32 a61, a125
  v_accvgpr_mov_b32 a62, a126
  v_accvgpr_mov_b32 a63, a127
  v_mov_b32 v16, v80
  v_mov_b32 v17, v84
  v_mov_b64 v[80:81], 0
  v_mov_b64 v[82:83], 0
  v_mov_b64 v[84:85], 0
  v_mov_b64 v[86:87], 0
  s_cmp_eq_u32 s35, 7
  s_cbranch_scc1 A_SW1_RET_P29
  s_cmp_eq_u32 s35, 0
  s_cbranch_scc1 A_SW1_RET_Q1
  s_branch A_SW1_RET_L1
A_SW2:
  s_lshl_b32 s54, s48, 2
  s_add_u32 s54, s54, s3
  s_lshl_b32 s55, s54, 10
  s_add_u32 s55, s55, 75497472
  s_lshl_b32 s54, s54, 14
  s_add_u32 s54, s54, 58720256
  v_lshrrev_b32 v110, 1, v1
  buffer_store_dwordx2 v[16:17], v110, s[16:19], s55 offen sc1
  buffer_store_dwordx2 v[8:9], v110, s[16:19], s55 offen offset:512 sc1
  v_cvt_pk_bf16_f32 v112, v128, v129
  v_cvt_pk_bf16_f32 v113, v130, v131
  v_cvt_pk_bf16_f32 v114, v132, v133
  v_cvt_pk_bf16_f32 v115, v134, v135
  v_mov_b64 v[128:129], 0
  v_mov_b64 v[130:131], 0
  v_mov_b64 v[132:133], 0
  v_mov_b64 v[134:135], 0
  buffer_store_dwordx4 v[112:115], v1, s[16:19], s54 offen offset:0 sc1
  v_cvt_pk_bf16_f32 v116, v136, v137
  v_cvt_pk_bf16_f32 v117, v138, v139
  v_cvt_pk_bf16_f32 v118, v140, v141
  v_cvt_pk_bf16_f32 v119, v142, v143
  v_mov_b64 v[136:137], 0
  v_mov_b64 v[138:139], 0
  v_mov_b64 v[140:141], 0
  v_mov_b64 v[142:143], 0
  buffer_store_dwordx4 v[116:119], v1, s[16:19], s54 offen offset:1024 sc1
  v_cvt_pk_bf16_f32 v112, v144, v145
  v_cvt_pk_bf16_f32 v113, v146, v147
  v_cvt_pk_bf16_f32 v114, v148, v149
  v_cvt_pk_bf16_f32 v115, v150, v151
  v_mov_b64 v[144:145], 0
  v_mov_b64 v[146:147], 0
  v_mov_b64 v[148:149], 0
  v_mov_b64 v[150:151], 0
  buffer_store_dwordx4 v[112:115], v1, s[16:19], s54 offen offset:2048 sc1
  v_cvt_pk_bf16_f32 v116, v152, v153
  v_cvt_pk_bf16_f32 v117, v154, v155
  v_cvt_pk_bf16_f32 v118, v156, v157
  v_cvt_pk_bf16_f32 v119, v158, v159
  v_mov_b64 v[152:153], 0
  v_mov_b64 v[154:155], 0
  v_mov_b64 v[156:157], 0
  v_mov_b64 v[158:159], 0
  buffer_store_dwordx4 v[116:119], v1, s[16:19], s54 offen offset:3072 sc1
  s_add_u32 s54, s54, 4096
  v_cvt_pk_bf16_f32 v112, v160, v161
  v_cvt_pk_bf16_f32 v113, v162, v163
  v_cvt_pk_bf16_f32 v114, v164, v165
  v_cvt_pk_bf16_f32 v115, v166, v167
  v_mov_b64 v[160:161], 0
  v_mov_b64 v[162:163], 0
  v_mov_b64 v[164:165], 0
  v_mov_b64 v[166:167], 0
  buffer_store_dwordx4 v[112:115], v1, s[16:19], s54 offen offset:0 sc1
  v_cvt_pk_bf16_f32 v116, v168, v169
  v_cvt_pk_bf16_f32 v117, v170, v171
  v_cvt_pk_bf16_f32 v118, v172, v173
  v_cvt_pk_bf16_f32 v119, v174, v175
  v_mov_b64 v[168:169], 0
  v_mov_b64 v[170:171], 0
  v_mov_b64 v[172:173], 0
  v_mov_b64 v[174:175], 0
  buffer_store_dwordx4 v[116:119], v1, s[16:19], s54 offen offset:1024 sc1
  v_cvt_pk_bf16_f32 v112, v176, v177
  v_cvt_pk_bf16_f32 v113, v178, v179
  v_cvt_pk_bf16_f32 v114, v180, v181
  v_cvt_pk_bf16_f32 v115, v182, v183
  v_mov_b64 v[176:177], 0
  v_mov_b64 v[178:179], 0
  v_mov_b64 v[180:181], 0
  v_mov_b64 v[182:183], 0
  buffer_store_dwordx4 v[112:115], v1, s[16:19], s54 offen offset:2048 sc1
  v_cvt_pk_bf16_f32 v116, v184, v185
  v_cvt_pk_bf16_f32 v117, v186, v187
  v_cvt_pk_bf16_f32 v118, v188, v189
  v_cvt_pk_bf16_f32 v119, v190, v191
  v_mov_b64 v[184:185], 0
  v_mov_b64 v[186:187], 0
  v_mov_b64 v[188:189], 0
  v_mov_b64 v[190:191], 0
  buffer_store_dwordx4 v[116:119], v1, s[16:19], s54 offen offset:3072 sc1
  s_add_u32 s54, s54, 4096
  v_cvt_pk_bf16_f32 v112, v192, v193
  v_cvt_pk_bf16_f32 v113, v194, v195
  v_cvt_pk_bf16_f32 v114, v196, v197
  v_cvt_pk_bf16_f32 v115, v198, v199
  v_mov_b64 v[192:193], 0
  v_mov_b64 v[194:195], 0
  v_mov_b64 v[196:197], 0
  v_mov_b64 v[198:199], 0
  buffer_store_dwordx4 v[112:115], v1, s[16:19], s54 offen offset:0 sc1
  v_cvt_pk_bf16_f32 v116, v200, v201
  v_cvt_pk_bf16_f32 v117, v202, v203
  v_cvt_pk_bf16_f32 v118, v204, v205
  v_cvt_pk_bf16_f32 v119, v206, v207
  v_mov_b64 v[200:201], 0
  v_mov_b64 v[202:203], 0
  v_mov_b64 v[204:205], 0
  v_mov_b64 v[206:207], 0
  buffer_store_dwordx4 v[116:119], v1, s[16:19], s54 offen offset:1024 sc1
  v_cvt_pk_bf16_f32 v112, v208, v209
  v_cvt_pk_bf16_f32 v113, v210, v211
  v_cvt_pk_bf16_f32 v114, v212, v213
  v_cvt_pk_bf16_f32 v115, v214, v215
  v_mov_b64 v[208:209], 0
  v_mov_b64 v[210:211], 0
  v_mov_b64 v[212:213], 0
  v_mov_b64 v[214:215], 0
  buffer_store_dwordx4 v[112:115], v1, s[16:19], s54 offen offset:2048 sc1
  v_cvt_pk_bf16_f32 v116, v216, v217
  v_cvt_pk_bf16_f32 v117, v218, v219
  v_cvt_pk_bf16_f32 v118, v220, v221
  v_cvt_pk_bf16_f32 v119, v222, v223
  v_mov_b64 v[216:217], 0
  v_mov_b64 v[218:219], 0
  v_mov_b64 v[220:221], 0
  v_mov_b64 v[222:223], 0
  buffer_store_dwordx4 v[116:119], v1, s[16:19], s54 offen offset:3072 sc1
  s_add_u32 s54, s54, 4096
  v_cvt_pk_bf16_f32 v112, v224, v225
  v_cvt_pk_bf16_f32 v113, v226, v227
  v_cvt_pk_bf16_f32 v114, v228, v229
  v_cvt_pk_bf16_f32 v115, v230, v231
  v_mov_b64 v[224:225], 0
  v_mov_b64 v[226:227], 0
  v_mov_b64 v[228:229], 0
  v_mov_b64 v[230:231], 0
  buffer_store_dwordx4 v[112:115], v1, s[16:19], s54 offen offset:0 sc1
  v_cvt_pk_bf16_f32 v116, v232, v233
  v_cvt_pk_bf16_f32 v117, v234, v235
  v_cvt_pk_bf16_f32 v118, v236, v237
  v_cvt_pk_bf16_f32 v119, v238, v239
  v_mov_b64 v[232:233], 0
  v_mov_b64 v[234:235], 0
  v_mov_b64 v[236:237], 0
  v_mov_b64 v[238:239], 0
  buffer_store_dwordx4 v[116:119], v1, s[16:19], s54 offen offset:1024 sc1
  v_cvt_pk_bf16_f32 v112, v240, v241
  v_cvt_pk_bf16_f32 v113, v242, v243
  v_cvt_pk_bf16_f32 v114, v244, v245
  v_cvt_pk_bf16_f32 v115, v246, v247
  v_mov_b64 v[240:241], 0
  v_mov_b64 v[242:243], 0
  v_mov_b64 v[244:245], 0
  v_mov_b64 v[246:247], 0
  buffer_store_dwordx4 v[112:115], v1, s[16:19], s54 offen offset:2048 sc1
  v_cvt_pk_bf16_f32 v116, v248, v249
  v_cvt_pk_bf16_f32 v117, v250, v251
  v_cvt_pk_bf16_f32 v118, v252, v253
  v_cvt_pk_bf16_f32 v119, v254, v255
  v_mov_b64 v[248:249], 0
  v_mov_b64 v[250:251], 0
  v_mov_b64 v[252:253], 0
  v_mov_b64 v[254:255], 0
  buffer_store_dwordx4 v[116:119], v1, s[16:19], s54 offen offset:3072 sc1
  v_mov_b64 v[8:9], 0
  s_mov_b32 s51, 1
  s_mov_b32 s37, 1
  s_branch A_FIRST
A_SIG:
  s_lshl_b32 s55, s48, 9
  s_add_u32 s55, s55, 121659392
  v_mov_b32 v108, s86
  v_mov_b32 v109, s87
  v_mov_b32 v110, 8
  s_mov_b64 exec, 1
  buffer_store_dwordx2 v[108:109], v110, s[16:19], s55 offen sc1
  s_mov_b64 exec, -1
  s_mov_b32 s51, 0
  s_cmp_eq_u32 s35, 0
  s_cbranch_scc1 A_SIG_RET_Q
  s_branch A_SIG_RET
A_KV2S:
  s_lshl_b32 s55, s76, 9
  s_add_u32 s55, s55, 121733120
  s_lshl_b32 s53, s35, 13
  s_add_u32 s55, s55, s53
  v_mov_b32 v108, s86
  v_mov_b32 v109, s87
  v_mov_b32 v110, s77
  s_mov_b64 exec, 1
  buffer_store_dwordx2 v[108:109], v110, s[16:19], s55 offen sc1
  s_mov_b64 exec, -1
  s_cmp_eq_u32 s35, 0
  s_cbranch_scc1 A_KV2S_RET_Q
  s_branch A_KV2S_RET
A_KV2L:
  s_lshl_b32 s85, s32, 9
  s_add_u32 s85, s85, 121733120
  s_lshr_b32 s53, s35, 1
  s_lshl_b32 s53, s53, 13
  s_add_u32 s85, s85, s53
  buffer_load_dwordx2 v[6:7], v5, s[16:19], s85 offen sc1
  s_branch A_KV2L_RET
A_KV2C:
  s_waitcnt vmcnt(8)
  s_cmp_lg_u32 s35, 4
  s_cbranch_scc1 A_NOEPF
  global_load_dword v2, v99, s[80:81]
A_NOEPF:
  s_mov_b32 s53, 0
A_KV2P:
  v_cmp_eq_u32 vcc, s86, v6
  v_cmp_eq_u32 s[4:5], s87, v7
  s_nop 0
  s_and_b64 vcc, vcc, s[4:5]
  s_cmp_eq_u64 vcc, exec
  s_cbranch_scc1 A_LOOP
  s_sleep 2
  buffer_load_dwordx2 v[6:7], v5, s[16:19], s85 offen sc1
  s_waitcnt vmcnt(0)
  s_add_u32 s53, s53, 1
  s_cmp_lt_u32 s53, 200000
  s_cbranch_scc1 A_KV2P
  s_branch A_LOOP
A_ALTW:
  s_waitcnt vmcnt(27)
  s_branch A_ALTW_RET
M_FB:
  s_waitcnt vmcnt(0)
  s_lshl_b32 s7, s33, 7
  s_lshl_b32 s6, s3, 5
  s_add_u32 s7, s7, s6
  v_and_b32 v6, 31, v0
  v_add_u32 v6, s7, v6
  v_mul_u32_u24 v6, 896, v6
  v_lshrrev_b32 v7, 5, v0
  v_lshl_add_u32 v6, v7, 5, v6
  buffer_load_dwordx4 v[96:99], v6, s[20:23], 0 offen offset:0
  buffer_load_dwordx4 v[100:103], v6, s[20:23], 0 offen offset:16
  buffer_load_dwordx4 v[104:107], v6, s[20:23], 0 offen offset:64
  buffer_load_dwordx4 v[108:111], v6, s[20:23], 0 offen offset:80
  buffer_load_dwordx4 v[112:115], v6, s[20:23], 0 offen offset:128
  buffer_load_dwordx4 v[116:119], v6, s[20:23], 0 offen offset:144
  buffer_load_dwordx4 v[120:123], v6, s[20:23], 0 offen offset:192
  buffer_load_dwordx4 v[124:127], v6, s[20:23], 0 offen offset:208
  buffer_load_dwordx4 v[128:131], v6, s[20:23], 0 offen offset:256
  buffer_load_dwordx4 v[132:135], v6, s[20:23], 0 offen offset:272
  buffer_load_dwordx4 v[136:139], v6, s[20:23], 0 offen offset:320
  buffer_load_dwordx4 v[140:143], v6, s[20:23], 0 offen offset:336
  buffer_load_dwordx4 v[144:147], v6, s[20:23], 0 offen offset:384
  buffer_load_dwordx4 v[148:151], v6, s[20:23], 0 offen offset:400
  buffer_load_dwordx4 v[152:155], v6, s[20:23], 0 offen offset:448
  buffer_load_dwordx4 v[156:159], v6, s[20:23], 0 offen offset:464
  buffer_load_dwordx4 v[160:163], v6, s[20:23], 0 offen offset:512
  buffer_load_dwordx4 v[164:167], v6, s[20:23], 0 offen offset:528
  buffer_load_dwordx4 v[168:171], v6, s[20:23], 0 offen offset:576
  buffer_load_dwordx4 v[172:175], v6, s[20:23], 0 offen offset:592
  buffer_load_dwordx4 v[176:179], v6, s[20:23], 0 offen offset:640
  buffer_load_dwordx4 v[180:183], v6, s[20:23], 0 offen offset:656
  buffer_load_dwordx4 v[184:187], v6, s[20:23], 0 offen offset:704
  buffer_load_dwordx4 v[188:191], v6, s[20:23], 0 offen offset:720
  buffer_load_dwordx4 v[192:195], v6, s[20:23], 0 offen offset:768
  buffer_load_dwordx4 v[196:199], v6, s[20:23], 0 offen offset:784
  buffer_load_dwordx4 v[200:203], v6, s[20:23], 0 offen offset:832
  buffer_load_dwordx4 v[204:207], v6, s[20:23], 0 offen offset:848
  s_mov_b32 s7, 0x3f803f80
  v_mov_b32 v224, 0
  v_mov_b32 v225, 0
  v_mov_b32 v226, 0
  v_mov_b32 v227, 0
  v_mov_b32 v228, 0
  v_mov_b32 v229, 0
  v_mov_b32 v230, 0
  v_mov_b32 v231, 0
  s_waitcnt vmcnt(27)
  v_dot2_f32_bf16 v224, v96, s7, v224
  v_dot2_f32_bf16 v228, v96, v96, v228
  v_dot2_f32_bf16 v225, v97, s7, v225
  v_dot2_f32_bf16 v229, v97, v97, v229
  v_dot2_f32_bf16 v226, v98, s7, v226
  v_dot2_f32_bf16 v230, v98, v98, v230
  v_dot2_f32_bf16 v227, v99, s7, v227
  v_dot2_f32_bf16 v231, v99, v99, v231
  s_waitcnt vmcnt(26)
  v_dot2_f32_bf16 v224, v100, s7, v224
  v_dot2_f32_bf16 v228, v100, v100, v228
  v_dot2_f32_bf16 v225, v101, s7, v225
  v_dot2_f32_bf16 v229, v101, v101, v229
  v_dot2_f32_bf16 v226, v102, s7, v226
  v_dot2_f32_bf16 v230, v102, v102, v230
  v_dot2_f32_bf16 v227, v103, s7, v227
  v_dot2_f32_bf16 v231, v103, v103, v231
  s_waitcnt vmcnt(25)
  v_dot2_f32_bf16 v224, v104, s7, v224
  v_dot2_f32_bf16 v228, v104, v104, v228
  v_dot2_f32_bf16 v225, v105, s7, v225
  v_dot2_f32_bf16 v229, v105, v105, v229
  v_dot2_f32_bf16 v226, v106, s7, v226
  v_dot2_f32_bf16 v230, v106, v106, v230
  v_dot2_f32_bf16 v227, v107, s7, v227
  v_dot2_f32_bf16 v231, v107, v107, v231
  s_waitcnt vmcnt(24)
  v_dot2_f32_bf16 v224, v108, s7, v224
  v_dot2_f32_bf16 v228, v108, v108, v228
  v_dot2_f32_bf16 v225, v109, s7, v225
  v_dot2_f32_bf16 v229, v109, v109, v229
  v_dot2_f32_bf16 v226, v110, s7, v226
  v_dot2_f32_bf16 v230, v110, v110, v230
  v_dot2_f32_bf16 v227, v111, s7, v227
  v_dot2_f32_bf16 v231, v111, v111, v231
  s_waitcnt vmcnt(23)
  v_dot2_f32_bf16 v224, v112, s7, v224
  v_dot2_f32_bf16 v228, v112, v112, v228
  v_dot2_f32_bf16 v225, v113, s7, v225
  v_dot2_f32_bf16 v229, v113, v113, v229
  v_dot2_f32_bf16 v226, v114, s7, v226
  v_dot2_f32_bf16 v230, v114, v114, v230
  v_dot2_f32_bf16 v227, v115, s7, v227
  v_dot2_f32_bf16 v231, v115, v115, v231
  s_waitcnt vmcnt(22)
  v_dot2_f32_bf16 v224, v116, s7, v224
  v_dot2_f32_bf16 v228, v116, v116, v228
  v_dot2_f32_bf16 v225, v117, s7, v225
  v_dot2_f32_bf16 v229, v117, v117, v229
  v_dot2_f32_bf16 v226, v118, s7, v226
  v_dot2_f32_bf16 v230, v118, v118, v230
  v_dot2_f32_bf16 v227, v119, s7, v227
  v_dot2_f32_bf16 v231, v119, v119, v231
  s_waitcnt vmcnt(21)
  v_dot2_f32_bf16 v224, v120, s7, v224
  v_dot2_f32_bf16 v228, v120, v120, v228
  v_dot2_f32_bf16 v225, v121, s7, v225
  v_dot2_f32_bf16 v229, v121, v121, v229
  v_dot2_f32_bf16 v226, v122, s7, v226
  v_dot2_f32_bf16 v230, v122, v122, v230
  v_dot2_f32_bf16 v227, v123, s7, v227
  v_dot2_f32_bf16 v231, v123, v123, v231
  s_waitcnt vmcnt(20)
  v_dot2_f32_bf16 v224, v124, s7, v224
  v_dot2_f32_bf16 v228, v124, v124, v228
  v_dot2_f32_bf16 v225, v125, s7, v225
  v_dot2_f32_bf16 v229, v125, v125, v229
  v_dot2_f32_bf16 v226, v126, s7, v226
  v_dot2_f32_bf16 v230, v126, v126, v230
  v_dot2_f32_bf16 v227, v127, s7, v227
  v_dot2_f32_bf16 v231, v127, v127, v231
  s_waitcnt vmcnt(19)
  v_dot2_f32_bf16 v224, v128, s7, v224
  v_dot2_f32_bf16 v228, v128, v128, v228
  v_dot2_f32_bf16 v225, v129, s7, v225
  v_dot2_f32_bf16 v229, v129, v129, v229
  v_dot2_f32_bf16 v226, v130, s7, v226
  v_dot2_f32_bf16 v230, v130, v130, v230
  v_dot2_f32_bf16 v227, v131, s7, v227
  v_dot2_f32_bf16 v231, v131, v131, v231
  s_waitcnt vmcnt(18)
  v_dot2_f32_bf16 v224, v132, s7, v224
  v_dot2_f32_bf16 v228, v132, v132, v228
  v_dot2_f32_bf16 v225, v133, s7, v225
  v_dot2_f32_bf16 v229, v133, v133, v229
  v_dot2_f32_bf16 v226, v134, s7, v226
  v_dot2_f32_bf16 v230, v134, v134, v230
  v_dot2_f32_bf16 v227, v135, s7, v227
  v_dot2_f32_bf16 v231, v135, v135, v231
  s_waitcnt vmcnt(17)
  v_dot2_f32_bf16 v224, v136, s7, v224
  v_dot2_f32_bf16 v228, v136, v136, v228
  v_dot2_f32_bf16 v225, v137, s7, v225
  v_dot2_f32_bf16 v229, v137, v137, v229
  v_dot2_f32_bf16 v226, v138, s7, v226
  v_dot2_f32_bf16 v230, v138, v138, v230
  v_dot2_f32_bf16 v227, v139, s7, v227
  v_dot2_f32_bf16 v231, v139, v139, v231
  s_waitcnt vmcnt(16)
  v_dot2_f32_bf16 v224, v140, s7, v224
  v_dot2_f32_bf16 v228, v140, v140, v228
  v_dot2_f32_bf16 v225, v141, s7, v225
  v_dot2_f32_bf16 v229, v141, v141, v229
  v_dot2_f32_bf16 v226, v142, s7, v226
  v_dot2_f32_bf16 v230, v142, v142, v230
  v_dot2_f32_bf16 v227, v143, s7, v227
  v_dot2_f32_bf16 v231, v143, v143, v231
  s_waitcnt vmcnt(15)
  v_dot2_f32_bf16 v224, v144, s7, v224
  v_dot2_f32_bf16 v228, v144, v144, v228
  v_dot2_f32_bf16 v225, v145, s7, v225
  v_dot2_f32_bf16 v229, v145, v145, v229
  v_dot2_f32_bf16 v226, v146, s7, v226
  v_dot2_f32_bf16 v230, v146, v146, v230
  v_dot2_f32_bf16 v227, v147, s7, v227
  v_dot2_f32_bf16 v231, v147, v147, v231
  s_waitcnt vmcnt(14)
  v_dot2_f32_bf16 v224, v148, s7, v224
  v_dot2_f32_bf16 v228, v148, v148, v228
  v_dot2_f32_bf16 v225, v149, s7, v225
  v_dot2_f32_bf16 v229, v149, v149, v229
  v_dot2_f32_bf16 v226, v150, s7, v226
  v_dot2_f32_bf16 v230, v150, v150, v230
  v_dot2_f32_bf16 v227, v151, s7, v227
  v_dot2_f32_bf16 v231, v151, v151, v231
  s_waitcnt vmcnt(13)
  v_dot2_f32_bf16 v224, v152, s7, v224
  v_dot2_f32_bf16 v228, v152, v152, v228
  v_dot2_f32_bf16 v225, v153, s7, v225
  v_dot2_f32_bf16 v229, v153, v153, v229
  v_dot2_f32_bf16 v226, v154, s7, v226
  v_dot2_f32_bf16 v230, v154, v154, v230
  v_dot2_f32_bf16 v227, v155, s7, v227
  v_dot2_f32_bf16 v231, v155, v155, v231
  s_waitcnt vmcnt(12)
  v_dot2_f32_bf16 v224, v156, s7, v224
  v_dot2_f32_bf16 v228, v156, v156, v228
  v_dot2_f32_bf16 v225, v157, s7, v225
  v_dot2_f32_bf16 v229, v157, v157, v229
  v_dot2_f32_bf16 v226, v158, s7, v226
  v_dot2_f32_bf16 v230, v158, v158, v230
  v_dot2_f32_bf16 v227, v159, s7, v227
  v_dot2_f32_bf16 v231, v159, v159, v231
  s_waitcnt vmcnt(11)
  v_dot2_f32_bf16 v224, v160, s7, v224
  v_dot2_f32_bf16 v228, v160, v160, v228
  v_dot2_f32_bf16 v225, v161, s7, v225
  v_dot2_f32_bf16 v229, v161, v161, v229
  v_dot2_f32_bf16 v226, v162, s7, v226
  v_dot2_f32_bf16 v230, v162, v162, v230
  v_dot2_f32_bf16 v227, v163, s7, v227
  v_dot2_f32_bf16 v231, v163, v163, v231
  s_waitcnt vmcnt(10)
  v_dot2_f32_bf16 v224, v164, s7, v224
  v_dot2_f32_bf16 v228, v164, v164, v228
  v_dot2_f32_bf16 v225, v165, s7, v225
  v_dot2_f32_bf16 v229, v165, v165, v229
  v_dot2_f32_bf16 v226, v166, s7, v226
  v_dot2_f32_bf16 v230, v166, v166, v230
  v_dot2_f32_bf16 v227, v167, s7, v227
  v_dot2_f32_bf16 v231, v167, v167, v231
  s_waitcnt vmcnt(9)
  v_dot2_f32_bf16 v224, v168, s7, v224
  v_dot2_f32_bf16 v228, v168, v168, v228
  v_dot2_f32_bf16 v225, v169, s7, v225
  v_dot2_f32_bf16 v229, v169, v169, v229
  v_dot2_f32_bf16 v226, v170, s7, v226
  v_dot2_f32_bf16 v230, v170, v170, v230
  v_dot2_f32_bf16 v227, v171, s7, v227
  v_dot2_f32_bf16 v231, v171, v171, v231
  s_waitcnt vmcnt(8)
  v_dot2_f32_bf16 v224, v172, s7, v224
  v_dot2_f32_bf16 v228, v172, v172, v228
  v_dot2_f32_bf16 v225, v173, s7, v225
  v_dot2_f32_bf16 v229, v173, v173, v229
  v_dot2_f32_bf16 v226, v174, s7, v226
  v_dot2_f32_bf16 v230, v174, v174, v230
  v_dot2_f32_bf16 v227, v175, s7, v227
  v_dot2_f32_bf16 v231, v175, v175, v231
  s_waitcnt vmcnt(7)
  v_dot2_f32_bf16 v224, v176, s7, v224
  v_dot2_f32_bf16 v228, v176, v176, v228
  v_dot2_f32_bf16 v225, v177, s7, v225
  v_dot2_f32_bf16 v229, v177, v177, v229
  v_dot2_f32_bf16 v226, v178, s7, v226
  v_dot2_f32_bf16 v230, v178, v178, v230
  v_dot2_f32_bf16 v227, v179, s7, v227
  v_dot2_f32_bf16 v231, v179, v179, v231
  s_waitcnt vmcnt(6)
  v_dot2_f32_bf16 v224, v180, s7, v224
  v_dot2_f32_bf16 v228, v180, v180, v228
  v_dot2_f32_bf16 v225, v181, s7, v225
  v_dot2_f32_bf16 v229, v181, v181, v229
  v_dot2_f32_bf16 v226, v182, s7, v226
  v_dot2_f32_bf16 v230, v182, v182, v230
  v_dot2_f32_bf16 v227, v183, s7, v227
  v_dot2_f32_bf16 v231, v183, v183, v231
  s_waitcnt vmcnt(5)
  v_dot2_f32_bf16 v224, v184, s7, v224
  v_dot2_f32_bf16 v228, v184, v184, v228
  v_dot2_f32_bf16 v225, v185, s7, v225
  v_dot2_f32_bf16 v229, v185, v185, v229
  v_dot2_f32_bf16 v226, v186, s7, v226
  v_dot2_f32_bf16 v230, v186, v186, v230
  v_dot2_f32_bf16 v227, v187, s7, v227
  v_dot2_f32_bf16 v231, v187, v187, v231
  s_waitcnt vmcnt(4)
  v_dot2_f32_bf16 v224, v188, s7, v224
  v_dot2_f32_bf16 v228, v188, v188, v228
  v_dot2_f32_bf16 v225, v189, s7, v225
  v_dot2_f32_bf16 v229, v189, v189, v229
  v_dot2_f32_bf16 v226, v190, s7, v226
  v_dot2_f32_bf16 v230, v190, v190, v230
  v_dot2_f32_bf16 v227, v191, s7, v227
  v_dot2_f32_bf16 v231, v191, v191, v231
  s_waitcnt vmcnt(3)
  v_dot2_f32_bf16 v224, v192, s7, v224
  v_dot2_f32_bf16 v228, v192, v192, v228
  v_dot2_f32_bf16 v225, v193, s7, v225
  v_dot2_f32_bf16 v229, v193, v193, v229
  v_dot2_f32_bf16 v226, v194, s7, v226
  v_dot2_f32_bf16 v230, v194, v194, v230
  v_dot2_f32_bf16 v227, v195, s7, v227
  v_dot2_f32_bf16 v231, v195, v195, v231
  s_waitcnt vmcnt(2)
  v_dot2_f32_bf16 v224, v196, s7, v224
  v_dot2_f32_bf16 v228, v196, v196, v228
  v_dot2_f32_bf16 v225, v197, s7, v225
  v_dot2_f32_bf16 v229, v197, v197, v229
  v_dot2_f32_bf16 v226, v198, s7, v226
  v_dot2_f32_bf16 v230, v198, v198, v230
  v_dot2_f32_bf16 v227, v199, s7, v227
  v_dot2_f32_bf16 v231, v199, v199, v231
  s_waitcnt vmcnt(1)
  v_dot2_f32_bf16 v224, v200, s7, v224
  v_dot2_f32_bf16 v228, v200, v200, v228
  v_dot2_f32_bf16 v225, v201, s7, v225
  v_dot2_f32_bf16 v229, v201, v201, v229
  v_dot2_f32_bf16 v226, v202, s7, v226
  v_dot2_f32_bf16 v230, v202, v202, v230
  v_dot2_f32_bf16 v227, v203, s7, v227
  v_dot2_f32_bf16 v231, v203, v203, v231
  s_waitcnt vmcnt(0)
  v_dot2_f32_bf16 v224, v204, s7, v224
  v_dot2_f32_bf16 v228, v204, v204, v228
  v_dot2_f32_bf16 v225, v205, s7, v225
  v_dot2_f32_bf16 v229, v205, v205, v229
  v_dot2_f32_bf16 v226, v206, s7, v226
  v_dot2_f32_bf16 v230, v206, v206, v230
  v_dot2_f32_bf16 v227, v207, s7, v227
  v_dot2_f32_bf16 v231, v207, v207, v231
  s_nop 3
  v_add_f32 v224, v224, v225
  v_add_f32 v226, v226, v227
  v_add_f32 v228, v228, v229
  v_add_f32 v230, v230, v231
  v_add_f32 v224, v224, v226
  v_add_f32 v228, v228, v230
  v_mov_b32 v225, v224
  v_mov_b32 v229, v228
  s_nop 1
  v_permlane32_swap_b32 v224, v225
  v_permlane32_swap_b32 v228, v229
  v_add_f32 v224, v224, v225
  v_add_f32 v228, v228, v229
  v_mul_f32 v224, 0x3b124925, v224
  v_mul_f32 v228, 0x3b124925, v228
  v_fma_f32 v228, -v224, v224, v228
  v_max_f32 v228, 0, v228
  v_add_f32 v228, 0x3727c5ac, v228
  v_rsq_f32 v228, v228
  s_nop 0
  v_mul_f32 v228, 0x3db8aa3b, v228
  v_mul_f32 v224, v224, v228
  v_mov_b32 v229, v228
  v_sub_f32 v224, 0, v224
  v_mov_b32 v225, v224
  v_lshlrev_b32 v232, 16, v96
  v_and_b32 v233, 0xffff0000, v96
  v_pk_fma_f32 v[232:233], v[232:233], v[228:229], v[224:225]
  v_cvt_pk_bf16_f32 v96, v232, v233
  v_lshlrev_b32 v234, 16, v97
  v_and_b32 v235, 0xffff0000, v97
  v_pk_fma_f32 v[234:235], v[234:235], v[228:229], v[224:225]
  v_cvt_pk_bf16_f32 v97, v234, v235
  v_lshlrev_b32 v236, 16, v98
  v_and_b32 v237, 0xffff0000, v98
  v_pk_fma_f32 v[236:237], v[236:237], v[228:229], v[224:225]
  v_cvt_pk_bf16_f32 v98, v236, v237
  v_lshlrev_b32 v238, 16, v99
  v_and_b32 v239, 0xffff0000, v99
  v_pk_fma_f32 v[238:239], v[238:239], v[228:229], v[224:225]
  v_cvt_pk_bf16_f32 v99, v238, v239
  v_lshlrev_b32 v240, 16, v100
  v_and_b32 v241, 0xffff0000, v100
  v_pk_fma_f32 v[240:241], v[240:241], v[228:229], v[224:225]
  v_cvt_pk_bf16_f32 v100, v240, v241
  v_lshlrev_b32 v242, 16, v101
  v_and_b32 v243, 0xffff0000, v101
  v_pk_fma_f32 v[242:243], v[242:243], v[228:229], v[224:225]
  v_cvt_pk_bf16_f32 v101, v242, v243
  v_lshlrev_b32 v244, 16, v102
  v_and_b32 v245, 0xffff0000, v102
  v_pk_fma_f32 v[244:245], v[244:245], v[228:229], v[224:225]
  v_cvt_pk_bf16_f32 v102, v244, v245
  v_lshlrev_b32 v246, 16, v103
  v_and_b32 v247, 0xffff0000, v103
  v_pk_fma_f32 v[246:247], v[246:247], v[228:229], v[224:225]
  v_cvt_pk_bf16_f32 v103, v246, v247
  v_lshlrev_b32 v232, 16, v104
  v_and_b32 v233, 0xffff0000, v104
  v_pk_fma_f32 v[232:233], v[232:233], v[228:229], v[224:225]
  v_cvt_pk_bf16_f32 v104, v232, v233
  v_lshlrev_b32 v234, 16, v105
  v_and_b32 v235, 0xffff0000, v105
  v_pk_fma_f32 v[234:235], v[234:235], v[228:229], v[224:225]
  v_cvt_pk_bf16_f32 v105, v234, v235
  v_lshlrev_b32 v236, 16, v106
  v_and_b32 v237, 0xffff0000, v106
  v_pk_fma_f32 v[236:237], v[236:237], v[228:229], v[224:225]
  v_cvt_pk_bf16_f32 v106, v236, v237
  v_lshlrev_b32 v238, 16, v107
  v_and_b32 v239, 0xffff0000, v107
  v_pk_fma_f32 v[238:239], v[238:239], v[228:229], v[224:225]
  v_cvt_pk_bf16_f32 v107, v238, v239
  v_lshlrev_b32 v240, 16, v108
  v_and_b32 v241, 0xffff0000, v108
  v_pk_fma_f32 v[240:241], v[240:241], v[228:229], v[224:225]
  v_cvt_pk_bf16_f32 v108, v240, v241
  v_lshlrev_b32 v242, 16, v109
  v_and_b32 v243, 0xffff0000, v109
  v_pk_fma_f32 v[242:243], v[242:243], v[228:229], v[224:225]
  v_cvt_pk_bf16_f32 v109, v242, v243
  v_lshlrev_b32 v244, 16, v110
  v_and_b32 v245, 0xffff0000, v110
  v_pk_fma_f32 v[244:245], v[244:245], v[228:229], v[224:225]
  v_cvt_pk_bf16_f32 v110, v244, v245
  v_lshlrev_b32 v246, 16, v111
  v_and_b32 v247, 0xffff0000, v111
  v_pk_fma_f32 v[246:247], v[246:247], v[228:229], v[224:225]
  v_cvt_pk_bf16_f32 v111, v246, v247
  v_lshlrev_b32 v232, 16, v112
  v_and_b32 v233, 0xffff0000, v112
  v_pk_fma_f32 v[232:233], v[232:233], v[228:229], v[224:225]
  v_cvt_pk_bf16_f32 v112, v232, v233
  v_lshlrev_b32 v234, 16, v113
  v_and_b32 v235, 0xffff0000, v113
  v_pk_fma_f32 v[234:235], v[234:235], v[228:229], v[224:225]
  v_cvt_pk_bf16_f32 v113, v234, v235
  v_lshlrev_b32 v236, 16, v114
  v_and_b32 v237, 0xffff0000, v114
  v_pk_fma_f32 v[236:237], v[236:237], v[228:229], v[224:225]
  v_cvt_pk_bf16_f32 v114, v236, v237
  v_lshlrev_b32 v238, 16, v115
  v_and_b32 v239, 0xffff0000, v115
  v_pk_fma_f32 v[238:239], v[238:239], v[228:229], v[224:225]
  v_cvt_pk_bf16_f32 v115, v238, v239
  v_lshlrev_b32 v240, 16, v116
  v_and_b32 v241, 0xffff0000, v116
  v_pk_fma_f32 v[240:241], v[240:241], v[228:229], v[224:225]
  v_cvt_pk_bf16_f32 v116, v240, v241
  v_lshlrev_b32 v242, 16, v117
  v_and_b32 v243, 0xffff0000, v117
  v_pk_fma_f32 v[242:243], v[242:243], v[228:229], v[224:225]
  v_cvt_pk_bf16_f32 v117, v242, v243
  v_lshlrev_b32 v244, 16, v118
  v_and_b32 v245, 0xffff0000, v118
  v_pk_fma_f32 v[244:245], v[244:245], v[228:229], v[224:225]
  v_cvt_pk_bf16_f32 v118, v244, v245
  v_lshlrev_b32 v246, 16, v119
  v_and_b32 v247, 0xffff0000, v119
  v_pk_fma_f32 v[246:247], v[246:247], v[228:229], v[224:225]
  v_cvt_pk_bf16_f32 v119, v246, v247
  v_lshlrev_b32 v232, 16, v120
  v_and_b32 v233, 0xffff0000, v120
  v_pk_fma_f32 v[232:233], v[232:233], v[228:229], v[224:225]
  v_cvt_pk_bf16_f32 v120, v232, v233
  v_lshlrev_b32 v234, 16, v121
  v_and_b32 v235, 0xffff0000, v121
  v_pk_fma_f32 v[234:235], v[234:235], v[228:229], v[224:225]
  v_cvt_pk_bf16_f32 v121, v234, v235
  v_lshlrev_b32 v236, 16, v122
  v_and_b32 v237, 0xffff0000, v122
  v_pk_fma_f32 v[236:237], v[236:237], v[228:229], v[224:225]
  v_cvt_pk_bf16_f32 v122, v236, v237
  v_lshlrev_b32 v238, 16, v123
  v_and_b32 v239, 0xffff0000, v123
  v_pk_fma_f32 v[238:239], v[238:239], v[228:229], v[224:225]
  v_cvt_pk_bf16_f32 v123, v238, v239
  v_lshlrev_b32 v240, 16, v124
  v_and_b32 v241, 0xffff0000, v124
  v_pk_fma_f32 v[240:241], v[240:241], v[228:229], v[224:225]
  v_cvt_pk_bf16_f32 v124, v240, v241
  v_lshlrev_b32 v242, 16, v125
  v_and_b32 v243, 0xffff0000, v125
  v_pk_fma_f32 v[242:243], v[242:243], v[228:229], v[224:225]
  v_cvt_pk_bf16_f32 v125, v242, v243
  v_lshlrev_b32 v244, 16, v126
  v_and_b32 v245, 0xffff0000, v126
  v_pk_fma_f32 v[244:245], v[244:245], v[228:229], v[224:225]
  v_cvt_pk_bf16_f32 v126, v244, v245
  v_lshlrev_b32 v246, 16, v127
  v_and_b32 v247, 0xffff0000, v127
  v_pk_fma_f32 v[246:247], v[246:247], v[228:229], v[224:225]
  v_cvt_pk_bf16_f32 v127, v246, v247
  v_lshlrev_b32 v232, 16, v128
  v_and_b32 v233, 0xffff0000, v128
  v_pk_fma_f32 v[232:233], v[232:233], v[228:229], v[224:225]
  v_cvt_pk_bf16_f32 v128, v232, v233
  v_lshlrev_b32 v234, 16, v129
  v_and_b32 v235, 0xffff0000, v129
  v_pk_fma_f32 v[234:235], v[234:235], v[228:229], v[224:225]
  v_cvt_pk_bf16_f32 v129, v234, v235
  v_lshlrev_b32 v236, 16, v130
  v_and_b32 v237, 0xffff0000, v130
  v_pk_fma_f32 v[236:237], v[236:237], v[228:229], v[224:225]
  v_cvt_pk_bf16_f32 v130, v236, v237
  v_lshlrev_b32 v238, 16, v131
  v_and_b32 v239, 0xffff0000, v131
  v_pk_fma_f32 v[238:239], v[238:239], v[228:229], v[224:225]
  v_cvt_pk_bf16_f32 v131, v238, v239
  v_lshlrev_b32 v240, 16, v132
  v_and_b32 v241, 0xffff0000, v132
  v_pk_fma_f32 v[240:241], v[240:241], v[228:229], v[224:225]
  v_cvt_pk_bf16_f32 v132, v240, v241
  v_lshlrev_b32 v242, 16, v133
  v_and_b32 v243, 0xffff0000, v133
  v_pk_fma_f32 v[242:243], v[242:243], v[228:229], v[224:225]
  v_cvt_pk_bf16_f32 v133, v242, v243
  v_lshlrev_b32 v244, 16, v134
  v_and_b32 v245, 0xffff0000, v134
  v_pk_fma_f32 v[244:245], v[244:245], v[228:229], v[224:225]
  v_cvt_pk_bf16_f32 v134, v244, v245
  v_lshlrev_b32 v246, 16, v135
  v_and_b32 v247, 0xffff0000, v135
  v_pk_fma_f32 v[246:247], v[246:247], v[228:229], v[224:225]
  v_cvt_pk_bf16_f32 v135, v246, v247
  v_lshlrev_b32 v232, 16, v136
  v_and_b32 v233, 0xffff0000, v136
  v_pk_fma_f32 v[232:233], v[232:233], v[228:229], v[224:225]
  v_cvt_pk_bf16_f32 v136, v232, v233
  v_lshlrev_b32 v234, 16, v137
  v_and_b32 v235, 0xffff0000, v137
  v_pk_fma_f32 v[234:235], v[234:235], v[228:229], v[224:225]
  v_cvt_pk_bf16_f32 v137, v234, v235
  v_lshlrev_b32 v236, 16, v138
  v_and_b32 v237, 0xffff0000, v138
  v_pk_fma_f32 v[236:237], v[236:237], v[228:229], v[224:225]
  v_cvt_pk_bf16_f32 v138, v236, v237
  v_lshlrev_b32 v238, 16, v139
  v_and_b32 v239, 0xffff0000, v139
  v_pk_fma_f32 v[238:239], v[238:239], v[228:229], v[224:225]
  v_cvt_pk_bf16_f32 v139, v238, v239
  v_lshlrev_b32 v240, 16, v140
  v_and_b32 v241, 0xffff0000, v140
  v_pk_fma_f32 v[240:241], v[240:241], v[228:229], v[224:225]
  v_cvt_pk_bf16_f32 v140, v240, v241
  v_lshlrev_b32 v242, 16, v141
  v_and_b32 v243, 0xffff0000, v141
  v_pk_fma_f32 v[242:243], v[242:243], v[228:229], v[224:225]
  v_cvt_pk_bf16_f32 v141, v242, v243
  v_lshlrev_b32 v244, 16, v142
  v_and_b32 v245, 0xffff0000, v142
  v_pk_fma_f32 v[244:245], v[244:245], v[228:229], v[224:225]
  v_cvt_pk_bf16_f32 v142, v244, v245
  v_lshlrev_b32 v246, 16, v143
  v_and_b32 v247, 0xffff0000, v143
  v_pk_fma_f32 v[246:247], v[246:247], v[228:229], v[224:225]
  v_cvt_pk_bf16_f32 v143, v246, v247
  v_lshlrev_b32 v232, 16, v144
  v_and_b32 v233, 0xffff0000, v144
  v_pk_fma_f32 v[232:233], v[232:233], v[228:229], v[224:225]
  v_cvt_pk_bf16_f32 v144, v232, v233
  v_lshlrev_b32 v234, 16, v145
  v_and_b32 v235, 0xffff0000, v145
  v_pk_fma_f32 v[234:235], v[234:235], v[228:229], v[224:225]
  v_cvt_pk_bf16_f32 v145, v234, v235
  v_lshlrev_b32 v236, 16, v146
  v_and_b32 v237, 0xffff0000, v146
  v_pk_fma_f32 v[236:237], v[236:237], v[228:229], v[224:225]
  v_cvt_pk_bf16_f32 v146, v236, v237
  v_lshlrev_b32 v238, 16, v147
  v_and_b32 v239, 0xffff0000, v147
  v_pk_fma_f32 v[238:239], v[238:239], v[228:229], v[224:225]
  v_cvt_pk_bf16_f32 v147, v238, v239
  v_lshlrev_b32 v240, 16, v148
  v_and_b32 v241, 0xffff0000, v148
  v_pk_fma_f32 v[240:241], v[240:241], v[228:229], v[224:225]
  v_cvt_pk_bf16_f32 v148, v240, v241
  v_lshlrev_b32 v242, 16, v149
  v_and_b32 v243, 0xffff0000, v149
  v_pk_fma_f32 v[242:243], v[242:243], v[228:229], v[224:225]
  v_cvt_pk_bf16_f32 v149, v242, v243
  v_lshlrev_b32 v244, 16, v150
  v_and_b32 v245, 0xffff0000, v150
  v_pk_fma_f32 v[244:245], v[244:245], v[228:229], v[224:225]
  v_cvt_pk_bf16_f32 v150, v244, v245
  v_lshlrev_b32 v246, 16, v151
  v_and_b32 v247, 0xffff0000, v151
  v_pk_fma_f32 v[246:247], v[246:247], v[228:229], v[224:225]
  v_cvt_pk_bf16_f32 v151, v246, v247
  v_lshlrev_b32 v232, 16, v152
  v_and_b32 v233, 0xffff0000, v152
  v_pk_fma_f32 v[232:233], v[232:233], v[228:229], v[224:225]
  v_cvt_pk_bf16_f32 v152, v232, v233
  v_lshlrev_b32 v234, 16, v153
  v_and_b32 v235, 0xffff0000, v153
  v_pk_fma_f32 v[234:235], v[234:235], v[228:229], v[224:225]
  v_cvt_pk_bf16_f32 v153, v234, v235
  v_lshlrev_b32 v236, 16, v154
  v_and_b32 v237, 0xffff0000, v154
  v_pk_fma_f32 v[236:237], v[236:237], v[228:229], v[224:225]
  v_cvt_pk_bf16_f32 v154, v236, v237
  v_lshlrev_b32 v238, 16, v155
  v_and_b32 v239, 0xffff0000, v155
  v_pk_fma_f32 v[238:239], v[238:239], v[228:229], v[224:225]
  v_cvt_pk_bf16_f32 v155, v238, v239
  v_lshlrev_b32 v240, 16, v156
  v_and_b32 v241, 0xffff0000, v156
  v_pk_fma_f32 v[240:241], v[240:241], v[228:229], v[224:225]
  v_cvt_pk_bf16_f32 v156, v240, v241
  v_lshlrev_b32 v242, 16, v157
  v_and_b32 v243, 0xffff0000, v157
  v_pk_fma_f32 v[242:243], v[242:243], v[228:229], v[224:225]
  v_cvt_pk_bf16_f32 v157, v242, v243
  v_lshlrev_b32 v244, 16, v158
  v_and_b32 v245, 0xffff0000, v158
  v_pk_fma_f32 v[244:245], v[244:245], v[228:229], v[224:225]
  v_cvt_pk_bf16_f32 v158, v244, v245
  v_lshlrev_b32 v246, 16, v159
  v_and_b32 v247, 0xffff0000, v159
  v_pk_fma_f32 v[246:247], v[246:247], v[228:229], v[224:225]
  v_cvt_pk_bf16_f32 v159, v246, v247
  v_lshlrev_b32 v232, 16, v160
  v_and_b32 v233, 0xffff0000, v160
  v_pk_fma_f32 v[232:233], v[232:233], v[228:229], v[224:225]
  v_cvt_pk_bf16_f32 v160, v232, v233
  v_lshlrev_b32 v234, 16, v161
  v_and_b32 v235, 0xffff0000, v161
  v_pk_fma_f32 v[234:235], v[234:235], v[228:229], v[224:225]
  v_cvt_pk_bf16_f32 v161, v234, v235
  v_lshlrev_b32 v236, 16, v162
  v_and_b32 v237, 0xffff0000, v162
  v_pk_fma_f32 v[236:237], v[236:237], v[228:229], v[224:225]
  v_cvt_pk_bf16_f32 v162, v236, v237
  v_lshlrev_b32 v238, 16, v163
  v_and_b32 v239, 0xffff0000, v163
  v_pk_fma_f32 v[238:239], v[238:239], v[228:229], v[224:225]
  v_cvt_pk_bf16_f32 v163, v238, v239
  v_lshlrev_b32 v240, 16, v164
  v_and_b32 v241, 0xffff0000, v164
  v_pk_fma_f32 v[240:241], v[240:241], v[228:229], v[224:225]
  v_cvt_pk_bf16_f32 v164, v240, v241
  v_lshlrev_b32 v242, 16, v165
  v_and_b32 v243, 0xffff0000, v165
  v_pk_fma_f32 v[242:243], v[242:243], v[228:229], v[224:225]
  v_cvt_pk_bf16_f32 v165, v242, v243
  v_lshlrev_b32 v244, 16, v166
  v_and_b32 v245, 0xffff0000, v166
  v_pk_fma_f32 v[244:245], v[244:245], v[228:229], v[224:225]
  v_cvt_pk_bf16_f32 v166, v244, v245
  v_lshlrev_b32 v246, 16, v167
  v_and_b32 v247, 0xffff0000, v167
  v_pk_fma_f32 v[246:247], v[246:247], v[228:229], v[224:225]
  v_cvt_pk_bf16_f32 v167, v246, v247
  v_lshlrev_b32 v232, 16, v168
  v_and_b32 v233, 0xffff0000, v168
  v_pk_fma_f32 v[232:233], v[232:233], v[228:229], v[224:225]
  v_cvt_pk_bf16_f32 v168, v232, v233
  v_lshlrev_b32 v234, 16, v169
  v_and_b32 v235, 0xffff0000, v169
  v_pk_fma_f32 v[234:235], v[234:235], v[228:229], v[224:225]
  v_cvt_pk_bf16_f32 v169, v234, v235
  v_lshlrev_b32 v236, 16, v170
  v_and_b32 v237, 0xffff0000, v170
  v_pk_fma_f32 v[236:237], v[236:237], v[228:229], v[224:225]
  v_cvt_pk_bf16_f32 v170, v236, v237
  v_lshlrev_b32 v238, 16, v171
  v_and_b32 v239, 0xffff0000, v171
  v_pk_fma_f32 v[238:239], v[238:239], v[228:229], v[224:225]
  v_cvt_pk_bf16_f32 v171, v238, v239
  v_lshlrev_b32 v240, 16, v172
  v_and_b32 v241, 0xffff0000, v172
  v_pk_fma_f32 v[240:241], v[240:241], v[228:229], v[224:225]
  v_cvt_pk_bf16_f32 v172, v240, v241
  v_lshlrev_b32 v242, 16, v173
  v_and_b32 v243, 0xffff0000, v173
  v_pk_fma_f32 v[242:243], v[242:243], v[228:229], v[224:225]
  v_cvt_pk_bf16_f32 v173, v242, v243
  v_lshlrev_b32 v244, 16, v174
  v_and_b32 v245, 0xffff0000, v174
  v_pk_fma_f32 v[244:245], v[244:245], v[228:229], v[224:225]
  v_cvt_pk_bf16_f32 v174, v244, v245
  v_lshlrev_b32 v246, 16, v175
  v_and_b32 v247, 0xffff0000, v175
  v_pk_fma_f32 v[246:247], v[246:247], v[228:229], v[224:225]
  v_cvt_pk_bf16_f32 v175, v246, v247
  v_lshlrev_b32 v232, 16, v176
  v_and_b32 v233, 0xffff0000, v176
  v_pk_fma_f32 v[232:233], v[232:233], v[228:229], v[224:225]
  v_cvt_pk_bf16_f32 v176, v232, v233
  v_lshlrev_b32 v234, 16, v177
  v_and_b32 v235, 0xffff0000, v177
  v_pk_fma_f32 v[234:235], v[234:235], v[228:229], v[224:225]
  v_cvt_pk_bf16_f32 v177, v234, v235
  v_lshlrev_b32 v236, 16, v178
  v_and_b32 v237, 0xffff0000, v178
  v_pk_fma_f32 v[236:237], v[236:237], v[228:229], v[224:225]
  v_cvt_pk_bf16_f32 v178, v236, v237
  v_lshlrev_b32 v238, 16, v179
  v_and_b32 v239, 0xffff0000, v179
  v_pk_fma_f32 v[238:239], v[238:239], v[228:229], v[224:225]
  v_cvt_pk_bf16_f32 v179, v238, v239
  v_lshlrev_b32 v240, 16, v180
  v_and_b32 v241, 0xffff0000, v180
  v_pk_fma_f32 v[240:241], v[240:241], v[228:229], v[224:225]
  v_cvt_pk_bf16_f32 v180, v240, v241
  v_lshlrev_b32 v242, 16, v181
  v_and_b32 v243, 0xffff0000, v181
  v_pk_fma_f32 v[242:243], v[242:243], v[228:229], v[224:225]
  v_cvt_pk_bf16_f32 v181, v242, v243
  v_lshlrev_b32 v244, 16, v182
  v_and_b32 v245, 0xffff0000, v182
  v_pk_fma_f32 v[244:245], v[244:245], v[228:229], v[224:225]
  v_cvt_pk_bf16_f32 v182, v244, v245
  v_lshlrev_b32 v246, 16, v183
  v_and_b32 v247, 0xffff0000, v183
  v_pk_fma_f32 v[246:247], v[246:247], v[228:229], v[224:225]
  v_cvt_pk_bf16_f32 v183, v246, v247
  v_lshlrev_b32 v232, 16, v184
  v_and_b32 v233, 0xffff0000, v184
  v_pk_fma_f32 v[232:233], v[232:233], v[228:229], v[224:225]
  v_cvt_pk_bf16_f32 v184, v232, v233
  v_lshlrev_b32 v234, 16, v185
  v_and_b32 v235, 0xffff0000, v185
  v_pk_fma_f32 v[234:235], v[234:235], v[228:229], v[224:225]
  v_cvt_pk_bf16_f32 v185, v234, v235
  v_lshlrev_b32 v236, 16, v186
  v_and_b32 v237, 0xffff0000, v186
  v_pk_fma_f32 v[236:237], v[236:237], v[228:229], v[224:225]
  v_cvt_pk_bf16_f32 v186, v236, v237
  v_lshlrev_b32 v238, 16, v187
  v_and_b32 v239, 0xffff0000, v187
  v_pk_fma_f32 v[238:239], v[238:239], v[228:229], v[224:225]
  v_cvt_pk_bf16_f32 v187, v238, v239
  v_lshlrev_b32 v240, 16, v188
  v_and_b32 v241, 0xffff0000, v188
  v_pk_fma_f32 v[240:241], v[240:241], v[228:229], v[224:225]
  v_cvt_pk_bf16_f32 v188, v240, v241
  v_lshlrev_b32 v242, 16, v189
  v_and_b32 v243, 0xffff0000, v189
  v_pk_fma_f32 v[242:243], v[242:243], v[228:229], v[224:225]
  v_cvt_pk_bf16_f32 v189, v242, v243
  v_lshlrev_b32 v244, 16, v190
  v_and_b32 v245, 0xffff0000, v190
  v_pk_fma_f32 v[244:245], v[244:245], v[228:229], v[224:225]
  v_cvt_pk_bf16_f32 v190, v244, v245
  v_lshlrev_b32 v246, 16, v191
  v_and_b32 v247, 0xffff0000, v191
  v_pk_fma_f32 v[246:247], v[246:247], v[228:229], v[224:225]
  v_cvt_pk_bf16_f32 v191, v246, v247
  v_lshlrev_b32 v232, 16, v192
  v_and_b32 v233, 0xffff0000, v192
  v_pk_fma_f32 v[232:233], v[232:233], v[228:229], v[224:225]
  v_cvt_pk_bf16_f32 v192, v232, v233
  v_lshlrev_b32 v234, 16, v193
  v_and_b32 v235, 0xffff0000, v193
  v_pk_fma_f32 v[234:235], v[234:235], v[228:229], v[224:225]
  v_cvt_pk_bf16_f32 v193, v234, v235
  v_lshlrev_b32 v236, 16, v194
  v_and_b32 v237, 0xffff0000, v194
  v_pk_fma_f32 v[236:237], v[236:237], v[228:229], v[224:225]
  v_cvt_pk_bf16_f32 v194, v236, v237
  v_lshlrev_b32 v238, 16, v195
  v_and_b32 v239, 0xffff0000, v195
  v_pk_fma_f32 v[238:239], v[238:239], v[228:229], v[224:225]
  v_cvt_pk_bf16_f32 v195, v238, v239
  v_lshlrev_b32 v240, 16, v196
  v_and_b32 v241, 0xffff0000, v196
  v_pk_fma_f32 v[240:241], v[240:241], v[228:229], v[224:225]
  v_cvt_pk_bf16_f32 v196, v240, v241
  v_lshlrev_b32 v242, 16, v197
  v_and_b32 v243, 0xffff0000, v197
  v_pk_fma_f32 v[242:243], v[242:243], v[228:229], v[224:225]
  v_cvt_pk_bf16_f32 v197, v242, v243
  v_lshlrev_b32 v244, 16, v198
  v_and_b32 v245, 0xffff0000, v198
  v_pk_fma_f32 v[244:245], v[244:245], v[228:229], v[224:225]
  v_cvt_pk_bf16_f32 v198, v244, v245
  v_lshlrev_b32 v246, 16, v199
  v_and_b32 v247, 0xffff0000, v199
  v_pk_fma_f32 v[246:247], v[246:247], v[228:229], v[224:225]
  v_cvt_pk_bf16_f32 v199, v246, v247
  v_lshlrev_b32 v232, 16, v200
  v_and_b32 v233, 0xffff0000, v200
  v_pk_fma_f32 v[232:233], v[232:233], v[228:229], v[224:225]
  v_cvt_pk_bf16_f32 v200, v232, v233
  v_lshlrev_b32 v234, 16, v201
  v_and_b32 v235, 0xffff0000, v201
  v_pk_fma_f32 v[234:235], v[234:235], v[228:229], v[224:225]
  v_cvt_pk_bf16_f32 v201, v234, v235
  v_lshlrev_b32 v236, 16, v202
  v_and_b32 v237, 0xffff0000, v202
  v_pk_fma_f32 v[236:237], v[236:237], v[228:229], v[224:225]
  v_cvt_pk_bf16_f32 v202, v236, v237
  v_lshlrev_b32 v238, 16, v203
  v_and_b32 v239, 0xffff0000, v203
  v_pk_fma_f32 v[238:239], v[238:239], v[228:229], v[224:225]
  v_cvt_pk_bf16_f32 v203, v238, v239
  v_lshlrev_b32 v240, 16, v204
  v_and_b32 v241, 0xffff0000, v204
  v_pk_fma_f32 v[240:241], v[240:241], v[228:229], v[224:225]
  v_cvt_pk_bf16_f32 v204, v240, v241
  v_lshlrev_b32 v242, 16, v205
  v_and_b32 v243, 0xffff0000, v205
  v_pk_fma_f32 v[242:243], v[242:243], v[228:229], v[224:225]
  v_cvt_pk_bf16_f32 v205, v242, v243
  v_lshlrev_b32 v244, 16, v206
  v_and_b32 v245, 0xffff0000, v206
  v_pk_fma_f32 v[244:245], v[244:245], v[228:229], v[224:225]
  v_cvt_pk_bf16_f32 v206, v244, v245
  v_lshlrev_b32 v246, 16, v207
  v_and_b32 v247, 0xffff0000, v207
  v_pk_fma_f32 v[246:247], v[246:247], v[228:229], v[224:225]
  v_cvt_pk_bf16_f32 v207, v246, v247
  s_nop 1
  v_permlane16_swap_b32 v96, v100
  v_permlane16_swap_b32 v97, v101
  v_permlane16_swap_b32 v98, v102
  v_permlane16_swap_b32 v99, v103
  v_permlane16_swap_b32 v104, v108
  v_permlane16_swap_b32 v105, v109
  v_permlane16_swap_b32 v106, v110
  v_permlane16_swap_b32 v107, v111
  v_permlane16_swap_b32 v112, v116
  v_permlane16_swap_b32 v113, v117
  v_permlane16_swap_b32 v114, v118
  v_permlane16_swap_b32 v115, v119
  v_permlane16_swap_b32 v120, v124
  v_permlane16_swap_b32 v121, v125
  v_permlane16_swap_b32 v122, v126
  v_permlane16_swap_b32 v123, v127
  v_permlane16_swap_b32 v128, v132
  v_permlane16_swap_b32 v129, v133
  v_permlane16_swap_b32 v130, v134
  v_permlane16_swap_b32 v131, v135
  v_permlane16_swap_b32 v136, v140
  v_permlane16_swap_b32 v137, v141
  v_permlane16_swap_b32 v138, v142
  v_permlane16_swap_b32 v139, v143
  v_permlane16_swap_b32 v144, v148
  v_permlane16_swap_b32 v145, v149
  v_permlane16_swap_b32 v146, v150
  v_permlane16_swap_b32 v147, v151
  v_permlane16_swap_b32 v152, v156
  v_permlane16_swap_b32 v153, v157
  v_permlane16_swap_b32 v154, v158
  v_permlane16_swap_b32 v155, v159
  v_permlane16_swap_b32 v160, v164
  v_permlane16_swap_b32 v161, v165
  v_permlane16_swap_b32 v162, v166
  v_permlane16_swap_b32 v163, v167
  v_permlane16_swap_b32 v168, v172
  v_permlane16_swap_b32 v169, v173
  v_permlane16_swap_b32 v170, v174
  v_permlane16_swap_b32 v171, v175
  v_permlane16_swap_b32 v176, v180
  v_permlane16_swap_b32 v177, v181
  v_permlane16_swap_b32 v178, v182
  v_permlane16_swap_b32 v179, v183
  v_permlane16_swap_b32 v184, v188
  v_permlane16_swap_b32 v185, v189
  v_permlane16_swap_b32 v186, v190
  v_permlane16_swap_b32 v187, v191
  v_permlane16_swap_b32 v192, v196
  v_permlane16_swap_b32 v193, v197
  v_permlane16_swap_b32 v194, v198
  v_permlane16_swap_b32 v195, v199
  v_permlane16_swap_b32 v200, v204
  v_permlane16_swap_b32 v201, v205
  v_permlane16_swap_b32 v202, v206
  v_permlane16_swap_b32 v203, v207
  s_nop 1
  s_branch M_FB_RET
M_SKV:
  s_lshl_b32 s7, s76, 9
  s_add_u32 s7, s7, 121643008
  v_mov_b32 v20, s86
  v_mov_b32 v21, s87
  v_mov_b32 v22, s77
  s_mov_b64 exec, 1
  buffer_store_dwordx2 v[20:21], v22, s[16:19], s7 offen sc1
  s_mov_b64 exec, -1
  s_branch M_SKV_RET
M_SQ:
  s_cmp_lt_u32 s33, 8
  s_cbranch_scc1 M_SQ_RET
  v_mov_b32 v96, s86
  v_mov_b32 v97, s87
  v_mov_b32 v98, 0
  s_mov_b64 exec, 1
  buffer_store_dwordx2 v[96:97], v98, s[16:19], s74 offen sc1
  s_mov_b64 exec, -1
  s_branch M_SQ_RET
M_LATE:
  s_mov_b32 s6, 0
M_PKV:
  buffer_load_dwordx2 v[104:105], v5, s[16:19], s73 offen sc1
  s_waitcnt vmcnt(0)
  v_cmp_eq_u32 vcc, s86, v104
  v_cmp_eq_u32 s[4:5], s87, v105
  s_nop 0
  s_and_b64 vcc, vcc, s[4:5]
  s_cmp_eq_u64 vcc, exec
  s_cbranch_scc1 M_PKV_OK
  s_sleep 2
  s_add_u32 s6, s6, 1
  s_cmp_lt_u32 s6, 200000
  s_cbranch_scc1 M_PKV
  s_waitcnt vmcnt(0)
M_PKV_OK:
  s_mov_b32 s44, 950272
  s_cmp_gt_u32 s34, 0
  s_cselect_b32 s44, 983040, s44
  s_add_u32 s44, s44, s42
  s_add_u32 m0, s43, 0
  s_nop 0
  buffer_load_dwordx4 v3, s[16:19], s44 offen offset:0 sc1 lds
  buffer_load_dwordx4 v3, s[16:19], s44 offen offset:1024 sc1 lds
  buffer_load_dwordx4 v3, s[16:19], s44 offen offset:2048 sc1 lds
  buffer_load_dwordx4 v3, s[16:19], s44 offen offset:3072 sc1 lds
  s_add_u32 m0, s43, 65536
  s_nop 0
  buffer_load_dwordx4 v4, s[16:19], s44 offen offset:0 sc1 lds
  buffer_load_dwordx4 v4, s[16:19], s44 offen offset:1024 sc1 lds
  buffer_load_dwordx4 v4, s[16:19], s44 offen offset:2048 sc1 lds
  buffer_load_dwordx4 v4, s[16:19], s44 offen offset:3072 sc1 lds
  s_mov_b32 s45, 917504
  s_cmp_gt_u32 s34, 1
  s_cselect_b32 s45, 1015808, s45
  s_add_u32 s45, s45, s42
  s_add_u32 m0, s43, 16384
  s_nop 0
  buffer_load_dwordx4 v3, s[16:19], s45 offen offset:0 sc1 lds
  buffer_load_dwordx4 v3, s[16:19], s45 offen offset:1024 sc1 lds
  buffer_load_dwordx4 v3, s[16:19], s45 offen offset:2048 sc1 lds
  buffer_load_dwordx4 v3, s[16:19], s45 offen offset:3072 sc1 lds
  s_add_u32 m0, s43, 81920
  s_nop 0
  buffer_load_dwordx4 v4, s[16:19], s45 offen offset:0 sc1 lds
  buffer_load_dwordx4 v4, s[16:19], s45 offen offset:1024 sc1 lds
  buffer_load_dwordx4 v4, s[16:19], s45 offen offset:2048 sc1 lds
  buffer_load_dwordx4 v4, s[16:19], s45 offen offset:3072 sc1 lds
  s_mov_b32 s46, 884736
  s_cmp_gt_u32 s34, 2
  s_cselect_b32 s46, 1048576, s46
  s_add_u32 s46, s46, s42
  s_add_u32 m0, s43, 32768
  s_nop 0
  buffer_load_dwordx4 v3, s[16:19], s46 offen offset:0 sc1 lds
  buffer_load_dwordx4 v3, s[16:19], s46 offen offset:1024 sc1 lds
  buffer_load_dwordx4 v3, s[16:19], s46 offen offset:2048 sc1 lds
  buffer_load_dwordx4 v3, s[16:19], s46 offen offset:3072 sc1 lds
  s_mov_b32 s47, 851968
  s_cmp_gt_u32 s34, 3
  s_cselect_b32 s47, 1081344, s47
  s_add_u32 s47, s47, s42
  s_add_u32 m0, s43, 49152
  s_nop 0
  buffer_load_dwordx4 v3, s[16:19], s47 offen offset:0 sc1 lds
  buffer_load_dwordx4 v3, s[16:19], s47 offen offset:1024 sc1 lds
  buffer_load_dwordx4 v3, s[16:19], s47 offen offset:2048 sc1 lds
  buffer_load_dwordx4 v3, s[16:19], s47 offen offset:3072 sc1 lds
  s_waitcnt vmcnt(0)
  s_branch M_LATE_RET
M_EQ:
  s_waitcnt vmcnt(9)
  v_cmp_eq_u32 vcc, s86, v100
  v_cmp_eq_u32 s[4:5], s87, v101
  s_nop 0
  s_and_b64 vcc, vcc, s[4:5]
  s_cmp_eq_u64 vcc, exec
  s_cbranch_scc0 M_EQ_RET
  buffer_load_dwordx4 a[0:3], v1, s[16:19], s62 offen offset:0 sc1
  buffer_load_dwordx4 a[4:7], v1, s[16:19], s62 offen offset:1024 sc1
  buffer_load_dwordx4 a[8:11], v1, s[16:19], s62 offen offset:2048 sc1
  buffer_load_dwordx4 a[12:15], v1, s[16:19], s62 offen offset:3072 sc1
  s_add_u32 s62, s62, 4096
  buffer_load_dwordx4 a[16:19], v1, s[16:19], s62 offen offset:0 sc1
  buffer_load_dwordx4 a[20:23], v1, s[16:19], s62 offen offset:1024 sc1
  buffer_load_dwordx4 a[24:27], v1, s[16:19], s62 offen offset:2048 sc1
  buffer_load_dwordx4 a[28:31], v1, s[16:19], s62 offen offset:3072 sc1
  s_add_u32 s62, s62, 4096
  buffer_load_dwordx4 a[32:35], v1, s[16:19], s62 offen offset:0 sc1
  buffer_load_dwordx4 a[36:39], v1, s[16:19], s62 offen offset:1024 sc1
  buffer_load_dwordx4 a[40:43], v1, s[16:19], s62 offen offset:2048 sc1
  buffer_load_dwordx4 a[44:47], v1, s[16:19], s62 offen offset:3072 sc1
  s_add_u32 s62, s62, 4096
  buffer_load_dwordx4 a[48:51], v1, s[16:19], s62 offen offset:0 sc1
  buffer_load_dwordx4 a[52:55], v1, s[16:19], s62 offen offset:1024 sc1
  buffer_load_dwordx4 a[56:59], v1, s[16:19], s62 offen offset:2048 sc1
  buffer_load_dwordx4 a[60:63], v1, s[16:19], s62 offen offset:3072 sc1
  s_mov_b32 s75, 1
  s_branch M_EQ_RET
M_GETQ:
  s_cmp_eq_u32 s75, 1
  s_cbranch_scc1 M_GETQ_RET
  s_mov_b32 s6, 0
M_PQ:
  buffer_load_dwordx2 v[100:101], v102, s[16:19], s74 offen sc1
  s_waitcnt vmcnt(0)
  v_cmp_eq_u32 vcc, s86, v100
  v_cmp_eq_u32 s[4:5], s87, v101
  s_nop 0
  s_and_b64 vcc, vcc, s[4:5]
  s_cmp_eq_u64 vcc, exec
  s_cbranch_scc1 M_PQ_OK
  s_sleep 2
  s_add_u32 s6, s6, 1
  s_cmp_lt_u32 s6, 200000
  s_cbranch_scc1 M_PQ
  s_waitcnt vmcnt(0)
M_PQ_OK:
  buffer_load_dwordx4 a[0:3], v1, s[16:19], s62 offen offset:0 sc1
  buffer_load_dwordx4 a[4:7], v1, s[16:19], s62 offen offset:1024 sc1
  buffer_load_dwordx4 a[8:11], v1, s[16:19], s62 offen offset:2048 sc1
  buffer_load_dwordx4 a[12:15], v1, s[16:19], s62 offen offset:3072 sc1
  s_add_u32 s62, s62, 4096
  buffer_load_dwordx4 a[16:19], v1, s[16:19], s62 offen offset:0 sc1
  buffer_load_dwordx4 a[20:23], v1, s[16:19], s62 offen offset:1024 sc1
  buffer_load_dwordx4 a[24:27], v1, s[16:19], s62 offen offset:2048 sc1
  buffer_load_dwordx4 a[28:31], v1, s[16:19], s62 offen offset:3072 sc1
  s_add_u32 s62, s62, 4096
  buffer_load_dwordx4 a[32:35], v1, s[16:19], s62 offen offset:0 sc1
  buffer_load_dwordx4 a[36:39], v1, s[16:19], s62 offen offset:1024 sc1
  buffer_load_dwordx4 a[40:43], v1, s[16:19], s62 offen offset:2048 sc1
  buffer_load_dwordx4 a[44:47], v1, s[16:19], s62 offen offset:3072 sc1
  s_add_u32 s62, s62, 4096
  buffer_load_dwordx4 a[48:51], v1, s[16:19], s62 offen offset:0 sc1
  buffer_load_dwordx4 a[52:55], v1, s[16:19], s62 offen offset:1024 sc1
  buffer_load_dwordx4 a[56:59], v1, s[16:19], s62 offen offset:2048 sc1
  buffer_load_dwordx4 a[60:63], v1, s[16:19], s62 offen offset:3072 sc1
  s_branch M_GETQ_RET
M_WAITQ:
  s_waitcnt vmcnt(0)
  s_branch M_WAITQ_RET
M_SYA:
  s_lshl_b32 s6, s32, 3
  v_mov_b32 v20, s86
  v_mov_b32 v21, s87
  v_mov_b32 v22, s6
  s_mov_b64 exec, 1
  buffer_store_dwordx2 v[20:21], v22, s[16:19], s63 offen sc1
  s_mov_b64 exec, -1
  s_branch M_SYA_RET
M_CODE_END:
.section .rodata,"a"
.p2align 6
.amdhsa_kernel parallel_sum__compressed_kv_cla__dense_activation_silu__prompt_kernel
  .amdhsa_next_free_vgpr 512
  .amdhsa_next_free_sgpr 102
  .amdhsa_accum_offset 256
  .amdhsa_group_segment_fixed_size 0
  .amdhsa_kernarg_size 96
  .amdhsa_user_sgpr_count 2
  .amdhsa_user_sgpr_kernarg_segment_ptr 1
  .amdhsa_system_sgpr_workgroup_id_x 1
.end_amdhsa_kernel
```
